```python
import torch

def _softmax(x, axis=-1):
    return torch.softmax(x, dim=axis)

def _gelu(x):
    return torch.nn.functional.gelu(x, approximate='tanh')

def _silu(x):
    return torch.nn.functional.silu(x)

def _sigmoid(x):
    return torch.sigmoid(x)

def _layernorm(x, axis=-1, eps=1e-05):
    m = x.mean(dim=axis, keepdim=True)
    v = x.var(dim=axis, keepdim=True, unbiased=False)
    return (x - m) / torch.sqrt(v + eps)

def _scatter_add(tgt, idx, src, axis=0):
    return tgt.clone().index_add_(axis, idx, src)

def _segment_sum(src, seg, n):
    out = torch.zeros((n,) + src.shape[1:], dtype=src.dtype)
    return out.index_add_(0, seg, src)

def _pad(x, pw):
    flat = tuple((v for pair in reversed(pw) for v in pair))
    return torch.nn.functional.pad(x, flat)
kernel_name = 'parallel_sum__memory_aug_recurrent_mem_tr__mixer_channel_mlp__prompt'

def setup_inputs():

    _w = lambda a: (lambda t: t.to(torch.bfloat16) if t.is_floating_point() else t)(torch.as_tensor(a))

    def _A_setup():
        B, S, Dm = (1, 2048, 512)
        H, Dh = (32, 128)
        M, seg = (8, 32)
        seg = min(seg, S)
        S = S // seg * seg
        return {'x': _w((lambda *s: torch.randn(*s, dtype=torch.bfloat16) * 0.05)(B, S, Dm)), 'mem0': _w((lambda *s: torch.randn(*s, dtype=torch.bfloat16) * 0.2)(B, M, Dm)), 'Wq': _w((lambda *s: torch.randn(*s, dtype=torch.bfloat16) * 1.6)(Dm, H, Dh) * Dm ** (-0.5)), 'Wk': _w((lambda *s: torch.randn(*s, dtype=torch.bfloat16) * 1.6)(Dm, H, Dh) * Dm ** (-0.5)), 'Wv': _w((lambda *s: torch.randn(*s, dtype=torch.bfloat16) * 0.2)(Dm, H, Dh) * Dm ** (-0.5)), 'Wo': _w((lambda *s: torch.randn(*s, dtype=torch.bfloat16) * 0.2)(H, Dh, Dm) * (H * Dh) ** (-0.5)), 'seg_len': seg}
    _A_in = _A_setup()

    def _B_setup():
        B, S, D, F = (1, 2048, 512, 1792)
        return {'x': _w((lambda *s: torch.randn(*s, dtype=torch.bfloat16) * 0.05)(B, S, D)), 'w1': _w((lambda *s: torch.randn(*s, dtype=torch.bfloat16) * 0.8)(D, F) * D ** (-0.5)), 'b1': _w((lambda *s: torch.randn(*s, dtype=torch.bfloat16) * 0.4)(F)), 'w2': _w((lambda *s: torch.randn(*s, dtype=torch.bfloat16) * 0.05)(F, D) * F ** (-0.5)), 'b2': _w((lambda *s: torch.randn(*s, dtype=torch.bfloat16) * 0.05)(D))}
    _B_in = _B_setup()
    return {'A_x': _A_in['x'], 'A_mem0': _A_in['mem0'], 'A_Wq': _A_in['Wq'], 'A_Wk': _A_in['Wk'], 'A_Wv': _A_in['Wv'], 'A_Wo': _A_in['Wo'], 'A_seg_len': _A_in['seg_len'], 'B_x': _B_in['x'], 'B_w1': _B_in['w1'], 'B_b1': _B_in['b1'], 'B_w2': _B_in['w2'], 'B_b2': _B_in['b2']}

def reference(A_x, A_mem0, A_Wq, A_Wk, A_Wv, A_Wo, A_seg_len, B_x, B_w1, B_b1, B_w2, B_b2):

    def _A_ref(x, mem0, Wq, Wk, Wv, Wo, seg_len):
        B, S, Dm = x.shape
        H, Dh = (Wq.shape[1], Wq.shape[2])
        M = mem0.shape[1]
        scale = Dh ** (-0.5)
        n_seg = S // seg_len
        L = M + seg_len
        idx = torch.arange(L)
        mask = (idx[:, None] < M) | (idx[:, None] >= idx[None, :])
        mem = mem0
        outs = []
        for s in range(n_seg):
            xs = x[:, s * seg_len:(s + 1) * seg_len, :].clone()
            h = torch.concatenate([mem, xs], axis=1)
            q = torch.einsum('btd,dhe->bhte', h, Wq)
            k = torch.einsum('btd,dhe->bhte', h, Wk)
            v = torch.einsum('btd,dhe->bhte', h, Wv)
            scores = torch.einsum('bhqe,bhke->bhqk', q, k) * scale
            scores = torch.where(mask[None, None], scores, -1000000000.0)
            p = _softmax(scores, axis=-1)
            o = torch.einsum('bhqk,bhke->bhqe', p, v)
            o = torch.einsum('bhte,hed->btd', o, Wo)
            mem = o[:, :M, :].clone()
            outs.append(o[:, M:, :])
        return torch.concatenate(outs, axis=1)

    def _B_ref(x, w1, b1, w2, b2):
        y = _layernorm(x, axis=-1)
        h = _gelu(torch.einsum('bsd,df->bsf', y, w1) + b1)
        return torch.einsum('bsf,fd->bsd', h, w2) + b2
    x = A_x
    xn = _layernorm(x, axis=-1)
    return x + _A_ref(xn, A_mem0, A_Wq, A_Wk, A_Wv, A_Wo, A_seg_len) + _B_ref(xn, B_w1, B_b1, B_w2, B_b2)
```

```asm
; @launch grid=(256,1,1) block=(256,1,1) lds=163840
.amdgcn_target "amdgcn-amd-amdhsa--gfx950"
.text
.globl parallel_sum__memory_aug_recurrent_mem_tr__mixer_channel_mlp__prompt_kernel
.p2align 8
.type parallel_sum__memory_aug_recurrent_mem_tr__mixer_channel_mlp__prompt_kernel,@function
parallel_sum__memory_aug_recurrent_mem_tr__mixer_channel_mlp__prompt_kernel:
  s_cmp_ge_u32 s2, 256
  s_cbranch_scc1 Lmain_exit_1
  s_load_dwordx2 s[4:5], s[0:1], 112
  s_load_dwordx2 s[6:7], s[0:1], 104
  s_load_dwordx2 s[16:17], s[0:1], 0
  s_load_dwordx2 s[28:29], s[0:1], 24
  s_mov_b32 s63, 0
  s_memrealtime s[24:25]
  s_mov_b32 s12, 262144
  s_getreg_b32 s96, hwreg(HW_REG_XCC_ID)
  s_and_b32 s96, s96, 15
  v_lshrrev_b32 v1, 6, v0
  s_nop 0
  v_readfirstlane_b32 s10, v1
  v_and_b32 v2, 63, v0
  v_lshrrev_b32 v3, 6, v0
  v_lshlrev_b32 v3, 11, v3
  v_lshl_add_u32 v2, v2, 4, v3
  s_lshl_b32 s13, s2, 13
  v_add_u32 v2, s13, v2
  s_waitcnt lgkmcnt(0)
  global_load_dwordx4 v[8:11], v2, s[16:17]
  global_load_dwordx4 v[12:15], v2, s[16:17] offset:1024
  s_getpc_b64 s[26:27]
Lpc_here:
  s_sub_u32 s26, s26, Lpc_here-parallel_sum__memory_aug_recurrent_mem_tr__mixer_channel_mlp__prompt_kernel
  s_subb_u32 s27, s27, 0
  s_lshr_b32 s13, s2, 3
  s_and_b32 s13, s13, 31
  s_lshl_b32 s13, s13, 2
  s_add_u32 s13, s13, s10
  s_lshl_b32 s13, s13, 10
  v_and_b32 v3, 63, v0
  v_lshlrev_b32 v3, 4, v3
  v_add_u32 v3, s13, v3
  v_min_u32 v3, Lcode_end-parallel_sum__memory_aug_recurrent_mem_tr__mixer_channel_mlp__prompt_kernel-16, v3
  global_load_dwordx4 a[0:3], v3, s[26:27]
  s_lshr_b32 s13, s2, 6
  s_mov_b32 s14, 24
  s_cmp_eq_u32 s13, 1
  s_cselect_b32 s14, 32, s14
  s_cmp_eq_u32 s13, 2
  s_cselect_b32 s14, 40, s14
  s_cmp_eq_u32 s13, 3
  s_cselect_b32 s14, 16, s14
  s_add_u32 s26, s0, s14
  s_addc_u32 s27, s1, 0
  s_load_dwordx2 s[26:27], s[26:27], 0
  s_and_b32 s13, s2, 63
  s_lshl_b32 s13, s13, 16
  s_lshl_b32 s14, s10, 14
  s_add_u32 s13, s13, s14
  v_and_b32 v4, 63, v0
  v_lshlrev_b32 v4, 4, v4
  v_add_u32 v4, s13, v4
  v_add_u32 v5, 4096, v4
  v_add_u32 v6, 8192, v4
  v_add_u32 v7, 12288, v4
  s_cmp_lt_u32 s2, 128
  s_cbranch_scc1 Lpro_pz_5
  s_cmp_lg_u32 s96, 0
  s_cbranch_scc1 Lpro_px_4
Lpro_pz_5:
  v_mov_b32 v4, 0
  v_mov_b32 v5, 0
  v_mov_b32 v6, 0
  v_mov_b32 v7, 0
Lpro_px_4:
  s_waitcnt lgkmcnt(0)
  global_load_dwordx4 a[64:67], v4, s[26:27] offset:0
  global_load_dwordx4 a[68:71], v4, s[26:27] offset:1024
  global_load_dwordx4 a[72:75], v4, s[26:27] offset:2048
  global_load_dwordx4 a[76:79], v4, s[26:27] offset:3072
  global_load_dwordx4 a[80:83], v5, s[26:27] offset:0
  global_load_dwordx4 a[84:87], v5, s[26:27] offset:1024
  global_load_dwordx4 a[88:91], v5, s[26:27] offset:2048
  global_load_dwordx4 a[92:95], v5, s[26:27] offset:3072
  global_load_dwordx4 a[96:99], v6, s[26:27] offset:0
  global_load_dwordx4 a[100:103], v6, s[26:27] offset:1024
  global_load_dwordx4 a[104:107], v6, s[26:27] offset:2048
  global_load_dwordx4 a[108:111], v6, s[26:27] offset:3072
  global_load_dwordx4 a[112:115], v7, s[26:27] offset:0
  global_load_dwordx4 a[116:119], v7, s[26:27] offset:1024
  global_load_dwordx4 a[120:123], v7, s[26:27] offset:2048
  global_load_dwordx4 a[124:127], v7, s[26:27] offset:3072
  s_cmp_lg_u32 s10, 0
  s_cbranch_scc1 Lpro_na_6
  s_lshl_b32 s14, s96, 2
  v_mov_b32 v4, s14
  v_mov_b32 v5, 1
  s_mov_b64 exec, 1
  global_atomic_add v50, v4, v5, s[6:7] sc0
  s_cmp_lg_u32 s2, 0
  s_cbranch_scc1 Lpro_nn_7
  s_or_b32 s24, s24, 1
  v_mov_b32 v6, s24
  v_mov_b32 v7, s25
  v_mov_b32 v4, 128
  global_store_dwordx2 v4, v[6:7], s[6:7] sc1
Lpro_nn_7:
  s_mov_b64 exec, -1
  s_cmp_lg_u32 s2, 0
  s_cbranch_scc0 Lpro_x2_9
  s_waitcnt vmcnt(18)
  s_branch Lpro_w1_8
Lpro_x2_9:
  s_waitcnt vmcnt(19)
  s_branch Lpro_w1_8
Lpro_na_6:
  s_waitcnt vmcnt(17)
Lpro_w1_8:
  s_add_u32 s20, s4, 0
  s_addc_u32 s21, s5, 0
  s_add_u32 s22, s4, 2097152
  s_addc_u32 s23, s5, 0
  v_lshlrev_b32 v16, 16, v8
  v_and_b32 v17, 0xffff0000, v8
  v_lshlrev_b32 v18, 16, v9
  v_and_b32 v19, 0xffff0000, v9
  v_lshlrev_b32 v20, 16, v10
  v_and_b32 v21, 0xffff0000, v10
  v_lshlrev_b32 v22, 16, v11
  v_and_b32 v23, 0xffff0000, v11
  v_add_f32 v40, v16, v17
  v_add_f32 v40, v40, v18
  v_add_f32 v40, v40, v19
  v_add_f32 v40, v40, v20
  v_add_f32 v40, v40, v21
  v_add_f32 v40, v40, v22
  v_add_f32 v40, v40, v23
  s_nop 1
  v_add_f32_dpp v40, v40, v40 quad_perm:[1,0,3,2] row_mask:0xf bank_mask:0xf
  s_nop 1
  v_add_f32_dpp v40, v40, v40 quad_perm:[2,3,0,1] row_mask:0xf bank_mask:0xf
  s_nop 1
  v_add_f32_dpp v40, v40, v40 row_half_mirror row_mask:0xf bank_mask:0xf
  s_nop 1
  v_add_f32_dpp v40, v40, v40 row_mirror row_mask:0xf bank_mask:0xf
  v_mov_b32 v42, v40
  s_nop 1
  v_permlane16_swap_b32 v40, v42
  s_nop 1
  v_add_f32 v40, v40, v42
  v_mov_b32 v42, v40
  s_nop 1
  v_permlane32_swap_b32 v40, v42
  s_nop 1
  v_add_f32 v40, v40, v42
  v_mul_f32 v40, 0x3b000000, v40
  v_sub_f32 v44, v16, v40
  v_mul_f32 v41, v44, v44
  v_sub_f32 v44, v17, v40
  v_fmac_f32 v41, v44, v44
  v_sub_f32 v44, v18, v40
  v_fmac_f32 v41, v44, v44
  v_sub_f32 v44, v19, v40
  v_fmac_f32 v41, v44, v44
  v_sub_f32 v44, v20, v40
  v_fmac_f32 v41, v44, v44
  v_sub_f32 v44, v21, v40
  v_fmac_f32 v41, v44, v44
  v_sub_f32 v44, v22, v40
  v_fmac_f32 v41, v44, v44
  v_sub_f32 v44, v23, v40
  v_fmac_f32 v41, v44, v44
  s_nop 1
  v_add_f32_dpp v41, v41, v41 quad_perm:[1,0,3,2] row_mask:0xf bank_mask:0xf
  s_nop 1
  v_add_f32_dpp v41, v41, v41 quad_perm:[2,3,0,1] row_mask:0xf bank_mask:0xf
  s_nop 1
  v_add_f32_dpp v41, v41, v41 row_half_mirror row_mask:0xf bank_mask:0xf
  s_nop 1
  v_add_f32_dpp v41, v41, v41 row_mirror row_mask:0xf bank_mask:0xf
  v_mov_b32 v42, v41
  s_nop 1
  v_permlane16_swap_b32 v41, v42
  s_nop 1
  v_add_f32 v41, v41, v42
  v_mov_b32 v42, v41
  s_nop 1
  v_permlane32_swap_b32 v41, v42
  s_nop 1
  v_add_f32 v41, v41, v42
  v_mul_f32 v41, 0x3b000000, v41
  v_cvt_pk_bf16_f32 v41, v41, v41
  v_and_b32 v41, 0xffff0000, v41
  v_add_f32 v41, 0x3727c5ac, v41
  v_cvt_pk_bf16_f32 v41, v41, v41
  v_and_b32 v41, 0xffff0000, v41
  v_sqrt_f32 v41, v41
  s_nop 0
  v_cvt_pk_bf16_f32 v41, v41, v41
  v_and_b32 v41, 0xffff0000, v41
  v_rcp_f32 v41, v41
  v_cvt_pk_bf16_f32 v43, v40, v40
  v_and_b32 v43, 0xffff0000, v43
  v_sub_f32 v24, v16, v43
  v_sub_f32 v25, v17, v43
  v_sub_f32 v26, v18, v43
  v_sub_f32 v27, v19, v43
  v_sub_f32 v28, v20, v43
  v_sub_f32 v29, v21, v43
  v_sub_f32 v30, v22, v43
  v_sub_f32 v31, v23, v43
  v_cvt_pk_bf16_f32 v44, v24, v25
  v_lshlrev_b32 v24, 16, v44
  v_and_b32 v25, 0xffff0000, v44
  v_cvt_pk_bf16_f32 v44, v26, v27
  v_lshlrev_b32 v26, 16, v44
  v_and_b32 v27, 0xffff0000, v44
  v_cvt_pk_bf16_f32 v44, v28, v29
  v_lshlrev_b32 v28, 16, v44
  v_and_b32 v29, 0xffff0000, v44
  v_cvt_pk_bf16_f32 v44, v30, v31
  v_lshlrev_b32 v30, 16, v44
  v_and_b32 v31, 0xffff0000, v44
  v_mul_f32 v24, v24, v41
  v_mul_f32 v25, v25, v41
  v_mul_f32 v26, v26, v41
  v_mul_f32 v27, v27, v41
  v_mul_f32 v28, v28, v41
  v_mul_f32 v29, v29, v41
  v_mul_f32 v30, v30, v41
  v_mul_f32 v31, v31, v41
  v_cvt_pk_bf16_f32 v32, v24, v25
  v_cvt_pk_bf16_f32 v33, v26, v27
  v_cvt_pk_bf16_f32 v34, v28, v29
  v_cvt_pk_bf16_f32 v35, v30, v31
  global_store_dwordx4 v2, v[32:35], s[20:21] offset:0 sc1
  v_lshlrev_b32 v16, 16, v32
  v_and_b32 v17, 0xffff0000, v32
  v_lshlrev_b32 v18, 16, v33
  v_and_b32 v19, 0xffff0000, v33
  v_lshlrev_b32 v20, 16, v34
  v_and_b32 v21, 0xffff0000, v34
  v_lshlrev_b32 v22, 16, v35
  v_and_b32 v23, 0xffff0000, v35
  v_add_f32 v40, v16, v17
  v_add_f32 v40, v40, v18
  v_add_f32 v40, v40, v19
  v_add_f32 v40, v40, v20
  v_add_f32 v40, v40, v21
  v_add_f32 v40, v40, v22
  v_add_f32 v40, v40, v23
  s_nop 1
  v_add_f32_dpp v40, v40, v40 quad_perm:[1,0,3,2] row_mask:0xf bank_mask:0xf
  s_nop 1
  v_add_f32_dpp v40, v40, v40 quad_perm:[2,3,0,1] row_mask:0xf bank_mask:0xf
  s_nop 1
  v_add_f32_dpp v40, v40, v40 row_half_mirror row_mask:0xf bank_mask:0xf
  s_nop 1
  v_add_f32_dpp v40, v40, v40 row_mirror row_mask:0xf bank_mask:0xf
  v_mov_b32 v42, v40
  s_nop 1
  v_permlane16_swap_b32 v40, v42
  s_nop 1
  v_add_f32 v40, v40, v42
  v_mov_b32 v42, v40
  s_nop 1
  v_permlane32_swap_b32 v40, v42
  s_nop 1
  v_add_f32 v40, v40, v42
  v_mul_f32 v40, 0x3b000000, v40
  v_sub_f32 v44, v16, v40
  v_mul_f32 v41, v44, v44
  v_sub_f32 v44, v17, v40
  v_fmac_f32 v41, v44, v44
  v_sub_f32 v44, v18, v40
  v_fmac_f32 v41, v44, v44
  v_sub_f32 v44, v19, v40
  v_fmac_f32 v41, v44, v44
  v_sub_f32 v44, v20, v40
  v_fmac_f32 v41, v44, v44
  v_sub_f32 v44, v21, v40
  v_fmac_f32 v41, v44, v44
  v_sub_f32 v44, v22, v40
  v_fmac_f32 v41, v44, v44
  v_sub_f32 v44, v23, v40
  v_fmac_f32 v41, v44, v44
  s_nop 1
  v_add_f32_dpp v41, v41, v41 quad_perm:[1,0,3,2] row_mask:0xf bank_mask:0xf
  s_nop 1
  v_add_f32_dpp v41, v41, v41 quad_perm:[2,3,0,1] row_mask:0xf bank_mask:0xf
  s_nop 1
  v_add_f32_dpp v41, v41, v41 row_half_mirror row_mask:0xf bank_mask:0xf
  s_nop 1
  v_add_f32_dpp v41, v41, v41 row_mirror row_mask:0xf bank_mask:0xf
  v_mov_b32 v42, v41
  s_nop 1
  v_permlane16_swap_b32 v41, v42
  s_nop 1
  v_add_f32 v41, v41, v42
  v_mov_b32 v42, v41
  s_nop 1
  v_permlane32_swap_b32 v41, v42
  s_nop 1
  v_add_f32 v41, v41, v42
  v_mul_f32 v41, 0x3b000000, v41
  v_cvt_pk_bf16_f32 v41, v41, v41
  v_and_b32 v41, 0xffff0000, v41
  v_add_f32 v41, 0x3727c5ac, v41
  v_cvt_pk_bf16_f32 v41, v41, v41
  v_and_b32 v41, 0xffff0000, v41
  v_sqrt_f32 v41, v41
  s_nop 0
  v_cvt_pk_bf16_f32 v41, v41, v41
  v_and_b32 v41, 0xffff0000, v41
  v_rcp_f32 v41, v41
  v_cvt_pk_bf16_f32 v43, v40, v40
  v_and_b32 v43, 0xffff0000, v43
  v_sub_f32 v24, v16, v43
  v_sub_f32 v25, v17, v43
  v_sub_f32 v26, v18, v43
  v_sub_f32 v27, v19, v43
  v_sub_f32 v28, v20, v43
  v_sub_f32 v29, v21, v43
  v_sub_f32 v30, v22, v43
  v_sub_f32 v31, v23, v43
  v_cvt_pk_bf16_f32 v44, v24, v25
  v_lshlrev_b32 v24, 16, v44
  v_and_b32 v25, 0xffff0000, v44
  v_cvt_pk_bf16_f32 v44, v26, v27
  v_lshlrev_b32 v26, 16, v44
  v_and_b32 v27, 0xffff0000, v44
  v_cvt_pk_bf16_f32 v44, v28, v29
  v_lshlrev_b32 v28, 16, v44
  v_and_b32 v29, 0xffff0000, v44
  v_cvt_pk_bf16_f32 v44, v30, v31
  v_lshlrev_b32 v30, 16, v44
  v_and_b32 v31, 0xffff0000, v44
  v_mul_f32 v24, v24, v41
  v_mul_f32 v25, v25, v41
  v_mul_f32 v26, v26, v41
  v_mul_f32 v27, v27, v41
  v_mul_f32 v28, v28, v41
  v_mul_f32 v29, v29, v41
  v_mul_f32 v30, v30, v41
  v_mul_f32 v31, v31, v41
  v_cvt_pk_bf16_f32 v36, v24, v25
  v_cvt_pk_bf16_f32 v37, v26, v27
  v_cvt_pk_bf16_f32 v38, v28, v29
  v_cvt_pk_bf16_f32 v39, v30, v31
  global_store_dwordx4 v2, v[36:39], s[22:23] offset:0 sc1
  s_nop 1
  v_lshlrev_b32 v16, 16, v12
  v_and_b32 v17, 0xffff0000, v12
  v_lshlrev_b32 v18, 16, v13
  v_and_b32 v19, 0xffff0000, v13
  v_lshlrev_b32 v20, 16, v14
  v_and_b32 v21, 0xffff0000, v14
  v_lshlrev_b32 v22, 16, v15
  v_and_b32 v23, 0xffff0000, v15
  v_add_f32 v40, v16, v17
  v_add_f32 v40, v40, v18
  v_add_f32 v40, v40, v19
  v_add_f32 v40, v40, v20
  v_add_f32 v40, v40, v21
  v_add_f32 v40, v40, v22
  v_add_f32 v40, v40, v23
  s_nop 1
  v_add_f32_dpp v40, v40, v40 quad_perm:[1,0,3,2] row_mask:0xf bank_mask:0xf
  s_nop 1
  v_add_f32_dpp v40, v40, v40 quad_perm:[2,3,0,1] row_mask:0xf bank_mask:0xf
  s_nop 1
  v_add_f32_dpp v40, v40, v40 row_half_mirror row_mask:0xf bank_mask:0xf
  s_nop 1
  v_add_f32_dpp v40, v40, v40 row_mirror row_mask:0xf bank_mask:0xf
  v_mov_b32 v42, v40
  s_nop 1
  v_permlane16_swap_b32 v40, v42
  s_nop 1
  v_add_f32 v40, v40, v42
  v_mov_b32 v42, v40
  s_nop 1
  v_permlane32_swap_b32 v40, v42
  s_nop 1
  v_add_f32 v40, v40, v42
  v_mul_f32 v40, 0x3b000000, v40
  v_sub_f32 v44, v16, v40
  v_mul_f32 v41, v44, v44
  v_sub_f32 v44, v17, v40
  v_fmac_f32 v41, v44, v44
  v_sub_f32 v44, v18, v40
  v_fmac_f32 v41, v44, v44
  v_sub_f32 v44, v19, v40
  v_fmac_f32 v41, v44, v44
  v_sub_f32 v44, v20, v40
  v_fmac_f32 v41, v44, v44
  v_sub_f32 v44, v21, v40
  v_fmac_f32 v41, v44, v44
  v_sub_f32 v44, v22, v40
  v_fmac_f32 v41, v44, v44
  v_sub_f32 v44, v23, v40
  v_fmac_f32 v41, v44, v44
  s_nop 1
  v_add_f32_dpp v41, v41, v41 quad_perm:[1,0,3,2] row_mask:0xf bank_mask:0xf
  s_nop 1
  v_add_f32_dpp v41, v41, v41 quad_perm:[2,3,0,1] row_mask:0xf bank_mask:0xf
  s_nop 1
  v_add_f32_dpp v41, v41, v41 row_half_mirror row_mask:0xf bank_mask:0xf
  s_nop 1
  v_add_f32_dpp v41, v41, v41 row_mirror row_mask:0xf bank_mask:0xf
  v_mov_b32 v42, v41
  s_nop 1
  v_permlane16_swap_b32 v41, v42
  s_nop 1
  v_add_f32 v41, v41, v42
  v_mov_b32 v42, v41
  s_nop 1
  v_permlane32_swap_b32 v41, v42
  s_nop 1
  v_add_f32 v41, v41, v42
  v_mul_f32 v41, 0x3b000000, v41
  v_cvt_pk_bf16_f32 v41, v41, v41
  v_and_b32 v41, 0xffff0000, v41
  v_add_f32 v41, 0x3727c5ac, v41
  v_cvt_pk_bf16_f32 v41, v41, v41
  v_and_b32 v41, 0xffff0000, v41
  v_sqrt_f32 v41, v41
  s_nop 0
  v_cvt_pk_bf16_f32 v41, v41, v41
  v_and_b32 v41, 0xffff0000, v41
  v_rcp_f32 v41, v41
  v_cvt_pk_bf16_f32 v43, v40, v40
  v_and_b32 v43, 0xffff0000, v43
  v_sub_f32 v24, v16, v43
  v_sub_f32 v25, v17, v43
  v_sub_f32 v26, v18, v43
  v_sub_f32 v27, v19, v43
  v_sub_f32 v28, v20, v43
  v_sub_f32 v29, v21, v43
  v_sub_f32 v30, v22, v43
  v_sub_f32 v31, v23, v43
  v_cvt_pk_bf16_f32 v44, v24, v25
  v_lshlrev_b32 v24, 16, v44
  v_and_b32 v25, 0xffff0000, v44
  v_cvt_pk_bf16_f32 v44, v26, v27
  v_lshlrev_b32 v26, 16, v44
  v_and_b32 v27, 0xffff0000, v44
  v_cvt_pk_bf16_f32 v44, v28, v29
  v_lshlrev_b32 v28, 16, v44
  v_and_b32 v29, 0xffff0000, v44
  v_cvt_pk_bf16_f32 v44, v30, v31
  v_lshlrev_b32 v30, 16, v44
  v_and_b32 v31, 0xffff0000, v44
  v_mul_f32 v24, v24, v41
  v_mul_f32 v25, v25, v41
  v_mul_f32 v26, v26, v41
  v_mul_f32 v27, v27, v41
  v_mul_f32 v28, v28, v41
  v_mul_f32 v29, v29, v41
  v_mul_f32 v30, v30, v41
  v_mul_f32 v31, v31, v41
  v_cvt_pk_bf16_f32 v32, v24, v25
  v_cvt_pk_bf16_f32 v33, v26, v27
  v_cvt_pk_bf16_f32 v34, v28, v29
  v_cvt_pk_bf16_f32 v35, v30, v31
  global_store_dwordx4 v2, v[32:35], s[20:21] offset:1024 sc1
  v_lshlrev_b32 v16, 16, v32
  v_and_b32 v17, 0xffff0000, v32
  v_lshlrev_b32 v18, 16, v33
  v_and_b32 v19, 0xffff0000, v33
  v_lshlrev_b32 v20, 16, v34
  v_and_b32 v21, 0xffff0000, v34
  v_lshlrev_b32 v22, 16, v35
  v_and_b32 v23, 0xffff0000, v35
  v_add_f32 v40, v16, v17
  v_add_f32 v40, v40, v18
  v_add_f32 v40, v40, v19
  v_add_f32 v40, v40, v20
  v_add_f32 v40, v40, v21
  v_add_f32 v40, v40, v22
  v_add_f32 v40, v40, v23
  s_nop 1
  v_add_f32_dpp v40, v40, v40 quad_perm:[1,0,3,2] row_mask:0xf bank_mask:0xf
  s_nop 1
  v_add_f32_dpp v40, v40, v40 quad_perm:[2,3,0,1] row_mask:0xf bank_mask:0xf
  s_nop 1
  v_add_f32_dpp v40, v40, v40 row_half_mirror row_mask:0xf bank_mask:0xf
  s_nop 1
  v_add_f32_dpp v40, v40, v40 row_mirror row_mask:0xf bank_mask:0xf
  v_mov_b32 v42, v40
  s_nop 1
  v_permlane16_swap_b32 v40, v42
  s_nop 1
  v_add_f32 v40, v40, v42
  v_mov_b32 v42, v40
  s_nop 1
  v_permlane32_swap_b32 v40, v42
  s_nop 1
  v_add_f32 v40, v40, v42
  v_mul_f32 v40, 0x3b000000, v40
  v_sub_f32 v44, v16, v40
  v_mul_f32 v41, v44, v44
  v_sub_f32 v44, v17, v40
  v_fmac_f32 v41, v44, v44
  v_sub_f32 v44, v18, v40
  v_fmac_f32 v41, v44, v44
  v_sub_f32 v44, v19, v40
  v_fmac_f32 v41, v44, v44
  v_sub_f32 v44, v20, v40
  v_fmac_f32 v41, v44, v44
  v_sub_f32 v44, v21, v40
  v_fmac_f32 v41, v44, v44
  v_sub_f32 v44, v22, v40
  v_fmac_f32 v41, v44, v44
  v_sub_f32 v44, v23, v40
  v_fmac_f32 v41, v44, v44
  s_nop 1
  v_add_f32_dpp v41, v41, v41 quad_perm:[1,0,3,2] row_mask:0xf bank_mask:0xf
  s_nop 1
  v_add_f32_dpp v41, v41, v41 quad_perm:[2,3,0,1] row_mask:0xf bank_mask:0xf
  s_nop 1
  v_add_f32_dpp v41, v41, v41 row_half_mirror row_mask:0xf bank_mask:0xf
  s_nop 1
  v_add_f32_dpp v41, v41, v41 row_mirror row_mask:0xf bank_mask:0xf
  v_mov_b32 v42, v41
  s_nop 1
  v_permlane16_swap_b32 v41, v42
  s_nop 1
  v_add_f32 v41, v41, v42
  v_mov_b32 v42, v41
  s_nop 1
  v_permlane32_swap_b32 v41, v42
  s_nop 1
  v_add_f32 v41, v41, v42
  v_mul_f32 v41, 0x3b000000, v41
  v_cvt_pk_bf16_f32 v41, v41, v41
  v_and_b32 v41, 0xffff0000, v41
  v_add_f32 v41, 0x3727c5ac, v41
  v_cvt_pk_bf16_f32 v41, v41, v41
  v_and_b32 v41, 0xffff0000, v41
  v_sqrt_f32 v41, v41
  s_nop 0
  v_cvt_pk_bf16_f32 v41, v41, v41
  v_and_b32 v41, 0xffff0000, v41
  v_rcp_f32 v41, v41
  v_cvt_pk_bf16_f32 v43, v40, v40
  v_and_b32 v43, 0xffff0000, v43
  v_sub_f32 v24, v16, v43
  v_sub_f32 v25, v17, v43
  v_sub_f32 v26, v18, v43
  v_sub_f32 v27, v19, v43
  v_sub_f32 v28, v20, v43
  v_sub_f32 v29, v21, v43
  v_sub_f32 v30, v22, v43
  v_sub_f32 v31, v23, v43
  v_cvt_pk_bf16_f32 v44, v24, v25
  v_lshlrev_b32 v24, 16, v44
  v_and_b32 v25, 0xffff0000, v44
  v_cvt_pk_bf16_f32 v44, v26, v27
  v_lshlrev_b32 v26, 16, v44
  v_and_b32 v27, 0xffff0000, v44
  v_cvt_pk_bf16_f32 v44, v28, v29
  v_lshlrev_b32 v28, 16, v44
  v_and_b32 v29, 0xffff0000, v44
  v_cvt_pk_bf16_f32 v44, v30, v31
  v_lshlrev_b32 v30, 16, v44
  v_and_b32 v31, 0xffff0000, v44
  v_mul_f32 v24, v24, v41
  v_mul_f32 v25, v25, v41
  v_mul_f32 v26, v26, v41
  v_mul_f32 v27, v27, v41
  v_mul_f32 v28, v28, v41
  v_mul_f32 v29, v29, v41
  v_mul_f32 v30, v30, v41
  v_mul_f32 v31, v31, v41
  v_cvt_pk_bf16_f32 v36, v24, v25
  v_cvt_pk_bf16_f32 v37, v26, v27
  v_cvt_pk_bf16_f32 v38, v28, v29
  v_cvt_pk_bf16_f32 v39, v30, v31
  global_store_dwordx4 v2, v[36:39], s[22:23] offset:1024 sc1
  s_nop 1
  s_cmp_lg_u32 s10, 0
  s_cbranch_scc1 Lpro_n0_11
  v_mov_b32 v4, 128
  global_load_dwordx2 v[62:63], v4, s[6:7] sc1
Lpro_n0_11:
  s_cmp_lg_u32 s96, 0
  s_cbranch_scc1 Lpro_ne_12
  s_cmp_lg_u32 s10, 0
  s_cbranch_scc1 Lpro_r_13
  s_waitcnt vmcnt(5)
  v_mov_b32 v4, 163072
  s_mov_b64 exec, 1
  ds_write_b32 v4, v50 offset:8
  s_mov_b64 exec, -1
  s_waitcnt lgkmcnt(0)
Lpro_r_13:
  s_barrier
  v_mov_b32 v4, 163072
  ds_read_b32 v5, v4 offset:8
  s_waitcnt lgkmcnt(0)
  v_readfirstlane_b32 s97, v5
  s_nop 3
  s_cmp_ge_u32 s97, 32
  s_cbranch_scc1 Lpro_ne_12
  v_mbcnt_lo_u32_b32 v44, -1, 0
  v_mbcnt_hi_u32_b32 v44, -1, v44
  v_and_b32 v45, 15, v44
  v_lshrrev_b32 v46, 4, v44
  v_lshrrev_b32 v47, 1, v46
  v_lshlrev_b32 v47, 3, v47
  v_and_b32 v44, 1, v46
  v_add_u32 v47, v47, v44
  v_lshlrev_b32 v47, 13, v47
  v_lshlrev_b32 v44, 2, v46
  v_xor_b32 v44, v44, v45
  v_lshl_add_u32 v47, v44, 4, v47
  s_lshl_b32 s13, s97, 8
  s_lshl_b32 s14, s10, 19
  s_add_u32 s13, s13, s14
  s_add_u32 s26, s28, s13
  s_addc_u32 s27, s29, 0
  s_lshl_b32 s13, s10, 14
  s_add_u32 s14, s26, 0
  s_addc_u32 s15, s27, 0
  s_mov_b32 m0, s13
  s_add_u32 s13, s13, 1024
  global_load_lds_dwordx4 v47, s[14:15]
  s_add_u32 s14, s26, 16384
  s_addc_u32 s15, s27, 0
  s_mov_b32 m0, s13
  s_add_u32 s13, s13, 1024
  global_load_lds_dwordx4 v47, s[14:15]
  s_add_u32 s14, s26, 32768
  s_addc_u32 s15, s27, 0
  s_mov_b32 m0, s13
  s_add_u32 s13, s13, 1024
  global_load_lds_dwordx4 v47, s[14:15]
  s_add_u32 s14, s26, 49152
  s_addc_u32 s15, s27, 0
  s_mov_b32 m0, s13
  s_add_u32 s13, s13, 1024
  global_load_lds_dwordx4 v47, s[14:15]
  s_add_u32 s14, s26, 131072
  s_addc_u32 s15, s27, 0
  s_mov_b32 m0, s13
  s_add_u32 s13, s13, 1024
  global_load_lds_dwordx4 v47, s[14:15]
  s_add_u32 s14, s26, 147456
  s_addc_u32 s15, s27, 0
  s_mov_b32 m0, s13
  s_add_u32 s13, s13, 1024
  global_load_lds_dwordx4 v47, s[14:15]
  s_add_u32 s14, s26, 163840
  s_addc_u32 s15, s27, 0
  s_mov_b32 m0, s13
  s_add_u32 s13, s13, 1024
  global_load_lds_dwordx4 v47, s[14:15]
  s_add_u32 s14, s26, 180224
  s_addc_u32 s15, s27, 0
  s_mov_b32 m0, s13
  s_add_u32 s13, s13, 1024
  global_load_lds_dwordx4 v47, s[14:15]
  s_add_u32 s14, s26, 262144
  s_addc_u32 s15, s27, 0
  s_mov_b32 m0, s13
  s_add_u32 s13, s13, 1024
  global_load_lds_dwordx4 v47, s[14:15]
  s_add_u32 s14, s26, 278528
  s_addc_u32 s15, s27, 0
  s_mov_b32 m0, s13
  s_add_u32 s13, s13, 1024
  global_load_lds_dwordx4 v47, s[14:15]
  s_add_u32 s14, s26, 294912
  s_addc_u32 s15, s27, 0
  s_mov_b32 m0, s13
  s_add_u32 s13, s13, 1024
  global_load_lds_dwordx4 v47, s[14:15]
  s_add_u32 s14, s26, 311296
  s_addc_u32 s15, s27, 0
  s_mov_b32 m0, s13
  s_add_u32 s13, s13, 1024
  global_load_lds_dwordx4 v47, s[14:15]
  s_add_u32 s14, s26, 393216
  s_addc_u32 s15, s27, 0
  s_mov_b32 m0, s13
  s_add_u32 s13, s13, 1024
  global_load_lds_dwordx4 v47, s[14:15]
  s_add_u32 s14, s26, 409600
  s_addc_u32 s15, s27, 0
  s_mov_b32 m0, s13
  s_add_u32 s13, s13, 1024
  global_load_lds_dwordx4 v47, s[14:15]
  s_add_u32 s14, s26, 425984
  s_addc_u32 s15, s27, 0
  s_mov_b32 m0, s13
  s_add_u32 s13, s13, 1024
  global_load_lds_dwordx4 v47, s[14:15]
  s_add_u32 s14, s26, 442368
  s_addc_u32 s15, s27, 0
  s_mov_b32 m0, s13
  s_add_u32 s13, s13, 1024
  global_load_lds_dwordx4 v47, s[14:15]
  s_lshl_b32 s13, s10, 14
  s_add_u32 s13, s13, 0x10000
  s_add_u32 s14, s26, 2097152
  s_addc_u32 s15, s27, 0
  s_mov_b32 m0, s13
  s_add_u32 s13, s13, 1024
  global_load_lds_dwordx4 v47, s[14:15]
  s_add_u32 s14, s26, 2113536
  s_addc_u32 s15, s27, 0
  s_mov_b32 m0, s13
  s_add_u32 s13, s13, 1024
  global_load_lds_dwordx4 v47, s[14:15]
  s_add_u32 s14, s26, 2129920
  s_addc_u32 s15, s27, 0
  s_mov_b32 m0, s13
  s_add_u32 s13, s13, 1024
  global_load_lds_dwordx4 v47, s[14:15]
  s_add_u32 s14, s26, 2146304
  s_addc_u32 s15, s27, 0
  s_mov_b32 m0, s13
  s_add_u32 s13, s13, 1024
  global_load_lds_dwordx4 v47, s[14:15]
  s_add_u32 s14, s26, 2228224
  s_addc_u32 s15, s27, 0
  s_mov_b32 m0, s13
  s_add_u32 s13, s13, 1024
  global_load_lds_dwordx4 v47, s[14:15]
  s_add_u32 s14, s26, 2244608
  s_addc_u32 s15, s27, 0
  s_mov_b32 m0, s13
  s_add_u32 s13, s13, 1024
  global_load_lds_dwordx4 v47, s[14:15]
  s_add_u32 s14, s26, 2260992
  s_addc_u32 s15, s27, 0
  s_mov_b32 m0, s13
  s_add_u32 s13, s13, 1024
  global_load_lds_dwordx4 v47, s[14:15]
  s_add_u32 s14, s26, 2277376
  s_addc_u32 s15, s27, 0
  s_mov_b32 m0, s13
  s_add_u32 s13, s13, 1024
  global_load_lds_dwordx4 v47, s[14:15]
  s_add_u32 s14, s26, 2359296
  s_addc_u32 s15, s27, 0
  s_mov_b32 m0, s13
  s_add_u32 s13, s13, 1024
  global_load_lds_dwordx4 v47, s[14:15]
  s_add_u32 s14, s26, 2375680
  s_addc_u32 s15, s27, 0
  s_mov_b32 m0, s13
  s_add_u32 s13, s13, 1024
  global_load_lds_dwordx4 v47, s[14:15]
  s_add_u32 s14, s26, 2392064
  s_addc_u32 s15, s27, 0
  s_mov_b32 m0, s13
  s_add_u32 s13, s13, 1024
  global_load_lds_dwordx4 v47, s[14:15]
  s_add_u32 s14, s26, 2408448
  s_addc_u32 s15, s27, 0
  s_mov_b32 m0, s13
  s_add_u32 s13, s13, 1024
  global_load_lds_dwordx4 v47, s[14:15]
  s_add_u32 s14, s26, 2490368
  s_addc_u32 s15, s27, 0
  s_mov_b32 m0, s13
  s_add_u32 s13, s13, 1024
  global_load_lds_dwordx4 v47, s[14:15]
  s_add_u32 s14, s26, 2506752
  s_addc_u32 s15, s27, 0
  s_mov_b32 m0, s13
  s_add_u32 s13, s13, 1024
  global_load_lds_dwordx4 v47, s[14:15]
  s_add_u32 s14, s26, 2523136
  s_addc_u32 s15, s27, 0
  s_mov_b32 m0, s13
  s_add_u32 s13, s13, 1024
  global_load_lds_dwordx4 v47, s[14:15]
  s_add_u32 s14, s26, 2539520
  s_addc_u32 s15, s27, 0
  s_mov_b32 m0, s13
  s_add_u32 s13, s13, 1024
  global_load_lds_dwordx4 v47, s[14:15]
  s_mov_b32 s63, 1
  s_mov_b32 s8, 0
  s_mov_b32 s9, s97
  s_branch Lchain_entry_2
Lpro_ne_12:
  s_cmp_lg_u32 s63, 0
  s_cbranch_scc1 Lpro_w32_14
  s_waitcnt vmcnt(0)
  s_branch Lpro_wd_15
Lpro_w32_14:
  s_waitcnt vmcnt(32)
Lpro_wd_15:
  s_cmp_lg_u32 s10, 0
  s_cbranch_scc1 Lpro_w_10
  v_cmp_eq_u32 vcc, 0, v62
  s_cbranch_vccz Lpro_nd_17
  v_mov_b32 v4, 128
Lpro_np_16:
  global_load_dwordx2 v[62:63], v4, s[6:7] sc1
  s_waitcnt vmcnt(0)
  v_cmp_eq_u32 vcc, 0, v62
  s_cbranch_vccz Lpro_nd_17
  s_sleep 4
  s_cmp_eq_u32 s12, 0
  s_cbranch_scc1 Lpro_nd_17
  s_sub_u32 s12, s12, 1
  s_branch Lpro_np_16
Lpro_nd_17:
  v_mov_b32 v4, 163072
  s_mov_b64 exec, 1
  v_mov_b32 v5, v50
  ds_write_b64 v4, v[62:63]
  ds_write_b32 v4, v5 offset:8
  s_mov_b64 exec, -1
Lpro_w_10:
  s_waitcnt lgkmcnt(0)
  s_barrier
  v_mov_b32 v4, 163072
  ds_read_b64 v[6:7], v4
  ds_read_b32 v5, v4 offset:8
  s_waitcnt lgkmcnt(0)
  v_readfirstlane_b32 s98, v6
  v_readfirstlane_b32 s99, v7
  v_readfirstlane_b32 s97, v5
  s_nop 3
  s_cmp_lg_u32 s10, 0
  s_cbranch_scc1 Lpro_x_18
  s_lshl_b32 s13, s2, 4
  s_add_u32 s13, s13, 94371840
  s_add_u32 s15, s98, 1
  v_mov_b32 v8, s15
  v_mov_b32 v9, s99
  v_mov_b32 v10, s13
  s_mov_b64 exec, 1
  global_store_dwordx2 v10, v[8:9], s[4:5] sc1
  s_mov_b64 exec, -1
Lpro_x_18:
  s_cmp_ge_u32 s96, 8
  s_cbranch_scc1 Lpro_ov_19
  s_cmp_ge_u32 s97, 32
  s_cbranch_scc1 Lpro_ov_19
  s_mov_b32 s8, s96
  s_mov_b32 s9, s97
  s_branch Lpro_ok_20
Lpro_ov_19:
  v_and_b32 v4, 15, v0
  v_lshlrev_b32 v7, 2, v4
Lrc_p_21:
  global_load_dword v6, v7, s[6:7] sc1
  s_waitcnt vmcnt(0)
  v_mov_b32 v8, v6
  s_nop 1
  v_add_u32_dpp v8, v8, v8 quad_perm:[1,0,3,2] row_mask:0xf bank_mask:0xf
  s_nop 1
  v_add_u32_dpp v8, v8, v8 quad_perm:[2,3,0,1] row_mask:0xf bank_mask:0xf
  s_nop 1
  v_add_u32_dpp v8, v8, v8 row_half_mirror row_mask:0xf bank_mask:0xf
  s_nop 1
  v_add_u32_dpp v8, v8, v8 row_mirror row_mask:0xf bank_mask:0xf
  s_nop 1
  v_readfirstlane_b32 s14, v8
  s_nop 3
  s_cmp_ge_u32 s14, 256
  s_cbranch_scc1 Lrc_d_22
  s_sleep 8
  s_cmp_eq_u32 s12, 0
  s_cbranch_scc1 Lrc_d_22
  s_sub_u32 s12, s12, 1
  s_branch Lrc_p_21
Lrc_d_22:
  s_mov_b32 s13, 0
  s_mov_b32 s15, 0
Lov_1_23:
  s_cmp_ge_u32 s13, s96
  s_cbranch_scc1 Lov_1d_24
  v_readlane_b32 s16, v6, s13
  s_nop 3
  s_cmp_lt_u32 s13, 8
  s_cselect_b32 s17, 32, 0
  s_max_u32 s16, s16, s17
  s_sub_u32 s16, s16, s17
  s_add_u32 s15, s15, s16
  s_add_u32 s13, s13, 1
  s_branch Lov_1_23
Lov_1d_24:
  s_cmp_lt_u32 s96, 8
  s_cselect_b32 s17, 32, 0
  s_add_u32 s15, s15, s97
  s_sub_u32 s15, s15, s17
  s_mov_b32 s13, 0
Lov_2_25:
  v_readlane_b32 s16, v6, s13
  s_nop 3
  s_min_u32 s16, s16, 32
  s_sub_u32 s17, 32, s16
  s_cmp_lt_u32 s15, s17
  s_cbranch_scc1 Lov_2d_26
  s_sub_u32 s15, s15, s17
  s_add_u32 s13, s13, 1
  s_cmp_lt_u32 s13, 7
  s_cbranch_scc1 Lov_2_25
  v_readlane_b32 s16, v6, s13
  s_nop 3
  s_min_u32 s16, s16, 32
Lov_2d_26:
  s_mov_b32 s8, s13
  s_add_u32 s9, s16, s15
  s_and_b32 s9, s9, 31
Lpro_ok_20:
  s_cmp_lg_u32 s8, 0
  s_cbranch_scc1 Lworker_3
Lchain_entry_2:
  s_cmp_lg_u32 s63, 0
  s_cbranch_scc1 Lst_early_27
  v_mbcnt_lo_u32_b32 v44, -1, 0
  v_mbcnt_hi_u32_b32 v44, -1, v44
  v_and_b32 v45, 15, v44
  v_lshrrev_b32 v46, 4, v44
  v_lshrrev_b32 v47, 1, v46
  v_lshlrev_b32 v47, 3, v47
  v_and_b32 v44, 1, v46
  v_add_u32 v47, v47, v44
  v_lshlrev_b32 v47, 13, v47
  v_lshlrev_b32 v44, 2, v46
  v_xor_b32 v44, v44, v45
  v_lshl_add_u32 v47, v44, 4, v47
  s_lshl_b32 s13, s9, 8
  s_lshl_b32 s14, s10, 19
  s_add_u32 s13, s13, s14
  s_add_u32 s26, s28, s13
  s_addc_u32 s27, s29, 0
  s_lshl_b32 s13, s10, 14
  s_add_u32 s14, s26, 0
  s_addc_u32 s15, s27, 0
  s_mov_b32 m0, s13
  s_add_u32 s13, s13, 1024
  global_load_lds_dwordx4 v47, s[14:15]
  s_add_u32 s14, s26, 16384
  s_addc_u32 s15, s27, 0
  s_mov_b32 m0, s13
  s_add_u32 s13, s13, 1024
  global_load_lds_dwordx4 v47, s[14:15]
  s_add_u32 s14, s26, 32768
  s_addc_u32 s15, s27, 0
  s_mov_b32 m0, s13
  s_add_u32 s13, s13, 1024
  global_load_lds_dwordx4 v47, s[14:15]
  s_add_u32 s14, s26, 49152
  s_addc_u32 s15, s27, 0
  s_mov_b32 m0, s13
  s_add_u32 s13, s13, 1024
  global_load_lds_dwordx4 v47, s[14:15]
  s_add_u32 s14, s26, 131072
  s_addc_u32 s15, s27, 0
  s_mov_b32 m0, s13
  s_add_u32 s13, s13, 1024
  global_load_lds_dwordx4 v47, s[14:15]
  s_add_u32 s14, s26, 147456
  s_addc_u32 s15, s27, 0
  s_mov_b32 m0, s13
  s_add_u32 s13, s13, 1024
  global_load_lds_dwordx4 v47, s[14:15]
  s_add_u32 s14, s26, 163840
  s_addc_u32 s15, s27, 0
  s_mov_b32 m0, s13
  s_add_u32 s13, s13, 1024
  global_load_lds_dwordx4 v47, s[14:15]
  s_add_u32 s14, s26, 180224
  s_addc_u32 s15, s27, 0
  s_mov_b32 m0, s13
  s_add_u32 s13, s13, 1024
  global_load_lds_dwordx4 v47, s[14:15]
  s_add_u32 s14, s26, 262144
  s_addc_u32 s15, s27, 0
  s_mov_b32 m0, s13
  s_add_u32 s13, s13, 1024
  global_load_lds_dwordx4 v47, s[14:15]
  s_add_u32 s14, s26, 278528
  s_addc_u32 s15, s27, 0
  s_mov_b32 m0, s13
  s_add_u32 s13, s13, 1024
  global_load_lds_dwordx4 v47, s[14:15]
  s_add_u32 s14, s26, 294912
  s_addc_u32 s15, s27, 0
  s_mov_b32 m0, s13
  s_add_u32 s13, s13, 1024
  global_load_lds_dwordx4 v47, s[14:15]
  s_add_u32 s14, s26, 311296
  s_addc_u32 s15, s27, 0
  s_mov_b32 m0, s13
  s_add_u32 s13, s13, 1024
  global_load_lds_dwordx4 v47, s[14:15]
  s_add_u32 s14, s26, 393216
  s_addc_u32 s15, s27, 0
  s_mov_b32 m0, s13
  s_add_u32 s13, s13, 1024
  global_load_lds_dwordx4 v47, s[14:15]
  s_add_u32 s14, s26, 409600
  s_addc_u32 s15, s27, 0
  s_mov_b32 m0, s13
  s_add_u32 s13, s13, 1024
  global_load_lds_dwordx4 v47, s[14:15]
  s_add_u32 s14, s26, 425984
  s_addc_u32 s15, s27, 0
  s_mov_b32 m0, s13
  s_add_u32 s13, s13, 1024
  global_load_lds_dwordx4 v47, s[14:15]
  s_add_u32 s14, s26, 442368
  s_addc_u32 s15, s27, 0
  s_mov_b32 m0, s13
  s_add_u32 s13, s13, 1024
  global_load_lds_dwordx4 v47, s[14:15]
  s_lshl_b32 s13, s10, 14
  s_add_u32 s13, s13, 0x10000
  s_add_u32 s14, s26, 2097152
  s_addc_u32 s15, s27, 0
  s_mov_b32 m0, s13
  s_add_u32 s13, s13, 1024
  global_load_lds_dwordx4 v47, s[14:15]
  s_add_u32 s14, s26, 2113536
  s_addc_u32 s15, s27, 0
  s_mov_b32 m0, s13
  s_add_u32 s13, s13, 1024
  global_load_lds_dwordx4 v47, s[14:15]
  s_add_u32 s14, s26, 2129920
  s_addc_u32 s15, s27, 0
  s_mov_b32 m0, s13
  s_add_u32 s13, s13, 1024
  global_load_lds_dwordx4 v47, s[14:15]
  s_add_u32 s14, s26, 2146304
  s_addc_u32 s15, s27, 0
  s_mov_b32 m0, s13
  s_add_u32 s13, s13, 1024
  global_load_lds_dwordx4 v47, s[14:15]
  s_add_u32 s14, s26, 2228224
  s_addc_u32 s15, s27, 0
  s_mov_b32 m0, s13
  s_add_u32 s13, s13, 1024
  global_load_lds_dwordx4 v47, s[14:15]
  s_add_u32 s14, s26, 2244608
  s_addc_u32 s15, s27, 0
  s_mov_b32 m0, s13
  s_add_u32 s13, s13, 1024
  global_load_lds_dwordx4 v47, s[14:15]
  s_add_u32 s14, s26, 2260992
  s_addc_u32 s15, s27, 0
  s_mov_b32 m0, s13
  s_add_u32 s13, s13, 1024
  global_load_lds_dwordx4 v47, s[14:15]
  s_add_u32 s14, s26, 2277376
  s_addc_u32 s15, s27, 0
  s_mov_b32 m0, s13
  s_add_u32 s13, s13, 1024
  global_load_lds_dwordx4 v47, s[14:15]
  s_add_u32 s14, s26, 2359296
  s_addc_u32 s15, s27, 0
  s_mov_b32 m0, s13
  s_add_u32 s13, s13, 1024
  global_load_lds_dwordx4 v47, s[14:15]
  s_add_u32 s14, s26, 2375680
  s_addc_u32 s15, s27, 0
  s_mov_b32 m0, s13
  s_add_u32 s13, s13, 1024
  global_load_lds_dwordx4 v47, s[14:15]
  s_add_u32 s14, s26, 2392064
  s_addc_u32 s15, s27, 0
  s_mov_b32 m0, s13
  s_add_u32 s13, s13, 1024
  global_load_lds_dwordx4 v47, s[14:15]
  s_add_u32 s14, s26, 2408448
  s_addc_u32 s15, s27, 0
  s_mov_b32 m0, s13
  s_add_u32 s13, s13, 1024
  global_load_lds_dwordx4 v47, s[14:15]
  s_add_u32 s14, s26, 2490368
  s_addc_u32 s15, s27, 0
  s_mov_b32 m0, s13
  s_add_u32 s13, s13, 1024
  global_load_lds_dwordx4 v47, s[14:15]
  s_add_u32 s14, s26, 2506752
  s_addc_u32 s15, s27, 0
  s_mov_b32 m0, s13
  s_add_u32 s13, s13, 1024
  global_load_lds_dwordx4 v47, s[14:15]
  s_add_u32 s14, s26, 2523136
  s_addc_u32 s15, s27, 0
  s_mov_b32 m0, s13
  s_add_u32 s13, s13, 1024
  global_load_lds_dwordx4 v47, s[14:15]
  s_add_u32 s14, s26, 2539520
  s_addc_u32 s15, s27, 0
  s_mov_b32 m0, s13
  s_add_u32 s13, s13, 1024
  global_load_lds_dwordx4 v47, s[14:15]
Lst_early_27:
  s_load_dwordx2 s[16:17], s[0:1], 16
  s_load_dwordx2 s[18:19], s[0:1], 24
  s_load_dwordx2 s[20:21], s[0:1], 32
  s_load_dwordx2 s[22:23], s[0:1], 40
  s_load_dwordx2 s[46:47], s[0:1], 8
  v_and_b32 v24, 63, v0
  v_and_b32 v25, 15, v0
  v_lshrrev_b32 v26, 4, v24
  v_lshrrev_b32 v27, 2, v25
  v_lshlrev_b32 v27, 1, v27
  v_and_b32 v29, 1, v25
  v_add_u32 v27, v27, v29
  v_bfe_u32 v28, v0, 1, 1
  v_and_b32 v31, 7, v0
  v_mov_b32 v29, 0x4444
  v_mov_b32 v30, 0xeeee
  v_cmp_eq_u32 vcc, 1, v28
  s_nop 1
  v_cndmask_b32 v1, v29, v30, vcc
  v_mul_u32_u24 v29, 1088, v27
  v_lshl_add_u32 v29, v26, 5, v29
  v_lshl_add_u32 v29, v28, 4, v29
  v_add_u32 v2, 147456, v29
  v_lshlrev_b32 v4, 4, v24
  s_mul_i32 s13, s10, 2176
  s_add_u32 s13, s13, 147456
  v_add_u32 v3, s13, v4
  s_lshl_b32 s13, s10, 15
  v_add_u32 v18, s13, v4
  v_lshlrev_b32 v29, 1, v26
  s_lshl_b32 s13, s10, 6
  v_mul_u32_u24 v30, 288, v29
  v_lshl_add_u32 v30, v25, 2, v30
  s_add_u32 s13, s13, 156160
  v_add_u32 v5, s13, v30
  v_mul_u32_u24 v30, 288, v31
  v_lshl_add_u32 v29, v26, 4, v30
  v_add_u32 v6, 156160, v29
  s_lshl_b32 s13, s10, 6
  s_add_u32 s13, s13, 160768
  v_add_u32 v16, s13, v29
  v_mul_u32_u24 v30, 288, v27
  v_lshl_add_u32 v29, v26, 4, v30
  v_add_u32 v0, 158464, v29
  v_lshl_add_u32 v29, v26, 5, v30
  v_lshl_add_u32 v29, v28, 4, v29
  v_add_u32 v17, 160768, v29
  v_add_u32 v7, 131072, v4
  v_bfe_u32 v29, v25, 1, 2
  v_xor_b32 v29, v29, v26
  v_lshlrev_b32 v29, 4, v29
  v_lshl_add_u32 v29, v25, 6, v29
  s_lshl_b32 s13, s10, 11
  s_add_u32 s13, s13, 139264
  v_add_u32 v12, s13, v29
  v_lshrrev_b32 v29, 2, v24
  v_bfe_u32 v30, v24, 3, 2
  v_xor_b32 v30, v30, v24
  v_and_b32 v30, 3, v30
  v_lshlrev_b32 v30, 4, v30
  v_lshl_add_u32 v13, v29, 6, v30
  v_lshrrev_b32 v29, 3, v24
  v_lshlrev_b32 v29, 8, v29
  v_and_b32 v30, 7, v24
  v_lshl_add_u32 v19, v30, 4, v29
  v_lshlrev_b32 v29, 9, v26
  v_lshl_add_u32 v29, v25, 3, v29
  s_lshl_b32 s13, s10, 7
  v_add_u32 v20, s13, v29
  v_and_b32 v29, 1, v25
  v_lshlrev_b32 v29, 4, v29
  v_mov_b32 v30, 0x3f80
  v_lshlrev_b32 v30, v29, v30
  v_lshrrev_b32 v29, 1, v25
  v_cmp_eq_u32 vcc, 0, v29
  s_nop 1
  v_cndmask_b32 v8, 0, v30, vcc
  v_cmp_eq_u32 vcc, 1, v29
  s_nop 1
  v_cndmask_b32 v9, 0, v30, vcc
  v_cmp_eq_u32 vcc, 2, v29
  s_nop 1
  v_cndmask_b32 v10, 0, v30, vcc
  v_cmp_eq_u32 vcc, 3, v29
  s_nop 1
  v_cndmask_b32 v11, 0, v30, vcc
  v_lshrrev_b32 v29, 2, v25
  v_lshlrev_b32 v29, 13, v29
  v_lshl_add_u32 v29, v26, 6, v29
  v_and_b32 v30, 3, v25
  v_lshl_add_u32 v14, v30, 4, v29
  v_lshlrev_b32 v29, 6, v25
  v_lshl_add_u32 v29, v26, 4, v29
  s_lshl_b32 s13, s10, 10
  v_add_u32 v21, s13, v29
  v_and_b32 v29, 1, v26
  v_lshlrev_b32 v29, 1, v29
  v_and_b32 v30, 1, v25
  v_add_u32 v29, v29, v30
  s_lshl_b32 s13, s10, 2
  v_add_u32 v29, s13, v29
  v_lshlrev_b32 v29, 10, v29
  v_lshrrev_b32 v30, 1, v25
  v_lshl_add_u32 v29, v30, 3, v29
  v_lshrrev_b32 v30, 1, v26
  v_lshl_add_u32 v29, v30, 2, v29
  s_lshl_b32 s13, s9, 5
  v_add_u32 v15, s13, v29
  s_lshl_b32 s13, s10, 11
  s_add_u32 s60, s13, 131072
  s_add_u32 s61, s13, 139264
  s_waitcnt lgkmcnt(0)
  s_lshl_b32 s13, s9, 13
  s_lshl_b32 s14, s10, 11
  s_add_u32 s13, s13, s14
  s_add_u32 s13, s13, 94502912
  s_add_u32 s14, s4, s13
  s_addc_u32 s15, s5, 0
  v_mov_b32 v56, 0
  v_mov_b32 v57, 0
  v_mov_b32 v58, 0
  v_mov_b32 v59, 0
  global_store_dwordx4 v4, v[56:59], s[14:15] sc1
  global_store_dwordx4 v4, v[56:59], s[14:15] offset:1024 sc1
  s_cmp_ge_u32 s10, 2
  s_cbranch_scc1 Lminit_28
  v_mov_b32 v60, -1
  s_mov_b32 exec_lo, 0x00ff00ff
  s_mov_b32 exec_hi, 0x00ff00ff
  s_add_u32 s14, s4, 95420416
  s_addc_u32 s15, s5, 0
  global_store_dword v15, v60, s[14:15] sc1
  s_add_u32 s14, s4, 95428608
  s_addc_u32 s15, s5, 0
  global_store_dword v15, v60, s[14:15] sc1
  s_add_u32 s14, s4, 95436800
  s_addc_u32 s15, s5, 0
  global_store_dword v15, v60, s[14:15] sc1
  s_mov_b64 exec, -1
Lminit_28:
  s_cmp_lg_u32 s10, 3
  s_cbranch_scc1 Lp3_29
  v_bfe_u32 v19, v4, 4, 1
  v_lshlrev_b32 v19, 13, v19
Lp3_29:
  s_lshl_b32 s13, s10, 11
  v_add_u32 v29, s13, v4
  global_load_dwordx4 v[48:51], v29, s[46:47]
  global_load_dwordx4 v[52:55], v29, s[46:47] offset:1024
  v_lshrrev_b32 v29, 1, v26
  v_lshlrev_b32 v29, 3, v29
  v_and_b32 v30, 1, v26
  v_add_u32 v29, v29, v30
  v_lshlrev_b32 v29, 13, v29
  v_lshlrev_b32 v30, 2, v26
  v_xor_b32 v30, v30, v25
  v_lshl_add_u32 v31, v30, 4, v29
  s_lshl_b32 s13, s9, 8
  s_lshl_b32 s14, s10, 19
  s_add_u32 s14, s14, s13
  s_add_u32 s18, s18, s14
  s_addc_u32 s19, s19, 0
  s_add_u32 s20, s20, s14
  s_addc_u32 s21, s21, 0
  s_lshl_b32 s14, s10, 6
  s_add_u32 s14, s14, s13
  s_add_u32 s16, s16, s14
  s_addc_u32 s17, s17, 0
  v_lshrrev_b32 v29, 2, v25
  v_lshl_add_u32 v30, v26, 3, v29
  v_lshlrev_b32 v30, 8, v30
  v_xor_b32 v29, s10, v29
  v_lshl_add_u32 v30, v29, 6, v30
  v_and_b32 v29, 3, v25
  v_lshl_add_u32 v32, v29, 3, v30
  v_add_u32 v33, 0x10000, v32
  v_bfe_u32 v29, v24, 3, 1
  v_lshlrev_b32 v29, 3, v29
  v_lshrrev_b32 v30, 4, v24
  v_lshl_add_u32 v29, v30, 1, v29
  v_bfe_u32 v30, v24, 2, 1
  v_add_u32 v29, v29, v30
  v_lshlrev_b32 v29, 13, v29
  v_and_b32 v30, 3, v24
  v_lshl_add_u32 v34, v30, 4, v29
  v_lshrrev_b32 v29, 2, v25
  v_lshl_add_u32 v30, v26, 3, v29
  v_lshlrev_b32 v30, 6, v30
  v_and_b32 v29, 3, v25
  v_lshl_add_u32 v30, v29, 3, v30
  s_lshl_b32 s13, s10, 15
  v_add_u32 v35, s13, v30
  v_xor_b32 v29, 0, v24
  v_lshlrev_b32 v36, 4, v29
  v_xor_b32 v29, 4, v24
  v_lshlrev_b32 v37, 4, v29
  v_xor_b32 v29, 8, v24
  v_lshlrev_b32 v38, 4, v29
  v_xor_b32 v29, 12, v24
  v_lshlrev_b32 v39, 4, v29
  s_lshl_b32 s13, s9, 7
  s_lshr_b32 s14, s10, 1
  s_lshl_b32 s14, s14, 5
  s_add_u32 s13, s13, s14
  s_and_b32 s14, s10, 1
  s_lshl_b32 s14, s14, 3
  s_add_u32 s13, s13, s14
  s_lshl_b32 s13, s13, 10
  s_add_u32 s22, s22, s13
  s_addc_u32 s23, s23, 0
  v_lshrrev_b32 v29, 2, v25
  v_lshl_add_u32 v30, v26, 3, v29
  v_lshlrev_b32 v30, 10, v30
  v_bfe_u32 v42, v25, 1, 1
  v_add_u32 v42, 0, v42
  v_xor_b32 v29, v29, v42
  v_lshl_add_u32 v30, v29, 6, v30
  v_and_b32 v29, 1, v25
  v_lshl_add_u32 v30, v29, 5, v30
  s_lshl_b32 s13, s10, 8
  v_add_u32 v40, s13, v30
  v_lshrrev_b32 v29, 2, v25
  v_lshl_add_u32 v30, v26, 3, v29
  v_lshlrev_b32 v30, 10, v30
  v_bfe_u32 v42, v25, 1, 1
  v_add_u32 v42, 2, v42
  v_xor_b32 v29, v29, v42
  v_lshl_add_u32 v30, v29, 6, v30
  v_and_b32 v29, 1, v25
  v_lshl_add_u32 v30, v29, 5, v30
  s_lshl_b32 s13, s10, 8
  v_add_u32 v41, s13, v30
  v_add_u32 v44, 0x10000, v40
  v_add_u32 v45, 0x10000, v41
  s_waitcnt vmcnt(20)
  s_cmp_eq_u32 s63, 0
  s_cbranch_scc1 Lst_nz_30
  s_cmp_lg_u32 s10, 0
  s_cbranch_scc1 Lst_nz_30
  v_cmp_eq_u32 vcc, 0, v62
  s_cbranch_vccz Lst_nd_32
  v_mov_b32 v60, 128
Lst_np_31:
  global_load_dwordx2 v[62:63], v60, s[6:7] sc1
  s_waitcnt vmcnt(0)
  v_cmp_eq_u32 vcc, 0, v62
  s_cbranch_vccz Lst_nd_32
  s_sleep 4
  s_cmp_eq_u32 s12, 0
  s_cbranch_scc1 Lst_nd_32
  s_sub_u32 s12, s12, 1
  s_branch Lst_np_31
Lst_nd_32:
  v_mov_b32 v60, 163072
  s_mov_b64 exec, 1
  ds_write_b64 v60, v[62:63]
  s_mov_b64 exec, -1
  s_waitcnt lgkmcnt(0)
Lst_nz_30:
  s_barrier
  s_cmp_eq_u32 s63, 0
  s_cbranch_scc1 Lst_x_33
  v_mov_b32 v60, 163072
  ds_read_b64 v[62:63], v60
  s_waitcnt lgkmcnt(0)
  v_readfirstlane_b32 s98, v62
  v_readfirstlane_b32 s99, v63
  s_nop 3
  s_cmp_lg_u32 s10, 0
  s_cbranch_scc1 Lst_x_33
  s_lshl_b32 s13, s2, 4
  s_add_u32 s13, s13, 94371840
  s_add_u32 s15, s98, 1
  v_mov_b32 v56, s15
  v_mov_b32 v57, s99
  v_mov_b32 v58, s13
  s_mov_b64 exec, 1
  global_store_dwordx2 v58, v[56:57], s[4:5] sc1
  s_mov_b64 exec, -1
Lst_x_33:
  ds_read_b64_tr_b16 a[0:1], v32 offset:0
  ds_read_b64_tr_b16 a[2:3], v32 offset:1024
  ds_read_b64_tr_b16 a[4:5], v32 offset:8192
  ds_read_b64_tr_b16 a[6:7], v32 offset:9216
  ds_read_b64_tr_b16 a[8:9], v32 offset:16384
  ds_read_b64_tr_b16 a[10:11], v32 offset:17408
  ds_read_b64_tr_b16 a[12:13], v32 offset:24576
  ds_read_b64_tr_b16 a[14:15], v32 offset:25600
  ds_read_b64_tr_b16 a[16:17], v32 offset:32768
  ds_read_b64_tr_b16 a[18:19], v32 offset:33792
  ds_read_b64_tr_b16 a[20:21], v32 offset:40960
  ds_read_b64_tr_b16 a[22:23], v32 offset:41984
  ds_read_b64_tr_b16 a[24:25], v32 offset:49152
  ds_read_b64_tr_b16 a[26:27], v32 offset:50176
  ds_read_b64_tr_b16 a[28:29], v32 offset:57344
  ds_read_b64_tr_b16 a[30:31], v32 offset:58368
  s_waitcnt lgkmcnt(0)
  ds_read_b64_tr_b16 a[64:65], v32 offset:32
  ds_read_b64_tr_b16 a[66:67], v32 offset:1056
  ds_read_b64_tr_b16 a[68:69], v32 offset:8224
  ds_read_b64_tr_b16 a[70:71], v32 offset:9248
  ds_read_b64_tr_b16 a[72:73], v32 offset:16416
  ds_read_b64_tr_b16 a[74:75], v32 offset:17440
  ds_read_b64_tr_b16 a[76:77], v32 offset:24608
  ds_read_b64_tr_b16 a[78:79], v32 offset:25632
  ds_read_b64_tr_b16 a[80:81], v32 offset:32800
  ds_read_b64_tr_b16 a[82:83], v32 offset:33824
  ds_read_b64_tr_b16 a[84:85], v32 offset:40992
  ds_read_b64_tr_b16 a[86:87], v32 offset:42016
  ds_read_b64_tr_b16 a[88:89], v32 offset:49184
  ds_read_b64_tr_b16 a[90:91], v32 offset:50208
  ds_read_b64_tr_b16 a[92:93], v32 offset:57376
  ds_read_b64_tr_b16 a[94:95], v32 offset:58400
  s_waitcnt lgkmcnt(0)
  s_barrier
  s_lshl_b32 s13, s10, 14
  s_add_u32 s14, s20, 0
  s_addc_u32 s15, s21, 0
  s_mov_b32 m0, s13
  s_add_u32 s13, s13, 1024
  global_load_lds_dwordx4 v31, s[14:15]
  s_add_u32 s14, s20, 16384
  s_addc_u32 s15, s21, 0
  s_mov_b32 m0, s13
  s_add_u32 s13, s13, 1024
  global_load_lds_dwordx4 v31, s[14:15]
  s_add_u32 s14, s20, 32768
  s_addc_u32 s15, s21, 0
  s_mov_b32 m0, s13
  s_add_u32 s13, s13, 1024
  global_load_lds_dwordx4 v31, s[14:15]
  s_add_u32 s14, s20, 49152
  s_addc_u32 s15, s21, 0
  s_mov_b32 m0, s13
  s_add_u32 s13, s13, 1024
  global_load_lds_dwordx4 v31, s[14:15]
  s_add_u32 s14, s20, 131072
  s_addc_u32 s15, s21, 0
  s_mov_b32 m0, s13
  s_add_u32 s13, s13, 1024
  global_load_lds_dwordx4 v31, s[14:15]
  s_add_u32 s14, s20, 147456
  s_addc_u32 s15, s21, 0
  s_mov_b32 m0, s13
  s_add_u32 s13, s13, 1024
  global_load_lds_dwordx4 v31, s[14:15]
  s_add_u32 s14, s20, 163840
  s_addc_u32 s15, s21, 0
  s_mov_b32 m0, s13
  s_add_u32 s13, s13, 1024
  global_load_lds_dwordx4 v31, s[14:15]
  s_add_u32 s14, s20, 180224
  s_addc_u32 s15, s21, 0
  s_mov_b32 m0, s13
  s_add_u32 s13, s13, 1024
  global_load_lds_dwordx4 v31, s[14:15]
  s_add_u32 s14, s20, 262144
  s_addc_u32 s15, s21, 0
  s_mov_b32 m0, s13
  s_add_u32 s13, s13, 1024
  global_load_lds_dwordx4 v31, s[14:15]
  s_add_u32 s14, s20, 278528
  s_addc_u32 s15, s21, 0
  s_mov_b32 m0, s13
  s_add_u32 s13, s13, 1024
  global_load_lds_dwordx4 v31, s[14:15]
  s_add_u32 s14, s20, 294912
  s_addc_u32 s15, s21, 0
  s_mov_b32 m0, s13
  s_add_u32 s13, s13, 1024
  global_load_lds_dwordx4 v31, s[14:15]
  s_add_u32 s14, s20, 311296
  s_addc_u32 s15, s21, 0
  s_mov_b32 m0, s13
  s_add_u32 s13, s13, 1024
  global_load_lds_dwordx4 v31, s[14:15]
  s_add_u32 s14, s20, 393216
  s_addc_u32 s15, s21, 0
  s_mov_b32 m0, s13
  s_add_u32 s13, s13, 1024
  global_load_lds_dwordx4 v31, s[14:15]
  s_add_u32 s14, s20, 409600
  s_addc_u32 s15, s21, 0
  s_mov_b32 m0, s13
  s_add_u32 s13, s13, 1024
  global_load_lds_dwordx4 v31, s[14:15]
  s_add_u32 s14, s20, 425984
  s_addc_u32 s15, s21, 0
  s_mov_b32 m0, s13
  s_add_u32 s13, s13, 1024
  global_load_lds_dwordx4 v31, s[14:15]
  s_add_u32 s14, s20, 442368
  s_addc_u32 s15, s21, 0
  s_mov_b32 m0, s13
  s_add_u32 s13, s13, 1024
  global_load_lds_dwordx4 v31, s[14:15]
  s_waitcnt vmcnt(16)
  s_mul_i32 s13, s10, 2176
  s_add_u32 s13, s13, 147456
  v_add_u32 v29, s13, v4
  ds_write_b128 v29, v[48:51]
  ds_write_b128 v29, v[52:55] offset:1088
  s_barrier
  s_cmp_lg_u32 s10, 0
  s_cbranch_scc1 Lci_s_34
  s_lshl_b32 s13, s9, 4
  s_add_u32 s13, s13, 94408704
  s_add_u32 s15, s98, 1
  v_mov_b32 v56, s15
  v_mov_b32 v57, s99
  v_mov_b32 v58, s13
  s_mov_b64 exec, 1
  global_store_dwordx2 v58, v[56:57], s[4:5] sc1
  s_mov_b64 exec, -1
Lci_s_34:
  ds_read_b64_tr_b16 a[32:33], v33 offset:0
  ds_read_b64_tr_b16 a[34:35], v33 offset:1024
  ds_read_b64_tr_b16 a[36:37], v33 offset:8192
  ds_read_b64_tr_b16 a[38:39], v33 offset:9216
  ds_read_b64_tr_b16 a[40:41], v33 offset:16384
  ds_read_b64_tr_b16 a[42:43], v33 offset:17408
  ds_read_b64_tr_b16 a[44:45], v33 offset:24576
  ds_read_b64_tr_b16 a[46:47], v33 offset:25600
  ds_read_b64_tr_b16 a[48:49], v33 offset:32768
  ds_read_b64_tr_b16 a[50:51], v33 offset:33792
  ds_read_b64_tr_b16 a[52:53], v33 offset:40960
  ds_read_b64_tr_b16 a[54:55], v33 offset:41984
  ds_read_b64_tr_b16 a[56:57], v33 offset:49152
  ds_read_b64_tr_b16 a[58:59], v33 offset:50176
  ds_read_b64_tr_b16 a[60:61], v33 offset:57344
  ds_read_b64_tr_b16 a[62:63], v33 offset:58368
  s_waitcnt lgkmcnt(0)
  ds_read_b64_tr_b16 a[96:97], v33 offset:32
  ds_read_b64_tr_b16 a[98:99], v33 offset:1056
  ds_read_b64_tr_b16 a[100:101], v33 offset:8224
  ds_read_b64_tr_b16 a[102:103], v33 offset:9248
  ds_read_b64_tr_b16 a[104:105], v33 offset:16416
  ds_read_b64_tr_b16 a[106:107], v33 offset:17440
  ds_read_b64_tr_b16 a[108:109], v33 offset:24608
  ds_read_b64_tr_b16 a[110:111], v33 offset:25632
  ds_read_b64_tr_b16 a[112:113], v33 offset:32800
  ds_read_b64_tr_b16 a[114:115], v33 offset:33824
  ds_read_b64_tr_b16 a[116:117], v33 offset:40992
  ds_read_b64_tr_b16 a[118:119], v33 offset:42016
  ds_read_b64_tr_b16 a[120:121], v33 offset:49184
  ds_read_b64_tr_b16 a[122:123], v33 offset:50208
  ds_read_b64_tr_b16 a[124:125], v33 offset:57376
  ds_read_b64_tr_b16 a[126:127], v33 offset:58400
  s_waitcnt lgkmcnt(0)
  s_barrier
  s_lshl_b32 s13, s10, 14
  s_add_u32 s13, s13, 0x10000
  s_add_u32 s14, s20, 2097152
  s_addc_u32 s15, s21, 0
  s_mov_b32 m0, s13
  s_add_u32 s13, s13, 1024
  global_load_lds_dwordx4 v31, s[14:15]
  s_add_u32 s14, s20, 2113536
  s_addc_u32 s15, s21, 0
  s_mov_b32 m0, s13
  s_add_u32 s13, s13, 1024
  global_load_lds_dwordx4 v31, s[14:15]
  s_add_u32 s14, s20, 2129920
  s_addc_u32 s15, s21, 0
  s_mov_b32 m0, s13
  s_add_u32 s13, s13, 1024
  global_load_lds_dwordx4 v31, s[14:15]
  s_add_u32 s14, s20, 2146304
  s_addc_u32 s15, s21, 0
  s_mov_b32 m0, s13
  s_add_u32 s13, s13, 1024
  global_load_lds_dwordx4 v31, s[14:15]
  s_add_u32 s14, s20, 2228224
  s_addc_u32 s15, s21, 0
  s_mov_b32 m0, s13
  s_add_u32 s13, s13, 1024
  global_load_lds_dwordx4 v31, s[14:15]
  s_add_u32 s14, s20, 2244608
  s_addc_u32 s15, s21, 0
  s_mov_b32 m0, s13
  s_add_u32 s13, s13, 1024
  global_load_lds_dwordx4 v31, s[14:15]
  s_add_u32 s14, s20, 2260992
  s_addc_u32 s15, s21, 0
  s_mov_b32 m0, s13
  s_add_u32 s13, s13, 1024
  global_load_lds_dwordx4 v31, s[14:15]
  s_add_u32 s14, s20, 2277376
  s_addc_u32 s15, s21, 0
  s_mov_b32 m0, s13
  s_add_u32 s13, s13, 1024
  global_load_lds_dwordx4 v31, s[14:15]
  s_add_u32 s14, s20, 2359296
  s_addc_u32 s15, s21, 0
  s_mov_b32 m0, s13
  s_add_u32 s13, s13, 1024
  global_load_lds_dwordx4 v31, s[14:15]
  s_add_u32 s14, s20, 2375680
  s_addc_u32 s15, s21, 0
  s_mov_b32 m0, s13
  s_add_u32 s13, s13, 1024
  global_load_lds_dwordx4 v31, s[14:15]
  s_add_u32 s14, s20, 2392064
  s_addc_u32 s15, s21, 0
  s_mov_b32 m0, s13
  s_add_u32 s13, s13, 1024
  global_load_lds_dwordx4 v31, s[14:15]
  s_add_u32 s14, s20, 2408448
  s_addc_u32 s15, s21, 0
  s_mov_b32 m0, s13
  s_add_u32 s13, s13, 1024
  global_load_lds_dwordx4 v31, s[14:15]
  s_add_u32 s14, s20, 2490368
  s_addc_u32 s15, s21, 0
  s_mov_b32 m0, s13
  s_add_u32 s13, s13, 1024
  global_load_lds_dwordx4 v31, s[14:15]
  s_add_u32 s14, s20, 2506752
  s_addc_u32 s15, s21, 0
  s_mov_b32 m0, s13
  s_add_u32 s13, s13, 1024
  global_load_lds_dwordx4 v31, s[14:15]
  s_add_u32 s14, s20, 2523136
  s_addc_u32 s15, s21, 0
  s_mov_b32 m0, s13
  s_add_u32 s13, s13, 1024
  global_load_lds_dwordx4 v31, s[14:15]
  s_add_u32 s14, s20, 2539520
  s_addc_u32 s15, s21, 0
  s_mov_b32 m0, s13
  s_add_u32 s13, s13, 1024
  global_load_lds_dwordx4 v31, s[14:15]
  s_waitcnt vmcnt(16)
  s_barrier
  ds_read_b64_tr_b16 a[128:129], v32 offset:0
  ds_read_b64_tr_b16 a[130:131], v32 offset:1024
  ds_read_b64_tr_b16 a[132:133], v32 offset:8192
  ds_read_b64_tr_b16 a[134:135], v32 offset:9216
  ds_read_b64_tr_b16 a[136:137], v32 offset:16384
  ds_read_b64_tr_b16 a[138:139], v32 offset:17408
  ds_read_b64_tr_b16 a[140:141], v32 offset:24576
  ds_read_b64_tr_b16 a[142:143], v32 offset:25600
  ds_read_b64_tr_b16 a[144:145], v32 offset:32768
  ds_read_b64_tr_b16 a[146:147], v32 offset:33792
  ds_read_b64_tr_b16 a[148:149], v32 offset:40960
  ds_read_b64_tr_b16 a[150:151], v32 offset:41984
  ds_read_b64_tr_b16 a[152:153], v32 offset:49152
  ds_read_b64_tr_b16 a[154:155], v32 offset:50176
  ds_read_b64_tr_b16 a[156:157], v32 offset:57344
  ds_read_b64_tr_b16 a[158:159], v32 offset:58368
  s_waitcnt lgkmcnt(0)
  ds_read_b64_tr_b16 a[192:193], v32 offset:32
  ds_read_b64_tr_b16 a[194:195], v32 offset:1056
  ds_read_b64_tr_b16 a[196:197], v32 offset:8224
  ds_read_b64_tr_b16 a[198:199], v32 offset:9248
  ds_read_b64_tr_b16 a[200:201], v32 offset:16416
  ds_read_b64_tr_b16 a[202:203], v32 offset:17440
  ds_read_b64_tr_b16 a[204:205], v32 offset:24608
  ds_read_b64_tr_b16 a[206:207], v32 offset:25632
  ds_read_b64_tr_b16 a[208:209], v32 offset:32800
  ds_read_b64_tr_b16 a[210:211], v32 offset:33824
  ds_read_b64_tr_b16 a[212:213], v32 offset:40992
  ds_read_b64_tr_b16 a[214:215], v32 offset:42016
  ds_read_b64_tr_b16 a[216:217], v32 offset:49184
  ds_read_b64_tr_b16 a[218:219], v32 offset:50208
  ds_read_b64_tr_b16 a[220:221], v32 offset:57376
  ds_read_b64_tr_b16 a[222:223], v32 offset:58400
  s_waitcnt lgkmcnt(0)
  s_barrier
  s_lshl_b32 s13, s10, 14
  s_add_u32 s14, s22, 0
  s_addc_u32 s15, s23, 0
  s_mov_b32 m0, s13
  s_add_u32 s13, s13, 1024
  global_load_lds_dwordx4 v36, s[14:15]
  s_add_u32 s14, s22, 1024
  s_addc_u32 s15, s23, 0
  s_mov_b32 m0, s13
  s_add_u32 s13, s13, 1024
  global_load_lds_dwordx4 v37, s[14:15]
  s_add_u32 s14, s22, 4096
  s_addc_u32 s15, s23, 0
  s_mov_b32 m0, s13
  s_add_u32 s13, s13, 1024
  global_load_lds_dwordx4 v38, s[14:15]
  s_add_u32 s14, s22, 5120
  s_addc_u32 s15, s23, 0
  s_mov_b32 m0, s13
  s_add_u32 s13, s13, 1024
  global_load_lds_dwordx4 v39, s[14:15]
  s_add_u32 s14, s22, 2048
  s_addc_u32 s15, s23, 0
  s_mov_b32 m0, s13
  s_add_u32 s13, s13, 1024
  global_load_lds_dwordx4 v36, s[14:15]
  s_add_u32 s14, s22, 3072
  s_addc_u32 s15, s23, 0
  s_mov_b32 m0, s13
  s_add_u32 s13, s13, 1024
  global_load_lds_dwordx4 v37, s[14:15]
  s_add_u32 s14, s22, 6144
  s_addc_u32 s15, s23, 0
  s_mov_b32 m0, s13
  s_add_u32 s13, s13, 1024
  global_load_lds_dwordx4 v38, s[14:15]
  s_add_u32 s14, s22, 7168
  s_addc_u32 s15, s23, 0
  s_mov_b32 m0, s13
  s_add_u32 s13, s13, 1024
  global_load_lds_dwordx4 v39, s[14:15]
  s_add_u32 s14, s22, 16384
  s_addc_u32 s15, s23, 0
  s_mov_b32 m0, s13
  s_add_u32 s13, s13, 1024
  global_load_lds_dwordx4 v36, s[14:15]
  s_add_u32 s14, s22, 17408
  s_addc_u32 s15, s23, 0
  s_mov_b32 m0, s13
  s_add_u32 s13, s13, 1024
  global_load_lds_dwordx4 v37, s[14:15]
  s_add_u32 s14, s22, 20480
  s_addc_u32 s15, s23, 0
  s_mov_b32 m0, s13
  s_add_u32 s13, s13, 1024
  global_load_lds_dwordx4 v38, s[14:15]
  s_add_u32 s14, s22, 21504
  s_addc_u32 s15, s23, 0
  s_mov_b32 m0, s13
  s_add_u32 s13, s13, 1024
  global_load_lds_dwordx4 v39, s[14:15]
  s_add_u32 s14, s22, 18432
  s_addc_u32 s15, s23, 0
  s_mov_b32 m0, s13
  s_add_u32 s13, s13, 1024
  global_load_lds_dwordx4 v36, s[14:15]
  s_add_u32 s14, s22, 19456
  s_addc_u32 s15, s23, 0
  s_mov_b32 m0, s13
  s_add_u32 s13, s13, 1024
  global_load_lds_dwordx4 v37, s[14:15]
  s_add_u32 s14, s22, 22528
  s_addc_u32 s15, s23, 0
  s_mov_b32 m0, s13
  s_add_u32 s13, s13, 1024
  global_load_lds_dwordx4 v38, s[14:15]
  s_add_u32 s14, s22, 23552
  s_addc_u32 s15, s23, 0
  s_mov_b32 m0, s13
  s_add_u32 s13, s13, 1024
  global_load_lds_dwordx4 v39, s[14:15]
  s_waitcnt vmcnt(16)
  s_barrier
  ds_read_b64_tr_b16 a[160:161], v33 offset:0
  ds_read_b64_tr_b16 a[162:163], v33 offset:1024
  ds_read_b64_tr_b16 a[164:165], v33 offset:8192
  ds_read_b64_tr_b16 a[166:167], v33 offset:9216
  ds_read_b64_tr_b16 a[168:169], v33 offset:16384
  ds_read_b64_tr_b16 a[170:171], v33 offset:17408
  ds_read_b64_tr_b16 a[172:173], v33 offset:24576
  ds_read_b64_tr_b16 a[174:175], v33 offset:25600
  ds_read_b64_tr_b16 a[176:177], v33 offset:32768
  ds_read_b64_tr_b16 a[178:179], v33 offset:33792
  ds_read_b64_tr_b16 a[180:181], v33 offset:40960
  ds_read_b64_tr_b16 a[182:183], v33 offset:41984
  ds_read_b64_tr_b16 a[184:185], v33 offset:49152
  ds_read_b64_tr_b16 a[186:187], v33 offset:50176
  ds_read_b64_tr_b16 a[188:189], v33 offset:57344
  ds_read_b64_tr_b16 a[190:191], v33 offset:58368
  s_waitcnt lgkmcnt(0)
  ds_read_b64_tr_b16 a[224:225], v33 offset:32
  ds_read_b64_tr_b16 a[226:227], v33 offset:1056
  ds_read_b64_tr_b16 a[228:229], v33 offset:8224
  ds_read_b64_tr_b16 a[230:231], v33 offset:9248
  ds_read_b64_tr_b16 a[232:233], v33 offset:16416
  ds_read_b64_tr_b16 a[234:235], v33 offset:17440
  ds_read_b64_tr_b16 a[236:237], v33 offset:24608
  ds_read_b64_tr_b16 a[238:239], v33 offset:25632
  ds_read_b64_tr_b16 a[240:241], v33 offset:32800
  ds_read_b64_tr_b16 a[242:243], v33 offset:33824
  ds_read_b64_tr_b16 a[244:245], v33 offset:40992
  ds_read_b64_tr_b16 a[246:247], v33 offset:42016
  ds_read_b64_tr_b16 a[248:249], v33 offset:49184
  ds_read_b64_tr_b16 a[250:251], v33 offset:50208
  ds_read_b64_tr_b16 a[252:253], v33 offset:57376
  ds_read_b64_tr_b16 a[254:255], v33 offset:58400
  s_waitcnt lgkmcnt(0)
  s_barrier
  s_lshl_b32 s13, s10, 14
  s_add_u32 s13, s13, 0x10000
  s_add_u32 s14, s22, 65536
  s_addc_u32 s15, s23, 0
  s_mov_b32 m0, s13
  s_add_u32 s13, s13, 1024
  global_load_lds_dwordx4 v36, s[14:15]
  s_add_u32 s14, s22, 66560
  s_addc_u32 s15, s23, 0
  s_mov_b32 m0, s13
  s_add_u32 s13, s13, 1024
  global_load_lds_dwordx4 v37, s[14:15]
  s_add_u32 s14, s22, 69632
  s_addc_u32 s15, s23, 0
  s_mov_b32 m0, s13
  s_add_u32 s13, s13, 1024
  global_load_lds_dwordx4 v38, s[14:15]
  s_add_u32 s14, s22, 70656
  s_addc_u32 s15, s23, 0
  s_mov_b32 m0, s13
  s_add_u32 s13, s13, 1024
  global_load_lds_dwordx4 v39, s[14:15]
  s_add_u32 s14, s22, 67584
  s_addc_u32 s15, s23, 0
  s_mov_b32 m0, s13
  s_add_u32 s13, s13, 1024
  global_load_lds_dwordx4 v36, s[14:15]
  s_add_u32 s14, s22, 68608
  s_addc_u32 s15, s23, 0
  s_mov_b32 m0, s13
  s_add_u32 s13, s13, 1024
  global_load_lds_dwordx4 v37, s[14:15]
  s_add_u32 s14, s22, 71680
  s_addc_u32 s15, s23, 0
  s_mov_b32 m0, s13
  s_add_u32 s13, s13, 1024
  global_load_lds_dwordx4 v38, s[14:15]
  s_add_u32 s14, s22, 72704
  s_addc_u32 s15, s23, 0
  s_mov_b32 m0, s13
  s_add_u32 s13, s13, 1024
  global_load_lds_dwordx4 v39, s[14:15]
  s_add_u32 s14, s22, 81920
  s_addc_u32 s15, s23, 0
  s_mov_b32 m0, s13
  s_add_u32 s13, s13, 1024
  global_load_lds_dwordx4 v36, s[14:15]
  s_add_u32 s14, s22, 82944
  s_addc_u32 s15, s23, 0
  s_mov_b32 m0, s13
  s_add_u32 s13, s13, 1024
  global_load_lds_dwordx4 v37, s[14:15]
  s_add_u32 s14, s22, 86016
  s_addc_u32 s15, s23, 0
  s_mov_b32 m0, s13
  s_add_u32 s13, s13, 1024
  global_load_lds_dwordx4 v38, s[14:15]
  s_add_u32 s14, s22, 87040
  s_addc_u32 s15, s23, 0
  s_mov_b32 m0, s13
  s_add_u32 s13, s13, 1024
  global_load_lds_dwordx4 v39, s[14:15]
  s_add_u32 s14, s22, 83968
  s_addc_u32 s15, s23, 0
  s_mov_b32 m0, s13
  s_add_u32 s13, s13, 1024
  global_load_lds_dwordx4 v36, s[14:15]
  s_add_u32 s14, s22, 84992
  s_addc_u32 s15, s23, 0
  s_mov_b32 m0, s13
  s_add_u32 s13, s13, 1024
  global_load_lds_dwordx4 v37, s[14:15]
  s_add_u32 s14, s22, 88064
  s_addc_u32 s15, s23, 0
  s_mov_b32 m0, s13
  s_add_u32 s13, s13, 1024
  global_load_lds_dwordx4 v38, s[14:15]
  s_add_u32 s14, s22, 89088
  s_addc_u32 s15, s23, 0
  s_mov_b32 m0, s13
  s_add_u32 s13, s13, 1024
  global_load_lds_dwordx4 v39, s[14:15]
  s_waitcnt vmcnt(16)
  s_barrier
  ds_read_b64_tr_b16 v[128:129], v40 offset:0
  ds_read_b64_tr_b16 v[130:131], v40 offset:4096
  ds_read_b64_tr_b16 v[132:133], v40 offset:32768
  ds_read_b64_tr_b16 v[134:135], v40 offset:36864
  ds_read_b64_tr_b16 v[144:145], v40 offset:8
  ds_read_b64_tr_b16 v[146:147], v40 offset:4104
  ds_read_b64_tr_b16 v[148:149], v40 offset:32776
  ds_read_b64_tr_b16 v[150:151], v40 offset:36872
  s_waitcnt lgkmcnt(0)
  ds_read_b64_tr_b16 v[160:161], v40 offset:16
  ds_read_b64_tr_b16 v[162:163], v40 offset:4112
  ds_read_b64_tr_b16 v[164:165], v40 offset:32784
  ds_read_b64_tr_b16 v[166:167], v40 offset:36880
  ds_read_b64_tr_b16 v[176:177], v40 offset:24
  ds_read_b64_tr_b16 v[178:179], v40 offset:4120
  ds_read_b64_tr_b16 v[180:181], v40 offset:32792
  ds_read_b64_tr_b16 v[182:183], v40 offset:36888
  s_waitcnt lgkmcnt(0)
  ds_read_b64_tr_b16 v[192:193], v41 offset:0
  ds_read_b64_tr_b16 v[194:195], v41 offset:4096
  ds_read_b64_tr_b16 v[196:197], v41 offset:32768
  ds_read_b64_tr_b16 v[198:199], v41 offset:36864
  ds_read_b64_tr_b16 v[208:209], v41 offset:8
  ds_read_b64_tr_b16 v[210:211], v41 offset:4104
  ds_read_b64_tr_b16 v[212:213], v41 offset:32776
  ds_read_b64_tr_b16 v[214:215], v41 offset:36872
  s_waitcnt lgkmcnt(0)
  ds_read_b64_tr_b16 v[224:225], v41 offset:16
  ds_read_b64_tr_b16 v[226:227], v41 offset:4112
  ds_read_b64_tr_b16 v[228:229], v41 offset:32784
  ds_read_b64_tr_b16 v[230:231], v41 offset:36880
  ds_read_b64_tr_b16 v[240:241], v41 offset:24
  ds_read_b64_tr_b16 v[242:243], v41 offset:4120
  ds_read_b64_tr_b16 v[244:245], v41 offset:32792
  ds_read_b64_tr_b16 v[246:247], v41 offset:36888
  s_waitcnt lgkmcnt(0)
  s_barrier
  s_cmp_ge_u32 s10, 2
  s_cbranch_scc1 Lwq_skip_35
  s_lshl_b32 s13, s10, 15
  s_add_u32 s14, s16, 0
  s_addc_u32 s15, s17, 0
  s_mov_b32 m0, s13
  s_add_u32 s13, s13, 1024
  global_load_lds_dwordx4 v34, s[14:15]
  s_add_u32 s14, s16, 131072
  s_addc_u32 s15, s17, 0
  s_mov_b32 m0, s13
  s_add_u32 s13, s13, 1024
  global_load_lds_dwordx4 v34, s[14:15]
  s_add_u32 s14, s16, 262144
  s_addc_u32 s15, s17, 0
  s_mov_b32 m0, s13
  s_add_u32 s13, s13, 1024
  global_load_lds_dwordx4 v34, s[14:15]
  s_add_u32 s14, s16, 393216
  s_addc_u32 s15, s17, 0
  s_mov_b32 m0, s13
  s_add_u32 s13, s13, 1024
  global_load_lds_dwordx4 v34, s[14:15]
  s_add_u32 s14, s16, 524288
  s_addc_u32 s15, s17, 0
  s_mov_b32 m0, s13
  s_add_u32 s13, s13, 1024
  global_load_lds_dwordx4 v34, s[14:15]
  s_add_u32 s14, s16, 655360
  s_addc_u32 s15, s17, 0
  s_mov_b32 m0, s13
  s_add_u32 s13, s13, 1024
  global_load_lds_dwordx4 v34, s[14:15]
  s_add_u32 s14, s16, 786432
  s_addc_u32 s15, s17, 0
  s_mov_b32 m0, s13
  s_add_u32 s13, s13, 1024
  global_load_lds_dwordx4 v34, s[14:15]
  s_add_u32 s14, s16, 917504
  s_addc_u32 s15, s17, 0
  s_mov_b32 m0, s13
  s_add_u32 s13, s13, 1024
  global_load_lds_dwordx4 v34, s[14:15]
  s_add_u32 s14, s16, 1048576
  s_addc_u32 s15, s17, 0
  s_mov_b32 m0, s13
  s_add_u32 s13, s13, 1024
  global_load_lds_dwordx4 v34, s[14:15]
  s_add_u32 s14, s16, 1179648
  s_addc_u32 s15, s17, 0
  s_mov_b32 m0, s13
  s_add_u32 s13, s13, 1024
  global_load_lds_dwordx4 v34, s[14:15]
  s_add_u32 s14, s16, 1310720
  s_addc_u32 s15, s17, 0
  s_mov_b32 m0, s13
  s_add_u32 s13, s13, 1024
  global_load_lds_dwordx4 v34, s[14:15]
  s_add_u32 s14, s16, 1441792
  s_addc_u32 s15, s17, 0
  s_mov_b32 m0, s13
  s_add_u32 s13, s13, 1024
  global_load_lds_dwordx4 v34, s[14:15]
  s_add_u32 s14, s16, 1572864
  s_addc_u32 s15, s17, 0
  s_mov_b32 m0, s13
  s_add_u32 s13, s13, 1024
  global_load_lds_dwordx4 v34, s[14:15]
  s_add_u32 s14, s16, 1703936
  s_addc_u32 s15, s17, 0
  s_mov_b32 m0, s13
  s_add_u32 s13, s13, 1024
  global_load_lds_dwordx4 v34, s[14:15]
  s_add_u32 s14, s16, 1835008
  s_addc_u32 s15, s17, 0
  s_mov_b32 m0, s13
  s_add_u32 s13, s13, 1024
  global_load_lds_dwordx4 v34, s[14:15]
  s_add_u32 s14, s16, 1966080
  s_addc_u32 s15, s17, 0
  s_mov_b32 m0, s13
  s_add_u32 s13, s13, 1024
  global_load_lds_dwordx4 v34, s[14:15]
  s_add_u32 s14, s16, 2097152
  s_addc_u32 s15, s17, 0
  s_mov_b32 m0, s13
  s_add_u32 s13, s13, 1024
  global_load_lds_dwordx4 v34, s[14:15]
  s_add_u32 s14, s16, 2228224
  s_addc_u32 s15, s17, 0
  s_mov_b32 m0, s13
  s_add_u32 s13, s13, 1024
  global_load_lds_dwordx4 v34, s[14:15]
  s_add_u32 s14, s16, 2359296
  s_addc_u32 s15, s17, 0
  s_mov_b32 m0, s13
  s_add_u32 s13, s13, 1024
  global_load_lds_dwordx4 v34, s[14:15]
  s_add_u32 s14, s16, 2490368
  s_addc_u32 s15, s17, 0
  s_mov_b32 m0, s13
  s_add_u32 s13, s13, 1024
  global_load_lds_dwordx4 v34, s[14:15]
  s_add_u32 s14, s16, 2621440
  s_addc_u32 s15, s17, 0
  s_mov_b32 m0, s13
  s_add_u32 s13, s13, 1024
  global_load_lds_dwordx4 v34, s[14:15]
  s_add_u32 s14, s16, 2752512
  s_addc_u32 s15, s17, 0
  s_mov_b32 m0, s13
  s_add_u32 s13, s13, 1024
  global_load_lds_dwordx4 v34, s[14:15]
  s_add_u32 s14, s16, 2883584
  s_addc_u32 s15, s17, 0
  s_mov_b32 m0, s13
  s_add_u32 s13, s13, 1024
  global_load_lds_dwordx4 v34, s[14:15]
  s_add_u32 s14, s16, 3014656
  s_addc_u32 s15, s17, 0
  s_mov_b32 m0, s13
  s_add_u32 s13, s13, 1024
  global_load_lds_dwordx4 v34, s[14:15]
  s_add_u32 s14, s16, 3145728
  s_addc_u32 s15, s17, 0
  s_mov_b32 m0, s13
  s_add_u32 s13, s13, 1024
  global_load_lds_dwordx4 v34, s[14:15]
  s_add_u32 s14, s16, 3276800
  s_addc_u32 s15, s17, 0
  s_mov_b32 m0, s13
  s_add_u32 s13, s13, 1024
  global_load_lds_dwordx4 v34, s[14:15]
  s_add_u32 s14, s16, 3407872
  s_addc_u32 s15, s17, 0
  s_mov_b32 m0, s13
  s_add_u32 s13, s13, 1024
  global_load_lds_dwordx4 v34, s[14:15]
  s_add_u32 s14, s16, 3538944
  s_addc_u32 s15, s17, 0
  s_mov_b32 m0, s13
  s_add_u32 s13, s13, 1024
  global_load_lds_dwordx4 v34, s[14:15]
  s_add_u32 s14, s16, 3670016
  s_addc_u32 s15, s17, 0
  s_mov_b32 m0, s13
  s_add_u32 s13, s13, 1024
  global_load_lds_dwordx4 v34, s[14:15]
  s_add_u32 s14, s16, 3801088
  s_addc_u32 s15, s17, 0
  s_mov_b32 m0, s13
  s_add_u32 s13, s13, 1024
  global_load_lds_dwordx4 v34, s[14:15]
  s_add_u32 s14, s16, 3932160
  s_addc_u32 s15, s17, 0
  s_mov_b32 m0, s13
  s_add_u32 s13, s13, 1024
  global_load_lds_dwordx4 v34, s[14:15]
  s_add_u32 s14, s16, 4063232
  s_addc_u32 s15, s17, 0
  s_mov_b32 m0, s13
  s_add_u32 s13, s13, 1024
  global_load_lds_dwordx4 v34, s[14:15]
Lwq_skip_35:
  s_cmp_lt_u32 s10, 2
  s_cbranch_scc1 Lkv_early_36
  s_lshl_b32 s13, s9, 4
  s_add_u32 s13, s13, 94375936
  v_bfe_u32 v59, v4, 4, 1
  v_lshlrev_b32 v59, 13, v59
  v_add_u32 v59, s13, v59
  global_load_dwordx2 v[62:63], v59, s[4:5] sc1
Lkv_early_36:
  s_cmp_lt_u32 s10, 2
  s_cbranch_scc1 Lst5a_37
  s_waitcnt vmcnt(0)
  s_branch Lst5b_38
Lst5a_37:
  s_waitcnt vmcnt(32)
Lst5b_38:
  s_barrier
  ds_read_b64_tr_b16 v[136:137], v44 offset:0
  ds_read_b64_tr_b16 v[138:139], v44 offset:4096
  ds_read_b64_tr_b16 v[140:141], v44 offset:32768
  ds_read_b64_tr_b16 v[142:143], v44 offset:36864
  ds_read_b64_tr_b16 v[152:153], v44 offset:8
  ds_read_b64_tr_b16 v[154:155], v44 offset:4104
  ds_read_b64_tr_b16 v[156:157], v44 offset:32776
  ds_read_b64_tr_b16 v[158:159], v44 offset:36872
  s_waitcnt lgkmcnt(0)
  ds_read_b64_tr_b16 v[168:169], v44 offset:16
  ds_read_b64_tr_b16 v[170:171], v44 offset:4112
  ds_read_b64_tr_b16 v[172:173], v44 offset:32784
  ds_read_b64_tr_b16 v[174:175], v44 offset:36880
  ds_read_b64_tr_b16 v[184:185], v44 offset:24
  ds_read_b64_tr_b16 v[186:187], v44 offset:4120
  ds_read_b64_tr_b16 v[188:189], v44 offset:32792
  ds_read_b64_tr_b16 v[190:191], v44 offset:36888
  s_waitcnt lgkmcnt(0)
  ds_read_b64_tr_b16 v[200:201], v45 offset:0
  ds_read_b64_tr_b16 v[202:203], v45 offset:4096
  ds_read_b64_tr_b16 v[204:205], v45 offset:32768
  ds_read_b64_tr_b16 v[206:207], v45 offset:36864
  ds_read_b64_tr_b16 v[216:217], v45 offset:8
  ds_read_b64_tr_b16 v[218:219], v45 offset:4104
  ds_read_b64_tr_b16 v[220:221], v45 offset:32776
  ds_read_b64_tr_b16 v[222:223], v45 offset:36872
  s_waitcnt lgkmcnt(0)
  ds_read_b64_tr_b16 v[232:233], v45 offset:16
  ds_read_b64_tr_b16 v[234:235], v45 offset:4112
  ds_read_b64_tr_b16 v[236:237], v45 offset:32784
  ds_read_b64_tr_b16 v[238:239], v45 offset:36880
  ds_read_b64_tr_b16 v[248:249], v45 offset:24
  ds_read_b64_tr_b16 v[250:251], v45 offset:4120
  ds_read_b64_tr_b16 v[252:253], v45 offset:32792
  ds_read_b64_tr_b16 v[254:255], v45 offset:36888
  s_waitcnt lgkmcnt(0)
  s_barrier
  s_cmp_lt_u32 s10, 2
  s_cbranch_scc1 Lwq_skip_39
  s_lshl_b32 s13, s10, 15
  s_add_u32 s14, s16, 0
  s_addc_u32 s15, s17, 0
  s_mov_b32 m0, s13
  s_add_u32 s13, s13, 1024
  global_load_lds_dwordx4 v34, s[14:15]
  s_add_u32 s14, s16, 131072
  s_addc_u32 s15, s17, 0
  s_mov_b32 m0, s13
  s_add_u32 s13, s13, 1024
  global_load_lds_dwordx4 v34, s[14:15]
  s_add_u32 s14, s16, 262144
  s_addc_u32 s15, s17, 0
  s_mov_b32 m0, s13
  s_add_u32 s13, s13, 1024
  global_load_lds_dwordx4 v34, s[14:15]
  s_add_u32 s14, s16, 393216
  s_addc_u32 s15, s17, 0
  s_mov_b32 m0, s13
  s_add_u32 s13, s13, 1024
  global_load_lds_dwordx4 v34, s[14:15]
  s_add_u32 s14, s16, 524288
  s_addc_u32 s15, s17, 0
  s_mov_b32 m0, s13
  s_add_u32 s13, s13, 1024
  global_load_lds_dwordx4 v34, s[14:15]
  s_add_u32 s14, s16, 655360
  s_addc_u32 s15, s17, 0
  s_mov_b32 m0, s13
  s_add_u32 s13, s13, 1024
  global_load_lds_dwordx4 v34, s[14:15]
  s_add_u32 s14, s16, 786432
  s_addc_u32 s15, s17, 0
  s_mov_b32 m0, s13
  s_add_u32 s13, s13, 1024
  global_load_lds_dwordx4 v34, s[14:15]
  s_add_u32 s14, s16, 917504
  s_addc_u32 s15, s17, 0
  s_mov_b32 m0, s13
  s_add_u32 s13, s13, 1024
  global_load_lds_dwordx4 v34, s[14:15]
  s_add_u32 s14, s16, 1048576
  s_addc_u32 s15, s17, 0
  s_mov_b32 m0, s13
  s_add_u32 s13, s13, 1024
  global_load_lds_dwordx4 v34, s[14:15]
  s_add_u32 s14, s16, 1179648
  s_addc_u32 s15, s17, 0
  s_mov_b32 m0, s13
  s_add_u32 s13, s13, 1024
  global_load_lds_dwordx4 v34, s[14:15]
  s_add_u32 s14, s16, 1310720
  s_addc_u32 s15, s17, 0
  s_mov_b32 m0, s13
  s_add_u32 s13, s13, 1024
  global_load_lds_dwordx4 v34, s[14:15]
  s_add_u32 s14, s16, 1441792
  s_addc_u32 s15, s17, 0
  s_mov_b32 m0, s13
  s_add_u32 s13, s13, 1024
  global_load_lds_dwordx4 v34, s[14:15]
  s_add_u32 s14, s16, 1572864
  s_addc_u32 s15, s17, 0
  s_mov_b32 m0, s13
  s_add_u32 s13, s13, 1024
  global_load_lds_dwordx4 v34, s[14:15]
  s_add_u32 s14, s16, 1703936
  s_addc_u32 s15, s17, 0
  s_mov_b32 m0, s13
  s_add_u32 s13, s13, 1024
  global_load_lds_dwordx4 v34, s[14:15]
  s_add_u32 s14, s16, 1835008
  s_addc_u32 s15, s17, 0
  s_mov_b32 m0, s13
  s_add_u32 s13, s13, 1024
  global_load_lds_dwordx4 v34, s[14:15]
  s_add_u32 s14, s16, 1966080
  s_addc_u32 s15, s17, 0
  s_mov_b32 m0, s13
  s_add_u32 s13, s13, 1024
  global_load_lds_dwordx4 v34, s[14:15]
  s_add_u32 s14, s16, 2097152
  s_addc_u32 s15, s17, 0
  s_mov_b32 m0, s13
  s_add_u32 s13, s13, 1024
  global_load_lds_dwordx4 v34, s[14:15]
  s_add_u32 s14, s16, 2228224
  s_addc_u32 s15, s17, 0
  s_mov_b32 m0, s13
  s_add_u32 s13, s13, 1024
  global_load_lds_dwordx4 v34, s[14:15]
  s_add_u32 s14, s16, 2359296
  s_addc_u32 s15, s17, 0
  s_mov_b32 m0, s13
  s_add_u32 s13, s13, 1024
  global_load_lds_dwordx4 v34, s[14:15]
  s_add_u32 s14, s16, 2490368
  s_addc_u32 s15, s17, 0
  s_mov_b32 m0, s13
  s_add_u32 s13, s13, 1024
  global_load_lds_dwordx4 v34, s[14:15]
  s_add_u32 s14, s16, 2621440
  s_addc_u32 s15, s17, 0
  s_mov_b32 m0, s13
  s_add_u32 s13, s13, 1024
  global_load_lds_dwordx4 v34, s[14:15]
  s_add_u32 s14, s16, 2752512
  s_addc_u32 s15, s17, 0
  s_mov_b32 m0, s13
  s_add_u32 s13, s13, 1024
  global_load_lds_dwordx4 v34, s[14:15]
  s_add_u32 s14, s16, 2883584
  s_addc_u32 s15, s17, 0
  s_mov_b32 m0, s13
  s_add_u32 s13, s13, 1024
  global_load_lds_dwordx4 v34, s[14:15]
  s_add_u32 s14, s16, 3014656
  s_addc_u32 s15, s17, 0
  s_mov_b32 m0, s13
  s_add_u32 s13, s13, 1024
  global_load_lds_dwordx4 v34, s[14:15]
  s_add_u32 s14, s16, 3145728
  s_addc_u32 s15, s17, 0
  s_mov_b32 m0, s13
  s_add_u32 s13, s13, 1024
  global_load_lds_dwordx4 v34, s[14:15]
  s_add_u32 s14, s16, 3276800
  s_addc_u32 s15, s17, 0
  s_mov_b32 m0, s13
  s_add_u32 s13, s13, 1024
  global_load_lds_dwordx4 v34, s[14:15]
  s_add_u32 s14, s16, 3407872
  s_addc_u32 s15, s17, 0
  s_mov_b32 m0, s13
  s_add_u32 s13, s13, 1024
  global_load_lds_dwordx4 v34, s[14:15]
  s_add_u32 s14, s16, 3538944
  s_addc_u32 s15, s17, 0
  s_mov_b32 m0, s13
  s_add_u32 s13, s13, 1024
  global_load_lds_dwordx4 v34, s[14:15]
  s_add_u32 s14, s16, 3670016
  s_addc_u32 s15, s17, 0
  s_mov_b32 m0, s13
  s_add_u32 s13, s13, 1024
  global_load_lds_dwordx4 v34, s[14:15]
  s_add_u32 s14, s16, 3801088
  s_addc_u32 s15, s17, 0
  s_mov_b32 m0, s13
  s_add_u32 s13, s13, 1024
  global_load_lds_dwordx4 v34, s[14:15]
  s_add_u32 s14, s16, 3932160
  s_addc_u32 s15, s17, 0
  s_mov_b32 m0, s13
  s_add_u32 s13, s13, 1024
  global_load_lds_dwordx4 v34, s[14:15]
  s_add_u32 s14, s16, 4063232
  s_addc_u32 s15, s17, 0
  s_mov_b32 m0, s13
  s_add_u32 s13, s13, 1024
  global_load_lds_dwordx4 v34, s[14:15]
  v_subrev_u32 v62, s98, v62
  v_xor_b32 v63, s99, v63
  v_subrev_u32 v62, 1, v62
  v_lshrrev_b32 v62, 7, v62
  v_or_b32 v62, v62, v63
  v_cmp_ne_u32 vcc, 0, v62
  s_cbranch_vccz Lkv_ok_40
  s_mov_b32 s15, 0
  s_lshl_b32 s13, s15, 9
  s_lshl_b32 s14, s9, 4
  s_add_u32 s13, s13, s14
  s_add_u32 s13, s13, 94375936
  v_bfe_u32 v62, v4, 4, 1
  v_lshlrev_b32 v62, 13, v62
  v_add_u32 v62, s13, v62
Lwf_p_41:
  global_load_dwordx2 v[22:23], v62, s[4:5] sc1
  s_waitcnt vmcnt(0)
  v_subrev_u32 v22, s98, v22
  v_xor_b32 v23, s99, v23
  v_subrev_u32 v22, 1, v22
  v_lshrrev_b32 v22, 7, v22
  v_or_b32 v22, v22, v23
  v_cmp_ne_u32 vcc, 0, v22
  s_cbranch_vccz Lwf_d_42
  s_sleep 4
  s_cmp_eq_u32 s12, 0
  s_cbranch_scc1 Lwf_d_42
  s_sub_u32 s12, s12, 1
  s_branch Lwf_p_41
Lwf_d_42:
Lkv_ok_40:
  s_cmp_eq_u32 s10, 3
  s_cbranch_scc1 Lkv_w3_43
  s_lshl_b32 s13, s9, 13
  s_add_u32 s13, s13, 20971520
  s_add_u32 s14, s4, s13
  s_addc_u32 s15, s5, 0
  s_mov_b32 m0, 131072
  s_nop 0
  global_load_lds_dwordx4 v4, s[14:15] offset:0 sc1
  global_load_lds_dwordx4 v4, s[14:15] offset:1024 sc1
  global_load_lds_dwordx4 v4, s[14:15] offset:2048 sc1
  global_load_lds_dwordx4 v4, s[14:15] offset:3072 sc1
  s_add_u32 s14, s14, 4096
  s_addc_u32 s15, s15, 0
  s_mov_b32 m0, 135168
  s_nop 0
  global_load_lds_dwordx4 v4, s[14:15] offset:0 sc1
  global_load_lds_dwordx4 v4, s[14:15] offset:1024 sc1
  global_load_lds_dwordx4 v4, s[14:15] offset:2048 sc1
  global_load_lds_dwordx4 v4, s[14:15] offset:3072 sc1
  s_branch Lkv_w3d_44
Lkv_w3_43:
  s_lshl_b32 s13, s9, 13
  s_add_u32 s13, s13, 37748736
  s_add_u32 s14, s4, s13
  s_addc_u32 s15, s5, 0
  s_mov_b32 m0, 139264
  s_nop 0
  global_load_lds_dwordx4 v13, s[14:15] offset:0 sc1
  global_load_lds_dwordx4 v13, s[14:15] offset:1024 sc1
  global_load_lds_dwordx4 v13, s[14:15] offset:2048 sc1
  global_load_lds_dwordx4 v13, s[14:15] offset:3072 sc1
  s_add_u32 s14, s14, 4096
  s_addc_u32 s15, s15, 0
  s_mov_b32 m0, 143360
  s_nop 0
  global_load_lds_dwordx4 v13, s[14:15] offset:0 sc1
  global_load_lds_dwordx4 v13, s[14:15] offset:1024 sc1
  global_load_lds_dwordx4 v13, s[14:15] offset:2048 sc1
  global_load_lds_dwordx4 v13, s[14:15] offset:3072 sc1
Lkv_w3d_44:
Lwq_skip_39:
  s_mov_b32 s13, 20971520
  s_mul_i32 s14, s9, 8192
  s_add_u32 s13, s13, s14
  s_add_u32 s24, s4, s13
  s_addc_u32 s25, s5, 0
  s_lshl_b32 s15, s10, 11
  s_add_u32 s24, s24, s15
  s_addc_u32 s25, s25, 0
  s_mov_b32 s13, 37748736
  s_mul_i32 s14, s9, 8192
  s_add_u32 s13, s13, s14
  s_add_u32 s26, s4, s13
  s_addc_u32 s27, s5, 0
  s_add_u32 s26, s26, s15
  s_addc_u32 s27, s27, 0
  s_mov_b32 s13, 94502912
  s_mul_i32 s14, s9, 256
  s_add_u32 s13, s13, s14
  s_mul_i32 s14, s10, 65536
  s_add_u32 s13, s13, s14
  s_add_u32 s28, s4, s13
  s_addc_u32 s29, s5, 0
  s_mov_b32 s13, 94535680
  s_mul_i32 s14, s9, 256
  s_add_u32 s13, s13, s14
  s_mul_i32 s14, s10, 65536
  s_add_u32 s13, s13, s14
  s_add_u32 s30, s4, s13
  s_addc_u32 s31, s5, 0
  s_mov_b32 s13, 94502912
  s_mul_i32 s14, s9, 8192
  s_add_u32 s13, s13, s14
  s_mul_i32 s14, s10, 128
  s_add_u32 s13, s13, s14
  s_add_u32 s32, s4, s13
  s_addc_u32 s33, s5, 0
  s_mov_b32 s13, 94507008
  s_mul_i32 s14, s9, 8192
  s_add_u32 s13, s13, s14
  s_mul_i32 s14, s10, 128
  s_add_u32 s13, s13, s14
  s_add_u32 s34, s4, s13
  s_addc_u32 s35, s5, 0
  s_mov_b32 s13, 95420416
  s_add_u32 s40, s4, s13
  s_addc_u32 s41, s5, 0
  s_mov_b32 s13, 95428608
  s_add_u32 s42, s4, s13
  s_addc_u32 s43, s5, 0
  s_mov_b32 s13, 95436800
  s_add_u32 s44, s4, s13
  s_addc_u32 s45, s5, 0
  s_mov_b32 s13, 81788928
  s_mul_i32 s14, s9, 2048
  s_add_u32 s13, s13, s14
  s_add_u32 s46, s4, s13
  s_addc_u32 s47, s5, 0
  s_mov_b32 s13, 85983232
  s_mul_i32 s14, s9, 4096
  s_add_u32 s13, s13, s14
  s_add_u32 s48, s4, s13
  s_addc_u32 s49, s5, 0
  s_mov_b32 s13, 94406656
  s_mul_i32 s14, s9, 64
  s_add_u32 s13, s13, s14
  s_mul_i32 s14, s10, 16
  s_add_u32 s13, s13, s14
  s_add_u32 s52, s4, s13
  s_addc_u32 s53, s5, 0
  s_mov_b32 s13, 96468992
  s_mul_i32 s14, s9, 16384
  s_add_u32 s13, s13, s14
  s_mul_i32 s14, s10, 4096
  s_add_u32 s13, s13, s14
  s_add_u32 s56, s4, s13
  s_addc_u32 s57, s5, 0
  s_mov_b32 s54, 0x3e0293ee
  s_mov_b32 s55, 0x3e0293ee
  s_mov_b32 s50, 0
  s_mov_b32 s13, 94376448
  s_mul_i32 s14, s9, 16
  s_add_u32 s13, s13, s14
  s_add_u32 s36, s4, s13
  s_addc_u32 s37, s5, 0
  s_cmp_eq_u32 s10, 3
  s_cselect_b32 s38, 1, 0xffff
  s_mov_b32 s51, 1
  v_lshrrev_b32 v57, 4, v4
  v_and_b32 v58, 31, v57
  v_lshlrev_b32 v58, 4, v58
  v_add_u32 v58, 94408704, v58
  v_mov_b32 v57, 0
  global_load_dword v56, v57, s[6:7] sc1
  global_load_dwordx2 v[60:61], v58, s[4:5] sc1
  s_add_u32 s24, s24, 262144
  s_addc_u32 s25, s25, 0
  s_add_u32 s26, s26, 262144
  s_addc_u32 s27, s27, 0
  s_waitcnt vmcnt(0)
  v_readfirstlane_b32 s16, v56
  v_subrev_u32 v60, s98, v60
  v_xor_b32 v61, s99, v61
  v_subrev_u32 v60, 1, v60
  v_lshrrev_b32 v60, 7, v60
  v_or_b32 v60, v60, v61
  v_cmp_ne_u32 vcc, 0, v60
  s_cbranch_vccnz Lst_slow_45
  s_cmp_lt_u32 s16, 32
  s_cbranch_scc1 Lst_slow_45
  s_mov_b32 s11, 1
  s_branch Lst_ok_46
Lst_slow_45:
  v_lshrrev_b32 v56, 4, v4
  v_and_b32 v57, 15, v56
  v_lshlrev_b32 v57, 2, v57
Lrs_p_47:
  global_load_dword v58, v57, s[6:7] sc1
  s_waitcnt vmcnt(0)
  v_readfirstlane_b32 s16, v58
  v_mov_b32 v60, v58
  s_nop 1
  v_add_u32_dpp v60, v60, v60 quad_perm:[1,0,3,2] row_mask:0xf bank_mask:0xf
  s_nop 1
  v_add_u32_dpp v60, v60, v60 quad_perm:[2,3,0,1] row_mask:0xf bank_mask:0xf
  s_nop 1
  v_add_u32_dpp v60, v60, v60 row_half_mirror row_mask:0xf bank_mask:0xf
  s_nop 1
  v_add_u32_dpp v60, v60, v60 row_mirror row_mask:0xf bank_mask:0xf
  s_nop 1
  v_readfirstlane_b32 s14, v60
  s_nop 3
  s_cmp_ge_u32 s16, 32
  s_cbranch_scc1 Lrs_f_49
  s_mov_b32 s11, 0
  s_cmp_ge_u32 s14, 256
  s_cbranch_scc1 Lrs_d_48
  s_sleep 8
  s_cmp_eq_u32 s12, 0
  s_cbranch_scc1 Lrs_d_48
  s_sub_u32 s12, s12, 1
  s_branch Lrs_p_47
Lrs_f_49:
  s_mov_b32 s11, 1
Lrs_d_48:
  v_and_b32 v56, 31, v56
  v_lshlrev_b32 v56, 4, v56
  v_add_u32 v56, 94408704, v56
Lwf_p_50:
  global_load_dwordx2 v[60:61], v56, s[4:5] sc1
  s_waitcnt vmcnt(0)
  v_subrev_u32 v60, s98, v60
  v_xor_b32 v61, s99, v61
  v_subrev_u32 v60, 1, v60
  v_lshrrev_b32 v60, 7, v60
  v_or_b32 v60, v60, v61
  v_cmp_ne_u32 vcc, 0, v60
  s_cbranch_vccz Lwf_d_51
  s_sleep 4
  s_cmp_eq_u32 s12, 0
  s_cbranch_scc1 Lwf_d_51
  s_sub_u32 s12, s12, 1
  s_branch Lwf_p_50
Lwf_d_51:
Lst_ok_46:
  ds_read_b64_tr_b16 v[64:65], v35 offset:0
  ds_read_b64_tr_b16 v[66:67], v35 offset:256
  ds_read_b64_tr_b16 v[68:69], v35 offset:2048
  ds_read_b64_tr_b16 v[70:71], v35 offset:2304
  ds_read_b64_tr_b16 v[72:73], v35 offset:32
  ds_read_b64_tr_b16 v[74:75], v35 offset:288
  ds_read_b64_tr_b16 v[76:77], v35 offset:2080
  ds_read_b64_tr_b16 v[78:79], v35 offset:2336
  ds_read_b64_tr_b16 v[80:81], v35 offset:4096
  ds_read_b64_tr_b16 v[82:83], v35 offset:4352
  ds_read_b64_tr_b16 v[84:85], v35 offset:6144
  ds_read_b64_tr_b16 v[86:87], v35 offset:6400
  ds_read_b64_tr_b16 v[88:89], v35 offset:4128
  ds_read_b64_tr_b16 v[90:91], v35 offset:4384
  ds_read_b64_tr_b16 v[92:93], v35 offset:6176
  ds_read_b64_tr_b16 v[94:95], v35 offset:6432
  s_waitcnt lgkmcnt(8)
  ds_write_b128 v18, v[64:67] offset:0
  ds_write_b128 v18, v[68:71] offset:1024
  ds_write_b128 v18, v[72:75] offset:2048
  ds_write_b128 v18, v[76:79] offset:3072
  ds_read_b64_tr_b16 v[64:65], v35 offset:8192
  ds_read_b64_tr_b16 v[66:67], v35 offset:8448
  ds_read_b64_tr_b16 v[68:69], v35 offset:10240
  ds_read_b64_tr_b16 v[70:71], v35 offset:10496
  ds_read_b64_tr_b16 v[72:73], v35 offset:8224
  ds_read_b64_tr_b16 v[74:75], v35 offset:8480
  ds_read_b64_tr_b16 v[76:77], v35 offset:10272
  ds_read_b64_tr_b16 v[78:79], v35 offset:10528
  s_waitcnt lgkmcnt(8)
  ds_write_b128 v18, v[80:83] offset:4096
  ds_write_b128 v18, v[84:87] offset:5120
  ds_write_b128 v18, v[88:91] offset:6144
  ds_write_b128 v18, v[92:95] offset:7168
  ds_read_b64_tr_b16 v[80:81], v35 offset:12288
  ds_read_b64_tr_b16 v[82:83], v35 offset:12544
  ds_read_b64_tr_b16 v[84:85], v35 offset:14336
  ds_read_b64_tr_b16 v[86:87], v35 offset:14592
  ds_read_b64_tr_b16 v[88:89], v35 offset:12320
  ds_read_b64_tr_b16 v[90:91], v35 offset:12576
  ds_read_b64_tr_b16 v[92:93], v35 offset:14368
  ds_read_b64_tr_b16 v[94:95], v35 offset:14624
  s_waitcnt lgkmcnt(8)
  ds_write_b128 v18, v[64:67] offset:8192
  ds_write_b128 v18, v[68:71] offset:9216
  ds_write_b128 v18, v[72:75] offset:10240
  ds_write_b128 v18, v[76:79] offset:11264
  ds_read_b64_tr_b16 v[64:65], v35 offset:16384
  ds_read_b64_tr_b16 v[66:67], v35 offset:16640
  ds_read_b64_tr_b16 v[68:69], v35 offset:18432
  ds_read_b64_tr_b16 v[70:71], v35 offset:18688
  ds_read_b64_tr_b16 v[72:73], v35 offset:16416
  ds_read_b64_tr_b16 v[74:75], v35 offset:16672
  ds_read_b64_tr_b16 v[76:77], v35 offset:18464
  ds_read_b64_tr_b16 v[78:79], v35 offset:18720
  s_waitcnt lgkmcnt(8)
  ds_write_b128 v18, v[80:83] offset:12288
  ds_write_b128 v18, v[84:87] offset:13312
  ds_write_b128 v18, v[88:91] offset:14336
  ds_write_b128 v18, v[92:95] offset:15360
  s_waitcnt lgkmcnt(0)
  ds_write_b128 v18, v[64:67] offset:16384
  ds_write_b128 v18, v[68:71] offset:17408
  ds_write_b128 v18, v[72:75] offset:18432
  ds_write_b128 v18, v[76:79] offset:19456
  ds_read_b64_tr_b16 v[80:81], v35 offset:20480
  ds_read_b64_tr_b16 v[82:83], v35 offset:20736
  ds_read_b64_tr_b16 v[84:85], v35 offset:22528
  ds_read_b64_tr_b16 v[86:87], v35 offset:22784
  ds_read_b64_tr_b16 v[88:89], v35 offset:20512
  ds_read_b64_tr_b16 v[90:91], v35 offset:20768
  ds_read_b64_tr_b16 v[92:93], v35 offset:22560
  ds_read_b64_tr_b16 v[94:95], v35 offset:22816
  s_waitcnt lgkmcnt(0)
  ds_write_b128 v18, v[208:211] offset:20480
  ds_write_b128 v18, v[212:215] offset:21504
  ds_write_b128 v18, v[216:219] offset:22528
  ds_write_b128 v18, v[220:223] offset:23552
  s_waitcnt lgkmcnt(0)
  v_mov_b64 v[208:209], v[80:81]
  v_mov_b64 v[210:211], v[82:83]
  v_mov_b64 v[212:213], v[84:85]
  v_mov_b64 v[214:215], v[86:87]
  v_mov_b64 v[216:217], v[88:89]
  v_mov_b64 v[218:219], v[90:91]
  v_mov_b64 v[220:221], v[92:93]
  v_mov_b64 v[222:223], v[94:95]
  ds_read_b64_tr_b16 v[64:65], v35 offset:24576
  ds_read_b64_tr_b16 v[66:67], v35 offset:24832
  ds_read_b64_tr_b16 v[68:69], v35 offset:26624
  ds_read_b64_tr_b16 v[70:71], v35 offset:26880
  ds_read_b64_tr_b16 v[72:73], v35 offset:24608
  ds_read_b64_tr_b16 v[74:75], v35 offset:24864
  ds_read_b64_tr_b16 v[76:77], v35 offset:26656
  ds_read_b64_tr_b16 v[78:79], v35 offset:26912
  s_waitcnt lgkmcnt(0)
  ds_write_b128 v18, v[224:227] offset:24576
  ds_write_b128 v18, v[228:231] offset:25600
  ds_write_b128 v18, v[232:235] offset:26624
  ds_write_b128 v18, v[236:239] offset:27648
  s_waitcnt lgkmcnt(0)
  v_mov_b64 v[224:225], v[64:65]
  v_mov_b64 v[226:227], v[66:67]
  v_mov_b64 v[228:229], v[68:69]
  v_mov_b64 v[230:231], v[70:71]
  v_mov_b64 v[232:233], v[72:73]
  v_mov_b64 v[234:235], v[74:75]
  v_mov_b64 v[236:237], v[76:77]
  v_mov_b64 v[238:239], v[78:79]
  ds_read_b64_tr_b16 v[80:81], v35 offset:28672
  ds_read_b64_tr_b16 v[82:83], v35 offset:28928
  ds_read_b64_tr_b16 v[84:85], v35 offset:30720
  ds_read_b64_tr_b16 v[86:87], v35 offset:30976
  ds_read_b64_tr_b16 v[88:89], v35 offset:28704
  ds_read_b64_tr_b16 v[90:91], v35 offset:28960
  ds_read_b64_tr_b16 v[92:93], v35 offset:30752
  ds_read_b64_tr_b16 v[94:95], v35 offset:31008
  s_waitcnt lgkmcnt(0)
  ds_write_b128 v18, v[240:243] offset:28672
  ds_write_b128 v18, v[244:247] offset:29696
  ds_write_b128 v18, v[248:251] offset:30720
  ds_write_b128 v18, v[252:255] offset:31744
  s_waitcnt lgkmcnt(0)
  v_mov_b64 v[240:241], v[80:81]
  v_mov_b64 v[242:243], v[82:83]
  v_mov_b64 v[244:245], v[84:85]
  v_mov_b64 v[246:247], v[86:87]
  v_mov_b64 v[248:249], v[88:89]
  v_mov_b64 v[250:251], v[90:91]
  v_mov_b64 v[252:253], v[92:93]
  v_mov_b64 v[254:255], v[94:95]
  s_waitcnt vmcnt(0) lgkmcnt(0)
  s_cmp_eq_u32 s11, 0
  s_cbranch_scc1 Lchain_slow_52
  ds_read_b128 v[64:67], v18 offset:4096
  ds_read_b128 v[68:71], v18 offset:5120
  ds_read_b128 v[72:75], v18 offset:6144
  ds_read_b128 v[76:79], v18 offset:7168
  ds_read_b128 v[80:83], v18 offset:8192
  ds_read_b128 v[84:87], v18 offset:9216
  ds_read_b128 v[88:91], v18 offset:10240
  ds_read_b128 v[92:95], v18 offset:11264
  ds_read_b128 v[96:99], v18 offset:12288
  ds_read_b128 v[100:103], v18 offset:13312
  ds_read_b128 v[104:107], v18 offset:14336
  ds_read_b128 v[108:111], v18 offset:15360
  ds_read_b128 v[112:115], v18 offset:16384
  ds_read_b128 v[116:119], v18 offset:17408
  ds_read_b128 v[120:123], v18 offset:18432
  ds_read_b128 v[124:127], v18 offset:19456
  ds_read_b128 v[40:43], v18 offset:0
  ds_read_b128 v[44:47], v18 offset:1024
  ds_read_b128 v[48:51], v18 offset:2048
  ds_read_b128 v[52:55], v18 offset:3072
  v_mov_b64 v[56:57], 0
  v_mov_b64 v[58:59], 0
  v_mov_b64 v[60:61], 0
  v_mov_b64 v[62:63], 0
  s_branch Lchain_first_55
.p2align 6
Lchain_loop_53:
  s_cmp_ge_u32 s10, 2
  s_cbranch_scc1 Lnocons_56
  s_sleep 4
  global_load_dwordx4 v[64:67], v19, s[32:33] offset:0 sc1
  global_load_dwordx4 v[68:71], v19, s[32:33] offset:2048 sc1
  global_load_dwordx4 v[72:75], v19, s[34:35] offset:0 sc1
  global_load_dwordx4 v[76:79], v19, s[34:35] offset:2048 sc1
  s_nop 15
  s_nop 3
  global_load_dwordx4 v[80:83], v19, s[32:33] offset:0 sc1
  global_load_dwordx4 v[84:87], v19, s[32:33] offset:2048 sc1
  global_load_dwordx4 v[88:91], v19, s[34:35] offset:0 sc1
  global_load_dwordx4 v[92:95], v19, s[34:35] offset:2048 sc1
Lp1_poll_58:
  s_waitcnt vmcnt(7)
  v_mfma_f32_16x16x32_bf16 v[56:59], v[64:67], v[8:11], 0
  v_xor_b32 v22, s51, v64
  s_waitcnt vmcnt(6)
  v_mfma_f32_16x16x32_bf16 v[56:59], v[68:71], v[8:11], v[56:59]
  v_xor_b32 v23, s51, v68
  v_or_b32 v22, v22, v23
  s_waitcnt vmcnt(5)
  v_mfma_f32_16x16x32_bf16 v[56:59], v[72:75], v[8:11], v[56:59]
  v_xor_b32 v23, s51, v72
  v_or_b32 v22, v22, v23
  s_waitcnt vmcnt(4)
  v_mfma_f32_16x16x32_bf16 v[56:59], v[76:79], v[8:11], v[56:59]
  v_xor_b32 v23, s51, v76
  v_or_b32 v22, v22, v23
  v_and_b32 v22, 1, v22
  v_cmp_ne_u32 vcc, 0, v22
  s_cbranch_vccz Lp1_doneA_59
  global_load_dwordx4 v[64:67], v19, s[32:33] offset:0 sc1
  global_load_dwordx4 v[68:71], v19, s[32:33] offset:2048 sc1
  global_load_dwordx4 v[72:75], v19, s[34:35] offset:0 sc1
  global_load_dwordx4 v[76:79], v19, s[34:35] offset:2048 sc1
  s_waitcnt vmcnt(7)
  v_mfma_f32_16x16x32_bf16 v[60:63], v[80:83], v[8:11], 0
  v_xor_b32 v22, s51, v80
  s_waitcnt vmcnt(6)
  v_mfma_f32_16x16x32_bf16 v[60:63], v[84:87], v[8:11], v[60:63]
  v_xor_b32 v23, s51, v84
  v_or_b32 v22, v22, v23
  s_waitcnt vmcnt(5)
  v_mfma_f32_16x16x32_bf16 v[60:63], v[88:91], v[8:11], v[60:63]
  v_xor_b32 v23, s51, v88
  v_or_b32 v22, v22, v23
  s_waitcnt vmcnt(4)
  v_mfma_f32_16x16x32_bf16 v[60:63], v[92:95], v[8:11], v[60:63]
  v_xor_b32 v23, s51, v92
  v_or_b32 v22, v22, v23
  v_and_b32 v22, 1, v22
  v_cmp_ne_u32 vcc, 0, v22
  s_cbranch_vccz Lp1_doneB_60
  global_load_dwordx4 v[80:83], v19, s[32:33] offset:0 sc1
  global_load_dwordx4 v[84:87], v19, s[32:33] offset:2048 sc1
  global_load_dwordx4 v[88:91], v19, s[34:35] offset:0 sc1
  global_load_dwordx4 v[92:95], v19, s[34:35] offset:2048 sc1
  s_cmp_eq_u32 s12, 0
  s_cbranch_scc1 Lp1_doneA_59
  s_sub_u32 s12, s12, 1
  s_branch Lp1_poll_58
Lp1_doneB_60:
  s_nop 3
  v_mov_b32 v56, v60
  v_mov_b32 v57, v61
  v_mov_b32 v58, v62
  v_mov_b32 v59, v63
  s_branch Lp1_tail_61
Lp1_doneA_59:
  s_nop 3
Lp1_tail_61:
  s_nop 1
  v_permlane32_swap_b32 v56, v58
  v_permlane32_swap_b32 v57, v59
  s_mov_b32 exec_lo, 0x00ff00ff
  v_pk_add_f32 v[56:57], v[56:57], v[58:59]
  s_mov_b32 exec_hi, 0x00ff00ff
  v_cvt_pk_bf16_f32 v56, v56, v57
  v_mov_b32 v22, -1
  v_min_u32 v56, -2, v56
  global_store_dword v15, v56, s[42:43]
  global_store_dword v15, v22, s[40:41]
  s_mov_b64 exec, -1
  s_waitcnt vmcnt(2)
  ds_read_b128 v[64:67], v18 offset:4096
  ds_read_b128 v[68:71], v18 offset:5120
  ds_read_b128 v[72:75], v18 offset:6144
  ds_read_b128 v[76:79], v18 offset:7168
  ds_read_b128 v[80:83], v18 offset:8192
  ds_read_b128 v[84:87], v18 offset:9216
  ds_read_b128 v[88:91], v18 offset:10240
  ds_read_b128 v[92:95], v18 offset:11264
  ds_read_b128 v[96:99], v18 offset:12288
  ds_read_b128 v[100:103], v18 offset:13312
  ds_read_b128 v[104:107], v18 offset:14336
  ds_read_b128 v[108:111], v18 offset:15360
  ds_read_b128 v[112:115], v18 offset:16384
  ds_read_b128 v[116:119], v18 offset:17408
  ds_read_b128 v[120:123], v18 offset:18432
  ds_read_b128 v[124:127], v18 offset:19456
  ds_read_b128 v[40:43], v18 offset:0
  ds_read_b128 v[44:47], v18 offset:1024
  ds_read_b128 v[48:51], v18 offset:2048
  ds_read_b128 v[52:55], v18 offset:3072
  s_nop 11
  s_branch Lhopjoin_57
Lnocons_56:
  ds_read_b128 v[64:67], v18 offset:4096
  ds_read_b128 v[68:71], v18 offset:5120
  ds_read_b128 v[72:75], v18 offset:6144
  ds_read_b128 v[76:79], v18 offset:7168
  ds_read_b128 v[80:83], v18 offset:8192
  ds_read_b128 v[84:87], v18 offset:9216
  ds_read_b128 v[88:91], v18 offset:10240
  ds_read_b128 v[92:95], v18 offset:11264
  ds_read_b128 v[96:99], v18 offset:12288
  ds_read_b128 v[100:103], v18 offset:13312
  ds_read_b128 v[104:107], v18 offset:14336
  ds_read_b128 v[108:111], v18 offset:15360
  ds_read_b128 v[112:115], v18 offset:16384
  ds_read_b128 v[116:119], v18 offset:17408
  ds_read_b128 v[120:123], v18 offset:18432
  ds_read_b128 v[124:127], v18 offset:19456
  ds_read_b128 v[40:43], v18 offset:0
  ds_read_b128 v[44:47], v18 offset:1024
  ds_read_b128 v[48:51], v18 offset:2048
  ds_read_b128 v[52:55], v18 offset:3072
  s_cmp_lg_u32 s38, s50
  s_cbranch_scc1 Lkvskip_62
  s_waitcnt vmcnt(0)
  v_subrev_u32 v8, s98, v8
  v_xor_b32 v9, s99, v9
  v_subrev_u32 v8, 1, v8
  v_lshrrev_b32 v8, 7, v8
  v_or_b32 v8, v8, v9
  v_cmp_ne_u32 vcc, 0, v8
  s_and_b32 s13, vcc_lo, 3
  s_lshr_b32 s15, s50, 2
  s_add_u32 s15, s15, 1
  s_add_u32 s38, s38, 4
  s_cmp_ge_u32 s38, 60
  s_cselect_b32 s38, 0xffff, s38
  s_add_u32 s36, s36, 512
  s_addc_u32 s37, s37, 0
  s_cmp_eq_u32 s13, 0
  s_cbranch_scc1 Lkvskip_62
  s_lshl_b32 s13, s15, 9
  s_lshl_b32 s14, s9, 4
  s_add_u32 s13, s13, s14
  s_add_u32 s13, s13, 94375936
  v_bfe_u32 v62, v4, 4, 1
  v_lshlrev_b32 v62, 13, v62
  v_add_u32 v62, s13, v62
Lwf_p_63:
  global_load_dwordx2 v[22:23], v62, s[4:5] sc1
  s_waitcnt vmcnt(0)
  v_subrev_u32 v22, s98, v22
  v_xor_b32 v23, s99, v23
  v_subrev_u32 v22, 1, v22
  v_lshrrev_b32 v22, 7, v22
  v_or_b32 v22, v22, v23
  v_cmp_ne_u32 vcc, 0, v22
  s_cbranch_vccz Lwf_d_64
  s_sleep 4
  s_cmp_eq_u32 s12, 0
  s_cbranch_scc1 Lwf_d_64
  s_sub_u32 s12, s12, 1
  s_branch Lwf_p_63
Lwf_d_64:
Lkvskip_62:
  s_sleep 10
  s_nop 7
Lhopjoin_57:
  s_mov_b64 s[14:15], s[40:41]
  s_mov_b64 s[40:41], s[42:43]
  s_mov_b64 s[42:43], s[44:45]
  s_mov_b64 s[44:45], s[14:15]
  s_add_u32 s50, s50, 1
  s_xor_b32 s51, s51, 1
  v_mov_b64 v[56:57], 0
  v_mov_b64 v[58:59], 0
  v_mov_b64 v[60:61], 0
  v_mov_b64 v[62:63], 0
  s_lshl_b32 s13, s10, 11
  s_add_u32 s14, s40, s13
  s_addc_u32 s15, s41, 0
Lm_poll_65:
  global_load_dwordx4 v[24:27], v4, s[14:15] sc1
  global_load_dwordx4 v[28:31], v4, s[14:15] offset:1024 sc1
  s_waitcnt vmcnt(0)
  v_max3_u32 v22, v24, v25, v26
  v_max3_u32 v23, v27, v28, v29
  v_max3_u32 v22, v22, v30, v31
  v_max_u32 v22, v22, v23
  v_cmp_eq_u32 vcc, -1, v22
  s_cbranch_vccz Lm_doneA_66
  s_cmp_eq_u32 s12, 0
  s_cbranch_scc1 Lm_doneA_66
  s_sub_u32 s12, s12, 1
  s_branch Lm_poll_65
Lm_doneA_66:
  ds_write_b128 v3, v[24:27]
  ds_write_b128 v3, v[28:31] offset:1088
  s_add_u32 s13, s98, s50
  v_mov_b32 v22, s13
  v_mov_b32 v23, s99
  s_mov_b64 exec, 1
  global_store_dwordx2 v4, v[22:23], s[52:53] sc1
  s_mov_b64 exec, -1
  s_waitcnt vmcnt(1)
Lchain_first_55:
  s_waitcnt lgkmcnt(0)
  s_barrier
  s_cmp_eq_u32 s50, 63
  s_cbranch_scc1 Lchain_last_70
  ds_read_b128 v[24:27], v2 offset:0
  ds_read_b128 v[28:31], v2 offset:128
  ds_read_b128 v[32:35], v2 offset:256
  ds_read_b128 v[36:39], v2 offset:384
  s_cmp_lg_u32 s38, s50
  s_cbranch_scc1 Lkvf_71
  s_mov_b64 exec, 3
  global_load_dwordx2 v[8:9], v19, s[36:37] sc1
  s_mov_b64 exec, -1
Lkvf_71:
  s_waitcnt lgkmcnt(3)
  v_smfmac_f32_16x16x64_bf16 v[56:59], v[24:27], v[40:47], v1
  v_smfmac_f32_16x16x64_bf16 v[60:63], v[24:27], v[48:55], v1
  ds_read_b128 v[40:43], v2 offset:512
  ds_read_b128 v[44:47], v2 offset:640
  ds_read_b128 v[48:51], v2 offset:768
  ds_read_b128 v[52:55], v2 offset:896
  s_waitcnt lgkmcnt(4)
  v_smfmac_f32_16x16x64_bf16 v[56:59], v[28:31], v[64:71], v1
  v_smfmac_f32_16x16x64_bf16 v[60:63], v[28:31], v[72:79], v1
  ds_read_b128 v[64:67], v7 offset:0
  v_smfmac_f32_16x16x64_bf16 v[56:59], v[32:35], v[80:87], v1
  ds_read_b128 v[68:71], v7 offset:1024
  v_smfmac_f32_16x16x64_bf16 v[60:63], v[32:35], v[88:95], v1
  ds_read_b128 v[72:75], v7 offset:2048
  v_smfmac_f32_16x16x64_bf16 v[56:59], v[36:39], v[96:103], v1
  ds_read_b128 v[76:79], v7 offset:3072
  v_smfmac_f32_16x16x64_bf16 v[60:63], v[36:39], v[104:111], v1
  ds_read_b128 v[80:83], v7 offset:4096
  s_waitcnt lgkmcnt(5)
  v_smfmac_f32_16x16x64_bf16 v[56:59], v[40:43], v[112:119], v1
  ds_read_b128 v[84:87], v7 offset:5120
  v_smfmac_f32_16x16x64_bf16 v[60:63], v[40:43], v[120:127], v1
  ds_read_b128 v[88:91], v7 offset:6144
  v_smfmac_f32_16x16x64_bf16 v[56:59], v[44:47], v[208:215], v1
  ds_read_b128 v[92:95], v7 offset:7168
  v_smfmac_f32_16x16x64_bf16 v[60:63], v[44:47], v[216:223], v1
  v_mov_b64 v[112:113], 0
  v_mov_b64 v[114:115], 0
  v_smfmac_f32_16x16x64_bf16 v[56:59], v[48:51], v[224:231], v1
  v_mov_b64 v[116:117], 0
  v_mov_b64 v[118:119], 0
  v_smfmac_f32_16x16x64_bf16 v[60:63], v[48:51], v[232:239], v1
  v_mov_b64 v[120:121], 0
  v_mov_b64 v[122:123], 0
  v_smfmac_f32_16x16x64_bf16 v[56:59], v[52:55], v[240:247], v1
  v_mov_b64 v[124:125], 0
  v_mov_b64 v[126:127], 0
  v_smfmac_f32_16x16x64_bf16 v[60:63], v[52:55], v[248:255], v1
  v_smfmac_f32_16x16x64_bf16 v[112:115], v[24:27], a[0:7], v1
  v_smfmac_f32_16x16x64_bf16 v[116:119], v[24:27], a[64:71], v1
  v_smfmac_f32_16x16x64_bf16 v[112:115], v[28:31], a[8:15], v1
  v_pk_add_f32 v[56:57], v[56:57], v[58:59]
  v_pk_add_f32 v[60:61], v[60:61], v[62:63]
  v_cvt_pk_bf16_f32 v56, v56, v60
  v_cvt_pk_bf16_f32 v57, v57, v61
  v_smfmac_f32_16x16x64_bf16 v[116:119], v[28:31], a[72:79], v1
  ds_write_b32 v5, v56 offset:0
  ds_write_b32 v5, v57 offset:288
  v_smfmac_f32_16x16x64_bf16 v[112:115], v[32:35], a[16:23], v1
  v_smfmac_f32_16x16x64_bf16 v[116:119], v[32:35], a[80:87], v1
  v_smfmac_f32_16x16x64_bf16 v[112:115], v[36:39], a[24:31], v1
  v_smfmac_f32_16x16x64_bf16 v[116:119], v[36:39], a[88:95], v1
  v_smfmac_f32_16x16x64_bf16 v[112:115], v[40:43], a[32:39], v1
  s_waitcnt lgkmcnt(0)
  s_barrier
  v_smfmac_f32_16x16x64_bf16 v[116:119], v[40:43], a[96:103], v1
  ds_read_b128 v[96:99], v6 offset:0
  v_smfmac_f32_16x16x64_bf16 v[112:115], v[44:47], a[40:47], v1
  ds_read_b128 v[100:103], v6 offset:64
  v_smfmac_f32_16x16x64_bf16 v[116:119], v[44:47], a[104:111], v1
  ds_read_b128 v[104:107], v6 offset:128
  v_smfmac_f32_16x16x64_bf16 v[112:115], v[48:51], a[48:55], v1
  ds_read_b128 v[108:111], v6 offset:192
  s_mov_b32 m0, s60
  v_smfmac_f32_16x16x64_bf16 v[116:119], v[48:51], a[112:119], v1
  global_load_lds_dwordx4 v4, s[24:25] sc1
  v_smfmac_f32_16x16x64_bf16 v[112:115], v[52:55], a[56:63], v1
  global_load_lds_dwordx4 v4, s[24:25] offset:1024 sc1
  v_smfmac_f32_16x16x64_bf16 v[116:119], v[52:55], a[120:127], v1
  v_smfmac_f32_16x16x64_bf16 v[120:123], v[24:27], a[128:135], v1
  v_smfmac_f32_16x16x64_bf16 v[124:127], v[24:27], a[192:199], v1
  v_smfmac_f32_16x16x64_bf16 v[120:123], v[28:31], a[136:143], v1
  v_pk_add_f32 v[112:113], v[112:113], v[114:115]
  v_pk_add_f32 v[116:117], v[116:117], v[118:119]
  v_cvt_pk_bf16_f32 v112, v112, v116
  v_cvt_pk_bf16_f32 v113, v113, v117
  ds_write_b32 v5, v112 offset:2304
  ds_write_b32 v5, v113 offset:2592
  s_waitcnt lgkmcnt(2)
  v_mfma_f32_16x16x32_bf16 v[56:59], v[64:67], v[96:99], 0
  v_mfma_f32_16x16x32_bf16 v[56:59], v[68:71], v[100:103], v[56:59]
  global_store_dwordx2 v20, v[112:113], s[46:47] sc1
  v_mfma_f32_16x16x32_bf16 v[56:59], v[72:75], v[104:107], v[56:59]
  v_mfma_f32_16x16x32_bf16 v[56:59], v[76:79], v[108:111], v[56:59]
  s_waitcnt lgkmcnt(0)
  s_barrier
  ds_read_b128 v[64:67], v0 offset:0
  ds_read_b128 v[68:71], v0 offset:64
  ds_read_b128 v[72:75], v0 offset:128
  ds_read_b128 v[76:79], v0 offset:192
  v_mfma_f32_16x16x32_bf16 v[60:63], v[80:83], v[96:99], 0
  v_mfma_f32_16x16x32_bf16 v[60:63], v[84:87], v[100:103], v[60:63]
  ds_read_b128 v[80:83], v12
  ds_read_b128 v[84:87], v12 offset:1024
  v_mfma_f32_16x16x32_bf16 v[60:63], v[88:91], v[104:107], v[60:63]
  v_mfma_f32_16x16x32_bf16 v[60:63], v[92:95], v[108:111], v[60:63]
  v_smfmac_f32_16x16x64_bf16 v[124:127], v[28:31], a[200:207], v1
  v_smfmac_f32_16x16x64_bf16 v[120:123], v[32:35], a[144:151], v1
  v_smfmac_f32_16x16x64_bf16 v[124:127], v[32:35], a[208:215], v1
  s_waitcnt lgkmcnt(2)
  v_mfma_f32_16x16x32_bf16 v[112:115], v[64:67], v[96:99], 0
  v_mfma_f32_16x16x32_bf16 v[112:115], v[68:71], v[100:103], v[112:115]
  v_mfma_f32_16x16x32_bf16 v[112:115], v[72:75], v[104:107], v[112:115]
  v_mfma_f32_16x16x32_bf16 v[112:115], v[76:79], v[108:111], v[112:115]
  v_smfmac_f32_16x16x64_bf16 v[120:123], v[36:39], a[152:159], v1
  v_smfmac_f32_16x16x64_bf16 v[124:127], v[36:39], a[216:223], v1
  v_max3_f32 v22, v56, v57, v58
  v_max3_f32 v23, v59, v60, v61
  v_smfmac_f32_16x16x64_bf16 v[120:123], v[40:43], a[160:167], v1
  v_max3_f32 v22, v22, v62, v63
  v_smfmac_f32_16x16x64_bf16 v[124:127], v[40:43], a[224:231], v1
  v_max_f32 v22, v22, v23
  v_smfmac_f32_16x16x64_bf16 v[120:123], v[44:47], a[168:175], v1
  s_waitcnt lgkmcnt(0)
  s_mov_b32 m0, s61
  v_max3_f32 v23, v112, v113, v114
  v_max3_f32 v22, v22, v23, v115
  v_mov_b32 v23, v22
  v_smfmac_f32_16x16x64_bf16 v[124:127], v[44:47], a[232:239], v1
  global_load_lds_dwordx4 v13, s[26:27] sc1
  v_permlane16_swap_b32 v22, v23
  v_max_f32 v22, v22, v23
  v_mov_b32 v23, v22
  v_smfmac_f32_16x16x64_bf16 v[120:123], v[48:51], a[176:183], v1
  global_load_lds_dwordx4 v13, s[26:27] offset:1024 sc1
  v_permlane32_swap_b32 v22, v23
  v_smfmac_f32_16x16x64_bf16 v[124:127], v[48:51], a[240:247], v1
  v_max_f32 v22, v22, v23
  v_smfmac_f32_16x16x64_bf16 v[120:123], v[52:55], a[184:191], v1
  v_smfmac_f32_16x16x64_bf16 v[124:127], v[52:55], a[248:255], v1
  v_mul_f32 v22, s54, v22
  v_pk_fma_f32 v[56:57], v[56:57], s[54:55], v[22:23] op_sel_hi:[1,1,0] neg_lo:[0,0,1] neg_hi:[0,0,1]
  v_pk_fma_f32 v[58:59], v[58:59], s[54:55], v[22:23] op_sel_hi:[1,1,0] neg_lo:[0,0,1] neg_hi:[0,0,1]
  v_pk_fma_f32 v[60:61], v[60:61], s[54:55], v[22:23] op_sel_hi:[1,1,0] neg_lo:[0,0,1] neg_hi:[0,0,1]
  v_pk_fma_f32 v[62:63], v[62:63], s[54:55], v[22:23] op_sel_hi:[1,1,0] neg_lo:[0,0,1] neg_hi:[0,0,1]
  v_pk_fma_f32 v[112:113], v[112:113], s[54:55], v[22:23] op_sel_hi:[1,1,0] neg_lo:[0,0,1] neg_hi:[0,0,1]
  v_pk_fma_f32 v[114:115], v[114:115], s[54:55], v[22:23] op_sel_hi:[1,1,0] neg_lo:[0,0,1] neg_hi:[0,0,1]
  v_exp_f32 v56, v56
  v_exp_f32 v57, v57
  v_exp_f32 v58, v58
  v_exp_f32 v59, v59
  v_exp_f32 v60, v60
  v_exp_f32 v61, v61
  v_exp_f32 v62, v62
  v_exp_f32 v63, v63
  v_exp_f32 v112, v112
  v_exp_f32 v113, v113
  v_exp_f32 v114, v114
  v_exp_f32 v115, v115
  v_cvt_pk_bf16_f32 v96, v56, v57
  v_cvt_pk_bf16_f32 v97, v58, v59
  v_cvt_pk_bf16_f32 v98, v60, v61
  v_cvt_pk_bf16_f32 v99, v62, v63
  v_cvt_pk_bf16_f32 v116, v120, v121
  v_cvt_pk_bf16_f32 v117, v122, v123
  s_waitcnt lgkmcnt(0)
  v_mfma_f32_16x16x32_bf16 v[104:107], v[80:83], v[96:99], 0
  v_mfma_f32_16x16x32_bf16 v[108:111], v[84:87], v[96:99], 0
  v_cvt_pk_bf16_f32 v100, v112, v113
  v_cvt_pk_bf16_f32 v101, v114, v115
  v_cvt_pk_bf16_f32 v118, v124, v125
  v_cvt_pk_bf16_f32 v119, v126, v127
  v_pk_add_f32 v[56:57], v[56:57], v[58:59]
  v_mfma_f32_16x16x16_bf16 v[104:107], v[116:117], v[100:101], v[104:107]
  v_mfma_f32_16x16x16_bf16 v[108:111], v[118:119], v[100:101], v[108:111]
  v_pk_add_f32 v[112:113], v[112:113], v[114:115]
  v_pk_add_f32 v[60:61], v[60:61], v[62:63]
  v_add_f32 v112, v112, v113
  v_pk_add_f32 v[56:57], v[56:57], v[60:61]
  v_add_f32 v56, v56, v57
  v_fma_f32 v22, v112, 0.5, v56
  v_mov_b32 v23, v22
  s_nop 1
  v_permlane16_swap_b32 v22, v23
  v_add_f32 v22, v22, v23
  v_mov_b32 v23, v22
  s_nop 1
  v_permlane32_swap_b32 v22, v23
  v_add_f32 v22, v22, v23
  v_rcp_f32 v22, v22
  s_mov_b32 exec_lo, 0x00ff00ff
  v_pk_mul_f32 v[104:105], v[104:105], v[22:23] op_sel_hi:[1,0]
  v_pk_mul_f32 v[106:107], v[106:107], v[22:23] op_sel_hi:[1,0]
  v_pk_mul_f32 v[108:109], v[108:109], v[22:23] op_sel_hi:[1,0]
  v_pk_mul_f32 v[110:111], v[110:111], v[22:23] op_sel_hi:[1,0]
  s_mov_b32 exec_hi, 0x00ff00ff
  v_cvt_pk_bf16_f32 v104, v104, v105
  v_cvt_pk_bf16_f32 v105, v106, v107
  v_cvt_pk_bf16_f32 v106, v108, v109
  v_cvt_pk_bf16_f32 v107, v110, v111
  ds_write_b128 v16, v[104:107]
  s_mov_b64 exec, -1
  global_store_dwordx4 v21, v[116:119], s[48:49] sc1
  ds_read_b128 v[64:67], v18 offset:20480
  ds_read_b128 v[68:71], v18 offset:21504
  ds_read_b128 v[72:75], v18 offset:22528
  ds_read_b128 v[76:79], v18 offset:23552
  s_waitcnt lgkmcnt(4)
  s_barrier
  ds_read_b128 v[80:83], v17
  ds_read_b128 v[84:87], v17 offset:128
  ds_read_b128 v[88:91], v18 offset:24576
  ds_read_b128 v[92:95], v18 offset:25600
  v_mov_b64 v[24:25], 0
  v_mov_b64 v[26:27], 0
  v_mov_b64 v[28:29], 0
  v_mov_b64 v[30:31], 0
  v_mov_b64 v[32:33], 0
  v_mov_b64 v[34:35], 0
  v_mov_b64 v[36:37], 0
  v_mov_b64 v[38:39], 0
  v_mov_b64 v[40:41], 0
  v_mov_b64 v[42:43], 0
  v_mov_b64 v[44:45], 0
  v_mov_b64 v[46:47], 0
  v_mov_b64 v[48:49], 0
  v_mov_b64 v[50:51], 0
  v_mov_b64 v[52:53], 0
  v_mov_b64 v[54:55], 0
  s_waitcnt lgkmcnt(2)
  v_smfmac_f32_16x16x64_bf16 v[24:27], v[80:83], v[128:135], v1
  ds_read_b128 v[120:123], v18 offset:26624
  v_smfmac_f32_16x16x64_bf16 v[24:27], v[84:87], v[136:143], v1
  ds_read_b128 v[124:127], v18 offset:27648
  v_smfmac_f32_16x16x64_bf16 v[28:31], v[80:83], v[144:151], v1
  ds_read_b128 v[56:59], v18 offset:28672
  v_smfmac_f32_16x16x64_bf16 v[28:31], v[84:87], v[152:159], v1
  ds_read_b128 v[60:63], v18 offset:29696
  v_smfmac_f32_16x16x64_bf16 v[32:35], v[80:83], v[160:167], v1
  ds_read_b128 v[96:99], v18 offset:30720
  v_smfmac_f32_16x16x64_bf16 v[32:35], v[84:87], v[168:175], v1
  ds_read_b128 v[100:103], v18 offset:31744
  v_smfmac_f32_16x16x64_bf16 v[36:39], v[80:83], v[176:183], v1
  v_smfmac_f32_16x16x64_bf16 v[36:39], v[84:87], v[184:191], v1
  v_smfmac_f32_16x16x64_bf16 v[40:43], v[80:83], v[192:199], v1
  v_smfmac_f32_16x16x64_bf16 v[40:43], v[84:87], v[200:207], v1
  s_waitcnt lgkmcnt(0)
  v_smfmac_f32_16x16x64_bf16 v[44:47], v[80:83], v[64:71], v1
  v_pk_add_f32 v[24:25], v[24:25], v[26:27]
  v_pk_add_f32 v[28:29], v[28:29], v[30:31]
  v_pk_add_f32 v[32:33], v[32:33], v[34:35]
  v_pk_add_f32 v[36:37], v[36:37], v[38:39]
  v_smfmac_f32_16x16x64_bf16 v[44:47], v[84:87], v[72:79], v1
  v_cvt_pk_bf16_f32 v24, v24, v25
  v_cvt_pk_bf16_f32 v25, v28, v29
  v_cvt_pk_bf16_f32 v26, v32, v33
  v_cvt_pk_bf16_f32 v27, v36, v37
  v_smfmac_f32_16x16x64_bf16 v[48:51], v[80:83], v[88:95], v1
  v_bfi_b32 v24, 1, s51, v24
  global_store_dwordx4 v14, v[24:27], s[28:29]
  v_smfmac_f32_16x16x64_bf16 v[48:51], v[84:87], v[120:127], v1
  v_pk_add_f32 v[40:41], v[40:41], v[42:43]
  v_cvt_pk_bf16_f32 v40, v40, v41
  v_smfmac_f32_16x16x64_bf16 v[52:55], v[80:83], v[56:63], v1
  v_pk_add_f32 v[44:45], v[44:45], v[46:47]
  v_cvt_pk_bf16_f32 v41, v44, v45
  v_smfmac_f32_16x16x64_bf16 v[52:55], v[84:87], v[96:103], v1
  v_pk_add_f32 v[48:49], v[48:49], v[50:51]
  v_cvt_pk_bf16_f32 v42, v48, v49
  s_nop 5
  v_pk_add_f32 v[52:53], v[52:53], v[54:55]
  v_cvt_pk_bf16_f32 v43, v52, v53
  v_bfi_b32 v40, 1, s51, v40
  global_store_dwordx4 v14, v[40:43], s[30:31]
  s_add_u32 s46, s46, 65536
  s_addc_u32 s47, s47, 0
  s_add_u32 s48, s48, 131072
  s_addc_u32 s49, s49, 0
  s_add_u32 s24, s24, 262144
  s_addc_u32 s25, s25, 0
  s_add_u32 s26, s26, 262144
  s_addc_u32 s27, s27, 0
  s_branch Lchain_loop_53
Lchain_last_70:
  ds_read_b128 v[24:27], v2 offset:0
  ds_read_b128 v[28:31], v2 offset:128
  ds_read_b128 v[32:35], v2 offset:256
  ds_read_b128 v[36:39], v2 offset:384
  ds_read_b128 v[40:43], v2 offset:512
  ds_read_b128 v[44:47], v2 offset:640
  ds_read_b128 v[48:51], v2 offset:768
  ds_read_b128 v[52:55], v2 offset:896
  v_mov_b64 v[112:113], 0
  v_mov_b64 v[120:121], 0
  v_mov_b64 v[114:115], 0
  v_mov_b64 v[122:123], 0
  v_mov_b64 v[116:117], 0
  v_mov_b64 v[124:125], 0
  v_mov_b64 v[118:119], 0
  v_mov_b64 v[126:127], 0
  s_waitcnt lgkmcnt(7)
  v_smfmac_f32_16x16x64_bf16 v[112:115], v[24:27], a[0:7], v1
  v_smfmac_f32_16x16x64_bf16 v[116:119], v[24:27], a[64:71], v1
  s_waitcnt lgkmcnt(6)
  v_smfmac_f32_16x16x64_bf16 v[112:115], v[28:31], a[8:15], v1
  v_smfmac_f32_16x16x64_bf16 v[116:119], v[28:31], a[72:79], v1
  s_waitcnt lgkmcnt(5)
  v_smfmac_f32_16x16x64_bf16 v[112:115], v[32:35], a[16:23], v1
  v_smfmac_f32_16x16x64_bf16 v[116:119], v[32:35], a[80:87], v1
  s_waitcnt lgkmcnt(4)
  v_smfmac_f32_16x16x64_bf16 v[112:115], v[36:39], a[24:31], v1
  v_smfmac_f32_16x16x64_bf16 v[116:119], v[36:39], a[88:95], v1
  s_waitcnt lgkmcnt(3)
  v_smfmac_f32_16x16x64_bf16 v[112:115], v[40:43], a[32:39], v1
  v_smfmac_f32_16x16x64_bf16 v[116:119], v[40:43], a[96:103], v1
  s_waitcnt lgkmcnt(2)
  v_smfmac_f32_16x16x64_bf16 v[112:115], v[44:47], a[40:47], v1
  v_smfmac_f32_16x16x64_bf16 v[116:119], v[44:47], a[104:111], v1
  s_waitcnt lgkmcnt(1)
  v_smfmac_f32_16x16x64_bf16 v[112:115], v[48:51], a[48:55], v1
  v_smfmac_f32_16x16x64_bf16 v[116:119], v[48:51], a[112:119], v1
  s_waitcnt lgkmcnt(0)
  v_smfmac_f32_16x16x64_bf16 v[112:115], v[52:55], a[56:63], v1
  v_smfmac_f32_16x16x64_bf16 v[116:119], v[52:55], a[120:127], v1
  v_smfmac_f32_16x16x64_bf16 v[120:123], v[24:27], a[128:135], v1
  v_smfmac_f32_16x16x64_bf16 v[124:127], v[24:27], a[192:199], v1
  v_smfmac_f32_16x16x64_bf16 v[120:123], v[28:31], a[136:143], v1
  v_pk_add_f32 v[112:113], v[112:113], v[114:115]
  v_pk_add_f32 v[116:117], v[116:117], v[118:119]
  v_cvt_pk_bf16_f32 v112, v112, v116
  v_cvt_pk_bf16_f32 v113, v113, v117
  global_store_dwordx2 v20, v[112:113], s[46:47] sc1
  v_smfmac_f32_16x16x64_bf16 v[124:127], v[28:31], a[200:207], v1
  v_smfmac_f32_16x16x64_bf16 v[120:123], v[32:35], a[144:151], v1
  v_smfmac_f32_16x16x64_bf16 v[124:127], v[32:35], a[208:215], v1
  v_smfmac_f32_16x16x64_bf16 v[120:123], v[36:39], a[152:159], v1
  v_smfmac_f32_16x16x64_bf16 v[124:127], v[36:39], a[216:223], v1
  v_smfmac_f32_16x16x64_bf16 v[120:123], v[40:43], a[160:167], v1
  v_smfmac_f32_16x16x64_bf16 v[124:127], v[40:43], a[224:231], v1
  v_smfmac_f32_16x16x64_bf16 v[120:123], v[44:47], a[168:175], v1
  v_smfmac_f32_16x16x64_bf16 v[124:127], v[44:47], a[232:239], v1
  v_smfmac_f32_16x16x64_bf16 v[120:123], v[48:51], a[176:183], v1
  v_smfmac_f32_16x16x64_bf16 v[124:127], v[48:51], a[240:247], v1
  v_smfmac_f32_16x16x64_bf16 v[120:123], v[52:55], a[184:191], v1
  v_smfmac_f32_16x16x64_bf16 v[124:127], v[52:55], a[248:255], v1
  s_nop 7
  v_cvt_pk_bf16_f32 v116, v120, v121
  v_cvt_pk_bf16_f32 v117, v122, v123
  v_cvt_pk_bf16_f32 v118, v124, v125
  v_cvt_pk_bf16_f32 v119, v126, v127
Lchain_end_54:
  global_store_dwordx4 v21, v[116:119], s[48:49] sc1
  s_waitcnt vmcnt(0)
  s_add_u32 s13, s50, 1
  s_add_u32 s13, s13, s98
  v_mov_b32 v22, s13
  v_mov_b32 v23, s99
  s_mov_b64 exec, 1
  global_store_dwordx2 v4, v[22:23], s[52:53] sc1
  s_mov_b64 exec, -1
  s_branch Lmain_exit_1
Lchain_slow_52:
  ds_read_b128 v[64:67], v18 offset:4096
  ds_read_b128 v[68:71], v18 offset:5120
  ds_read_b128 v[72:75], v18 offset:6144
  ds_read_b128 v[76:79], v18 offset:7168
  ds_read_b128 v[80:83], v18 offset:8192
  ds_read_b128 v[84:87], v18 offset:9216
  ds_read_b128 v[88:91], v18 offset:10240
  ds_read_b128 v[92:95], v18 offset:11264
  ds_read_b128 v[96:99], v18 offset:12288
  ds_read_b128 v[100:103], v18 offset:13312
  ds_read_b128 v[104:107], v18 offset:14336
  ds_read_b128 v[108:111], v18 offset:15360
  ds_read_b128 v[112:115], v18 offset:16384
  ds_read_b128 v[116:119], v18 offset:17408
  ds_read_b128 v[120:123], v18 offset:18432
  ds_read_b128 v[124:127], v18 offset:19456
  ds_read_b128 v[40:43], v18 offset:0
  ds_read_b128 v[44:47], v18 offset:1024
  ds_read_b128 v[48:51], v18 offset:2048
  ds_read_b128 v[52:55], v18 offset:3072
  v_mov_b64 v[56:57], 0
  v_mov_b64 v[58:59], 0
  v_mov_b64 v[60:61], 0
  v_mov_b64 v[62:63], 0
  s_branch Lchain_first_74
.p2align 6
Lchain_loop_72:
  s_cmp_ge_u32 s10, 2
  s_cbranch_scc1 Lnocons_75
  s_sleep 4
  global_load_dwordx4 v[64:67], v19, s[32:33] offset:0 sc1
  global_load_dwordx4 v[68:71], v19, s[32:33] offset:2048 sc1
  global_load_dwordx4 v[72:75], v19, s[34:35] offset:0 sc1
  global_load_dwordx4 v[76:79], v19, s[34:35] offset:2048 sc1
  s_nop 15
  s_nop 3
  global_load_dwordx4 v[80:83], v19, s[32:33] offset:0 sc1
  global_load_dwordx4 v[84:87], v19, s[32:33] offset:2048 sc1
  global_load_dwordx4 v[88:91], v19, s[34:35] offset:0 sc1
  global_load_dwordx4 v[92:95], v19, s[34:35] offset:2048 sc1
Lp1_poll_77:
  s_waitcnt vmcnt(7)
  v_mfma_f32_16x16x32_bf16 v[56:59], v[64:67], v[8:11], 0
  v_xor_b32 v22, s51, v64
  s_waitcnt vmcnt(6)
  v_mfma_f32_16x16x32_bf16 v[56:59], v[68:71], v[8:11], v[56:59]
  v_xor_b32 v23, s51, v68
  v_or_b32 v22, v22, v23
  s_waitcnt vmcnt(5)
  v_mfma_f32_16x16x32_bf16 v[56:59], v[72:75], v[8:11], v[56:59]
  v_xor_b32 v23, s51, v72
  v_or_b32 v22, v22, v23
  s_waitcnt vmcnt(4)
  v_mfma_f32_16x16x32_bf16 v[56:59], v[76:79], v[8:11], v[56:59]
  v_xor_b32 v23, s51, v76
  v_or_b32 v22, v22, v23
  v_and_b32 v22, 1, v22
  v_cmp_ne_u32 vcc, 0, v22
  s_cbranch_vccz Lp1_doneA_78
  global_load_dwordx4 v[64:67], v19, s[32:33] offset:0 sc1
  global_load_dwordx4 v[68:71], v19, s[32:33] offset:2048 sc1
  global_load_dwordx4 v[72:75], v19, s[34:35] offset:0 sc1
  global_load_dwordx4 v[76:79], v19, s[34:35] offset:2048 sc1
  s_waitcnt vmcnt(7)
  v_mfma_f32_16x16x32_bf16 v[60:63], v[80:83], v[8:11], 0
  v_xor_b32 v22, s51, v80
  s_waitcnt vmcnt(6)
  v_mfma_f32_16x16x32_bf16 v[60:63], v[84:87], v[8:11], v[60:63]
  v_xor_b32 v23, s51, v84
  v_or_b32 v22, v22, v23
  s_waitcnt vmcnt(5)
  v_mfma_f32_16x16x32_bf16 v[60:63], v[88:91], v[8:11], v[60:63]
  v_xor_b32 v23, s51, v88
  v_or_b32 v22, v22, v23
  s_waitcnt vmcnt(4)
  v_mfma_f32_16x16x32_bf16 v[60:63], v[92:95], v[8:11], v[60:63]
  v_xor_b32 v23, s51, v92
  v_or_b32 v22, v22, v23
  v_and_b32 v22, 1, v22
  v_cmp_ne_u32 vcc, 0, v22
  s_cbranch_vccz Lp1_doneB_79
  global_load_dwordx4 v[80:83], v19, s[32:33] offset:0 sc1
  global_load_dwordx4 v[84:87], v19, s[32:33] offset:2048 sc1
  global_load_dwordx4 v[88:91], v19, s[34:35] offset:0 sc1
  global_load_dwordx4 v[92:95], v19, s[34:35] offset:2048 sc1
  s_cmp_eq_u32 s12, 0
  s_cbranch_scc1 Lp1_doneA_78
  s_sub_u32 s12, s12, 1
  s_branch Lp1_poll_77
Lp1_doneB_79:
  s_nop 3
  v_mov_b32 v56, v60
  v_mov_b32 v57, v61
  v_mov_b32 v58, v62
  v_mov_b32 v59, v63
  s_branch Lp1_tail_80
Lp1_doneA_78:
  s_nop 3
Lp1_tail_80:
  s_nop 1
  v_permlane32_swap_b32 v56, v58
  v_permlane32_swap_b32 v57, v59
  s_mov_b32 exec_lo, 0x00ff00ff
  v_pk_add_f32 v[56:57], v[56:57], v[58:59]
  s_mov_b32 exec_hi, 0x00ff00ff
  v_cvt_pk_bf16_f32 v56, v56, v57
  v_mov_b32 v22, -1
  v_min_u32 v56, -2, v56
  global_store_dword v15, v56, s[42:43] sc1
  global_store_dword v15, v22, s[40:41] sc1
  s_mov_b64 exec, -1
  s_waitcnt vmcnt(2)
  ds_read_b128 v[64:67], v18 offset:4096
  ds_read_b128 v[68:71], v18 offset:5120
  ds_read_b128 v[72:75], v18 offset:6144
  ds_read_b128 v[76:79], v18 offset:7168
  ds_read_b128 v[80:83], v18 offset:8192
  ds_read_b128 v[84:87], v18 offset:9216
  ds_read_b128 v[88:91], v18 offset:10240
  ds_read_b128 v[92:95], v18 offset:11264
  ds_read_b128 v[96:99], v18 offset:12288
  ds_read_b128 v[100:103], v18 offset:13312
  ds_read_b128 v[104:107], v18 offset:14336
  ds_read_b128 v[108:111], v18 offset:15360
  ds_read_b128 v[112:115], v18 offset:16384
  ds_read_b128 v[116:119], v18 offset:17408
  ds_read_b128 v[120:123], v18 offset:18432
  ds_read_b128 v[124:127], v18 offset:19456
  ds_read_b128 v[40:43], v18 offset:0
  ds_read_b128 v[44:47], v18 offset:1024
  ds_read_b128 v[48:51], v18 offset:2048
  ds_read_b128 v[52:55], v18 offset:3072
  s_nop 11
  s_branch Lhopjoin_76
Lnocons_75:
  ds_read_b128 v[64:67], v18 offset:4096
  ds_read_b128 v[68:71], v18 offset:5120
  ds_read_b128 v[72:75], v18 offset:6144
  ds_read_b128 v[76:79], v18 offset:7168
  ds_read_b128 v[80:83], v18 offset:8192
  ds_read_b128 v[84:87], v18 offset:9216
  ds_read_b128 v[88:91], v18 offset:10240
  ds_read_b128 v[92:95], v18 offset:11264
  ds_read_b128 v[96:99], v18 offset:12288
  ds_read_b128 v[100:103], v18 offset:13312
  ds_read_b128 v[104:107], v18 offset:14336
  ds_read_b128 v[108:111], v18 offset:15360
  ds_read_b128 v[112:115], v18 offset:16384
  ds_read_b128 v[116:119], v18 offset:17408
  ds_read_b128 v[120:123], v18 offset:18432
  ds_read_b128 v[124:127], v18 offset:19456
  ds_read_b128 v[40:43], v18 offset:0
  ds_read_b128 v[44:47], v18 offset:1024
  ds_read_b128 v[48:51], v18 offset:2048
  ds_read_b128 v[52:55], v18 offset:3072
  s_cmp_lg_u32 s38, s50
  s_cbranch_scc1 Lkvskip_81
  s_waitcnt vmcnt(0)
  v_subrev_u32 v8, s98, v8
  v_xor_b32 v9, s99, v9
  v_subrev_u32 v8, 1, v8
  v_lshrrev_b32 v8, 7, v8
  v_or_b32 v8, v8, v9
  v_cmp_ne_u32 vcc, 0, v8
  s_and_b32 s13, vcc_lo, 3
  s_lshr_b32 s15, s50, 2
  s_add_u32 s15, s15, 1
  s_add_u32 s38, s38, 4
  s_cmp_ge_u32 s38, 60
  s_cselect_b32 s38, 0xffff, s38
  s_add_u32 s36, s36, 512
  s_addc_u32 s37, s37, 0
  s_cmp_eq_u32 s13, 0
  s_cbranch_scc1 Lkvskip_81
  s_lshl_b32 s13, s15, 9
  s_lshl_b32 s14, s9, 4
  s_add_u32 s13, s13, s14
  s_add_u32 s13, s13, 94375936
  v_bfe_u32 v62, v4, 4, 1
  v_lshlrev_b32 v62, 13, v62
  v_add_u32 v62, s13, v62
Lwf_p_82:
  global_load_dwordx2 v[22:23], v62, s[4:5] sc1
  s_waitcnt vmcnt(0)
  v_subrev_u32 v22, s98, v22
  v_xor_b32 v23, s99, v23
  v_subrev_u32 v22, 1, v22
  v_lshrrev_b32 v22, 7, v22
  v_or_b32 v22, v22, v23
  v_cmp_ne_u32 vcc, 0, v22
  s_cbranch_vccz Lwf_d_83
  s_sleep 4
  s_cmp_eq_u32 s12, 0
  s_cbranch_scc1 Lwf_d_83
  s_sub_u32 s12, s12, 1
  s_branch Lwf_p_82
Lwf_d_83:
Lkvskip_81:
  s_sleep 10
  s_nop 7
Lhopjoin_76:
  s_mov_b64 s[14:15], s[40:41]
  s_mov_b64 s[40:41], s[42:43]
  s_mov_b64 s[42:43], s[44:45]
  s_mov_b64 s[44:45], s[14:15]
  s_add_u32 s50, s50, 1
  s_xor_b32 s51, s51, 1
  v_mov_b64 v[56:57], 0
  v_mov_b64 v[58:59], 0
  v_mov_b64 v[60:61], 0
  v_mov_b64 v[62:63], 0
  s_lshl_b32 s13, s10, 11
  s_add_u32 s14, s40, s13
  s_addc_u32 s15, s41, 0
Lm_poll_84:
  global_load_dwordx4 v[24:27], v4, s[14:15] sc1
  global_load_dwordx4 v[28:31], v4, s[14:15] offset:1024 sc1
  s_waitcnt vmcnt(0)
  v_max3_u32 v22, v24, v25, v26
  v_max3_u32 v23, v27, v28, v29
  v_max3_u32 v22, v22, v30, v31
  v_max_u32 v22, v22, v23
  v_cmp_eq_u32 vcc, -1, v22
  s_cbranch_vccz Lm_doneA_85
  s_cmp_eq_u32 s12, 0
  s_cbranch_scc1 Lm_doneA_85
  s_sub_u32 s12, s12, 1
  s_branch Lm_poll_84
Lm_doneA_85:
  ds_write_b128 v3, v[24:27]
  ds_write_b128 v3, v[28:31] offset:1088
  s_add_u32 s13, s98, s50
  v_mov_b32 v22, s13
  v_mov_b32 v23, s99
  s_mov_b64 exec, 1
  global_store_dwordx2 v4, v[22:23], s[52:53] sc1
  s_mov_b64 exec, -1
  s_waitcnt vmcnt(1)
Lchain_first_74:
  s_waitcnt lgkmcnt(0)
  s_barrier
  s_cmp_eq_u32 s50, 63
  s_cbranch_scc1 Lchain_last_89
  ds_read_b128 v[24:27], v2 offset:0
  ds_read_b128 v[28:31], v2 offset:128
  ds_read_b128 v[32:35], v2 offset:256
  ds_read_b128 v[36:39], v2 offset:384
  s_cmp_lg_u32 s38, s50
  s_cbranch_scc1 Lkvf_90
  s_mov_b64 exec, 3
  global_load_dwordx2 v[8:9], v19, s[36:37] sc1
  s_mov_b64 exec, -1
Lkvf_90:
  s_waitcnt lgkmcnt(3)
  v_smfmac_f32_16x16x64_bf16 v[56:59], v[24:27], v[40:47], v1
  v_smfmac_f32_16x16x64_bf16 v[60:63], v[24:27], v[48:55], v1
  ds_read_b128 v[40:43], v2 offset:512
  ds_read_b128 v[44:47], v2 offset:640
  ds_read_b128 v[48:51], v2 offset:768
  ds_read_b128 v[52:55], v2 offset:896
  s_waitcnt lgkmcnt(4)
  v_smfmac_f32_16x16x64_bf16 v[56:59], v[28:31], v[64:71], v1
  v_smfmac_f32_16x16x64_bf16 v[60:63], v[28:31], v[72:79], v1
  ds_read_b128 v[64:67], v7 offset:0
  v_smfmac_f32_16x16x64_bf16 v[56:59], v[32:35], v[80:87], v1
  ds_read_b128 v[68:71], v7 offset:1024
  v_smfmac_f32_16x16x64_bf16 v[60:63], v[32:35], v[88:95], v1
  ds_read_b128 v[72:75], v7 offset:2048
  v_smfmac_f32_16x16x64_bf16 v[56:59], v[36:39], v[96:103], v1
  ds_read_b128 v[76:79], v7 offset:3072
  v_smfmac_f32_16x16x64_bf16 v[60:63], v[36:39], v[104:111], v1
  ds_read_b128 v[80:83], v7 offset:4096
  s_waitcnt lgkmcnt(5)
  v_smfmac_f32_16x16x64_bf16 v[56:59], v[40:43], v[112:119], v1
  ds_read_b128 v[84:87], v7 offset:5120
  v_smfmac_f32_16x16x64_bf16 v[60:63], v[40:43], v[120:127], v1
  ds_read_b128 v[88:91], v7 offset:6144
  v_smfmac_f32_16x16x64_bf16 v[56:59], v[44:47], v[208:215], v1
  ds_read_b128 v[92:95], v7 offset:7168
  v_smfmac_f32_16x16x64_bf16 v[60:63], v[44:47], v[216:223], v1
  v_mov_b64 v[112:113], 0
  v_mov_b64 v[114:115], 0
  v_smfmac_f32_16x16x64_bf16 v[56:59], v[48:51], v[224:231], v1
  v_mov_b64 v[116:117], 0
  v_mov_b64 v[118:119], 0
  v_smfmac_f32_16x16x64_bf16 v[60:63], v[48:51], v[232:239], v1
  v_mov_b64 v[120:121], 0
  v_mov_b64 v[122:123], 0
  v_smfmac_f32_16x16x64_bf16 v[56:59], v[52:55], v[240:247], v1
  v_mov_b64 v[124:125], 0
  v_mov_b64 v[126:127], 0
  v_smfmac_f32_16x16x64_bf16 v[60:63], v[52:55], v[248:255], v1
  v_smfmac_f32_16x16x64_bf16 v[112:115], v[24:27], a[0:7], v1
  v_smfmac_f32_16x16x64_bf16 v[116:119], v[24:27], a[64:71], v1
  v_smfmac_f32_16x16x64_bf16 v[112:115], v[28:31], a[8:15], v1
  v_pk_add_f32 v[56:57], v[56:57], v[58:59]
  v_pk_add_f32 v[60:61], v[60:61], v[62:63]
  v_cvt_pk_bf16_f32 v56, v56, v60
  v_cvt_pk_bf16_f32 v57, v57, v61
  v_smfmac_f32_16x16x64_bf16 v[116:119], v[28:31], a[72:79], v1
  ds_write_b32 v5, v56 offset:0
  ds_write_b32 v5, v57 offset:288
  v_smfmac_f32_16x16x64_bf16 v[112:115], v[32:35], a[16:23], v1
  v_smfmac_f32_16x16x64_bf16 v[116:119], v[32:35], a[80:87], v1
  v_smfmac_f32_16x16x64_bf16 v[112:115], v[36:39], a[24:31], v1
  v_smfmac_f32_16x16x64_bf16 v[116:119], v[36:39], a[88:95], v1
  v_smfmac_f32_16x16x64_bf16 v[112:115], v[40:43], a[32:39], v1
  s_waitcnt lgkmcnt(0)
  s_barrier
  v_smfmac_f32_16x16x64_bf16 v[116:119], v[40:43], a[96:103], v1
  ds_read_b128 v[96:99], v6 offset:0
  v_smfmac_f32_16x16x64_bf16 v[112:115], v[44:47], a[40:47], v1
  ds_read_b128 v[100:103], v6 offset:64
  v_smfmac_f32_16x16x64_bf16 v[116:119], v[44:47], a[104:111], v1
  ds_read_b128 v[104:107], v6 offset:128
  v_smfmac_f32_16x16x64_bf16 v[112:115], v[48:51], a[48:55], v1
  ds_read_b128 v[108:111], v6 offset:192
  s_mov_b32 m0, s60
  v_smfmac_f32_16x16x64_bf16 v[116:119], v[48:51], a[112:119], v1
  global_load_lds_dwordx4 v4, s[24:25] sc1
  v_smfmac_f32_16x16x64_bf16 v[112:115], v[52:55], a[56:63], v1
  global_load_lds_dwordx4 v4, s[24:25] offset:1024 sc1
  v_smfmac_f32_16x16x64_bf16 v[116:119], v[52:55], a[120:127], v1
  v_smfmac_f32_16x16x64_bf16 v[120:123], v[24:27], a[128:135], v1
  v_smfmac_f32_16x16x64_bf16 v[124:127], v[24:27], a[192:199], v1
  v_smfmac_f32_16x16x64_bf16 v[120:123], v[28:31], a[136:143], v1
  v_pk_add_f32 v[112:113], v[112:113], v[114:115]
  v_pk_add_f32 v[116:117], v[116:117], v[118:119]
  v_cvt_pk_bf16_f32 v112, v112, v116
  v_cvt_pk_bf16_f32 v113, v113, v117
  ds_write_b32 v5, v112 offset:2304
  ds_write_b32 v5, v113 offset:2592
  s_waitcnt lgkmcnt(2)
  v_mfma_f32_16x16x32_bf16 v[56:59], v[64:67], v[96:99], 0
  v_mfma_f32_16x16x32_bf16 v[56:59], v[68:71], v[100:103], v[56:59]
  global_store_dwordx2 v20, v[112:113], s[46:47] sc1
  v_mfma_f32_16x16x32_bf16 v[56:59], v[72:75], v[104:107], v[56:59]
  v_mfma_f32_16x16x32_bf16 v[56:59], v[76:79], v[108:111], v[56:59]
  s_waitcnt lgkmcnt(0)
  s_barrier
  ds_read_b128 v[64:67], v0 offset:0
  ds_read_b128 v[68:71], v0 offset:64
  ds_read_b128 v[72:75], v0 offset:128
  ds_read_b128 v[76:79], v0 offset:192
  v_mfma_f32_16x16x32_bf16 v[60:63], v[80:83], v[96:99], 0
  v_mfma_f32_16x16x32_bf16 v[60:63], v[84:87], v[100:103], v[60:63]
  ds_read_b128 v[80:83], v12
  ds_read_b128 v[84:87], v12 offset:1024
  v_mfma_f32_16x16x32_bf16 v[60:63], v[88:91], v[104:107], v[60:63]
  v_mfma_f32_16x16x32_bf16 v[60:63], v[92:95], v[108:111], v[60:63]
  v_smfmac_f32_16x16x64_bf16 v[124:127], v[28:31], a[200:207], v1
  v_smfmac_f32_16x16x64_bf16 v[120:123], v[32:35], a[144:151], v1
  v_smfmac_f32_16x16x64_bf16 v[124:127], v[32:35], a[208:215], v1
  s_waitcnt lgkmcnt(2)
  v_mfma_f32_16x16x32_bf16 v[112:115], v[64:67], v[96:99], 0
  v_mfma_f32_16x16x32_bf16 v[112:115], v[68:71], v[100:103], v[112:115]
  v_mfma_f32_16x16x32_bf16 v[112:115], v[72:75], v[104:107], v[112:115]
  v_mfma_f32_16x16x32_bf16 v[112:115], v[76:79], v[108:111], v[112:115]
  v_smfmac_f32_16x16x64_bf16 v[120:123], v[36:39], a[152:159], v1
  v_smfmac_f32_16x16x64_bf16 v[124:127], v[36:39], a[216:223], v1
  v_max3_f32 v22, v56, v57, v58
  v_max3_f32 v23, v59, v60, v61
  v_smfmac_f32_16x16x64_bf16 v[120:123], v[40:43], a[160:167], v1
  v_max3_f32 v22, v22, v62, v63
  v_smfmac_f32_16x16x64_bf16 v[124:127], v[40:43], a[224:231], v1
  v_max_f32 v22, v22, v23
  v_smfmac_f32_16x16x64_bf16 v[120:123], v[44:47], a[168:175], v1
  s_waitcnt lgkmcnt(0)
  s_mov_b32 m0, s61
  v_max3_f32 v23, v112, v113, v114
  v_max3_f32 v22, v22, v23, v115
  v_mov_b32 v23, v22
  v_smfmac_f32_16x16x64_bf16 v[124:127], v[44:47], a[232:239], v1
  global_load_lds_dwordx4 v13, s[26:27] sc1
  v_permlane16_swap_b32 v22, v23
  v_max_f32 v22, v22, v23
  v_mov_b32 v23, v22
  v_smfmac_f32_16x16x64_bf16 v[120:123], v[48:51], a[176:183], v1
  global_load_lds_dwordx4 v13, s[26:27] offset:1024 sc1
  v_permlane32_swap_b32 v22, v23
  v_smfmac_f32_16x16x64_bf16 v[124:127], v[48:51], a[240:247], v1
  v_max_f32 v22, v22, v23
  v_smfmac_f32_16x16x64_bf16 v[120:123], v[52:55], a[184:191], v1
  v_smfmac_f32_16x16x64_bf16 v[124:127], v[52:55], a[248:255], v1
  v_mul_f32 v22, s54, v22
  v_pk_fma_f32 v[56:57], v[56:57], s[54:55], v[22:23] op_sel_hi:[1,1,0] neg_lo:[0,0,1] neg_hi:[0,0,1]
  v_pk_fma_f32 v[58:59], v[58:59], s[54:55], v[22:23] op_sel_hi:[1,1,0] neg_lo:[0,0,1] neg_hi:[0,0,1]
  v_pk_fma_f32 v[60:61], v[60:61], s[54:55], v[22:23] op_sel_hi:[1,1,0] neg_lo:[0,0,1] neg_hi:[0,0,1]
  v_pk_fma_f32 v[62:63], v[62:63], s[54:55], v[22:23] op_sel_hi:[1,1,0] neg_lo:[0,0,1] neg_hi:[0,0,1]
  v_pk_fma_f32 v[112:113], v[112:113], s[54:55], v[22:23] op_sel_hi:[1,1,0] neg_lo:[0,0,1] neg_hi:[0,0,1]
  v_pk_fma_f32 v[114:115], v[114:115], s[54:55], v[22:23] op_sel_hi:[1,1,0] neg_lo:[0,0,1] neg_hi:[0,0,1]
  v_exp_f32 v56, v56
  v_exp_f32 v57, v57
  v_exp_f32 v58, v58
  v_exp_f32 v59, v59
  v_exp_f32 v60, v60
  v_exp_f32 v61, v61
  v_exp_f32 v62, v62
  v_exp_f32 v63, v63
  v_exp_f32 v112, v112
  v_exp_f32 v113, v113
  v_exp_f32 v114, v114
  v_exp_f32 v115, v115
  v_cvt_pk_bf16_f32 v96, v56, v57
  v_cvt_pk_bf16_f32 v97, v58, v59
  v_cvt_pk_bf16_f32 v98, v60, v61
  v_cvt_pk_bf16_f32 v99, v62, v63
  v_cvt_pk_bf16_f32 v116, v120, v121
  v_cvt_pk_bf16_f32 v117, v122, v123
  s_waitcnt lgkmcnt(0)
  v_mfma_f32_16x16x32_bf16 v[104:107], v[80:83], v[96:99], 0
  v_mfma_f32_16x16x32_bf16 v[108:111], v[84:87], v[96:99], 0
  v_cvt_pk_bf16_f32 v100, v112, v113
  v_cvt_pk_bf16_f32 v101, v114, v115
  v_cvt_pk_bf16_f32 v118, v124, v125
  v_cvt_pk_bf16_f32 v119, v126, v127
  v_pk_add_f32 v[56:57], v[56:57], v[58:59]
  v_mfma_f32_16x16x16_bf16 v[104:107], v[116:117], v[100:101], v[104:107]
  v_mfma_f32_16x16x16_bf16 v[108:111], v[118:119], v[100:101], v[108:111]
  v_pk_add_f32 v[112:113], v[112:113], v[114:115]
  v_pk_add_f32 v[60:61], v[60:61], v[62:63]
  v_add_f32 v112, v112, v113
  v_pk_add_f32 v[56:57], v[56:57], v[60:61]
  v_add_f32 v56, v56, v57
  v_fma_f32 v22, v112, 0.5, v56
  v_mov_b32 v23, v22
  s_nop 1
  v_permlane16_swap_b32 v22, v23
  v_add_f32 v22, v22, v23
  v_mov_b32 v23, v22
  s_nop 1
  v_permlane32_swap_b32 v22, v23
  v_add_f32 v22, v22, v23
  v_rcp_f32 v22, v22
  s_mov_b32 exec_lo, 0x00ff00ff
  v_pk_mul_f32 v[104:105], v[104:105], v[22:23] op_sel_hi:[1,0]
  v_pk_mul_f32 v[106:107], v[106:107], v[22:23] op_sel_hi:[1,0]
  v_pk_mul_f32 v[108:109], v[108:109], v[22:23] op_sel_hi:[1,0]
  v_pk_mul_f32 v[110:111], v[110:111], v[22:23] op_sel_hi:[1,0]
  s_mov_b32 exec_hi, 0x00ff00ff
  v_cvt_pk_bf16_f32 v104, v104, v105
  v_cvt_pk_bf16_f32 v105, v106, v107
  v_cvt_pk_bf16_f32 v106, v108, v109
  v_cvt_pk_bf16_f32 v107, v110, v111
  ds_write_b128 v16, v[104:107]
  s_mov_b64 exec, -1
  global_store_dwordx4 v21, v[116:119], s[48:49] sc1
  ds_read_b128 v[64:67], v18 offset:20480
  ds_read_b128 v[68:71], v18 offset:21504
  ds_read_b128 v[72:75], v18 offset:22528
  ds_read_b128 v[76:79], v18 offset:23552
  s_waitcnt lgkmcnt(4)
  s_barrier
  ds_read_b128 v[80:83], v17
  ds_read_b128 v[84:87], v17 offset:128
  ds_read_b128 v[88:91], v18 offset:24576
  ds_read_b128 v[92:95], v18 offset:25600
  v_mov_b64 v[24:25], 0
  v_mov_b64 v[26:27], 0
  v_mov_b64 v[28:29], 0
  v_mov_b64 v[30:31], 0
  v_mov_b64 v[32:33], 0
  v_mov_b64 v[34:35], 0
  v_mov_b64 v[36:37], 0
  v_mov_b64 v[38:39], 0
  v_mov_b64 v[40:41], 0
  v_mov_b64 v[42:43], 0
  v_mov_b64 v[44:45], 0
  v_mov_b64 v[46:47], 0
  v_mov_b64 v[48:49], 0
  v_mov_b64 v[50:51], 0
  v_mov_b64 v[52:53], 0
  v_mov_b64 v[54:55], 0
  s_waitcnt lgkmcnt(2)
  v_smfmac_f32_16x16x64_bf16 v[24:27], v[80:83], v[128:135], v1
  ds_read_b128 v[120:123], v18 offset:26624
  v_smfmac_f32_16x16x64_bf16 v[24:27], v[84:87], v[136:143], v1
  ds_read_b128 v[124:127], v18 offset:27648
  v_smfmac_f32_16x16x64_bf16 v[28:31], v[80:83], v[144:151], v1
  ds_read_b128 v[56:59], v18 offset:28672
  v_smfmac_f32_16x16x64_bf16 v[28:31], v[84:87], v[152:159], v1
  ds_read_b128 v[60:63], v18 offset:29696
  v_smfmac_f32_16x16x64_bf16 v[32:35], v[80:83], v[160:167], v1
  ds_read_b128 v[96:99], v18 offset:30720
  v_smfmac_f32_16x16x64_bf16 v[32:35], v[84:87], v[168:175], v1
  ds_read_b128 v[100:103], v18 offset:31744
  v_smfmac_f32_16x16x64_bf16 v[36:39], v[80:83], v[176:183], v1
  v_smfmac_f32_16x16x64_bf16 v[36:39], v[84:87], v[184:191], v1
  v_smfmac_f32_16x16x64_bf16 v[40:43], v[80:83], v[192:199], v1
  v_smfmac_f32_16x16x64_bf16 v[40:43], v[84:87], v[200:207], v1
  s_waitcnt lgkmcnt(0)
  v_smfmac_f32_16x16x64_bf16 v[44:47], v[80:83], v[64:71], v1
  v_pk_add_f32 v[24:25], v[24:25], v[26:27]
  v_pk_add_f32 v[28:29], v[28:29], v[30:31]
  v_pk_add_f32 v[32:33], v[32:33], v[34:35]
  v_pk_add_f32 v[36:37], v[36:37], v[38:39]
  v_smfmac_f32_16x16x64_bf16 v[44:47], v[84:87], v[72:79], v1
  v_cvt_pk_bf16_f32 v24, v24, v25
  v_cvt_pk_bf16_f32 v25, v28, v29
  v_cvt_pk_bf16_f32 v26, v32, v33
  v_cvt_pk_bf16_f32 v27, v36, v37
  v_smfmac_f32_16x16x64_bf16 v[48:51], v[80:83], v[88:95], v1
  v_bfi_b32 v24, 1, s51, v24
  global_store_dwordx4 v14, v[24:27], s[28:29] sc1
  v_smfmac_f32_16x16x64_bf16 v[48:51], v[84:87], v[120:127], v1
  v_pk_add_f32 v[40:41], v[40:41], v[42:43]
  v_cvt_pk_bf16_f32 v40, v40, v41
  v_smfmac_f32_16x16x64_bf16 v[52:55], v[80:83], v[56:63], v1
  v_pk_add_f32 v[44:45], v[44:45], v[46:47]
  v_cvt_pk_bf16_f32 v41, v44, v45
  v_smfmac_f32_16x16x64_bf16 v[52:55], v[84:87], v[96:103], v1
  v_pk_add_f32 v[48:49], v[48:49], v[50:51]
  v_cvt_pk_bf16_f32 v42, v48, v49
  s_nop 5
  v_pk_add_f32 v[52:53], v[52:53], v[54:55]
  v_cvt_pk_bf16_f32 v43, v52, v53
  v_bfi_b32 v40, 1, s51, v40
  global_store_dwordx4 v14, v[40:43], s[30:31] sc1
  s_add_u32 s46, s46, 65536
  s_addc_u32 s47, s47, 0
  s_add_u32 s48, s48, 131072
  s_addc_u32 s49, s49, 0
  s_add_u32 s24, s24, 262144
  s_addc_u32 s25, s25, 0
  s_add_u32 s26, s26, 262144
  s_addc_u32 s27, s27, 0
  s_branch Lchain_loop_72
Lchain_last_89:
  ds_read_b128 v[24:27], v2 offset:0
  ds_read_b128 v[28:31], v2 offset:128
  ds_read_b128 v[32:35], v2 offset:256
  ds_read_b128 v[36:39], v2 offset:384
  ds_read_b128 v[40:43], v2 offset:512
  ds_read_b128 v[44:47], v2 offset:640
  ds_read_b128 v[48:51], v2 offset:768
  ds_read_b128 v[52:55], v2 offset:896
  v_mov_b64 v[112:113], 0
  v_mov_b64 v[120:121], 0
  v_mov_b64 v[114:115], 0
  v_mov_b64 v[122:123], 0
  v_mov_b64 v[116:117], 0
  v_mov_b64 v[124:125], 0
  v_mov_b64 v[118:119], 0
  v_mov_b64 v[126:127], 0
  s_waitcnt lgkmcnt(7)
  v_smfmac_f32_16x16x64_bf16 v[112:115], v[24:27], a[0:7], v1
  v_smfmac_f32_16x16x64_bf16 v[116:119], v[24:27], a[64:71], v1
  s_waitcnt lgkmcnt(6)
  v_smfmac_f32_16x16x64_bf16 v[112:115], v[28:31], a[8:15], v1
  v_smfmac_f32_16x16x64_bf16 v[116:119], v[28:31], a[72:79], v1
  s_waitcnt lgkmcnt(5)
  v_smfmac_f32_16x16x64_bf16 v[112:115], v[32:35], a[16:23], v1
  v_smfmac_f32_16x16x64_bf16 v[116:119], v[32:35], a[80:87], v1
  s_waitcnt lgkmcnt(4)
  v_smfmac_f32_16x16x64_bf16 v[112:115], v[36:39], a[24:31], v1
  v_smfmac_f32_16x16x64_bf16 v[116:119], v[36:39], a[88:95], v1
  s_waitcnt lgkmcnt(3)
  v_smfmac_f32_16x16x64_bf16 v[112:115], v[40:43], a[32:39], v1
  v_smfmac_f32_16x16x64_bf16 v[116:119], v[40:43], a[96:103], v1
  s_waitcnt lgkmcnt(2)
  v_smfmac_f32_16x16x64_bf16 v[112:115], v[44:47], a[40:47], v1
  v_smfmac_f32_16x16x64_bf16 v[116:119], v[44:47], a[104:111], v1
  s_waitcnt lgkmcnt(1)
  v_smfmac_f32_16x16x64_bf16 v[112:115], v[48:51], a[48:55], v1
  v_smfmac_f32_16x16x64_bf16 v[116:119], v[48:51], a[112:119], v1
  s_waitcnt lgkmcnt(0)
  v_smfmac_f32_16x16x64_bf16 v[112:115], v[52:55], a[56:63], v1
  v_smfmac_f32_16x16x64_bf16 v[116:119], v[52:55], a[120:127], v1
  v_smfmac_f32_16x16x64_bf16 v[120:123], v[24:27], a[128:135], v1
  v_smfmac_f32_16x16x64_bf16 v[124:127], v[24:27], a[192:199], v1
  v_smfmac_f32_16x16x64_bf16 v[120:123], v[28:31], a[136:143], v1
  v_pk_add_f32 v[112:113], v[112:113], v[114:115]
  v_pk_add_f32 v[116:117], v[116:117], v[118:119]
  v_cvt_pk_bf16_f32 v112, v112, v116
  v_cvt_pk_bf16_f32 v113, v113, v117
  global_store_dwordx2 v20, v[112:113], s[46:47] sc1
  v_smfmac_f32_16x16x64_bf16 v[124:127], v[28:31], a[200:207], v1
  v_smfmac_f32_16x16x64_bf16 v[120:123], v[32:35], a[144:151], v1
  v_smfmac_f32_16x16x64_bf16 v[124:127], v[32:35], a[208:215], v1
  v_smfmac_f32_16x16x64_bf16 v[120:123], v[36:39], a[152:159], v1
  v_smfmac_f32_16x16x64_bf16 v[124:127], v[36:39], a[216:223], v1
  v_smfmac_f32_16x16x64_bf16 v[120:123], v[40:43], a[160:167], v1
  v_smfmac_f32_16x16x64_bf16 v[124:127], v[40:43], a[224:231], v1
  v_smfmac_f32_16x16x64_bf16 v[120:123], v[44:47], a[168:175], v1
  v_smfmac_f32_16x16x64_bf16 v[124:127], v[44:47], a[232:239], v1
  v_smfmac_f32_16x16x64_bf16 v[120:123], v[48:51], a[176:183], v1
  v_smfmac_f32_16x16x64_bf16 v[124:127], v[48:51], a[240:247], v1
  v_smfmac_f32_16x16x64_bf16 v[120:123], v[52:55], a[184:191], v1
  v_smfmac_f32_16x16x64_bf16 v[124:127], v[52:55], a[248:255], v1
  s_nop 7
  v_cvt_pk_bf16_f32 v116, v120, v121
  v_cvt_pk_bf16_f32 v117, v122, v123
  v_cvt_pk_bf16_f32 v118, v124, v125
  v_cvt_pk_bf16_f32 v119, v126, v127
Lchain_end_73:
  global_store_dwordx4 v21, v[116:119], s[48:49] sc1
  s_waitcnt vmcnt(0)
  s_add_u32 s13, s50, 1
  s_add_u32 s13, s13, s98
  v_mov_b32 v22, s13
  v_mov_b32 v23, s99
  s_mov_b64 exec, 1
  global_store_dwordx2 v4, v[22:23], s[52:53] sc1
  s_mov_b64 exec, -1
  s_branch Lmain_exit_1
Lworker_3:
  s_load_dwordx2 s[40:41], s[0:1], 16
  s_load_dwordx2 s[42:43], s[0:1], 24
  s_load_dwordx2 s[44:45], s[0:1], 32
  s_load_dwordx2 s[46:47], s[0:1], 64
  s_load_dwordx2 s[48:49], s[0:1], 72
  s_load_dwordx2 s[50:51], s[0:1], 80
  s_load_dwordx2 s[52:53], s[0:1], 88
  s_load_dwordx2 s[54:55], s[0:1], 0
  v_and_b32 v22, 63, v0
  v_and_b32 v23, 31, v0
  v_bfe_u32 v24, v0, 5, 1
  v_bfe_u32 v25, v23, 1, 3
  v_xor_b32 v25, v25, v24
  v_lshlrev_b32 v25, 4, v25
  v_lshl_add_u32 v25, v23, 7, v25
  s_lshr_b32 s13, s10, 1
  s_lshl_b32 s13, s13, 13
  v_add_u32 v25, s13, v25
  v_xor_b32 v16, 0, v25
  v_xor_b32 v17, 32, v25
  v_xor_b32 v18, 64, v25
  v_xor_b32 v19, 96, v25
  v_bfe_u32 v25, v22, 2, 2
  v_lshl_add_u32 v26, v24, 3, v25
  v_lshlrev_b32 v26, 8, v26
  s_and_b32 s13, s10, 1
  s_lshl_b32 s13, s13, 1
  v_xor_b32 v25, s13, v25
  v_lshl_add_u32 v26, v25, 6, v26
  v_bfe_u32 v25, v22, 4, 1
  v_lshl_add_u32 v26, v25, 5, v26
  v_and_b32 v25, 3, v22
  v_lshl_add_u32 v26, v25, 3, v26
  v_add_u32 v26, 49152, v26
  v_mov_b32 v20, v26
  v_xor_b32 v21, 64, v26
  s_lshl_b32 s27, s10, 12
  s_add_u32 s28, s27, 49152
  s_waitcnt lgkmcnt(0)
  s_sub_u32 s62, s8, 1
  s_mov_b32 s61, 0
  s_mov_b32 s93, 0
  s_mov_b32 s94, 96468992
  s_add_u32 s60, s62, 0
  s_sub_u32 s57, 70, s60
  s_mul_i32 s57, s57, 9363
  s_lshr_b32 s57, s57, 16
  s_lshl_b32 s59, s57, 4
  s_mov_b32 s58, 16384
  s_cmp_eq_u32 s57, 5
  s_cselect_b32 s58, 13108, s58
  s_cmp_eq_u32 s57, 9
  s_cselect_b32 s58, 7282, s58
  s_cmp_eq_u32 s57, 10
  s_cselect_b32 s58, 6554, s58
  s_mov_b32 s56, s9
  s_mov_b32 s89, 32
  s_cmp_eq_u32 s61, 1
  s_cbranch_scc1 Lf_p2_93
  s_cmp_ge_u32 s61, 3
  s_cbranch_scc1 Lf_none_94
Lf_list_91:
  s_cmp_ge_u32 s56, s59
  s_cbranch_scc1 Lf_endlist_97
  s_mul_i32 s23, s56, s58
  s_lshr_b32 s23, s23, 16
  s_mul_i32 s13, s23, s57
  s_sub_u32 s13, s56, s13
  s_mul_i32 s13, s13, 7
  s_add_u32 s13, s13, s60
  s_lshr_b32 s22, s13, 5
  s_and_b32 s24, s13, 31
  s_add_u32 s56, s56, s89
  s_mov_b32 s63, 1
  s_branch Lf_d_95
Lf_endlist_97:
  s_cmp_eq_u32 s61, 0
  s_cbranch_scc1 Lf_p1_92
  s_mov_b32 s61, 3
  s_branch Lf_none_94
Lf_p1_92:
  s_mov_b32 s61, 1
  s_lshr_b32 s23, s9, 1
  s_and_b32 s13, s9, 1
  s_lshl_b32 s24, s62, 1
  s_add_u32 s24, s24, s13
  s_mov_b32 s22, 3
  s_mov_b32 s63, 1
  s_branch Lf_d_95
Lf_p2_93:
  s_cmp_lt_u32 s62, 2
  s_cselect_b32 s13, 12, 8
  s_cmp_ge_u32 s9, s13
  s_cbranch_scc1 Lf_q_96
  s_mov_b32 s61, 3
  s_lshr_b32 s23, s9, 2
  s_mul_i32 s23, s23, 7
  s_add_u32 s23, s23, s62
  s_and_b32 s24, s9, 3
  s_mov_b32 s22, 4
  s_mov_b32 s63, 1
  s_branch Lf_d_95
Lf_q_96:
  s_mov_b32 s61, 2
  s_mov_b32 s56, s13
  s_add_u32 s60, s62, 64
  s_sub_u32 s57, 102, s60
  s_mul_i32 s57, s57, 9363
  s_lshr_b32 s57, s57, 16
  s_lshl_b32 s59, s57, 4
  s_mov_b32 s58, 16384
  s_cmp_eq_u32 s57, 5
  s_cselect_b32 s58, 13108, s58
  s_cmp_eq_u32 s57, 9
  s_cselect_b32 s58, 7282, s58
  s_cmp_eq_u32 s57, 10
  s_cselect_b32 s58, 6554, s58
  s_sub_u32 s89, 32, s56
  s_sub_u32 s56, s9, s56
  s_branch Lf_list_91
Lf_none_94:
  s_mov_b32 s63, 0
Lf_d_95:
  s_mov_b32 s25, 1024
  s_mov_b32 s26, 8192
  s_mov_b32 s20, 8
  s_lshl_b32 s36, s23, 17
  s_add_u32 s16, s4, s36
  s_addc_u32 s17, s5, 0
  s_lshl_b32 s37, s24, 8
  s_cmp_eq_u32 s22, 1
  s_cbranch_scc1 Lsetupv_98
  s_cmp_eq_u32 s22, 2
  s_cbranch_scc1 Lsetupq_99
  s_cmp_eq_u32 s22, 3
  s_cbranch_scc1 Lsetuph_100
  s_cmp_eq_u32 s22, 4
  s_cbranch_scc1 Lsetupb_101
  s_mov_b64 s[18:19], s[42:43]
  s_branch Lsetupdone_102
Lsetupv_98:
  s_mov_b64 s[18:19], s[44:45]
  s_branch Lsetupdone_102
Lsetupq_99:
  s_mov_b64 s[18:19], s[40:41]
  s_branch Lsetupdone_102
Lsetuph_100:
  s_mov_b64 s[18:19], s[46:47]
  s_mov_b32 s26, 3584
  s_add_u32 s16, s16, 2097152
  s_addc_u32 s17, s17, 0
  s_branch Lsetupdone_102
Lsetupb_101:
  s_mov_b64 s[18:19], s[50:51]
  s_mov_b32 s26, 1024
  s_mov_b32 s25, 3584
  s_mov_b32 s20, 28
  s_mul_i32 s36, s23, 458752
  s_add_u32 s36, s36, 71303168
  s_add_u32 s16, s4, s36
  s_addc_u32 s17, s5, 0
Lsetupdone_102:
  s_add_u32 s18, s18, s37
  s_addc_u32 s19, s19, 0
  s_lshl_b32 s13, s10, 5
  s_add_u32 s13, s13, 0
  v_lshrrev_b32 v25, 3, v22
  v_add_u32 v25, s13, v25
  v_bfe_u32 v26, v25, 1, 3
  v_xor_b32 v26, v26, v22
  v_and_b32 v26, 7, v26
  v_mul_lo_u32 v25, v25, s25
  v_lshl_add_u32 v25, v26, 4, v25
  v_subrev_u32 v8, 0, v25
  s_lshl_b32 s13, s10, 5
  s_add_u32 s13, s13, 8
  v_lshrrev_b32 v25, 3, v22
  v_add_u32 v25, s13, v25
  v_bfe_u32 v26, v25, 1, 3
  v_xor_b32 v26, v26, v22
  v_and_b32 v26, 7, v26
  v_mul_lo_u32 v25, v25, s25
  v_lshl_add_u32 v25, v26, 4, v25
  v_subrev_u32 v9, 1024, v25
  s_lshl_b32 s13, s10, 5
  s_add_u32 s13, s13, 16
  v_lshrrev_b32 v25, 3, v22
  v_add_u32 v25, s13, v25
  v_bfe_u32 v26, v25, 1, 3
  v_xor_b32 v26, v26, v22
  v_and_b32 v26, 7, v26
  v_mul_lo_u32 v25, v25, s25
  v_lshl_add_u32 v25, v26, 4, v25
  v_subrev_u32 v10, 2048, v25
  s_lshl_b32 s13, s10, 5
  s_add_u32 s13, s13, 24
  v_lshrrev_b32 v25, 3, v22
  v_add_u32 v25, s13, v25
  v_bfe_u32 v26, v25, 1, 3
  v_xor_b32 v26, v26, v22
  v_and_b32 v26, 7, v26
  v_mul_lo_u32 v25, v25, s25
  v_lshl_add_u32 v25, v26, 4, v25
  v_subrev_u32 v11, 3072, v25
  v_lshrrev_b32 v27, 4, v22
  v_lshlrev_b32 v26, 2, v27
  v_xor_b32 v26, v26, v22
  v_and_b32 v26, 15, v26
  v_lshlrev_b32 v26, 4, v26
  s_cmp_eq_u32 s22, 4
  s_cbranch_scc1 Lperm_103
  s_lshl_b32 s13, s10, 4
  s_add_u32 s13, s13, 0
  v_add_u32 v25, s13, v27
  v_mul_lo_u32 v25, v25, s26
  v_add_u32 v25, v25, v26
  v_subrev_u32 v12, 0, v25
  s_lshl_b32 s13, s10, 4
  s_add_u32 s13, s13, 4
  v_add_u32 v25, s13, v27
  v_mul_lo_u32 v25, v25, s26
  v_add_u32 v25, v25, v26
  v_subrev_u32 v13, 1024, v25
  s_lshl_b32 s13, s10, 4
  s_add_u32 s13, s13, 8
  v_add_u32 v25, s13, v27
  v_mul_lo_u32 v25, v25, s26
  v_add_u32 v25, v25, v26
  v_subrev_u32 v14, 2048, v25
  s_lshl_b32 s13, s10, 4
  s_add_u32 s13, s13, 12
  v_add_u32 v25, s13, v27
  v_mul_lo_u32 v25, v25, s26
  v_add_u32 v25, v25, v26
  v_subrev_u32 v15, 3072, v25
  s_branch Lpermd_104
Lperm_103:
  v_and_b32 v25, 1, v27
  v_lshlrev_b32 v25, 4, v25
  v_lshrrev_b32 v27, 1, v27
  v_add_u32 v27, v27, v25
  s_lshl_b32 s13, s10, 4
  s_add_u32 s13, s13, 0
  s_and_b32 s14, s13, 31
  s_lshr_b32 s14, s14, 1
  s_and_b32 s13, s13, 32
  s_add_u32 s13, s13, s14
  v_add_u32 v25, s13, v27
  v_mul_lo_u32 v25, v25, s26
  v_add_u32 v25, v25, v26
  v_subrev_u32 v12, 0, v25
  s_lshl_b32 s13, s10, 4
  s_add_u32 s13, s13, 4
  s_and_b32 s14, s13, 31
  s_lshr_b32 s14, s14, 1
  s_and_b32 s13, s13, 32
  s_add_u32 s13, s13, s14
  v_add_u32 v25, s13, v27
  v_mul_lo_u32 v25, v25, s26
  v_add_u32 v25, v25, v26
  v_subrev_u32 v13, 1024, v25
  s_lshl_b32 s13, s10, 4
  s_add_u32 s13, s13, 8
  s_and_b32 s14, s13, 31
  s_lshr_b32 s14, s14, 1
  s_and_b32 s13, s13, 32
  s_add_u32 s13, s13, s14
  v_add_u32 v25, s13, v27
  v_mul_lo_u32 v25, v25, s26
  v_add_u32 v25, v25, v26
  v_subrev_u32 v14, 2048, v25
  s_lshl_b32 s13, s10, 4
  s_add_u32 s13, s13, 12
  s_and_b32 s14, s13, 31
  s_lshr_b32 s14, s14, 1
  s_and_b32 s13, s13, 32
  s_add_u32 s13, s13, s14
  v_add_u32 v25, s13, v27
  v_mul_lo_u32 v25, v25, s26
  v_add_u32 v25, v25, v26
  v_subrev_u32 v15, 3072, v25
Lpermd_104:
  s_cmp_lg_u32 s10, 0
  s_cbranch_scc1 Lwx_105
  s_lshl_b32 s13, s23, 8
  s_add_u32 s13, s13, 94371840
  v_and_b32 v25, 15, v22
  v_lshlrev_b32 v25, 4, v25
  v_add_u32 v25, s13, v25
Lwf_p_106:
  global_load_dwordx2 v[26:27], v25, s[4:5] sc1
  s_waitcnt vmcnt(0)
  v_subrev_u32 v26, s98, v26
  v_xor_b32 v27, s99, v27
  v_subrev_u32 v26, 1, v26
  v_lshrrev_b32 v26, 7, v26
  v_or_b32 v26, v26, v27
  v_cmp_ne_u32 vcc, 0, v26
  s_cbranch_vccz Lwf_d_107
  s_sleep 2
  s_cmp_eq_u32 s12, 0
  s_cbranch_scc1 Lwf_d_107
  s_sub_u32 s12, s12, 1
  s_branch Lwf_p_106
Lwf_d_107:
Lwx_105:
  s_barrier
  s_mov_b32 s95, 0
  s_add_u32 m0, s27, 0
  s_nop 0
  global_load_lds_dwordx4 v8, s[16:17] offset:0
  global_load_lds_dwordx4 v9, s[16:17] offset:1024
  global_load_lds_dwordx4 v10, s[16:17] offset:2048
  global_load_lds_dwordx4 v11, s[16:17] offset:3072
  s_add_u32 s16, s16, 128
  s_addc_u32 s17, s17, 0
  s_add_u32 m0, s28, 0
  s_nop 0
  global_load_lds_dwordx4 v12, s[18:19] offset:0
  global_load_lds_dwordx4 v13, s[18:19] offset:1024
  global_load_lds_dwordx4 v14, s[18:19] offset:2048
  global_load_lds_dwordx4 v15, s[18:19] offset:3072
  s_lshl_b32 s13, s26, 6
  s_add_u32 s18, s18, s13
  s_addc_u32 s19, s19, 0
  s_add_u32 m0, s27, 16384
  s_nop 0
  global_load_lds_dwordx4 v8, s[16:17] offset:0
  global_load_lds_dwordx4 v9, s[16:17] offset:1024
  global_load_lds_dwordx4 v10, s[16:17] offset:2048
  global_load_lds_dwordx4 v11, s[16:17] offset:3072
  s_add_u32 s16, s16, 128
  s_addc_u32 s17, s17, 0
  s_add_u32 m0, s28, 16384
  s_nop 0
  global_load_lds_dwordx4 v12, s[18:19] offset:0
  global_load_lds_dwordx4 v13, s[18:19] offset:1024
  global_load_lds_dwordx4 v14, s[18:19] offset:2048
  global_load_lds_dwordx4 v15, s[18:19] offset:3072
  s_lshl_b32 s13, s26, 6
  s_add_u32 s18, s18, s13
  s_addc_u32 s19, s19, 0
  s_cmp_lg_u32 s10, 0
  s_cbranch_scc1 Lw1_xe_108
  v_lshlrev_b32 v25, 4, v22
  v_add_u32 v25, 94371840, v25
  global_load_dwordx2 v[64:65], v25, s[4:5] offset:0 sc1
  global_load_dwordx2 v[66:67], v25, s[4:5] offset:1024 sc1
  global_load_dwordx2 v[68:69], v25, s[4:5] offset:2048 sc1
  global_load_dwordx2 v[70:71], v25, s[4:5] offset:3072 sc1
Lw1_xe_108:
Lw1_loop_109:
  s_cmp_eq_u32 s22, 1
  s_cbranch_scc1 Lw1_v_110
  s_cmp_eq_u32 s22, 4
  s_cbranch_scc1 Lw1_b_111
  v_mov_b64 v[128:129], 0
  v_mov_b64 v[130:131], 0
  v_mov_b64 v[132:133], 0
  v_mov_b64 v[134:135], 0
  v_mov_b64 v[136:137], 0
  v_mov_b64 v[138:139], 0
  v_mov_b64 v[140:141], 0
  v_mov_b64 v[142:143], 0
  v_mov_b64 v[144:145], 0
  v_mov_b64 v[146:147], 0
  v_mov_b64 v[148:149], 0
  v_mov_b64 v[150:151], 0
  v_mov_b64 v[152:153], 0
  v_mov_b64 v[154:155], 0
  v_mov_b64 v[156:157], 0
  v_mov_b64 v[158:159], 0
  v_mov_b64 v[160:161], 0
  v_mov_b64 v[162:163], 0
  v_mov_b64 v[164:165], 0
  v_mov_b64 v[166:167], 0
  v_mov_b64 v[168:169], 0
  v_mov_b64 v[170:171], 0
  v_mov_b64 v[172:173], 0
  v_mov_b64 v[174:175], 0
  v_mov_b64 v[176:177], 0
  v_mov_b64 v[178:179], 0
  v_mov_b64 v[180:181], 0
  v_mov_b64 v[182:183], 0
  v_mov_b64 v[184:185], 0
  v_mov_b64 v[186:187], 0
  v_mov_b64 v[188:189], 0
  v_mov_b64 v[190:191], 0
  s_cmp_eq_u32 s93, 0
  s_cbranch_scc1 Lkp1_116
  s_waitcnt vmcnt(16)
  s_branch Lkp2_117
Lkp1_116:
  s_waitcnt vmcnt(8)
Lkp2_117:
  s_barrier
  ds_read_b128 v[32:35], v16 offset:0
  ds_read_b128 v[36:39], v16 offset:4096
  ds_read_b64_tr_b16 v[40:41], v20 offset:0
  ds_read_b64_tr_b16 v[42:43], v20 offset:1024
  ds_read_b64_tr_b16 v[44:45], v21 offset:0
  ds_read_b64_tr_b16 v[46:47], v21 offset:1024
  s_mov_b32 s21, 0
Lk_top_118:
  s_add_u32 s13, s21, 2
  s_cmp_ge_u32 s13, s20
  s_cbranch_scc1 Lk_nodma_120
  ds_read_b128 v[48:51], v17 offset:0
  ds_read_b128 v[52:55], v17 offset:4096
  ds_read_b64_tr_b16 v[56:57], v20 offset:4096
  ds_read_b64_tr_b16 v[58:59], v20 offset:5120
  ds_read_b64_tr_b16 v[60:61], v21 offset:4096
  ds_read_b64_tr_b16 v[62:63], v21 offset:5120
  s_waitcnt lgkmcnt(6)
  v_mfma_f32_32x32x16_bf16 v[128:143], v[40:43], v[32:35], v[128:143]
  v_mfma_f32_32x32x16_bf16 v[144:159], v[44:47], v[32:35], v[144:159]
  s_add_u32 m0, s27, 32768
  s_nop 0
  global_load_lds_dwordx4 v8, s[16:17] offset:0
  global_load_lds_dwordx4 v9, s[16:17] offset:1024
  v_mfma_f32_32x32x16_bf16 v[160:175], v[40:43], v[36:39], v[160:175]
  v_mfma_f32_32x32x16_bf16 v[176:191], v[44:47], v[36:39], v[176:191]
  ds_read_b128 v[32:35], v18 offset:0
  ds_read_b128 v[36:39], v18 offset:4096
  ds_read_b64_tr_b16 v[40:41], v20 offset:8192
  ds_read_b64_tr_b16 v[42:43], v20 offset:9216
  ds_read_b64_tr_b16 v[44:45], v21 offset:8192
  ds_read_b64_tr_b16 v[46:47], v21 offset:9216
  s_waitcnt lgkmcnt(6)
  v_mfma_f32_32x32x16_bf16 v[128:143], v[56:59], v[48:51], v[128:143]
  v_mfma_f32_32x32x16_bf16 v[144:159], v[60:63], v[48:51], v[144:159]
  global_load_lds_dwordx4 v10, s[16:17] offset:2048
  global_load_lds_dwordx4 v11, s[16:17] offset:3072
  s_add_u32 s16, s16, 128
  s_addc_u32 s17, s17, 0
  v_mfma_f32_32x32x16_bf16 v[160:175], v[56:59], v[52:55], v[160:175]
  v_mfma_f32_32x32x16_bf16 v[176:191], v[60:63], v[52:55], v[176:191]
  ds_read_b128 v[48:51], v19 offset:0
  ds_read_b128 v[52:55], v19 offset:4096
  ds_read_b64_tr_b16 v[56:57], v20 offset:12288
  ds_read_b64_tr_b16 v[58:59], v20 offset:13312
  ds_read_b64_tr_b16 v[60:61], v21 offset:12288
  ds_read_b64_tr_b16 v[62:63], v21 offset:13312
  s_waitcnt lgkmcnt(6)
  v_mfma_f32_32x32x16_bf16 v[128:143], v[40:43], v[32:35], v[128:143]
  v_mfma_f32_32x32x16_bf16 v[144:159], v[44:47], v[32:35], v[144:159]
  s_add_u32 m0, s28, 32768
  s_nop 0
  global_load_lds_dwordx4 v12, s[18:19] offset:0
  global_load_lds_dwordx4 v13, s[18:19] offset:1024
  v_mfma_f32_32x32x16_bf16 v[160:175], v[40:43], v[36:39], v[160:175]
  v_mfma_f32_32x32x16_bf16 v[176:191], v[44:47], v[36:39], v[176:191]
  global_load_lds_dwordx4 v14, s[18:19] offset:2048
  global_load_lds_dwordx4 v15, s[18:19] offset:3072
  s_lshl_b32 s13, s26, 6
  s_add_u32 s18, s18, s13
  s_addc_u32 s19, s19, 0
  s_branch Lk_join_121
Lk_nodma_120:
  ds_read_b128 v[48:51], v17 offset:0
  ds_read_b128 v[52:55], v17 offset:4096
  ds_read_b64_tr_b16 v[56:57], v20 offset:4096
  ds_read_b64_tr_b16 v[58:59], v20 offset:5120
  ds_read_b64_tr_b16 v[60:61], v21 offset:4096
  ds_read_b64_tr_b16 v[62:63], v21 offset:5120
  s_waitcnt lgkmcnt(6)
  v_mfma_f32_32x32x16_bf16 v[128:143], v[40:43], v[32:35], v[128:143]
  v_mfma_f32_32x32x16_bf16 v[144:159], v[44:47], v[32:35], v[144:159]
  v_mfma_f32_32x32x16_bf16 v[160:175], v[40:43], v[36:39], v[160:175]
  v_mfma_f32_32x32x16_bf16 v[176:191], v[44:47], v[36:39], v[176:191]
  ds_read_b128 v[32:35], v18 offset:0
  ds_read_b128 v[36:39], v18 offset:4096
  ds_read_b64_tr_b16 v[40:41], v20 offset:8192
  ds_read_b64_tr_b16 v[42:43], v20 offset:9216
  ds_read_b64_tr_b16 v[44:45], v21 offset:8192
  ds_read_b64_tr_b16 v[46:47], v21 offset:9216
  s_waitcnt lgkmcnt(6)
  v_mfma_f32_32x32x16_bf16 v[128:143], v[56:59], v[48:51], v[128:143]
  v_mfma_f32_32x32x16_bf16 v[144:159], v[60:63], v[48:51], v[144:159]
  v_mfma_f32_32x32x16_bf16 v[160:175], v[56:59], v[52:55], v[160:175]
  v_mfma_f32_32x32x16_bf16 v[176:191], v[60:63], v[52:55], v[176:191]
  ds_read_b128 v[48:51], v19 offset:0
  ds_read_b128 v[52:55], v19 offset:4096
  ds_read_b64_tr_b16 v[56:57], v20 offset:12288
  ds_read_b64_tr_b16 v[58:59], v20 offset:13312
  ds_read_b64_tr_b16 v[60:61], v21 offset:12288
  ds_read_b64_tr_b16 v[62:63], v21 offset:13312
  s_waitcnt lgkmcnt(6)
  v_mfma_f32_32x32x16_bf16 v[128:143], v[40:43], v[32:35], v[128:143]
  v_mfma_f32_32x32x16_bf16 v[144:159], v[44:47], v[32:35], v[144:159]
  v_mfma_f32_32x32x16_bf16 v[160:175], v[40:43], v[36:39], v[160:175]
  v_mfma_f32_32x32x16_bf16 v[176:191], v[44:47], v[36:39], v[176:191]
Lk_join_121:
  s_waitcnt lgkmcnt(0)
  s_add_u32 s21, s21, 1
  s_cmp_ge_u32 s21, s20
  s_cbranch_scc1 Lk_last_122
  s_add_u32 s13, s21, 1
  s_cmp_lt_u32 s13, s20
  s_cbranch_scc1 Lk_w0_123
  s_waitcnt vmcnt(0)
  s_branch Lk_w1_124
Lk_w0_123:
  s_cmp_eq_u32 s21, 1
  s_cselect_b32 s13, s93, 0
  s_cmp_eq_u32 s13, 0
  s_cbranch_scc1 Lk_w2_125
  s_waitcnt vmcnt(16)
  s_branch Lk_w1_124
Lk_w2_125:
  s_waitcnt vmcnt(8)
Lk_w1_124:
  s_barrier
  ds_read_b128 v[32:35], v16 offset:16384
  ds_read_b128 v[36:39], v16 offset:20480
  ds_read_b64_tr_b16 v[40:41], v20 offset:16384
  ds_read_b64_tr_b16 v[42:43], v20 offset:17408
  ds_read_b64_tr_b16 v[44:45], v21 offset:16384
  ds_read_b64_tr_b16 v[46:47], v21 offset:17408
  v_mfma_f32_32x32x16_bf16 v[128:143], v[56:59], v[48:51], v[128:143]
  v_mfma_f32_32x32x16_bf16 v[144:159], v[60:63], v[48:51], v[144:159]
  v_mfma_f32_32x32x16_bf16 v[160:175], v[56:59], v[52:55], v[160:175]
  v_mfma_f32_32x32x16_bf16 v[176:191], v[60:63], v[52:55], v[176:191]
  s_branch Lk_next_126
Lk_last_122:
  v_mfma_f32_32x32x16_bf16 v[128:143], v[56:59], v[48:51], v[128:143]
  v_mfma_f32_32x32x16_bf16 v[144:159], v[60:63], v[48:51], v[144:159]
  v_mfma_f32_32x32x16_bf16 v[160:175], v[56:59], v[52:55], v[160:175]
  v_mfma_f32_32x32x16_bf16 v[176:191], v[60:63], v[52:55], v[176:191]
  s_branch Lk_end_119
Lk_next_126:
  s_add_u32 s13, s21, 2
  s_cmp_ge_u32 s13, s20
  s_cbranch_scc1 Lk_nodma_127
  ds_read_b128 v[48:51], v17 offset:16384
  ds_read_b128 v[52:55], v17 offset:20480
  ds_read_b64_tr_b16 v[56:57], v20 offset:20480
  ds_read_b64_tr_b16 v[58:59], v20 offset:21504
  ds_read_b64_tr_b16 v[60:61], v21 offset:20480
  ds_read_b64_tr_b16 v[62:63], v21 offset:21504
  s_waitcnt lgkmcnt(6)
  v_mfma_f32_32x32x16_bf16 v[128:143], v[40:43], v[32:35], v[128:143]
  v_mfma_f32_32x32x16_bf16 v[144:159], v[44:47], v[32:35], v[144:159]
  s_add_u32 m0, s27, 0
  s_nop 0
  global_load_lds_dwordx4 v8, s[16:17] offset:0
  global_load_lds_dwordx4 v9, s[16:17] offset:1024
  v_mfma_f32_32x32x16_bf16 v[160:175], v[40:43], v[36:39], v[160:175]
  v_mfma_f32_32x32x16_bf16 v[176:191], v[44:47], v[36:39], v[176:191]
  ds_read_b128 v[32:35], v18 offset:16384
  ds_read_b128 v[36:39], v18 offset:20480
  ds_read_b64_tr_b16 v[40:41], v20 offset:24576
  ds_read_b64_tr_b16 v[42:43], v20 offset:25600
  ds_read_b64_tr_b16 v[44:45], v21 offset:24576
  ds_read_b64_tr_b16 v[46:47], v21 offset:25600
  s_waitcnt lgkmcnt(6)
  v_mfma_f32_32x32x16_bf16 v[128:143], v[56:59], v[48:51], v[128:143]
  v_mfma_f32_32x32x16_bf16 v[144:159], v[60:63], v[48:51], v[144:159]
  global_load_lds_dwordx4 v10, s[16:17] offset:2048
  global_load_lds_dwordx4 v11, s[16:17] offset:3072
  s_add_u32 s16, s16, 128
  s_addc_u32 s17, s17, 0
  v_mfma_f32_32x32x16_bf16 v[160:175], v[56:59], v[52:55], v[160:175]
  v_mfma_f32_32x32x16_bf16 v[176:191], v[60:63], v[52:55], v[176:191]
  ds_read_b128 v[48:51], v19 offset:16384
  ds_read_b128 v[52:55], v19 offset:20480
  ds_read_b64_tr_b16 v[56:57], v20 offset:28672
  ds_read_b64_tr_b16 v[58:59], v20 offset:29696
  ds_read_b64_tr_b16 v[60:61], v21 offset:28672
  ds_read_b64_tr_b16 v[62:63], v21 offset:29696
  s_waitcnt lgkmcnt(6)
  v_mfma_f32_32x32x16_bf16 v[128:143], v[40:43], v[32:35], v[128:143]
  v_mfma_f32_32x32x16_bf16 v[144:159], v[44:47], v[32:35], v[144:159]
  s_add_u32 m0, s28, 0
  s_nop 0
  global_load_lds_dwordx4 v12, s[18:19] offset:0
  global_load_lds_dwordx4 v13, s[18:19] offset:1024
  v_mfma_f32_32x32x16_bf16 v[160:175], v[40:43], v[36:39], v[160:175]
  v_mfma_f32_32x32x16_bf16 v[176:191], v[44:47], v[36:39], v[176:191]
  global_load_lds_dwordx4 v14, s[18:19] offset:2048
  global_load_lds_dwordx4 v15, s[18:19] offset:3072
  s_lshl_b32 s13, s26, 6
  s_add_u32 s18, s18, s13
  s_addc_u32 s19, s19, 0
  s_branch Lk_join_128
Lk_nodma_127:
  ds_read_b128 v[48:51], v17 offset:16384
  ds_read_b128 v[52:55], v17 offset:20480
  ds_read_b64_tr_b16 v[56:57], v20 offset:20480
  ds_read_b64_tr_b16 v[58:59], v20 offset:21504
  ds_read_b64_tr_b16 v[60:61], v21 offset:20480
  ds_read_b64_tr_b16 v[62:63], v21 offset:21504
  s_waitcnt lgkmcnt(6)
  v_mfma_f32_32x32x16_bf16 v[128:143], v[40:43], v[32:35], v[128:143]
  v_mfma_f32_32x32x16_bf16 v[144:159], v[44:47], v[32:35], v[144:159]
  v_mfma_f32_32x32x16_bf16 v[160:175], v[40:43], v[36:39], v[160:175]
  v_mfma_f32_32x32x16_bf16 v[176:191], v[44:47], v[36:39], v[176:191]
  ds_read_b128 v[32:35], v18 offset:16384
  ds_read_b128 v[36:39], v18 offset:20480
  ds_read_b64_tr_b16 v[40:41], v20 offset:24576
  ds_read_b64_tr_b16 v[42:43], v20 offset:25600
  ds_read_b64_tr_b16 v[44:45], v21 offset:24576
  ds_read_b64_tr_b16 v[46:47], v21 offset:25600
  s_waitcnt lgkmcnt(6)
  v_mfma_f32_32x32x16_bf16 v[128:143], v[56:59], v[48:51], v[128:143]
  v_mfma_f32_32x32x16_bf16 v[144:159], v[60:63], v[48:51], v[144:159]
  v_mfma_f32_32x32x16_bf16 v[160:175], v[56:59], v[52:55], v[160:175]
  v_mfma_f32_32x32x16_bf16 v[176:191], v[60:63], v[52:55], v[176:191]
  ds_read_b128 v[48:51], v19 offset:16384
  ds_read_b128 v[52:55], v19 offset:20480
  ds_read_b64_tr_b16 v[56:57], v20 offset:28672
  ds_read_b64_tr_b16 v[58:59], v20 offset:29696
  ds_read_b64_tr_b16 v[60:61], v21 offset:28672
  ds_read_b64_tr_b16 v[62:63], v21 offset:29696
  s_waitcnt lgkmcnt(6)
  v_mfma_f32_32x32x16_bf16 v[128:143], v[40:43], v[32:35], v[128:143]
  v_mfma_f32_32x32x16_bf16 v[144:159], v[44:47], v[32:35], v[144:159]
  v_mfma_f32_32x32x16_bf16 v[160:175], v[40:43], v[36:39], v[160:175]
  v_mfma_f32_32x32x16_bf16 v[176:191], v[44:47], v[36:39], v[176:191]
Lk_join_128:
  s_waitcnt lgkmcnt(0)
  s_add_u32 s21, s21, 1
  s_cmp_ge_u32 s21, s20
  s_cbranch_scc1 Lk_last_129
  s_add_u32 s13, s21, 1
  s_cmp_lt_u32 s13, s20
  s_cbranch_scc1 Lk_w0_130
  s_waitcnt vmcnt(0)
  s_branch Lk_w1_131
Lk_w0_130:
  s_waitcnt vmcnt(8)
Lk_w1_131:
  s_barrier
  s_cmp_eq_u32 s93, 0
  s_cbranch_scc1 Lsp_133
  s_mov_b32 s93, 0
  s_cmp_lg_u32 s10, 0
  s_cbranch_scc1 Lsp_133
  s_add_u32 s15, s98, 1
  v_mov_b32 v26, s15
  v_mov_b32 v27, s99
  v_mov_b32 v28, s94
  s_mov_b64 exec, 1
  global_store_dwordx2 v28, v[26:27], s[4:5] sc1
  s_mov_b64 exec, -1
  s_mov_b64 exec, 1
  s_mov_b64 exec, -1
Lsp_133:
  ds_read_b128 v[32:35], v16 offset:32768
  ds_read_b128 v[36:39], v16 offset:36864
  ds_read_b64_tr_b16 v[40:41], v20 offset:32768
  ds_read_b64_tr_b16 v[42:43], v20 offset:33792
  ds_read_b64_tr_b16 v[44:45], v21 offset:32768
  ds_read_b64_tr_b16 v[46:47], v21 offset:33792
  v_mfma_f32_32x32x16_bf16 v[128:143], v[56:59], v[48:51], v[128:143]
  v_mfma_f32_32x32x16_bf16 v[144:159], v[60:63], v[48:51], v[144:159]
  v_mfma_f32_32x32x16_bf16 v[160:175], v[56:59], v[52:55], v[160:175]
  v_mfma_f32_32x32x16_bf16 v[176:191], v[60:63], v[52:55], v[176:191]
  s_branch Lk_next_134
Lk_last_129:
  v_mfma_f32_32x32x16_bf16 v[128:143], v[56:59], v[48:51], v[128:143]
  v_mfma_f32_32x32x16_bf16 v[144:159], v[60:63], v[48:51], v[144:159]
  v_mfma_f32_32x32x16_bf16 v[160:175], v[56:59], v[52:55], v[160:175]
  v_mfma_f32_32x32x16_bf16 v[176:191], v[60:63], v[52:55], v[176:191]
  s_branch Lk_end_119
Lk_next_134:
  s_add_u32 s13, s21, 2
  s_cmp_ge_u32 s13, s20
  s_cbranch_scc1 Lk_nodma_135
  ds_read_b128 v[48:51], v17 offset:32768
  ds_read_b128 v[52:55], v17 offset:36864
  ds_read_b64_tr_b16 v[56:57], v20 offset:36864
  ds_read_b64_tr_b16 v[58:59], v20 offset:37888
  ds_read_b64_tr_b16 v[60:61], v21 offset:36864
  ds_read_b64_tr_b16 v[62:63], v21 offset:37888
  s_waitcnt lgkmcnt(6)
  v_mfma_f32_32x32x16_bf16 v[128:143], v[40:43], v[32:35], v[128:143]
  v_mfma_f32_32x32x16_bf16 v[144:159], v[44:47], v[32:35], v[144:159]
  s_add_u32 m0, s27, 16384
  s_nop 0
  global_load_lds_dwordx4 v8, s[16:17] offset:0
  global_load_lds_dwordx4 v9, s[16:17] offset:1024
  v_mfma_f32_32x32x16_bf16 v[160:175], v[40:43], v[36:39], v[160:175]
  v_mfma_f32_32x32x16_bf16 v[176:191], v[44:47], v[36:39], v[176:191]
  ds_read_b128 v[32:35], v18 offset:32768
  ds_read_b128 v[36:39], v18 offset:36864
  ds_read_b64_tr_b16 v[40:41], v20 offset:40960
  ds_read_b64_tr_b16 v[42:43], v20 offset:41984
  ds_read_b64_tr_b16 v[44:45], v21 offset:40960
  ds_read_b64_tr_b16 v[46:47], v21 offset:41984
  s_waitcnt lgkmcnt(6)
  v_mfma_f32_32x32x16_bf16 v[128:143], v[56:59], v[48:51], v[128:143]
  v_mfma_f32_32x32x16_bf16 v[144:159], v[60:63], v[48:51], v[144:159]
  global_load_lds_dwordx4 v10, s[16:17] offset:2048
  global_load_lds_dwordx4 v11, s[16:17] offset:3072
  s_add_u32 s16, s16, 128
  s_addc_u32 s17, s17, 0
  v_mfma_f32_32x32x16_bf16 v[160:175], v[56:59], v[52:55], v[160:175]
  v_mfma_f32_32x32x16_bf16 v[176:191], v[60:63], v[52:55], v[176:191]
  ds_read_b128 v[48:51], v19 offset:32768
  ds_read_b128 v[52:55], v19 offset:36864
  ds_read_b64_tr_b16 v[56:57], v20 offset:45056
  ds_read_b64_tr_b16 v[58:59], v20 offset:46080
  ds_read_b64_tr_b16 v[60:61], v21 offset:45056
  ds_read_b64_tr_b16 v[62:63], v21 offset:46080
  s_waitcnt lgkmcnt(6)
  v_mfma_f32_32x32x16_bf16 v[128:143], v[40:43], v[32:35], v[128:143]
  v_mfma_f32_32x32x16_bf16 v[144:159], v[44:47], v[32:35], v[144:159]
  s_add_u32 m0, s28, 16384
  s_nop 0
  global_load_lds_dwordx4 v12, s[18:19] offset:0
  global_load_lds_dwordx4 v13, s[18:19] offset:1024
  v_mfma_f32_32x32x16_bf16 v[160:175], v[40:43], v[36:39], v[160:175]
  v_mfma_f32_32x32x16_bf16 v[176:191], v[44:47], v[36:39], v[176:191]
  global_load_lds_dwordx4 v14, s[18:19] offset:2048
  global_load_lds_dwordx4 v15, s[18:19] offset:3072
  s_lshl_b32 s13, s26, 6
  s_add_u32 s18, s18, s13
  s_addc_u32 s19, s19, 0
  s_branch Lk_join_136
Lk_nodma_135:
  ds_read_b128 v[48:51], v17 offset:32768
  ds_read_b128 v[52:55], v17 offset:36864
  ds_read_b64_tr_b16 v[56:57], v20 offset:36864
  ds_read_b64_tr_b16 v[58:59], v20 offset:37888
  ds_read_b64_tr_b16 v[60:61], v21 offset:36864
  ds_read_b64_tr_b16 v[62:63], v21 offset:37888
  s_waitcnt lgkmcnt(6)
  v_mfma_f32_32x32x16_bf16 v[128:143], v[40:43], v[32:35], v[128:143]
  v_mfma_f32_32x32x16_bf16 v[144:159], v[44:47], v[32:35], v[144:159]
  v_mfma_f32_32x32x16_bf16 v[160:175], v[40:43], v[36:39], v[160:175]
  v_mfma_f32_32x32x16_bf16 v[176:191], v[44:47], v[36:39], v[176:191]
  ds_read_b128 v[32:35], v18 offset:32768
  ds_read_b128 v[36:39], v18 offset:36864
  ds_read_b64_tr_b16 v[40:41], v20 offset:40960
  ds_read_b64_tr_b16 v[42:43], v20 offset:41984
  ds_read_b64_tr_b16 v[44:45], v21 offset:40960
  ds_read_b64_tr_b16 v[46:47], v21 offset:41984
  s_waitcnt lgkmcnt(6)
  v_mfma_f32_32x32x16_bf16 v[128:143], v[56:59], v[48:51], v[128:143]
  v_mfma_f32_32x32x16_bf16 v[144:159], v[60:63], v[48:51], v[144:159]
  v_mfma_f32_32x32x16_bf16 v[160:175], v[56:59], v[52:55], v[160:175]
  v_mfma_f32_32x32x16_bf16 v[176:191], v[60:63], v[52:55], v[176:191]
  ds_read_b128 v[48:51], v19 offset:32768
  ds_read_b128 v[52:55], v19 offset:36864
  ds_read_b64_tr_b16 v[56:57], v20 offset:45056
  ds_read_b64_tr_b16 v[58:59], v20 offset:46080
  ds_read_b64_tr_b16 v[60:61], v21 offset:45056
  ds_read_b64_tr_b16 v[62:63], v21 offset:46080
  s_waitcnt lgkmcnt(6)
  v_mfma_f32_32x32x16_bf16 v[128:143], v[40:43], v[32:35], v[128:143]
  v_mfma_f32_32x32x16_bf16 v[144:159], v[44:47], v[32:35], v[144:159]
  v_mfma_f32_32x32x16_bf16 v[160:175], v[40:43], v[36:39], v[160:175]
  v_mfma_f32_32x32x16_bf16 v[176:191], v[44:47], v[36:39], v[176:191]
Lk_join_136:
  s_waitcnt lgkmcnt(0)
  s_add_u32 s21, s21, 1
  s_cmp_ge_u32 s21, s20
  s_cbranch_scc1 Lk_last_137
  s_add_u32 s13, s21, 1
  s_cmp_lt_u32 s13, s20
  s_cbranch_scc1 Lk_w0_138
  s_waitcnt vmcnt(0)
  s_branch Lk_w1_139
Lk_w0_138:
  s_waitcnt vmcnt(8)
Lk_w1_139:
  s_barrier
  ds_read_b128 v[32:35], v16 offset:0
  ds_read_b128 v[36:39], v16 offset:4096
  ds_read_b64_tr_b16 v[40:41], v20 offset:0
  ds_read_b64_tr_b16 v[42:43], v20 offset:1024
  ds_read_b64_tr_b16 v[44:45], v21 offset:0
  ds_read_b64_tr_b16 v[46:47], v21 offset:1024
  v_mfma_f32_32x32x16_bf16 v[128:143], v[56:59], v[48:51], v[128:143]
  v_mfma_f32_32x32x16_bf16 v[144:159], v[60:63], v[48:51], v[144:159]
  v_mfma_f32_32x32x16_bf16 v[160:175], v[56:59], v[52:55], v[160:175]
  v_mfma_f32_32x32x16_bf16 v[176:191], v[60:63], v[52:55], v[176:191]
  s_branch Lk_top_118
Lk_last_137:
  v_mfma_f32_32x32x16_bf16 v[128:143], v[56:59], v[48:51], v[128:143]
  v_mfma_f32_32x32x16_bf16 v[144:159], v[60:63], v[48:51], v[144:159]
  v_mfma_f32_32x32x16_bf16 v[160:175], v[56:59], v[52:55], v[160:175]
  v_mfma_f32_32x32x16_bf16 v[176:191], v[60:63], v[52:55], v[176:191]
  s_branch Lk_end_119
Lk_end_119:
  s_branch Lw1_kdone_112
Lw1_v_110:
  v_mov_b64 v[128:129], 0
  v_mov_b64 v[130:131], 0
  v_mov_b64 v[132:133], 0
  v_mov_b64 v[134:135], 0
  v_mov_b64 v[136:137], 0
  v_mov_b64 v[138:139], 0
  v_mov_b64 v[140:141], 0
  v_mov_b64 v[142:143], 0
  v_mov_b64 v[144:145], 0
  v_mov_b64 v[146:147], 0
  v_mov_b64 v[148:149], 0
  v_mov_b64 v[150:151], 0
  v_mov_b64 v[152:153], 0
  v_mov_b64 v[154:155], 0
  v_mov_b64 v[156:157], 0
  v_mov_b64 v[158:159], 0
  v_mov_b64 v[160:161], 0
  v_mov_b64 v[162:163], 0
  v_mov_b64 v[164:165], 0
  v_mov_b64 v[166:167], 0
  v_mov_b64 v[168:169], 0
  v_mov_b64 v[170:171], 0
  v_mov_b64 v[172:173], 0
  v_mov_b64 v[174:175], 0
  v_mov_b64 v[176:177], 0
  v_mov_b64 v[178:179], 0
  v_mov_b64 v[180:181], 0
  v_mov_b64 v[182:183], 0
  v_mov_b64 v[184:185], 0
  v_mov_b64 v[186:187], 0
  v_mov_b64 v[188:189], 0
  v_mov_b64 v[190:191], 0
  s_cmp_eq_u32 s93, 0
  s_cbranch_scc1 Lkp1_141
  s_waitcnt vmcnt(16)
  s_branch Lkp2_142
Lkp1_141:
  s_waitcnt vmcnt(8)
Lkp2_142:
  s_barrier
  ds_read_b128 v[32:35], v16 offset:0
  ds_read_b128 v[36:39], v16 offset:4096
  ds_read_b64_tr_b16 v[40:41], v20 offset:0
  ds_read_b64_tr_b16 v[42:43], v20 offset:1024
  ds_read_b64_tr_b16 v[44:45], v21 offset:0
  ds_read_b64_tr_b16 v[46:47], v21 offset:1024
  s_mov_b32 s21, 0
Lk_top_143:
  s_add_u32 s13, s21, 2
  s_cmp_ge_u32 s13, s20
  s_cbranch_scc1 Lk_nodma_145
  ds_read_b128 v[48:51], v17 offset:0
  ds_read_b128 v[52:55], v17 offset:4096
  ds_read_b64_tr_b16 v[56:57], v20 offset:4096
  ds_read_b64_tr_b16 v[58:59], v20 offset:5120
  ds_read_b64_tr_b16 v[60:61], v21 offset:4096
  ds_read_b64_tr_b16 v[62:63], v21 offset:5120
  s_waitcnt lgkmcnt(6)
  v_mfma_f32_32x32x16_bf16 v[128:143], v[32:35], v[40:43], v[128:143]
  v_mfma_f32_32x32x16_bf16 v[144:159], v[32:35], v[44:47], v[144:159]
  s_add_u32 m0, s27, 32768
  s_nop 0
  global_load_lds_dwordx4 v8, s[16:17] offset:0
  global_load_lds_dwordx4 v9, s[16:17] offset:1024
  v_mfma_f32_32x32x16_bf16 v[160:175], v[36:39], v[40:43], v[160:175]
  v_mfma_f32_32x32x16_bf16 v[176:191], v[36:39], v[44:47], v[176:191]
  ds_read_b128 v[32:35], v18 offset:0
  ds_read_b128 v[36:39], v18 offset:4096
  ds_read_b64_tr_b16 v[40:41], v20 offset:8192
  ds_read_b64_tr_b16 v[42:43], v20 offset:9216
  ds_read_b64_tr_b16 v[44:45], v21 offset:8192
  ds_read_b64_tr_b16 v[46:47], v21 offset:9216
  s_waitcnt lgkmcnt(6)
  v_mfma_f32_32x32x16_bf16 v[128:143], v[48:51], v[56:59], v[128:143]
  v_mfma_f32_32x32x16_bf16 v[144:159], v[48:51], v[60:63], v[144:159]
  global_load_lds_dwordx4 v10, s[16:17] offset:2048
  global_load_lds_dwordx4 v11, s[16:17] offset:3072
  s_add_u32 s16, s16, 128
  s_addc_u32 s17, s17, 0
  v_mfma_f32_32x32x16_bf16 v[160:175], v[52:55], v[56:59], v[160:175]
  v_mfma_f32_32x32x16_bf16 v[176:191], v[52:55], v[60:63], v[176:191]
  ds_read_b128 v[48:51], v19 offset:0
  ds_read_b128 v[52:55], v19 offset:4096
  ds_read_b64_tr_b16 v[56:57], v20 offset:12288
  ds_read_b64_tr_b16 v[58:59], v20 offset:13312
  ds_read_b64_tr_b16 v[60:61], v21 offset:12288
  ds_read_b64_tr_b16 v[62:63], v21 offset:13312
  s_waitcnt lgkmcnt(6)
  v_mfma_f32_32x32x16_bf16 v[128:143], v[32:35], v[40:43], v[128:143]
  v_mfma_f32_32x32x16_bf16 v[144:159], v[32:35], v[44:47], v[144:159]
  s_add_u32 m0, s28, 32768
  s_nop 0
  global_load_lds_dwordx4 v12, s[18:19] offset:0
  global_load_lds_dwordx4 v13, s[18:19] offset:1024
  v_mfma_f32_32x32x16_bf16 v[160:175], v[36:39], v[40:43], v[160:175]
  v_mfma_f32_32x32x16_bf16 v[176:191], v[36:39], v[44:47], v[176:191]
  global_load_lds_dwordx4 v14, s[18:19] offset:2048
  global_load_lds_dwordx4 v15, s[18:19] offset:3072
  s_lshl_b32 s13, s26, 6
  s_add_u32 s18, s18, s13
  s_addc_u32 s19, s19, 0
  s_branch Lk_join_146
Lk_nodma_145:
  ds_read_b128 v[48:51], v17 offset:0
  ds_read_b128 v[52:55], v17 offset:4096
  ds_read_b64_tr_b16 v[56:57], v20 offset:4096
  ds_read_b64_tr_b16 v[58:59], v20 offset:5120
  ds_read_b64_tr_b16 v[60:61], v21 offset:4096
  ds_read_b64_tr_b16 v[62:63], v21 offset:5120
  s_waitcnt lgkmcnt(6)
  v_mfma_f32_32x32x16_bf16 v[128:143], v[32:35], v[40:43], v[128:143]
  v_mfma_f32_32x32x16_bf16 v[144:159], v[32:35], v[44:47], v[144:159]
  v_mfma_f32_32x32x16_bf16 v[160:175], v[36:39], v[40:43], v[160:175]
  v_mfma_f32_32x32x16_bf16 v[176:191], v[36:39], v[44:47], v[176:191]
  ds_read_b128 v[32:35], v18 offset:0
  ds_read_b128 v[36:39], v18 offset:4096
  ds_read_b64_tr_b16 v[40:41], v20 offset:8192
  ds_read_b64_tr_b16 v[42:43], v20 offset:9216
  ds_read_b64_tr_b16 v[44:45], v21 offset:8192
  ds_read_b64_tr_b16 v[46:47], v21 offset:9216
  s_waitcnt lgkmcnt(6)
  v_mfma_f32_32x32x16_bf16 v[128:143], v[48:51], v[56:59], v[128:143]
  v_mfma_f32_32x32x16_bf16 v[144:159], v[48:51], v[60:63], v[144:159]
  v_mfma_f32_32x32x16_bf16 v[160:175], v[52:55], v[56:59], v[160:175]
  v_mfma_f32_32x32x16_bf16 v[176:191], v[52:55], v[60:63], v[176:191]
  ds_read_b128 v[48:51], v19 offset:0
  ds_read_b128 v[52:55], v19 offset:4096
  ds_read_b64_tr_b16 v[56:57], v20 offset:12288
  ds_read_b64_tr_b16 v[58:59], v20 offset:13312
  ds_read_b64_tr_b16 v[60:61], v21 offset:12288
  ds_read_b64_tr_b16 v[62:63], v21 offset:13312
  s_waitcnt lgkmcnt(6)
  v_mfma_f32_32x32x16_bf16 v[128:143], v[32:35], v[40:43], v[128:143]
  v_mfma_f32_32x32x16_bf16 v[144:159], v[32:35], v[44:47], v[144:159]
  v_mfma_f32_32x32x16_bf16 v[160:175], v[36:39], v[40:43], v[160:175]
  v_mfma_f32_32x32x16_bf16 v[176:191], v[36:39], v[44:47], v[176:191]
Lk_join_146:
  s_waitcnt lgkmcnt(0)
  s_add_u32 s21, s21, 1
  s_cmp_ge_u32 s21, s20
  s_cbranch_scc1 Lk_last_147
  s_add_u32 s13, s21, 1
  s_cmp_lt_u32 s13, s20
  s_cbranch_scc1 Lk_w0_148
  s_waitcnt vmcnt(0)
  s_branch Lk_w1_149
Lk_w0_148:
  s_cmp_eq_u32 s21, 1
  s_cselect_b32 s13, s93, 0
  s_cmp_eq_u32 s13, 0
  s_cbranch_scc1 Lk_w2_150
  s_waitcnt vmcnt(16)
  s_branch Lk_w1_149
Lk_w2_150:
  s_waitcnt vmcnt(8)
Lk_w1_149:
  s_barrier
  ds_read_b128 v[32:35], v16 offset:16384
  ds_read_b128 v[36:39], v16 offset:20480
  ds_read_b64_tr_b16 v[40:41], v20 offset:16384
  ds_read_b64_tr_b16 v[42:43], v20 offset:17408
  ds_read_b64_tr_b16 v[44:45], v21 offset:16384
  ds_read_b64_tr_b16 v[46:47], v21 offset:17408
  v_mfma_f32_32x32x16_bf16 v[128:143], v[48:51], v[56:59], v[128:143]
  v_mfma_f32_32x32x16_bf16 v[144:159], v[48:51], v[60:63], v[144:159]
  v_mfma_f32_32x32x16_bf16 v[160:175], v[52:55], v[56:59], v[160:175]
  v_mfma_f32_32x32x16_bf16 v[176:191], v[52:55], v[60:63], v[176:191]
  s_branch Lk_next_151
Lk_last_147:
  v_mfma_f32_32x32x16_bf16 v[128:143], v[48:51], v[56:59], v[128:143]
  v_mfma_f32_32x32x16_bf16 v[144:159], v[48:51], v[60:63], v[144:159]
  v_mfma_f32_32x32x16_bf16 v[160:175], v[52:55], v[56:59], v[160:175]
  v_mfma_f32_32x32x16_bf16 v[176:191], v[52:55], v[60:63], v[176:191]
  s_branch Lk_end_144
Lk_next_151:
  s_add_u32 s13, s21, 2
  s_cmp_ge_u32 s13, s20
  s_cbranch_scc1 Lk_nodma_152
  ds_read_b128 v[48:51], v17 offset:16384
  ds_read_b128 v[52:55], v17 offset:20480
  ds_read_b64_tr_b16 v[56:57], v20 offset:20480
  ds_read_b64_tr_b16 v[58:59], v20 offset:21504
  ds_read_b64_tr_b16 v[60:61], v21 offset:20480
  ds_read_b64_tr_b16 v[62:63], v21 offset:21504
  s_waitcnt lgkmcnt(6)
  v_mfma_f32_32x32x16_bf16 v[128:143], v[32:35], v[40:43], v[128:143]
  v_mfma_f32_32x32x16_bf16 v[144:159], v[32:35], v[44:47], v[144:159]
  s_add_u32 m0, s27, 0
  s_nop 0
  global_load_lds_dwordx4 v8, s[16:17] offset:0
  global_load_lds_dwordx4 v9, s[16:17] offset:1024
  v_mfma_f32_32x32x16_bf16 v[160:175], v[36:39], v[40:43], v[160:175]
  v_mfma_f32_32x32x16_bf16 v[176:191], v[36:39], v[44:47], v[176:191]
  ds_read_b128 v[32:35], v18 offset:16384
  ds_read_b128 v[36:39], v18 offset:20480
  ds_read_b64_tr_b16 v[40:41], v20 offset:24576
  ds_read_b64_tr_b16 v[42:43], v20 offset:25600
  ds_read_b64_tr_b16 v[44:45], v21 offset:24576
  ds_read_b64_tr_b16 v[46:47], v21 offset:25600
  s_waitcnt lgkmcnt(6)
  v_mfma_f32_32x32x16_bf16 v[128:143], v[48:51], v[56:59], v[128:143]
  v_mfma_f32_32x32x16_bf16 v[144:159], v[48:51], v[60:63], v[144:159]
  global_load_lds_dwordx4 v10, s[16:17] offset:2048
  global_load_lds_dwordx4 v11, s[16:17] offset:3072
  s_add_u32 s16, s16, 128
  s_addc_u32 s17, s17, 0
  v_mfma_f32_32x32x16_bf16 v[160:175], v[52:55], v[56:59], v[160:175]
  v_mfma_f32_32x32x16_bf16 v[176:191], v[52:55], v[60:63], v[176:191]
  ds_read_b128 v[48:51], v19 offset:16384
  ds_read_b128 v[52:55], v19 offset:20480
  ds_read_b64_tr_b16 v[56:57], v20 offset:28672
  ds_read_b64_tr_b16 v[58:59], v20 offset:29696
  ds_read_b64_tr_b16 v[60:61], v21 offset:28672
  ds_read_b64_tr_b16 v[62:63], v21 offset:29696
  s_waitcnt lgkmcnt(6)
  v_mfma_f32_32x32x16_bf16 v[128:143], v[32:35], v[40:43], v[128:143]
  v_mfma_f32_32x32x16_bf16 v[144:159], v[32:35], v[44:47], v[144:159]
  s_add_u32 m0, s28, 0
  s_nop 0
  global_load_lds_dwordx4 v12, s[18:19] offset:0
  global_load_lds_dwordx4 v13, s[18:19] offset:1024
  v_mfma_f32_32x32x16_bf16 v[160:175], v[36:39], v[40:43], v[160:175]
  v_mfma_f32_32x32x16_bf16 v[176:191], v[36:39], v[44:47], v[176:191]
  global_load_lds_dwordx4 v14, s[18:19] offset:2048
  global_load_lds_dwordx4 v15, s[18:19] offset:3072
  s_lshl_b32 s13, s26, 6
  s_add_u32 s18, s18, s13
  s_addc_u32 s19, s19, 0
  s_branch Lk_join_153
Lk_nodma_152:
  ds_read_b128 v[48:51], v17 offset:16384
  ds_read_b128 v[52:55], v17 offset:20480
  ds_read_b64_tr_b16 v[56:57], v20 offset:20480
  ds_read_b64_tr_b16 v[58:59], v20 offset:21504
  ds_read_b64_tr_b16 v[60:61], v21 offset:20480
  ds_read_b64_tr_b16 v[62:63], v21 offset:21504
  s_waitcnt lgkmcnt(6)
  v_mfma_f32_32x32x16_bf16 v[128:143], v[32:35], v[40:43], v[128:143]
  v_mfma_f32_32x32x16_bf16 v[144:159], v[32:35], v[44:47], v[144:159]
  v_mfma_f32_32x32x16_bf16 v[160:175], v[36:39], v[40:43], v[160:175]
  v_mfma_f32_32x32x16_bf16 v[176:191], v[36:39], v[44:47], v[176:191]
  ds_read_b128 v[32:35], v18 offset:16384
  ds_read_b128 v[36:39], v18 offset:20480
  ds_read_b64_tr_b16 v[40:41], v20 offset:24576
  ds_read_b64_tr_b16 v[42:43], v20 offset:25600
  ds_read_b64_tr_b16 v[44:45], v21 offset:24576
  ds_read_b64_tr_b16 v[46:47], v21 offset:25600
  s_waitcnt lgkmcnt(6)
  v_mfma_f32_32x32x16_bf16 v[128:143], v[48:51], v[56:59], v[128:143]
  v_mfma_f32_32x32x16_bf16 v[144:159], v[48:51], v[60:63], v[144:159]
  v_mfma_f32_32x32x16_bf16 v[160:175], v[52:55], v[56:59], v[160:175]
  v_mfma_f32_32x32x16_bf16 v[176:191], v[52:55], v[60:63], v[176:191]
  ds_read_b128 v[48:51], v19 offset:16384
  ds_read_b128 v[52:55], v19 offset:20480
  ds_read_b64_tr_b16 v[56:57], v20 offset:28672
  ds_read_b64_tr_b16 v[58:59], v20 offset:29696
  ds_read_b64_tr_b16 v[60:61], v21 offset:28672
  ds_read_b64_tr_b16 v[62:63], v21 offset:29696
  s_waitcnt lgkmcnt(6)
  v_mfma_f32_32x32x16_bf16 v[128:143], v[32:35], v[40:43], v[128:143]
  v_mfma_f32_32x32x16_bf16 v[144:159], v[32:35], v[44:47], v[144:159]
  v_mfma_f32_32x32x16_bf16 v[160:175], v[36:39], v[40:43], v[160:175]
  v_mfma_f32_32x32x16_bf16 v[176:191], v[36:39], v[44:47], v[176:191]
Lk_join_153:
  s_waitcnt lgkmcnt(0)
  s_add_u32 s21, s21, 1
  s_cmp_ge_u32 s21, s20
  s_cbranch_scc1 Lk_last_154
  s_add_u32 s13, s21, 1
  s_cmp_lt_u32 s13, s20
  s_cbranch_scc1 Lk_w0_155
  s_waitcnt vmcnt(0)
  s_branch Lk_w1_156
Lk_w0_155:
  s_waitcnt vmcnt(8)
Lk_w1_156:
  s_barrier
  s_cmp_eq_u32 s93, 0
  s_cbranch_scc1 Lsp_158
  s_mov_b32 s93, 0
  s_cmp_lg_u32 s10, 0
  s_cbranch_scc1 Lsp_158
  s_add_u32 s15, s98, 1
  v_mov_b32 v26, s15
  v_mov_b32 v27, s99
  v_mov_b32 v28, s94
  s_mov_b64 exec, 1
  global_store_dwordx2 v28, v[26:27], s[4:5] sc1
  s_mov_b64 exec, -1
  s_mov_b64 exec, 1
  s_mov_b64 exec, -1
Lsp_158:
  ds_read_b128 v[32:35], v16 offset:32768
  ds_read_b128 v[36:39], v16 offset:36864
  ds_read_b64_tr_b16 v[40:41], v20 offset:32768
  ds_read_b64_tr_b16 v[42:43], v20 offset:33792
  ds_read_b64_tr_b16 v[44:45], v21 offset:32768
  ds_read_b64_tr_b16 v[46:47], v21 offset:33792
  v_mfma_f32_32x32x16_bf16 v[128:143], v[48:51], v[56:59], v[128:143]
  v_mfma_f32_32x32x16_bf16 v[144:159], v[48:51], v[60:63], v[144:159]
  v_mfma_f32_32x32x16_bf16 v[160:175], v[52:55], v[56:59], v[160:175]
  v_mfma_f32_32x32x16_bf16 v[176:191], v[52:55], v[60:63], v[176:191]
  s_branch Lk_next_159
Lk_last_154:
  v_mfma_f32_32x32x16_bf16 v[128:143], v[48:51], v[56:59], v[128:143]
  v_mfma_f32_32x32x16_bf16 v[144:159], v[48:51], v[60:63], v[144:159]
  v_mfma_f32_32x32x16_bf16 v[160:175], v[52:55], v[56:59], v[160:175]
  v_mfma_f32_32x32x16_bf16 v[176:191], v[52:55], v[60:63], v[176:191]
  s_branch Lk_end_144
Lk_next_159:
  s_add_u32 s13, s21, 2
  s_cmp_ge_u32 s13, s20
  s_cbranch_scc1 Lk_nodma_160
  ds_read_b128 v[48:51], v17 offset:32768
  ds_read_b128 v[52:55], v17 offset:36864
  ds_read_b64_tr_b16 v[56:57], v20 offset:36864
  ds_read_b64_tr_b16 v[58:59], v20 offset:37888
  ds_read_b64_tr_b16 v[60:61], v21 offset:36864
  ds_read_b64_tr_b16 v[62:63], v21 offset:37888
  s_waitcnt lgkmcnt(6)
  v_mfma_f32_32x32x16_bf16 v[128:143], v[32:35], v[40:43], v[128:143]
  v_mfma_f32_32x32x16_bf16 v[144:159], v[32:35], v[44:47], v[144:159]
  s_add_u32 m0, s27, 16384
  s_nop 0
  global_load_lds_dwordx4 v8, s[16:17] offset:0
  global_load_lds_dwordx4 v9, s[16:17] offset:1024
  v_mfma_f32_32x32x16_bf16 v[160:175], v[36:39], v[40:43], v[160:175]
  v_mfma_f32_32x32x16_bf16 v[176:191], v[36:39], v[44:47], v[176:191]
  ds_read_b128 v[32:35], v18 offset:32768
  ds_read_b128 v[36:39], v18 offset:36864
  ds_read_b64_tr_b16 v[40:41], v20 offset:40960
  ds_read_b64_tr_b16 v[42:43], v20 offset:41984
  ds_read_b64_tr_b16 v[44:45], v21 offset:40960
  ds_read_b64_tr_b16 v[46:47], v21 offset:41984
  s_waitcnt lgkmcnt(6)
  v_mfma_f32_32x32x16_bf16 v[128:143], v[48:51], v[56:59], v[128:143]
  v_mfma_f32_32x32x16_bf16 v[144:159], v[48:51], v[60:63], v[144:159]
  global_load_lds_dwordx4 v10, s[16:17] offset:2048
  global_load_lds_dwordx4 v11, s[16:17] offset:3072
  s_add_u32 s16, s16, 128
  s_addc_u32 s17, s17, 0
  v_mfma_f32_32x32x16_bf16 v[160:175], v[52:55], v[56:59], v[160:175]
  v_mfma_f32_32x32x16_bf16 v[176:191], v[52:55], v[60:63], v[176:191]
  ds_read_b128 v[48:51], v19 offset:32768
  ds_read_b128 v[52:55], v19 offset:36864
  ds_read_b64_tr_b16 v[56:57], v20 offset:45056
  ds_read_b64_tr_b16 v[58:59], v20 offset:46080
  ds_read_b64_tr_b16 v[60:61], v21 offset:45056
  ds_read_b64_tr_b16 v[62:63], v21 offset:46080
  s_waitcnt lgkmcnt(6)
  v_mfma_f32_32x32x16_bf16 v[128:143], v[32:35], v[40:43], v[128:143]
  v_mfma_f32_32x32x16_bf16 v[144:159], v[32:35], v[44:47], v[144:159]
  s_add_u32 m0, s28, 16384
  s_nop 0
  global_load_lds_dwordx4 v12, s[18:19] offset:0
  global_load_lds_dwordx4 v13, s[18:19] offset:1024
  v_mfma_f32_32x32x16_bf16 v[160:175], v[36:39], v[40:43], v[160:175]
  v_mfma_f32_32x32x16_bf16 v[176:191], v[36:39], v[44:47], v[176:191]
  global_load_lds_dwordx4 v14, s[18:19] offset:2048
  global_load_lds_dwordx4 v15, s[18:19] offset:3072
  s_lshl_b32 s13, s26, 6
  s_add_u32 s18, s18, s13
  s_addc_u32 s19, s19, 0
  s_branch Lk_join_161
Lk_nodma_160:
  ds_read_b128 v[48:51], v17 offset:32768
  ds_read_b128 v[52:55], v17 offset:36864
  ds_read_b64_tr_b16 v[56:57], v20 offset:36864
  ds_read_b64_tr_b16 v[58:59], v20 offset:37888
  ds_read_b64_tr_b16 v[60:61], v21 offset:36864
  ds_read_b64_tr_b16 v[62:63], v21 offset:37888
  s_waitcnt lgkmcnt(6)
  v_mfma_f32_32x32x16_bf16 v[128:143], v[32:35], v[40:43], v[128:143]
  v_mfma_f32_32x32x16_bf16 v[144:159], v[32:35], v[44:47], v[144:159]
  v_mfma_f32_32x32x16_bf16 v[160:175], v[36:39], v[40:43], v[160:175]
  v_mfma_f32_32x32x16_bf16 v[176:191], v[36:39], v[44:47], v[176:191]
  ds_read_b128 v[32:35], v18 offset:32768
  ds_read_b128 v[36:39], v18 offset:36864
  ds_read_b64_tr_b16 v[40:41], v20 offset:40960
  ds_read_b64_tr_b16 v[42:43], v20 offset:41984
  ds_read_b64_tr_b16 v[44:45], v21 offset:40960
  ds_read_b64_tr_b16 v[46:47], v21 offset:41984
  s_waitcnt lgkmcnt(6)
  v_mfma_f32_32x32x16_bf16 v[128:143], v[48:51], v[56:59], v[128:143]
  v_mfma_f32_32x32x16_bf16 v[144:159], v[48:51], v[60:63], v[144:159]
  v_mfma_f32_32x32x16_bf16 v[160:175], v[52:55], v[56:59], v[160:175]
  v_mfma_f32_32x32x16_bf16 v[176:191], v[52:55], v[60:63], v[176:191]
  ds_read_b128 v[48:51], v19 offset:32768
  ds_read_b128 v[52:55], v19 offset:36864
  ds_read_b64_tr_b16 v[56:57], v20 offset:45056
  ds_read_b64_tr_b16 v[58:59], v20 offset:46080
  ds_read_b64_tr_b16 v[60:61], v21 offset:45056
  ds_read_b64_tr_b16 v[62:63], v21 offset:46080
  s_waitcnt lgkmcnt(6)
  v_mfma_f32_32x32x16_bf16 v[128:143], v[32:35], v[40:43], v[128:143]
  v_mfma_f32_32x32x16_bf16 v[144:159], v[32:35], v[44:47], v[144:159]
  v_mfma_f32_32x32x16_bf16 v[160:175], v[36:39], v[40:43], v[160:175]
  v_mfma_f32_32x32x16_bf16 v[176:191], v[36:39], v[44:47], v[176:191]
Lk_join_161:
  s_waitcnt lgkmcnt(0)
  s_add_u32 s21, s21, 1
  s_cmp_ge_u32 s21, s20
  s_cbranch_scc1 Lk_last_162
  s_add_u32 s13, s21, 1
  s_cmp_lt_u32 s13, s20
  s_cbranch_scc1 Lk_w0_163
  s_waitcnt vmcnt(0)
  s_branch Lk_w1_164
Lk_w0_163:
  s_waitcnt vmcnt(8)
Lk_w1_164:
  s_barrier
  ds_read_b128 v[32:35], v16 offset:0
  ds_read_b128 v[36:39], v16 offset:4096
  ds_read_b64_tr_b16 v[40:41], v20 offset:0
  ds_read_b64_tr_b16 v[42:43], v20 offset:1024
  ds_read_b64_tr_b16 v[44:45], v21 offset:0
  ds_read_b64_tr_b16 v[46:47], v21 offset:1024
  v_mfma_f32_32x32x16_bf16 v[128:143], v[48:51], v[56:59], v[128:143]
  v_mfma_f32_32x32x16_bf16 v[144:159], v[48:51], v[60:63], v[144:159]
  v_mfma_f32_32x32x16_bf16 v[160:175], v[52:55], v[56:59], v[160:175]
  v_mfma_f32_32x32x16_bf16 v[176:191], v[52:55], v[60:63], v[176:191]
  s_branch Lk_top_143
Lk_last_162:
  v_mfma_f32_32x32x16_bf16 v[128:143], v[48:51], v[56:59], v[128:143]
  v_mfma_f32_32x32x16_bf16 v[144:159], v[48:51], v[60:63], v[144:159]
  v_mfma_f32_32x32x16_bf16 v[160:175], v[52:55], v[56:59], v[160:175]
  v_mfma_f32_32x32x16_bf16 v[176:191], v[52:55], v[60:63], v[176:191]
  s_branch Lk_end_144
Lk_end_144:
  s_branch Lw1_kdone_112
Lw1_b_111:
  v_mov_b64 v[128:129], 0
  v_mov_b64 v[130:131], 0
  v_mov_b64 v[132:133], 0
  v_mov_b64 v[134:135], 0
  v_mov_b64 v[136:137], 0
  v_mov_b64 v[138:139], 0
  v_mov_b64 v[140:141], 0
  v_mov_b64 v[142:143], 0
  v_mov_b64 v[144:145], 0
  v_mov_b64 v[146:147], 0
  v_mov_b64 v[148:149], 0
  v_mov_b64 v[150:151], 0
  v_mov_b64 v[152:153], 0
  v_mov_b64 v[154:155], 0
  v_mov_b64 v[156:157], 0
  v_mov_b64 v[158:159], 0
  v_mov_b64 v[160:161], 0
  v_mov_b64 v[162:163], 0
  v_mov_b64 v[164:165], 0
  v_mov_b64 v[166:167], 0
  v_mov_b64 v[168:169], 0
  v_mov_b64 v[170:171], 0
  v_mov_b64 v[172:173], 0
  v_mov_b64 v[174:175], 0
  v_mov_b64 v[176:177], 0
  v_mov_b64 v[178:179], 0
  v_mov_b64 v[180:181], 0
  v_mov_b64 v[182:183], 0
  v_mov_b64 v[184:185], 0
  v_mov_b64 v[186:187], 0
  v_mov_b64 v[188:189], 0
  v_mov_b64 v[190:191], 0
  s_cmp_eq_u32 s93, 0
  s_cbranch_scc1 Lkp1_166
  s_waitcnt vmcnt(16)
  s_branch Lkp2_167
Lkp1_166:
  s_waitcnt vmcnt(8)
Lkp2_167:
  s_barrier
  ds_read_b128 v[32:35], v16 offset:0
  ds_read_b128 v[36:39], v16 offset:4096
  ds_read_b64_tr_b16 v[40:41], v20 offset:0
  ds_read_b64_tr_b16 v[42:43], v20 offset:1024
  ds_read_b64_tr_b16 v[44:45], v21 offset:0
  ds_read_b64_tr_b16 v[46:47], v21 offset:1024
  s_mov_b32 s21, 0
Lk_top_168:
  s_add_u32 s13, s21, 2
  s_cmp_ge_u32 s13, s20
  s_cbranch_scc1 Lk_nodma_170
  ds_read_b128 v[48:51], v17 offset:0
  ds_read_b128 v[52:55], v17 offset:4096
  ds_read_b64_tr_b16 v[56:57], v20 offset:4096
  ds_read_b64_tr_b16 v[58:59], v20 offset:5120
  ds_read_b64_tr_b16 v[60:61], v21 offset:4096
  ds_read_b64_tr_b16 v[62:63], v21 offset:5120
  s_waitcnt lgkmcnt(6)
  v_mfma_f32_32x32x16_bf16 v[128:143], v[40:43], v[32:35], v[128:143]
  v_mfma_f32_32x32x16_bf16 v[144:159], v[44:47], v[32:35], v[144:159]
  s_add_u32 m0, s27, 32768
  s_nop 0
  global_load_lds_dwordx4 v8, s[16:17] offset:0
  global_load_lds_dwordx4 v9, s[16:17] offset:1024
  v_mfma_f32_32x32x16_bf16 v[160:175], v[40:43], v[36:39], v[160:175]
  v_mfma_f32_32x32x16_bf16 v[176:191], v[44:47], v[36:39], v[176:191]
  ds_read_b128 v[32:35], v18 offset:0
  ds_read_b128 v[36:39], v18 offset:4096
  ds_read_b64_tr_b16 v[40:41], v20 offset:8192
  ds_read_b64_tr_b16 v[42:43], v20 offset:9216
  ds_read_b64_tr_b16 v[44:45], v21 offset:8192
  ds_read_b64_tr_b16 v[46:47], v21 offset:9216
  s_waitcnt lgkmcnt(6)
  v_mfma_f32_32x32x16_bf16 v[128:143], v[56:59], v[48:51], v[128:143]
  v_mfma_f32_32x32x16_bf16 v[144:159], v[60:63], v[48:51], v[144:159]
  global_load_lds_dwordx4 v10, s[16:17] offset:2048
  global_load_lds_dwordx4 v11, s[16:17] offset:3072
  s_add_u32 s16, s16, 128
  s_addc_u32 s17, s17, 0
  v_mfma_f32_32x32x16_bf16 v[160:175], v[56:59], v[52:55], v[160:175]
  v_mfma_f32_32x32x16_bf16 v[176:191], v[60:63], v[52:55], v[176:191]
  ds_read_b128 v[48:51], v19 offset:0
  ds_read_b128 v[52:55], v19 offset:4096
  ds_read_b64_tr_b16 v[56:57], v20 offset:12288
  ds_read_b64_tr_b16 v[58:59], v20 offset:13312
  ds_read_b64_tr_b16 v[60:61], v21 offset:12288
  ds_read_b64_tr_b16 v[62:63], v21 offset:13312
  s_waitcnt lgkmcnt(6)
  v_mfma_f32_32x32x16_bf16 v[128:143], v[40:43], v[32:35], v[128:143]
  v_mfma_f32_32x32x16_bf16 v[144:159], v[44:47], v[32:35], v[144:159]
  s_add_u32 m0, s28, 32768
  s_nop 0
  global_load_lds_dwordx4 v12, s[18:19] offset:0
  global_load_lds_dwordx4 v13, s[18:19] offset:1024
  v_mfma_f32_32x32x16_bf16 v[160:175], v[40:43], v[36:39], v[160:175]
  v_mfma_f32_32x32x16_bf16 v[176:191], v[44:47], v[36:39], v[176:191]
  global_load_lds_dwordx4 v14, s[18:19] offset:2048
  global_load_lds_dwordx4 v15, s[18:19] offset:3072
  s_lshl_b32 s13, s26, 6
  s_add_u32 s18, s18, s13
  s_addc_u32 s19, s19, 0
  s_branch Lk_join_171
Lk_nodma_170:
  ds_read_b128 v[48:51], v17 offset:0
  ds_read_b128 v[52:55], v17 offset:4096
  ds_read_b64_tr_b16 v[56:57], v20 offset:4096
  ds_read_b64_tr_b16 v[58:59], v20 offset:5120
  ds_read_b64_tr_b16 v[60:61], v21 offset:4096
  ds_read_b64_tr_b16 v[62:63], v21 offset:5120
  s_waitcnt lgkmcnt(6)
  v_mfma_f32_32x32x16_bf16 v[128:143], v[40:43], v[32:35], v[128:143]
  v_mfma_f32_32x32x16_bf16 v[144:159], v[44:47], v[32:35], v[144:159]
  v_mfma_f32_32x32x16_bf16 v[160:175], v[40:43], v[36:39], v[160:175]
  v_mfma_f32_32x32x16_bf16 v[176:191], v[44:47], v[36:39], v[176:191]
  ds_read_b128 v[32:35], v18 offset:0
  ds_read_b128 v[36:39], v18 offset:4096
  ds_read_b64_tr_b16 v[40:41], v20 offset:8192
  ds_read_b64_tr_b16 v[42:43], v20 offset:9216
  ds_read_b64_tr_b16 v[44:45], v21 offset:8192
  ds_read_b64_tr_b16 v[46:47], v21 offset:9216
  s_waitcnt lgkmcnt(6)
  v_mfma_f32_32x32x16_bf16 v[128:143], v[56:59], v[48:51], v[128:143]
  v_mfma_f32_32x32x16_bf16 v[144:159], v[60:63], v[48:51], v[144:159]
  v_mfma_f32_32x32x16_bf16 v[160:175], v[56:59], v[52:55], v[160:175]
  v_mfma_f32_32x32x16_bf16 v[176:191], v[60:63], v[52:55], v[176:191]
  ds_read_b128 v[48:51], v19 offset:0
  ds_read_b128 v[52:55], v19 offset:4096
  ds_read_b64_tr_b16 v[56:57], v20 offset:12288
  ds_read_b64_tr_b16 v[58:59], v20 offset:13312
  ds_read_b64_tr_b16 v[60:61], v21 offset:12288
  ds_read_b64_tr_b16 v[62:63], v21 offset:13312
  s_waitcnt lgkmcnt(6)
  v_mfma_f32_32x32x16_bf16 v[128:143], v[40:43], v[32:35], v[128:143]
  v_mfma_f32_32x32x16_bf16 v[144:159], v[44:47], v[32:35], v[144:159]
  v_mfma_f32_32x32x16_bf16 v[160:175], v[40:43], v[36:39], v[160:175]
  v_mfma_f32_32x32x16_bf16 v[176:191], v[44:47], v[36:39], v[176:191]
Lk_join_171:
  s_waitcnt lgkmcnt(0)
  s_add_u32 s21, s21, 1
  s_cmp_ge_u32 s21, s20
  s_cbranch_scc1 Lk_last_172
  s_add_u32 s13, s21, 1
  s_cmp_lt_u32 s13, s20
  s_cbranch_scc1 Lk_w0_173
  s_waitcnt vmcnt(0)
  s_branch Lk_w1_174
Lk_w0_173:
  s_cmp_eq_u32 s21, 1
  s_cselect_b32 s13, s93, 0
  s_cmp_eq_u32 s13, 0
  s_cbranch_scc1 Lk_w2_175
  s_waitcnt vmcnt(16)
  s_branch Lk_w1_174
Lk_w2_175:
  s_waitcnt vmcnt(8)
Lk_w1_174:
  s_barrier
  ds_read_b128 v[32:35], v16 offset:16384
  ds_read_b128 v[36:39], v16 offset:20480
  ds_read_b64_tr_b16 v[40:41], v20 offset:16384
  ds_read_b64_tr_b16 v[42:43], v20 offset:17408
  ds_read_b64_tr_b16 v[44:45], v21 offset:16384
  ds_read_b64_tr_b16 v[46:47], v21 offset:17408
  v_mfma_f32_32x32x16_bf16 v[128:143], v[56:59], v[48:51], v[128:143]
  v_mfma_f32_32x32x16_bf16 v[144:159], v[60:63], v[48:51], v[144:159]
  v_mfma_f32_32x32x16_bf16 v[160:175], v[56:59], v[52:55], v[160:175]
  v_mfma_f32_32x32x16_bf16 v[176:191], v[60:63], v[52:55], v[176:191]
  s_branch Lk_next_176
Lk_last_172:
  v_mfma_f32_32x32x16_bf16 v[128:143], v[56:59], v[48:51], v[128:143]
  v_mfma_f32_32x32x16_bf16 v[144:159], v[60:63], v[48:51], v[144:159]
  v_mfma_f32_32x32x16_bf16 v[160:175], v[56:59], v[52:55], v[160:175]
  v_mfma_f32_32x32x16_bf16 v[176:191], v[60:63], v[52:55], v[176:191]
  s_branch Lk_end_169
Lk_next_176:
  s_add_u32 s13, s21, 2
  s_cmp_ge_u32 s13, s20
  s_cbranch_scc1 Lk_nodma_177
  ds_read_b128 v[48:51], v17 offset:16384
  ds_read_b128 v[52:55], v17 offset:20480
  ds_read_b64_tr_b16 v[56:57], v20 offset:20480
  ds_read_b64_tr_b16 v[58:59], v20 offset:21504
  ds_read_b64_tr_b16 v[60:61], v21 offset:20480
  ds_read_b64_tr_b16 v[62:63], v21 offset:21504
  s_waitcnt lgkmcnt(6)
  v_mfma_f32_32x32x16_bf16 v[128:143], v[40:43], v[32:35], v[128:143]
  v_mfma_f32_32x32x16_bf16 v[144:159], v[44:47], v[32:35], v[144:159]
  s_add_u32 m0, s27, 0
  s_nop 0
  global_load_lds_dwordx4 v8, s[16:17] offset:0
  global_load_lds_dwordx4 v9, s[16:17] offset:1024
  v_mfma_f32_32x32x16_bf16 v[160:175], v[40:43], v[36:39], v[160:175]
  v_mfma_f32_32x32x16_bf16 v[176:191], v[44:47], v[36:39], v[176:191]
  ds_read_b128 v[32:35], v18 offset:16384
  ds_read_b128 v[36:39], v18 offset:20480
  ds_read_b64_tr_b16 v[40:41], v20 offset:24576
  ds_read_b64_tr_b16 v[42:43], v20 offset:25600
  ds_read_b64_tr_b16 v[44:45], v21 offset:24576
  ds_read_b64_tr_b16 v[46:47], v21 offset:25600
  s_waitcnt lgkmcnt(6)
  v_mfma_f32_32x32x16_bf16 v[128:143], v[56:59], v[48:51], v[128:143]
  v_mfma_f32_32x32x16_bf16 v[144:159], v[60:63], v[48:51], v[144:159]
  global_load_lds_dwordx4 v10, s[16:17] offset:2048
  global_load_lds_dwordx4 v11, s[16:17] offset:3072
  s_add_u32 s16, s16, 128
  s_addc_u32 s17, s17, 0
  v_mfma_f32_32x32x16_bf16 v[160:175], v[56:59], v[52:55], v[160:175]
  v_mfma_f32_32x32x16_bf16 v[176:191], v[60:63], v[52:55], v[176:191]
  ds_read_b128 v[48:51], v19 offset:16384
  ds_read_b128 v[52:55], v19 offset:20480
  ds_read_b64_tr_b16 v[56:57], v20 offset:28672
  ds_read_b64_tr_b16 v[58:59], v20 offset:29696
  ds_read_b64_tr_b16 v[60:61], v21 offset:28672
  ds_read_b64_tr_b16 v[62:63], v21 offset:29696
  s_waitcnt lgkmcnt(6)
  v_mfma_f32_32x32x16_bf16 v[128:143], v[40:43], v[32:35], v[128:143]
  v_mfma_f32_32x32x16_bf16 v[144:159], v[44:47], v[32:35], v[144:159]
  s_add_u32 m0, s28, 0
  s_nop 0
  global_load_lds_dwordx4 v12, s[18:19] offset:0
  global_load_lds_dwordx4 v13, s[18:19] offset:1024
  v_mfma_f32_32x32x16_bf16 v[160:175], v[40:43], v[36:39], v[160:175]
  v_mfma_f32_32x32x16_bf16 v[176:191], v[44:47], v[36:39], v[176:191]
  global_load_lds_dwordx4 v14, s[18:19] offset:2048
  global_load_lds_dwordx4 v15, s[18:19] offset:3072
  s_lshl_b32 s13, s26, 6
  s_add_u32 s18, s18, s13
  s_addc_u32 s19, s19, 0
  s_branch Lk_join_178
Lk_nodma_177:
  ds_read_b128 v[48:51], v17 offset:16384
  ds_read_b128 v[52:55], v17 offset:20480
  ds_read_b64_tr_b16 v[56:57], v20 offset:20480
  ds_read_b64_tr_b16 v[58:59], v20 offset:21504
  ds_read_b64_tr_b16 v[60:61], v21 offset:20480
  ds_read_b64_tr_b16 v[62:63], v21 offset:21504
  s_waitcnt lgkmcnt(6)
  v_mfma_f32_32x32x16_bf16 v[128:143], v[40:43], v[32:35], v[128:143]
  v_mfma_f32_32x32x16_bf16 v[144:159], v[44:47], v[32:35], v[144:159]
  v_mfma_f32_32x32x16_bf16 v[160:175], v[40:43], v[36:39], v[160:175]
  v_mfma_f32_32x32x16_bf16 v[176:191], v[44:47], v[36:39], v[176:191]
  ds_read_b128 v[32:35], v18 offset:16384
  ds_read_b128 v[36:39], v18 offset:20480
  ds_read_b64_tr_b16 v[40:41], v20 offset:24576
  ds_read_b64_tr_b16 v[42:43], v20 offset:25600
  ds_read_b64_tr_b16 v[44:45], v21 offset:24576
  ds_read_b64_tr_b16 v[46:47], v21 offset:25600
  s_waitcnt lgkmcnt(6)
  v_mfma_f32_32x32x16_bf16 v[128:143], v[56:59], v[48:51], v[128:143]
  v_mfma_f32_32x32x16_bf16 v[144:159], v[60:63], v[48:51], v[144:159]
  v_mfma_f32_32x32x16_bf16 v[160:175], v[56:59], v[52:55], v[160:175]
  v_mfma_f32_32x32x16_bf16 v[176:191], v[60:63], v[52:55], v[176:191]
  ds_read_b128 v[48:51], v19 offset:16384
  ds_read_b128 v[52:55], v19 offset:20480
  ds_read_b64_tr_b16 v[56:57], v20 offset:28672
  ds_read_b64_tr_b16 v[58:59], v20 offset:29696
  ds_read_b64_tr_b16 v[60:61], v21 offset:28672
  ds_read_b64_tr_b16 v[62:63], v21 offset:29696
  s_waitcnt lgkmcnt(6)
  v_mfma_f32_32x32x16_bf16 v[128:143], v[40:43], v[32:35], v[128:143]
  v_mfma_f32_32x32x16_bf16 v[144:159], v[44:47], v[32:35], v[144:159]
  v_mfma_f32_32x32x16_bf16 v[160:175], v[40:43], v[36:39], v[160:175]
  v_mfma_f32_32x32x16_bf16 v[176:191], v[44:47], v[36:39], v[176:191]
Lk_join_178:
  s_waitcnt lgkmcnt(0)
  s_add_u32 s21, s21, 1
  s_cmp_ge_u32 s21, s20
  s_cbranch_scc1 Lk_last_179
  s_add_u32 s13, s21, 1
  s_cmp_lt_u32 s13, s20
  s_cbranch_scc1 Lk_w0_180
  s_waitcnt vmcnt(0)
  s_branch Lk_w1_181
Lk_w0_180:
  s_waitcnt vmcnt(8)
Lk_w1_181:
  s_barrier
  s_cmp_eq_u32 s93, 0
  s_cbranch_scc1 Lsp_183
  s_mov_b32 s93, 0
  s_cmp_lg_u32 s10, 0
  s_cbranch_scc1 Lsp_183
  s_add_u32 s15, s98, 1
  v_mov_b32 v26, s15
  v_mov_b32 v27, s99
  v_mov_b32 v28, s94
  s_mov_b64 exec, 1
  global_store_dwordx2 v28, v[26:27], s[4:5] sc1
  s_mov_b64 exec, -1
  s_mov_b64 exec, 1
  s_mov_b64 exec, -1
Lsp_183:
  ds_read_b128 v[32:35], v16 offset:32768
  ds_read_b128 v[36:39], v16 offset:36864
  ds_read_b64_tr_b16 v[40:41], v20 offset:32768
  ds_read_b64_tr_b16 v[42:43], v20 offset:33792
  ds_read_b64_tr_b16 v[44:45], v21 offset:32768
  ds_read_b64_tr_b16 v[46:47], v21 offset:33792
  v_mfma_f32_32x32x16_bf16 v[128:143], v[56:59], v[48:51], v[128:143]
  v_mfma_f32_32x32x16_bf16 v[144:159], v[60:63], v[48:51], v[144:159]
  v_mfma_f32_32x32x16_bf16 v[160:175], v[56:59], v[52:55], v[160:175]
  v_mfma_f32_32x32x16_bf16 v[176:191], v[60:63], v[52:55], v[176:191]
  s_branch Lk_next_184
Lk_last_179:
  v_mfma_f32_32x32x16_bf16 v[128:143], v[56:59], v[48:51], v[128:143]
  v_mfma_f32_32x32x16_bf16 v[144:159], v[60:63], v[48:51], v[144:159]
  v_mfma_f32_32x32x16_bf16 v[160:175], v[56:59], v[52:55], v[160:175]
  v_mfma_f32_32x32x16_bf16 v[176:191], v[60:63], v[52:55], v[176:191]
  s_branch Lk_end_169
Lk_next_184:
  s_add_u32 s13, s21, 2
  s_cmp_ge_u32 s13, s20
  s_cbranch_scc1 Lk_nodma_185
  ds_read_b128 v[48:51], v17 offset:32768
  ds_read_b128 v[52:55], v17 offset:36864
  ds_read_b64_tr_b16 v[56:57], v20 offset:36864
  ds_read_b64_tr_b16 v[58:59], v20 offset:37888
  ds_read_b64_tr_b16 v[60:61], v21 offset:36864
  ds_read_b64_tr_b16 v[62:63], v21 offset:37888
  s_waitcnt lgkmcnt(6)
  v_mfma_f32_32x32x16_bf16 v[128:143], v[40:43], v[32:35], v[128:143]
  v_mfma_f32_32x32x16_bf16 v[144:159], v[44:47], v[32:35], v[144:159]
  s_add_u32 m0, s27, 16384
  s_nop 0
  global_load_lds_dwordx4 v8, s[16:17] offset:0
  global_load_lds_dwordx4 v9, s[16:17] offset:1024
  v_mfma_f32_32x32x16_bf16 v[160:175], v[40:43], v[36:39], v[160:175]
  v_mfma_f32_32x32x16_bf16 v[176:191], v[44:47], v[36:39], v[176:191]
  ds_read_b128 v[32:35], v18 offset:32768
  ds_read_b128 v[36:39], v18 offset:36864
  ds_read_b64_tr_b16 v[40:41], v20 offset:40960
  ds_read_b64_tr_b16 v[42:43], v20 offset:41984
  ds_read_b64_tr_b16 v[44:45], v21 offset:40960
  ds_read_b64_tr_b16 v[46:47], v21 offset:41984
  s_waitcnt lgkmcnt(6)
  v_mfma_f32_32x32x16_bf16 v[128:143], v[56:59], v[48:51], v[128:143]
  v_mfma_f32_32x32x16_bf16 v[144:159], v[60:63], v[48:51], v[144:159]
  global_load_lds_dwordx4 v10, s[16:17] offset:2048
  global_load_lds_dwordx4 v11, s[16:17] offset:3072
  s_add_u32 s16, s16, 128
  s_addc_u32 s17, s17, 0
  v_mfma_f32_32x32x16_bf16 v[160:175], v[56:59], v[52:55], v[160:175]
  v_mfma_f32_32x32x16_bf16 v[176:191], v[60:63], v[52:55], v[176:191]
  ds_read_b128 v[48:51], v19 offset:32768
  ds_read_b128 v[52:55], v19 offset:36864
  ds_read_b64_tr_b16 v[56:57], v20 offset:45056
  ds_read_b64_tr_b16 v[58:59], v20 offset:46080
  ds_read_b64_tr_b16 v[60:61], v21 offset:45056
  ds_read_b64_tr_b16 v[62:63], v21 offset:46080
  s_waitcnt lgkmcnt(6)
  v_mfma_f32_32x32x16_bf16 v[128:143], v[40:43], v[32:35], v[128:143]
  v_mfma_f32_32x32x16_bf16 v[144:159], v[44:47], v[32:35], v[144:159]
  s_add_u32 m0, s28, 16384
  s_nop 0
  global_load_lds_dwordx4 v12, s[18:19] offset:0
  global_load_lds_dwordx4 v13, s[18:19] offset:1024
  v_mfma_f32_32x32x16_bf16 v[160:175], v[40:43], v[36:39], v[160:175]
  v_mfma_f32_32x32x16_bf16 v[176:191], v[44:47], v[36:39], v[176:191]
  global_load_lds_dwordx4 v14, s[18:19] offset:2048
  global_load_lds_dwordx4 v15, s[18:19] offset:3072
  s_lshl_b32 s13, s26, 6
  s_add_u32 s18, s18, s13
  s_addc_u32 s19, s19, 0
  s_branch Lk_join_186
Lk_nodma_185:
  ds_read_b128 v[48:51], v17 offset:32768
  ds_read_b128 v[52:55], v17 offset:36864
  ds_read_b64_tr_b16 v[56:57], v20 offset:36864
  ds_read_b64_tr_b16 v[58:59], v20 offset:37888
  ds_read_b64_tr_b16 v[60:61], v21 offset:36864
  ds_read_b64_tr_b16 v[62:63], v21 offset:37888
  s_waitcnt lgkmcnt(6)
  v_mfma_f32_32x32x16_bf16 v[128:143], v[40:43], v[32:35], v[128:143]
  v_mfma_f32_32x32x16_bf16 v[144:159], v[44:47], v[32:35], v[144:159]
  v_mfma_f32_32x32x16_bf16 v[160:175], v[40:43], v[36:39], v[160:175]
  v_mfma_f32_32x32x16_bf16 v[176:191], v[44:47], v[36:39], v[176:191]
  ds_read_b128 v[32:35], v18 offset:32768
  ds_read_b128 v[36:39], v18 offset:36864
  ds_read_b64_tr_b16 v[40:41], v20 offset:40960
  ds_read_b64_tr_b16 v[42:43], v20 offset:41984
  ds_read_b64_tr_b16 v[44:45], v21 offset:40960
  ds_read_b64_tr_b16 v[46:47], v21 offset:41984
  s_waitcnt lgkmcnt(6)
  v_mfma_f32_32x32x16_bf16 v[128:143], v[56:59], v[48:51], v[128:143]
  v_mfma_f32_32x32x16_bf16 v[144:159], v[60:63], v[48:51], v[144:159]
  v_mfma_f32_32x32x16_bf16 v[160:175], v[56:59], v[52:55], v[160:175]
  v_mfma_f32_32x32x16_bf16 v[176:191], v[60:63], v[52:55], v[176:191]
  ds_read_b128 v[48:51], v19 offset:32768
  ds_read_b128 v[52:55], v19 offset:36864
  ds_read_b64_tr_b16 v[56:57], v20 offset:45056
  ds_read_b64_tr_b16 v[58:59], v20 offset:46080
  ds_read_b64_tr_b16 v[60:61], v21 offset:45056
  ds_read_b64_tr_b16 v[62:63], v21 offset:46080
  s_waitcnt lgkmcnt(6)
  v_mfma_f32_32x32x16_bf16 v[128:143], v[40:43], v[32:35], v[128:143]
  v_mfma_f32_32x32x16_bf16 v[144:159], v[44:47], v[32:35], v[144:159]
  v_mfma_f32_32x32x16_bf16 v[160:175], v[40:43], v[36:39], v[160:175]
  v_mfma_f32_32x32x16_bf16 v[176:191], v[44:47], v[36:39], v[176:191]
Lk_join_186:
  s_waitcnt lgkmcnt(0)
  s_add_u32 s21, s21, 1
  s_cmp_ge_u32 s21, s20
  s_cbranch_scc1 Lk_last_187
  s_add_u32 s13, s21, 1
  s_cmp_lt_u32 s13, s20
  s_cbranch_scc1 Lk_w0_188
  s_waitcnt vmcnt(0)
  s_branch Lk_w1_189
Lk_w0_188:
  s_waitcnt vmcnt(8)
Lk_w1_189:
  s_barrier
  ds_read_b128 v[32:35], v16 offset:0
  ds_read_b128 v[36:39], v16 offset:4096
  ds_read_b64_tr_b16 v[40:41], v20 offset:0
  ds_read_b64_tr_b16 v[42:43], v20 offset:1024
  ds_read_b64_tr_b16 v[44:45], v21 offset:0
  ds_read_b64_tr_b16 v[46:47], v21 offset:1024
  v_mfma_f32_32x32x16_bf16 v[128:143], v[56:59], v[48:51], v[128:143]
  v_mfma_f32_32x32x16_bf16 v[144:159], v[60:63], v[48:51], v[144:159]
  v_mfma_f32_32x32x16_bf16 v[160:175], v[56:59], v[52:55], v[160:175]
  v_mfma_f32_32x32x16_bf16 v[176:191], v[60:63], v[52:55], v[176:191]
  s_branch Lk_top_168
Lk_last_187:
  v_mfma_f32_32x32x16_bf16 v[128:143], v[56:59], v[48:51], v[128:143]
  v_mfma_f32_32x32x16_bf16 v[144:159], v[60:63], v[48:51], v[144:159]
  v_mfma_f32_32x32x16_bf16 v[160:175], v[56:59], v[52:55], v[160:175]
  v_mfma_f32_32x32x16_bf16 v[176:191], v[60:63], v[52:55], v[176:191]
  s_branch Lk_end_169
Lk_end_169:
Lw1_kdone_112:
  s_mov_b32 s90, s22
  s_mov_b32 s91, s23
  s_mov_b32 s92, s24
  s_cmp_eq_u32 s61, 1
  s_cbranch_scc1 Lf_p2_193
  s_cmp_ge_u32 s61, 3
  s_cbranch_scc1 Lf_none_194
Lf_list_191:
  s_cmp_ge_u32 s56, s59
  s_cbranch_scc1 Lf_endlist_197
  s_mul_i32 s23, s56, s58
  s_lshr_b32 s23, s23, 16
  s_mul_i32 s13, s23, s57
  s_sub_u32 s13, s56, s13
  s_mul_i32 s13, s13, 7
  s_add_u32 s13, s13, s60
  s_lshr_b32 s22, s13, 5
  s_and_b32 s24, s13, 31
  s_add_u32 s56, s56, s89
  s_mov_b32 s63, 1
  s_branch Lf_d_195
Lf_endlist_197:
  s_cmp_eq_u32 s61, 0
  s_cbranch_scc1 Lf_p1_192
  s_mov_b32 s61, 3
  s_branch Lf_none_194
Lf_p1_192:
  s_mov_b32 s61, 1
  s_lshr_b32 s23, s9, 1
  s_and_b32 s13, s9, 1
  s_lshl_b32 s24, s62, 1
  s_add_u32 s24, s24, s13
  s_mov_b32 s22, 3
  s_mov_b32 s63, 1
  s_branch Lf_d_195
Lf_p2_193:
  s_cmp_lt_u32 s62, 2
  s_cselect_b32 s13, 12, 8
  s_cmp_ge_u32 s9, s13
  s_cbranch_scc1 Lf_q_196
  s_mov_b32 s61, 3
  s_lshr_b32 s23, s9, 2
  s_mul_i32 s23, s23, 7
  s_add_u32 s23, s23, s62
  s_and_b32 s24, s9, 3
  s_mov_b32 s22, 4
  s_mov_b32 s63, 1
  s_branch Lf_d_195
Lf_q_196:
  s_mov_b32 s61, 2
  s_mov_b32 s56, s13
  s_add_u32 s60, s62, 64
  s_sub_u32 s57, 102, s60
  s_mul_i32 s57, s57, 9363
  s_lshr_b32 s57, s57, 16
  s_lshl_b32 s59, s57, 4
  s_mov_b32 s58, 16384
  s_cmp_eq_u32 s57, 5
  s_cselect_b32 s58, 13108, s58
  s_cmp_eq_u32 s57, 9
  s_cselect_b32 s58, 7282, s58
  s_cmp_eq_u32 s57, 10
  s_cselect_b32 s58, 6554, s58
  s_sub_u32 s89, 32, s56
  s_sub_u32 s56, s9, s56
  s_branch Lf_list_191
Lf_none_194:
  s_mov_b32 s63, 0
Lf_d_195:
  s_cmp_eq_u32 s63, 0
  s_cbranch_scc1 Lw1_nonext_113
  s_cmp_eq_u32 s22, 4
  s_cbranch_scc1 Lw1_waitb_115
  s_mov_b32 s25, 1024
  s_mov_b32 s26, 8192
  s_mov_b32 s20, 8
  s_lshl_b32 s36, s23, 17
  s_add_u32 s16, s4, s36
  s_addc_u32 s17, s5, 0
  s_lshl_b32 s37, s24, 8
  s_cmp_eq_u32 s22, 1
  s_cbranch_scc1 Lsetupv_198
  s_cmp_eq_u32 s22, 2
  s_cbranch_scc1 Lsetupq_199
  s_cmp_eq_u32 s22, 3
  s_cbranch_scc1 Lsetuph_200
  s_cmp_eq_u32 s22, 4
  s_cbranch_scc1 Lsetupb_201
  s_mov_b64 s[18:19], s[42:43]
  s_branch Lsetupdone_202
Lsetupv_198:
  s_mov_b64 s[18:19], s[44:45]
  s_branch Lsetupdone_202
Lsetupq_199:
  s_mov_b64 s[18:19], s[40:41]
  s_branch Lsetupdone_202
Lsetuph_200:
  s_mov_b64 s[18:19], s[46:47]
  s_mov_b32 s26, 3584
  s_add_u32 s16, s16, 2097152
  s_addc_u32 s17, s17, 0
  s_branch Lsetupdone_202
Lsetupb_201:
  s_mov_b64 s[18:19], s[50:51]
  s_mov_b32 s26, 1024
  s_mov_b32 s25, 3584
  s_mov_b32 s20, 28
  s_mul_i32 s36, s23, 458752
  s_add_u32 s36, s36, 71303168
  s_add_u32 s16, s4, s36
  s_addc_u32 s17, s5, 0
Lsetupdone_202:
  s_add_u32 s18, s18, s37
  s_addc_u32 s19, s19, 0
  s_lshl_b32 s13, s10, 5
  s_add_u32 s13, s13, 0
  v_lshrrev_b32 v25, 3, v22
  v_add_u32 v25, s13, v25
  v_bfe_u32 v26, v25, 1, 3
  v_xor_b32 v26, v26, v22
  v_and_b32 v26, 7, v26
  v_mul_lo_u32 v25, v25, s25
  v_lshl_add_u32 v25, v26, 4, v25
  v_subrev_u32 v8, 0, v25
  s_lshl_b32 s13, s10, 5
  s_add_u32 s13, s13, 8
  v_lshrrev_b32 v25, 3, v22
  v_add_u32 v25, s13, v25
  v_bfe_u32 v26, v25, 1, 3
  v_xor_b32 v26, v26, v22
  v_and_b32 v26, 7, v26
  v_mul_lo_u32 v25, v25, s25
  v_lshl_add_u32 v25, v26, 4, v25
  v_subrev_u32 v9, 1024, v25
  s_lshl_b32 s13, s10, 5
  s_add_u32 s13, s13, 16
  v_lshrrev_b32 v25, 3, v22
  v_add_u32 v25, s13, v25
  v_bfe_u32 v26, v25, 1, 3
  v_xor_b32 v26, v26, v22
  v_and_b32 v26, 7, v26
  v_mul_lo_u32 v25, v25, s25
  v_lshl_add_u32 v25, v26, 4, v25
  v_subrev_u32 v10, 2048, v25
  s_lshl_b32 s13, s10, 5
  s_add_u32 s13, s13, 24
  v_lshrrev_b32 v25, 3, v22
  v_add_u32 v25, s13, v25
  v_bfe_u32 v26, v25, 1, 3
  v_xor_b32 v26, v26, v22
  v_and_b32 v26, 7, v26
  v_mul_lo_u32 v25, v25, s25
  v_lshl_add_u32 v25, v26, 4, v25
  v_subrev_u32 v11, 3072, v25
  v_lshrrev_b32 v27, 4, v22
  v_lshlrev_b32 v26, 2, v27
  v_xor_b32 v26, v26, v22
  v_and_b32 v26, 15, v26
  v_lshlrev_b32 v26, 4, v26
  s_cmp_eq_u32 s22, 4
  s_cbranch_scc1 Lperm_203
  s_lshl_b32 s13, s10, 4
  s_add_u32 s13, s13, 0
  v_add_u32 v25, s13, v27
  v_mul_lo_u32 v25, v25, s26
  v_add_u32 v25, v25, v26
  v_subrev_u32 v12, 0, v25
  s_lshl_b32 s13, s10, 4
  s_add_u32 s13, s13, 4
  v_add_u32 v25, s13, v27
  v_mul_lo_u32 v25, v25, s26
  v_add_u32 v25, v25, v26
  v_subrev_u32 v13, 1024, v25
  s_lshl_b32 s13, s10, 4
  s_add_u32 s13, s13, 8
  v_add_u32 v25, s13, v27
  v_mul_lo_u32 v25, v25, s26
  v_add_u32 v25, v25, v26
  v_subrev_u32 v14, 2048, v25
  s_lshl_b32 s13, s10, 4
  s_add_u32 s13, s13, 12
  v_add_u32 v25, s13, v27
  v_mul_lo_u32 v25, v25, s26
  v_add_u32 v25, v25, v26
  v_subrev_u32 v15, 3072, v25
  s_branch Lpermd_204
Lperm_203:
  v_and_b32 v25, 1, v27
  v_lshlrev_b32 v25, 4, v25
  v_lshrrev_b32 v27, 1, v27
  v_add_u32 v27, v27, v25
  s_lshl_b32 s13, s10, 4
  s_add_u32 s13, s13, 0
  s_and_b32 s14, s13, 31
  s_lshr_b32 s14, s14, 1
  s_and_b32 s13, s13, 32
  s_add_u32 s13, s13, s14
  v_add_u32 v25, s13, v27
  v_mul_lo_u32 v25, v25, s26
  v_add_u32 v25, v25, v26
  v_subrev_u32 v12, 0, v25
  s_lshl_b32 s13, s10, 4
  s_add_u32 s13, s13, 4
  s_and_b32 s14, s13, 31
  s_lshr_b32 s14, s14, 1
  s_and_b32 s13, s13, 32
  s_add_u32 s13, s13, s14
  v_add_u32 v25, s13, v27
  v_mul_lo_u32 v25, v25, s26
  v_add_u32 v25, v25, v26
  v_subrev_u32 v13, 1024, v25
  s_lshl_b32 s13, s10, 4
  s_add_u32 s13, s13, 8
  s_and_b32 s14, s13, 31
  s_lshr_b32 s14, s14, 1
  s_and_b32 s13, s13, 32
  s_add_u32 s13, s13, s14
  v_add_u32 v25, s13, v27
  v_mul_lo_u32 v25, v25, s26
  v_add_u32 v25, v25, v26
  v_subrev_u32 v14, 2048, v25
  s_lshl_b32 s13, s10, 4
  s_add_u32 s13, s13, 12
  s_and_b32 s14, s13, 31
  s_lshr_b32 s14, s14, 1
  s_and_b32 s13, s13, 32
  s_add_u32 s13, s13, s14
  v_add_u32 v25, s13, v27
  v_mul_lo_u32 v25, v25, s26
  v_add_u32 v25, v25, v26
  v_subrev_u32 v15, 3072, v25
Lpermd_204:
  s_cmp_lg_u32 s95, 0
  s_cbranch_scc1 Lw1_xnall_205
  s_cmp_lg_u32 s10, 0
  s_cbranch_scc1 Lwx_206
  v_lshlrev_b32 v25, 4, v22
  v_add_u32 v25, 94371840, v25
  s_branch Lwx_c_209
Lwx_p_207:
  global_load_dwordx2 v[64:65], v25, s[4:5] offset:0 sc1
  global_load_dwordx2 v[66:67], v25, s[4:5] offset:1024 sc1
  global_load_dwordx2 v[68:69], v25, s[4:5] offset:2048 sc1
  global_load_dwordx2 v[70:71], v25, s[4:5] offset:3072 sc1
Lwx_c_209:
  s_waitcnt vmcnt(0)
  v_subrev_u32 v64, s98, v64
  v_xor_b32 v65, s99, v65
  v_subrev_u32 v64, 1, v64
  v_lshrrev_b32 v64, 7, v64
  v_or_b32 v64, v64, v65
  v_cmp_ne_u32 vcc, 0, v64
  s_mov_b64 s[14:15], vcc
  v_subrev_u32 v66, s98, v66
  v_xor_b32 v67, s99, v67
  v_subrev_u32 v66, 1, v66
  v_lshrrev_b32 v66, 7, v66
  v_or_b32 v66, v66, v67
  v_cmp_ne_u32 vcc, 0, v66
  s_or_b64 s[14:15], s[14:15], vcc
  v_subrev_u32 v68, s98, v68
  v_xor_b32 v69, s99, v69
  v_subrev_u32 v68, 1, v68
  v_lshrrev_b32 v68, 7, v68
  v_or_b32 v68, v68, v69
  v_cmp_ne_u32 vcc, 0, v68
  s_or_b64 s[14:15], s[14:15], vcc
  v_subrev_u32 v70, s98, v70
  v_xor_b32 v71, s99, v71
  v_subrev_u32 v70, 1, v70
  v_lshrrev_b32 v70, 7, v70
  v_or_b32 v70, v70, v71
  v_cmp_ne_u32 vcc, 0, v70
  s_or_b64 s[14:15], s[14:15], vcc
  s_cmp_eq_u64 s[14:15], 0
  s_cbranch_scc1 Lwx_d_208
  s_sleep 4
  s_cmp_eq_u32 s12, 0
  s_cbranch_scc1 Lwx_d_208
  s_sub_u32 s12, s12, 1
  s_branch Lwx_p_207
Lwx_d_208:
Lwx_206:
  s_barrier
  s_mov_b32 s95, 1
Lw1_xnall_205:
  s_barrier
  s_nop 15
  s_nop 3
  s_cmp_eq_u32 s90, 1
  s_cbranch_scc1 Le_v_210
  s_cmp_eq_u32 s90, 4
  s_cbranch_scc1 Le_b_211
  s_cmp_eq_u32 s90, 3
  s_cbranch_scc1 Le_h_212
  s_cmp_eq_u32 s90, 0
  s_mov_b32 s13, 4194304
  s_cselect_b32 s13, 20971520, s13
  s_lshl_b32 s14, s91, 20
  s_add_u32 s13, s13, s14
  s_lshl_b32 s14, s92, 13
  s_add_u32 s13, s13, s14
  s_add_u32 s30, s4, s13
  s_addc_u32 s31, s5, 0
  s_lshr_b32 s13, s10, 1
  s_lshl_b32 s13, s13, 14
  s_and_b32 s14, s10, 1
  s_lshl_b32 s14, s14, 11
  s_add_u32 s13, s13, s14
  s_add_u32 s13, s13, 98304
  v_bfe_u32 v29, v23, 4, 1
  v_lshlrev_b32 v29, 12, v29
  v_and_b32 v25, 15, v23
  v_lshl_add_u32 v29, v25, 4, v29
  v_lshl_add_u32 v29, v24, 8, v29
  v_add_u32 v29, s13, v29
  v_cvt_pk_bf16_f32 v64, v128, v136
  v_cvt_pk_bf16_f32 v65, v129, v137
  v_cvt_pk_bf16_f32 v66, v130, v138
  v_cvt_pk_bf16_f32 v67, v131, v139
  ds_write_b128 v29, v[64:67] offset:0
  v_cvt_pk_bf16_f32 v68, v132, v140
  v_cvt_pk_bf16_f32 v69, v133, v141
  v_cvt_pk_bf16_f32 v70, v134, v142
  v_cvt_pk_bf16_f32 v71, v135, v143
  ds_write_b128 v29, v[68:71] offset:512
  s_add_u32 m0, s27, 0
  s_nop 0
  global_load_lds_dwordx4 v8, s[16:17] offset:0
  global_load_lds_dwordx4 v9, s[16:17] offset:1024
  v_cvt_pk_bf16_f32 v64, v144, v152
  v_cvt_pk_bf16_f32 v65, v145, v153
  v_cvt_pk_bf16_f32 v66, v146, v154
  v_cvt_pk_bf16_f32 v67, v147, v155
  ds_write_b128 v29, v[64:67] offset:1024
  v_cvt_pk_bf16_f32 v68, v148, v156
  v_cvt_pk_bf16_f32 v69, v149, v157
  v_cvt_pk_bf16_f32 v70, v150, v158
  v_cvt_pk_bf16_f32 v71, v151, v159
  ds_write_b128 v29, v[68:71] offset:1536
  global_load_lds_dwordx4 v10, s[16:17] offset:2048
  global_load_lds_dwordx4 v11, s[16:17] offset:3072
  s_add_u32 s16, s16, 128
  s_addc_u32 s17, s17, 0
  v_cvt_pk_bf16_f32 v64, v160, v168
  v_cvt_pk_bf16_f32 v65, v161, v169
  v_cvt_pk_bf16_f32 v66, v162, v170
  v_cvt_pk_bf16_f32 v67, v163, v171
  ds_write_b128 v29, v[64:67] offset:8192
  v_cvt_pk_bf16_f32 v68, v164, v172
  v_cvt_pk_bf16_f32 v69, v165, v173
  v_cvt_pk_bf16_f32 v70, v166, v174
  v_cvt_pk_bf16_f32 v71, v167, v175
  ds_write_b128 v29, v[68:71] offset:8704
  s_add_u32 m0, s28, 0
  s_nop 0
  global_load_lds_dwordx4 v12, s[18:19] offset:0
  global_load_lds_dwordx4 v13, s[18:19] offset:1024
  v_cvt_pk_bf16_f32 v64, v176, v184
  v_cvt_pk_bf16_f32 v65, v177, v185
  v_cvt_pk_bf16_f32 v66, v178, v186
  v_cvt_pk_bf16_f32 v67, v179, v187
  ds_write_b128 v29, v[64:67] offset:9216
  v_cvt_pk_bf16_f32 v68, v180, v188
  v_cvt_pk_bf16_f32 v69, v181, v189
  v_cvt_pk_bf16_f32 v70, v182, v190
  v_cvt_pk_bf16_f32 v71, v183, v191
  ds_write_b128 v29, v[68:71] offset:9728
  global_load_lds_dwordx4 v14, s[18:19] offset:2048
  global_load_lds_dwordx4 v15, s[18:19] offset:3072
  s_lshl_b32 s13, s26, 6
  s_add_u32 s18, s18, s13
  s_addc_u32 s19, s19, 0
  s_waitcnt lgkmcnt(0)
  s_barrier
  v_lshlrev_b32 v25, 4, v22
  s_lshl_b32 s13, s10, 13
  s_add_u32 s13, s13, 98304
  v_add_u32 v26, s13, v25
  ds_read_b128 v[64:67], v26 offset:0
  ds_read_b128 v[68:71], v26 offset:1024
  ds_read_b128 v[72:75], v26 offset:2048
  ds_read_b128 v[76:79], v26 offset:3072
  ds_read_b128 v[80:83], v26 offset:4096
  ds_read_b128 v[84:87], v26 offset:5120
  ds_read_b128 v[88:91], v26 offset:6144
  ds_read_b128 v[92:95], v26 offset:7168
  s_lshl_b32 s13, s10, 18
  s_add_u32 s34, s30, s13
  s_addc_u32 s35, s31, 0
  v_add_u32 v27, 4096, v25
  s_add_u32 m0, s27, 16384
  s_nop 0
  global_load_lds_dwordx4 v8, s[16:17] offset:0
  global_load_lds_dwordx4 v9, s[16:17] offset:1024
  global_load_lds_dwordx4 v10, s[16:17] offset:2048
  global_load_lds_dwordx4 v11, s[16:17] offset:3072
  s_add_u32 s16, s16, 128
  s_addc_u32 s17, s17, 0
  s_add_u32 m0, s28, 16384
  s_nop 0
  global_load_lds_dwordx4 v12, s[18:19] offset:0
  global_load_lds_dwordx4 v13, s[18:19] offset:1024
  global_load_lds_dwordx4 v14, s[18:19] offset:2048
  global_load_lds_dwordx4 v15, s[18:19] offset:3072
  s_lshl_b32 s13, s26, 6
  s_add_u32 s18, s18, s13
  s_addc_u32 s19, s19, 0
  s_waitcnt lgkmcnt(7)
  global_store_dwordx4 v25, v[64:67], s[34:35] offset:0 sc1
  s_waitcnt lgkmcnt(6)
  global_store_dwordx4 v25, v[68:71], s[34:35] offset:1024 sc1
  s_waitcnt lgkmcnt(5)
  global_store_dwordx4 v25, v[72:75], s[34:35] offset:2048 sc1
  s_waitcnt lgkmcnt(4)
  global_store_dwordx4 v25, v[76:79], s[34:35] offset:3072 sc1
  s_waitcnt lgkmcnt(3)
  global_store_dwordx4 v27, v[80:83], s[34:35] offset:0 sc1
  s_waitcnt lgkmcnt(2)
  global_store_dwordx4 v27, v[84:87], s[34:35] offset:1024 sc1
  s_waitcnt lgkmcnt(1)
  global_store_dwordx4 v27, v[88:91], s[34:35] offset:2048 sc1
  s_waitcnt lgkmcnt(0)
  global_store_dwordx4 v27, v[92:95], s[34:35] offset:3072 sc1
  s_cmp_eq_u32 s90, 0
  s_mov_b32 s94, 94392320
  s_cselect_b32 s94, 94375936, s94
  s_lshl_b32 s14, s91, 9
  s_add_u32 s94, s94, s14
  s_lshl_b32 s14, s92, 4
  s_add_u32 s94, s94, s14
  s_branch Le_done_213
Le_h_212:
  s_lshr_b32 s13, s10, 1
  s_lshl_b32 s13, s13, 14
  s_add_u32 s13, s13, 98304
  v_lshlrev_b32 v29, 8, v23
  v_add_u32 v29, s13, v29
  v_and_b32 v31, 15, v23
  s_and_b32 s14, s10, 1
  s_lshl_b32 s14, s14, 3
  v_add_u32 v30, s14, v24
  s_lshl_b32 s13, s92, 8
  s_and_b32 s14, s10, 1
  s_lshl_b32 s14, s14, 7
  s_add_u32 s13, s13, s14
  s_add_u32 s34, s48, s13
  s_addc_u32 s35, s49, 0
  v_lshlrev_b32 v25, 3, v24
  global_load_dwordx2 v[104:105], v25, s[34:35] offset:0
  global_load_dwordx2 v[106:107], v25, s[34:35] offset:16
  global_load_dwordx2 v[108:109], v25, s[34:35] offset:32
  global_load_dwordx2 v[110:111], v25, s[34:35] offset:48
  global_load_dwordx2 v[112:113], v25, s[34:35] offset:64
  global_load_dwordx2 v[114:115], v25, s[34:35] offset:80
  global_load_dwordx2 v[116:117], v25, s[34:35] offset:96
  global_load_dwordx2 v[118:119], v25, s[34:35] offset:112
  s_mov_b32 s36, 0xc0135761
  s_mov_b32 s37, 0xbdd2d3e8
  s_waitcnt vmcnt(0)
  v_mov_b64 v[64:65], v[128:129]
  v_mov_b64 v[66:67], v[130:131]
  v_mov_b64 v[68:69], v[132:133]
  v_mov_b64 v[70:71], v[134:135]
  v_mov_b64 v[72:73], v[136:137]
  v_mov_b64 v[74:75], v[138:139]
  v_mov_b64 v[76:77], v[140:141]
  v_mov_b64 v[78:79], v[142:143]
  v_cvt_pk_bf16_f32 v64, v64, v64
  v_and_b32 v64, 0xffff0000, v64
  v_lshlrev_b32 v84, 16, v104
  v_add_f32 v64, v64, v84
  v_cvt_pk_bf16_f32 v64, v64, v64
  v_and_b32 v64, 0xffff0000, v64
  v_cvt_pk_bf16_f32 v65, v65, v65
  v_and_b32 v65, 0xffff0000, v65
  v_and_b32 v84, 0xffff0000, v104
  v_add_f32 v65, v65, v84
  v_cvt_pk_bf16_f32 v65, v65, v65
  v_and_b32 v65, 0xffff0000, v65
  v_cvt_pk_bf16_f32 v66, v66, v66
  v_and_b32 v66, 0xffff0000, v66
  v_lshlrev_b32 v84, 16, v105
  v_add_f32 v66, v66, v84
  v_cvt_pk_bf16_f32 v66, v66, v66
  v_and_b32 v66, 0xffff0000, v66
  v_cvt_pk_bf16_f32 v67, v67, v67
  v_and_b32 v67, 0xffff0000, v67
  v_and_b32 v84, 0xffff0000, v105
  v_add_f32 v67, v67, v84
  v_cvt_pk_bf16_f32 v67, v67, v67
  v_and_b32 v67, 0xffff0000, v67
  v_cvt_pk_bf16_f32 v68, v68, v68
  v_and_b32 v68, 0xffff0000, v68
  v_lshlrev_b32 v84, 16, v106
  v_add_f32 v68, v68, v84
  v_cvt_pk_bf16_f32 v68, v68, v68
  v_and_b32 v68, 0xffff0000, v68
  v_cvt_pk_bf16_f32 v69, v69, v69
  v_and_b32 v69, 0xffff0000, v69
  v_and_b32 v84, 0xffff0000, v106
  v_add_f32 v69, v69, v84
  v_cvt_pk_bf16_f32 v69, v69, v69
  v_and_b32 v69, 0xffff0000, v69
  v_cvt_pk_bf16_f32 v70, v70, v70
  v_and_b32 v70, 0xffff0000, v70
  v_lshlrev_b32 v84, 16, v107
  v_add_f32 v70, v70, v84
  v_cvt_pk_bf16_f32 v70, v70, v70
  v_and_b32 v70, 0xffff0000, v70
  v_cvt_pk_bf16_f32 v71, v71, v71
  v_and_b32 v71, 0xffff0000, v71
  v_and_b32 v84, 0xffff0000, v107
  v_add_f32 v71, v71, v84
  v_cvt_pk_bf16_f32 v71, v71, v71
  v_and_b32 v71, 0xffff0000, v71
  v_cvt_pk_bf16_f32 v72, v72, v72
  v_and_b32 v72, 0xffff0000, v72
  v_lshlrev_b32 v84, 16, v108
  v_add_f32 v72, v72, v84
  v_cvt_pk_bf16_f32 v72, v72, v72
  v_and_b32 v72, 0xffff0000, v72
  v_cvt_pk_bf16_f32 v73, v73, v73
  v_and_b32 v73, 0xffff0000, v73
  v_and_b32 v84, 0xffff0000, v108
  v_add_f32 v73, v73, v84
  v_cvt_pk_bf16_f32 v73, v73, v73
  v_and_b32 v73, 0xffff0000, v73
  v_cvt_pk_bf16_f32 v74, v74, v74
  v_and_b32 v74, 0xffff0000, v74
  v_lshlrev_b32 v84, 16, v109
  v_add_f32 v74, v74, v84
  v_cvt_pk_bf16_f32 v74, v74, v74
  v_and_b32 v74, 0xffff0000, v74
  v_cvt_pk_bf16_f32 v75, v75, v75
  v_and_b32 v75, 0xffff0000, v75
  v_and_b32 v84, 0xffff0000, v109
  v_add_f32 v75, v75, v84
  v_cvt_pk_bf16_f32 v75, v75, v75
  v_and_b32 v75, 0xffff0000, v75
  v_cvt_pk_bf16_f32 v76, v76, v76
  v_and_b32 v76, 0xffff0000, v76
  v_lshlrev_b32 v84, 16, v110
  v_add_f32 v76, v76, v84
  v_cvt_pk_bf16_f32 v76, v76, v76
  v_and_b32 v76, 0xffff0000, v76
  v_cvt_pk_bf16_f32 v77, v77, v77
  v_and_b32 v77, 0xffff0000, v77
  v_and_b32 v84, 0xffff0000, v110
  v_add_f32 v77, v77, v84
  v_cvt_pk_bf16_f32 v77, v77, v77
  v_and_b32 v77, 0xffff0000, v77
  v_cvt_pk_bf16_f32 v78, v78, v78
  v_and_b32 v78, 0xffff0000, v78
  v_lshlrev_b32 v84, 16, v111
  v_add_f32 v78, v78, v84
  v_cvt_pk_bf16_f32 v78, v78, v78
  v_and_b32 v78, 0xffff0000, v78
  v_cvt_pk_bf16_f32 v79, v79, v79
  v_and_b32 v79, 0xffff0000, v79
  v_and_b32 v84, 0xffff0000, v111
  v_add_f32 v79, v79, v84
  v_cvt_pk_bf16_f32 v79, v79, v79
  v_and_b32 v79, 0xffff0000, v79
  v_mul_f32 v84, v64, v64
  v_mov_b32 v88, s36
  v_fma_f32 v84, v84, s37, v88
  v_mul_f32 v84, v84, v64
  v_exp_f32 v84, v84
  s_nop 0
  v_add_f32 v84, 1.0, v84
  v_rcp_f32 v84, v84
  s_nop 0
  v_mul_f32 v64, v64, v84
  v_mul_f32 v85, v65, v65
  v_mov_b32 v88, s36
  v_fma_f32 v85, v85, s37, v88
  v_mul_f32 v85, v85, v65
  v_exp_f32 v85, v85
  s_nop 0
  v_add_f32 v85, 1.0, v85
  v_rcp_f32 v85, v85
  s_nop 0
  v_mul_f32 v65, v65, v85
  v_mul_f32 v86, v66, v66
  v_mov_b32 v88, s36
  v_fma_f32 v86, v86, s37, v88
  v_mul_f32 v86, v86, v66
  v_exp_f32 v86, v86
  s_nop 0
  v_add_f32 v86, 1.0, v86
  v_rcp_f32 v86, v86
  s_nop 0
  v_mul_f32 v66, v66, v86
  v_mul_f32 v87, v67, v67
  v_mov_b32 v88, s36
  v_fma_f32 v87, v87, s37, v88
  v_mul_f32 v87, v87, v67
  v_exp_f32 v87, v87
  s_nop 0
  v_add_f32 v87, 1.0, v87
  v_rcp_f32 v87, v87
  s_nop 0
  v_mul_f32 v67, v67, v87
  v_mul_f32 v84, v68, v68
  v_mov_b32 v88, s36
  v_fma_f32 v84, v84, s37, v88
  v_mul_f32 v84, v84, v68
  v_exp_f32 v84, v84
  s_nop 0
  v_add_f32 v84, 1.0, v84
  v_rcp_f32 v84, v84
  s_nop 0
  v_mul_f32 v68, v68, v84
  v_mul_f32 v85, v69, v69
  v_mov_b32 v88, s36
  v_fma_f32 v85, v85, s37, v88
  v_mul_f32 v85, v85, v69
  v_exp_f32 v85, v85
  s_nop 0
  v_add_f32 v85, 1.0, v85
  v_rcp_f32 v85, v85
  s_nop 0
  v_mul_f32 v69, v69, v85
  v_mul_f32 v86, v70, v70
  v_mov_b32 v88, s36
  v_fma_f32 v86, v86, s37, v88
  v_mul_f32 v86, v86, v70
  v_exp_f32 v86, v86
  s_nop 0
  v_add_f32 v86, 1.0, v86
  v_rcp_f32 v86, v86
  s_nop 0
  v_mul_f32 v70, v70, v86
  v_mul_f32 v87, v71, v71
  v_mov_b32 v88, s36
  v_fma_f32 v87, v87, s37, v88
  v_mul_f32 v87, v87, v71
  v_exp_f32 v87, v87
  s_nop 0
  v_add_f32 v87, 1.0, v87
  v_rcp_f32 v87, v87
  s_nop 0
  v_mul_f32 v71, v71, v87
  v_mul_f32 v84, v72, v72
  v_mov_b32 v88, s36
  v_fma_f32 v84, v84, s37, v88
  v_mul_f32 v84, v84, v72
  v_exp_f32 v84, v84
  s_nop 0
  v_add_f32 v84, 1.0, v84
  v_rcp_f32 v84, v84
  s_nop 0
  v_mul_f32 v72, v72, v84
  v_mul_f32 v85, v73, v73
  v_mov_b32 v88, s36
  v_fma_f32 v85, v85, s37, v88
  v_mul_f32 v85, v85, v73
  v_exp_f32 v85, v85
  s_nop 0
  v_add_f32 v85, 1.0, v85
  v_rcp_f32 v85, v85
  s_nop 0
  v_mul_f32 v73, v73, v85
  v_mul_f32 v86, v74, v74
  v_mov_b32 v88, s36
  v_fma_f32 v86, v86, s37, v88
  v_mul_f32 v86, v86, v74
  v_exp_f32 v86, v86
  s_nop 0
  v_add_f32 v86, 1.0, v86
  v_rcp_f32 v86, v86
  s_nop 0
  v_mul_f32 v74, v74, v86
  v_mul_f32 v87, v75, v75
  v_mov_b32 v88, s36
  v_fma_f32 v87, v87, s37, v88
  v_mul_f32 v87, v87, v75
  v_exp_f32 v87, v87
  s_nop 0
  v_add_f32 v87, 1.0, v87
  v_rcp_f32 v87, v87
  s_nop 0
  v_mul_f32 v75, v75, v87
  v_mul_f32 v84, v76, v76
  v_mov_b32 v88, s36
  v_fma_f32 v84, v84, s37, v88
  v_mul_f32 v84, v84, v76
  v_exp_f32 v84, v84
  s_nop 0
  v_add_f32 v84, 1.0, v84
  v_rcp_f32 v84, v84
  s_nop 0
  v_mul_f32 v76, v76, v84
  v_mul_f32 v85, v77, v77
  v_mov_b32 v88, s36
  v_fma_f32 v85, v85, s37, v88
  v_mul_f32 v85, v85, v77
  v_exp_f32 v85, v85
  s_nop 0
  v_add_f32 v85, 1.0, v85
  v_rcp_f32 v85, v85
  s_nop 0
  v_mul_f32 v77, v77, v85
  v_mul_f32 v86, v78, v78
  v_mov_b32 v88, s36
  v_fma_f32 v86, v86, s37, v88
  v_mul_f32 v86, v86, v78
  v_exp_f32 v86, v86
  s_nop 0
  v_add_f32 v86, 1.0, v86
  v_rcp_f32 v86, v86
  s_nop 0
  v_mul_f32 v78, v78, v86
  v_mul_f32 v87, v79, v79
  v_mov_b32 v88, s36
  v_fma_f32 v87, v87, s37, v88
  v_mul_f32 v87, v87, v79
  v_exp_f32 v87, v87
  s_nop 0
  v_add_f32 v87, 1.0, v87
  v_rcp_f32 v87, v87
  s_nop 0
  v_mul_f32 v79, v79, v87
  v_cvt_pk_bf16_f32 v80, v64, v72
  v_cvt_pk_bf16_f32 v81, v65, v73
  v_cvt_pk_bf16_f32 v82, v66, v74
  v_cvt_pk_bf16_f32 v83, v67, v75
  v_add_u32 v25, 0, v30
  v_xor_b32 v25, v25, v31
  v_lshl_add_u32 v25, v25, 4, v29
  ds_write_b128 v25, v[80:83] offset:0
  v_cvt_pk_bf16_f32 v80, v68, v76
  v_cvt_pk_bf16_f32 v81, v69, v77
  v_cvt_pk_bf16_f32 v82, v70, v78
  v_cvt_pk_bf16_f32 v83, v71, v79
  v_add_u32 v25, 2, v30
  v_xor_b32 v25, v25, v31
  v_lshl_add_u32 v25, v25, 4, v29
  ds_write_b128 v25, v[80:83] offset:0
  s_add_u32 m0, s27, 0
  s_nop 0
  global_load_lds_dwordx4 v8, s[16:17] offset:0
  global_load_lds_dwordx4 v9, s[16:17] offset:1024
  v_mov_b64 v[64:65], v[144:145]
  v_mov_b64 v[66:67], v[146:147]
  v_mov_b64 v[68:69], v[148:149]
  v_mov_b64 v[70:71], v[150:151]
  v_mov_b64 v[72:73], v[152:153]
  v_mov_b64 v[74:75], v[154:155]
  v_mov_b64 v[76:77], v[156:157]
  v_mov_b64 v[78:79], v[158:159]
  v_cvt_pk_bf16_f32 v64, v64, v64
  v_and_b32 v64, 0xffff0000, v64
  v_lshlrev_b32 v84, 16, v112
  v_add_f32 v64, v64, v84
  v_cvt_pk_bf16_f32 v64, v64, v64
  v_and_b32 v64, 0xffff0000, v64
  v_cvt_pk_bf16_f32 v65, v65, v65
  v_and_b32 v65, 0xffff0000, v65
  v_and_b32 v84, 0xffff0000, v112
  v_add_f32 v65, v65, v84
  v_cvt_pk_bf16_f32 v65, v65, v65
  v_and_b32 v65, 0xffff0000, v65
  v_cvt_pk_bf16_f32 v66, v66, v66
  v_and_b32 v66, 0xffff0000, v66
  v_lshlrev_b32 v84, 16, v113
  v_add_f32 v66, v66, v84
  v_cvt_pk_bf16_f32 v66, v66, v66
  v_and_b32 v66, 0xffff0000, v66
  v_cvt_pk_bf16_f32 v67, v67, v67
  v_and_b32 v67, 0xffff0000, v67
  v_and_b32 v84, 0xffff0000, v113
  v_add_f32 v67, v67, v84
  v_cvt_pk_bf16_f32 v67, v67, v67
  v_and_b32 v67, 0xffff0000, v67
  v_cvt_pk_bf16_f32 v68, v68, v68
  v_and_b32 v68, 0xffff0000, v68
  v_lshlrev_b32 v84, 16, v114
  v_add_f32 v68, v68, v84
  v_cvt_pk_bf16_f32 v68, v68, v68
  v_and_b32 v68, 0xffff0000, v68
  v_cvt_pk_bf16_f32 v69, v69, v69
  v_and_b32 v69, 0xffff0000, v69
  v_and_b32 v84, 0xffff0000, v114
  v_add_f32 v69, v69, v84
  v_cvt_pk_bf16_f32 v69, v69, v69
  v_and_b32 v69, 0xffff0000, v69
  v_cvt_pk_bf16_f32 v70, v70, v70
  v_and_b32 v70, 0xffff0000, v70
  v_lshlrev_b32 v84, 16, v115
  v_add_f32 v70, v70, v84
  v_cvt_pk_bf16_f32 v70, v70, v70
  v_and_b32 v70, 0xffff0000, v70
  v_cvt_pk_bf16_f32 v71, v71, v71
  v_and_b32 v71, 0xffff0000, v71
  v_and_b32 v84, 0xffff0000, v115
  v_add_f32 v71, v71, v84
  v_cvt_pk_bf16_f32 v71, v71, v71
  v_and_b32 v71, 0xffff0000, v71
  v_cvt_pk_bf16_f32 v72, v72, v72
  v_and_b32 v72, 0xffff0000, v72
  v_lshlrev_b32 v84, 16, v116
  v_add_f32 v72, v72, v84
  v_cvt_pk_bf16_f32 v72, v72, v72
  v_and_b32 v72, 0xffff0000, v72
  v_cvt_pk_bf16_f32 v73, v73, v73
  v_and_b32 v73, 0xffff0000, v73
  v_and_b32 v84, 0xffff0000, v116
  v_add_f32 v73, v73, v84
  v_cvt_pk_bf16_f32 v73, v73, v73
  v_and_b32 v73, 0xffff0000, v73
  v_cvt_pk_bf16_f32 v74, v74, v74
  v_and_b32 v74, 0xffff0000, v74
  v_lshlrev_b32 v84, 16, v117
  v_add_f32 v74, v74, v84
  v_cvt_pk_bf16_f32 v74, v74, v74
  v_and_b32 v74, 0xffff0000, v74
  v_cvt_pk_bf16_f32 v75, v75, v75
  v_and_b32 v75, 0xffff0000, v75
  v_and_b32 v84, 0xffff0000, v117
  v_add_f32 v75, v75, v84
  v_cvt_pk_bf16_f32 v75, v75, v75
  v_and_b32 v75, 0xffff0000, v75
  v_cvt_pk_bf16_f32 v76, v76, v76
  v_and_b32 v76, 0xffff0000, v76
  v_lshlrev_b32 v84, 16, v118
  v_add_f32 v76, v76, v84
  v_cvt_pk_bf16_f32 v76, v76, v76
  v_and_b32 v76, 0xffff0000, v76
  v_cvt_pk_bf16_f32 v77, v77, v77
  v_and_b32 v77, 0xffff0000, v77
  v_and_b32 v84, 0xffff0000, v118
  v_add_f32 v77, v77, v84
  v_cvt_pk_bf16_f32 v77, v77, v77
  v_and_b32 v77, 0xffff0000, v77
  v_cvt_pk_bf16_f32 v78, v78, v78
  v_and_b32 v78, 0xffff0000, v78
  v_lshlrev_b32 v84, 16, v119
  v_add_f32 v78, v78, v84
  v_cvt_pk_bf16_f32 v78, v78, v78
  v_and_b32 v78, 0xffff0000, v78
  v_cvt_pk_bf16_f32 v79, v79, v79
  v_and_b32 v79, 0xffff0000, v79
  v_and_b32 v84, 0xffff0000, v119
  v_add_f32 v79, v79, v84
  v_cvt_pk_bf16_f32 v79, v79, v79
  v_and_b32 v79, 0xffff0000, v79
  v_mul_f32 v84, v64, v64
  v_mov_b32 v88, s36
  v_fma_f32 v84, v84, s37, v88
  v_mul_f32 v84, v84, v64
  v_exp_f32 v84, v84
  s_nop 0
  v_add_f32 v84, 1.0, v84
  v_rcp_f32 v84, v84
  s_nop 0
  v_mul_f32 v64, v64, v84
  v_mul_f32 v85, v65, v65
  v_mov_b32 v88, s36
  v_fma_f32 v85, v85, s37, v88
  v_mul_f32 v85, v85, v65
  v_exp_f32 v85, v85
  s_nop 0
  v_add_f32 v85, 1.0, v85
  v_rcp_f32 v85, v85
  s_nop 0
  v_mul_f32 v65, v65, v85
  v_mul_f32 v86, v66, v66
  v_mov_b32 v88, s36
  v_fma_f32 v86, v86, s37, v88
  v_mul_f32 v86, v86, v66
  v_exp_f32 v86, v86
  s_nop 0
  v_add_f32 v86, 1.0, v86
  v_rcp_f32 v86, v86
  s_nop 0
  v_mul_f32 v66, v66, v86
  v_mul_f32 v87, v67, v67
  v_mov_b32 v88, s36
  v_fma_f32 v87, v87, s37, v88
  v_mul_f32 v87, v87, v67
  v_exp_f32 v87, v87
  s_nop 0
  v_add_f32 v87, 1.0, v87
  v_rcp_f32 v87, v87
  s_nop 0
  v_mul_f32 v67, v67, v87
  v_mul_f32 v84, v68, v68
  v_mov_b32 v88, s36
  v_fma_f32 v84, v84, s37, v88
  v_mul_f32 v84, v84, v68
  v_exp_f32 v84, v84
  s_nop 0
  v_add_f32 v84, 1.0, v84
  v_rcp_f32 v84, v84
  s_nop 0
  v_mul_f32 v68, v68, v84
  v_mul_f32 v85, v69, v69
  v_mov_b32 v88, s36
  v_fma_f32 v85, v85, s37, v88
  v_mul_f32 v85, v85, v69
  v_exp_f32 v85, v85
  s_nop 0
  v_add_f32 v85, 1.0, v85
  v_rcp_f32 v85, v85
  s_nop 0
  v_mul_f32 v69, v69, v85
  v_mul_f32 v86, v70, v70
  v_mov_b32 v88, s36
  v_fma_f32 v86, v86, s37, v88
  v_mul_f32 v86, v86, v70
  v_exp_f32 v86, v86
  s_nop 0
  v_add_f32 v86, 1.0, v86
  v_rcp_f32 v86, v86
  s_nop 0
  v_mul_f32 v70, v70, v86
  v_mul_f32 v87, v71, v71
  v_mov_b32 v88, s36
  v_fma_f32 v87, v87, s37, v88
  v_mul_f32 v87, v87, v71
  v_exp_f32 v87, v87
  s_nop 0
  v_add_f32 v87, 1.0, v87
  v_rcp_f32 v87, v87
  s_nop 0
  v_mul_f32 v71, v71, v87
  v_mul_f32 v84, v72, v72
  v_mov_b32 v88, s36
  v_fma_f32 v84, v84, s37, v88
  v_mul_f32 v84, v84, v72
  v_exp_f32 v84, v84
  s_nop 0
  v_add_f32 v84, 1.0, v84
  v_rcp_f32 v84, v84
  s_nop 0
  v_mul_f32 v72, v72, v84
  v_mul_f32 v85, v73, v73
  v_mov_b32 v88, s36
  v_fma_f32 v85, v85, s37, v88
  v_mul_f32 v85, v85, v73
  v_exp_f32 v85, v85
  s_nop 0
  v_add_f32 v85, 1.0, v85
  v_rcp_f32 v85, v85
  s_nop 0
  v_mul_f32 v73, v73, v85
  v_mul_f32 v86, v74, v74
  v_mov_b32 v88, s36
  v_fma_f32 v86, v86, s37, v88
  v_mul_f32 v86, v86, v74
  v_exp_f32 v86, v86
  s_nop 0
  v_add_f32 v86, 1.0, v86
  v_rcp_f32 v86, v86
  s_nop 0
  v_mul_f32 v74, v74, v86
  v_mul_f32 v87, v75, v75
  v_mov_b32 v88, s36
  v_fma_f32 v87, v87, s37, v88
  v_mul_f32 v87, v87, v75
  v_exp_f32 v87, v87
  s_nop 0
  v_add_f32 v87, 1.0, v87
  v_rcp_f32 v87, v87
  s_nop 0
  v_mul_f32 v75, v75, v87
  v_mul_f32 v84, v76, v76
  v_mov_b32 v88, s36
  v_fma_f32 v84, v84, s37, v88
  v_mul_f32 v84, v84, v76
  v_exp_f32 v84, v84
  s_nop 0
  v_add_f32 v84, 1.0, v84
  v_rcp_f32 v84, v84
  s_nop 0
  v_mul_f32 v76, v76, v84
  v_mul_f32 v85, v77, v77
  v_mov_b32 v88, s36
  v_fma_f32 v85, v85, s37, v88
  v_mul_f32 v85, v85, v77
  v_exp_f32 v85, v85
  s_nop 0
  v_add_f32 v85, 1.0, v85
  v_rcp_f32 v85, v85
  s_nop 0
  v_mul_f32 v77, v77, v85
  v_mul_f32 v86, v78, v78
  v_mov_b32 v88, s36
  v_fma_f32 v86, v86, s37, v88
  v_mul_f32 v86, v86, v78
  v_exp_f32 v86, v86
  s_nop 0
  v_add_f32 v86, 1.0, v86
  v_rcp_f32 v86, v86
  s_nop 0
  v_mul_f32 v78, v78, v86
  v_mul_f32 v87, v79, v79
  v_mov_b32 v88, s36
  v_fma_f32 v87, v87, s37, v88
  v_mul_f32 v87, v87, v79
  v_exp_f32 v87, v87
  s_nop 0
  v_add_f32 v87, 1.0, v87
  v_rcp_f32 v87, v87
  s_nop 0
  v_mul_f32 v79, v79, v87
  v_cvt_pk_bf16_f32 v80, v64, v72
  v_cvt_pk_bf16_f32 v81, v65, v73
  v_cvt_pk_bf16_f32 v82, v66, v74
  v_cvt_pk_bf16_f32 v83, v67, v75
  v_add_u32 v25, 4, v30
  v_xor_b32 v25, v25, v31
  v_lshl_add_u32 v25, v25, 4, v29
  ds_write_b128 v25, v[80:83] offset:0
  v_cvt_pk_bf16_f32 v80, v68, v76
  v_cvt_pk_bf16_f32 v81, v69, v77
  v_cvt_pk_bf16_f32 v82, v70, v78
  v_cvt_pk_bf16_f32 v83, v71, v79
  v_add_u32 v25, 6, v30
  v_xor_b32 v25, v25, v31
  v_lshl_add_u32 v25, v25, 4, v29
  ds_write_b128 v25, v[80:83] offset:0
  global_load_lds_dwordx4 v10, s[16:17] offset:2048
  global_load_lds_dwordx4 v11, s[16:17] offset:3072
  s_add_u32 s16, s16, 128
  s_addc_u32 s17, s17, 0
  v_mov_b64 v[64:65], v[160:161]
  v_mov_b64 v[66:67], v[162:163]
  v_mov_b64 v[68:69], v[164:165]
  v_mov_b64 v[70:71], v[166:167]
  v_mov_b64 v[72:73], v[168:169]
  v_mov_b64 v[74:75], v[170:171]
  v_mov_b64 v[76:77], v[172:173]
  v_mov_b64 v[78:79], v[174:175]
  v_cvt_pk_bf16_f32 v64, v64, v64
  v_and_b32 v64, 0xffff0000, v64
  v_lshlrev_b32 v84, 16, v104
  v_add_f32 v64, v64, v84
  v_cvt_pk_bf16_f32 v64, v64, v64
  v_and_b32 v64, 0xffff0000, v64
  v_cvt_pk_bf16_f32 v65, v65, v65
  v_and_b32 v65, 0xffff0000, v65
  v_and_b32 v84, 0xffff0000, v104
  v_add_f32 v65, v65, v84
  v_cvt_pk_bf16_f32 v65, v65, v65
  v_and_b32 v65, 0xffff0000, v65
  v_cvt_pk_bf16_f32 v66, v66, v66
  v_and_b32 v66, 0xffff0000, v66
  v_lshlrev_b32 v84, 16, v105
  v_add_f32 v66, v66, v84
  v_cvt_pk_bf16_f32 v66, v66, v66
  v_and_b32 v66, 0xffff0000, v66
  v_cvt_pk_bf16_f32 v67, v67, v67
  v_and_b32 v67, 0xffff0000, v67
  v_and_b32 v84, 0xffff0000, v105
  v_add_f32 v67, v67, v84
  v_cvt_pk_bf16_f32 v67, v67, v67
  v_and_b32 v67, 0xffff0000, v67
  v_cvt_pk_bf16_f32 v68, v68, v68
  v_and_b32 v68, 0xffff0000, v68
  v_lshlrev_b32 v84, 16, v106
  v_add_f32 v68, v68, v84
  v_cvt_pk_bf16_f32 v68, v68, v68
  v_and_b32 v68, 0xffff0000, v68
  v_cvt_pk_bf16_f32 v69, v69, v69
  v_and_b32 v69, 0xffff0000, v69
  v_and_b32 v84, 0xffff0000, v106
  v_add_f32 v69, v69, v84
  v_cvt_pk_bf16_f32 v69, v69, v69
  v_and_b32 v69, 0xffff0000, v69
  v_cvt_pk_bf16_f32 v70, v70, v70
  v_and_b32 v70, 0xffff0000, v70
  v_lshlrev_b32 v84, 16, v107
  v_add_f32 v70, v70, v84
  v_cvt_pk_bf16_f32 v70, v70, v70
  v_and_b32 v70, 0xffff0000, v70
  v_cvt_pk_bf16_f32 v71, v71, v71
  v_and_b32 v71, 0xffff0000, v71
  v_and_b32 v84, 0xffff0000, v107
  v_add_f32 v71, v71, v84
  v_cvt_pk_bf16_f32 v71, v71, v71
  v_and_b32 v71, 0xffff0000, v71
  v_cvt_pk_bf16_f32 v72, v72, v72
  v_and_b32 v72, 0xffff0000, v72
  v_lshlrev_b32 v84, 16, v108
  v_add_f32 v72, v72, v84
  v_cvt_pk_bf16_f32 v72, v72, v72
  v_and_b32 v72, 0xffff0000, v72
  v_cvt_pk_bf16_f32 v73, v73, v73
  v_and_b32 v73, 0xffff0000, v73
  v_and_b32 v84, 0xffff0000, v108
  v_add_f32 v73, v73, v84
  v_cvt_pk_bf16_f32 v73, v73, v73
  v_and_b32 v73, 0xffff0000, v73
  v_cvt_pk_bf16_f32 v74, v74, v74
  v_and_b32 v74, 0xffff0000, v74
  v_lshlrev_b32 v84, 16, v109
  v_add_f32 v74, v74, v84
  v_cvt_pk_bf16_f32 v74, v74, v74
  v_and_b32 v74, 0xffff0000, v74
  v_cvt_pk_bf16_f32 v75, v75, v75
  v_and_b32 v75, 0xffff0000, v75
  v_and_b32 v84, 0xffff0000, v109
  v_add_f32 v75, v75, v84
  v_cvt_pk_bf16_f32 v75, v75, v75
  v_and_b32 v75, 0xffff0000, v75
  v_cvt_pk_bf16_f32 v76, v76, v76
  v_and_b32 v76, 0xffff0000, v76
  v_lshlrev_b32 v84, 16, v110
  v_add_f32 v76, v76, v84
  v_cvt_pk_bf16_f32 v76, v76, v76
  v_and_b32 v76, 0xffff0000, v76
  v_cvt_pk_bf16_f32 v77, v77, v77
  v_and_b32 v77, 0xffff0000, v77
  v_and_b32 v84, 0xffff0000, v110
  v_add_f32 v77, v77, v84
  v_cvt_pk_bf16_f32 v77, v77, v77
  v_and_b32 v77, 0xffff0000, v77
  v_cvt_pk_bf16_f32 v78, v78, v78
  v_and_b32 v78, 0xffff0000, v78
  v_lshlrev_b32 v84, 16, v111
  v_add_f32 v78, v78, v84
  v_cvt_pk_bf16_f32 v78, v78, v78
  v_and_b32 v78, 0xffff0000, v78
  v_cvt_pk_bf16_f32 v79, v79, v79
  v_and_b32 v79, 0xffff0000, v79
  v_and_b32 v84, 0xffff0000, v111
  v_add_f32 v79, v79, v84
  v_cvt_pk_bf16_f32 v79, v79, v79
  v_and_b32 v79, 0xffff0000, v79
  v_mul_f32 v84, v64, v64
  v_mov_b32 v88, s36
  v_fma_f32 v84, v84, s37, v88
  v_mul_f32 v84, v84, v64
  v_exp_f32 v84, v84
  s_nop 0
  v_add_f32 v84, 1.0, v84
  v_rcp_f32 v84, v84
  s_nop 0
  v_mul_f32 v64, v64, v84
  v_mul_f32 v85, v65, v65
  v_mov_b32 v88, s36
  v_fma_f32 v85, v85, s37, v88
  v_mul_f32 v85, v85, v65
  v_exp_f32 v85, v85
  s_nop 0
  v_add_f32 v85, 1.0, v85
  v_rcp_f32 v85, v85
  s_nop 0
  v_mul_f32 v65, v65, v85
  v_mul_f32 v86, v66, v66
  v_mov_b32 v88, s36
  v_fma_f32 v86, v86, s37, v88
  v_mul_f32 v86, v86, v66
  v_exp_f32 v86, v86
  s_nop 0
  v_add_f32 v86, 1.0, v86
  v_rcp_f32 v86, v86
  s_nop 0
  v_mul_f32 v66, v66, v86
  v_mul_f32 v87, v67, v67
  v_mov_b32 v88, s36
  v_fma_f32 v87, v87, s37, v88
  v_mul_f32 v87, v87, v67
  v_exp_f32 v87, v87
  s_nop 0
  v_add_f32 v87, 1.0, v87
  v_rcp_f32 v87, v87
  s_nop 0
  v_mul_f32 v67, v67, v87
  v_mul_f32 v84, v68, v68
  v_mov_b32 v88, s36
  v_fma_f32 v84, v84, s37, v88
  v_mul_f32 v84, v84, v68
  v_exp_f32 v84, v84
  s_nop 0
  v_add_f32 v84, 1.0, v84
  v_rcp_f32 v84, v84
  s_nop 0
  v_mul_f32 v68, v68, v84
  v_mul_f32 v85, v69, v69
  v_mov_b32 v88, s36
  v_fma_f32 v85, v85, s37, v88
  v_mul_f32 v85, v85, v69
  v_exp_f32 v85, v85
  s_nop 0
  v_add_f32 v85, 1.0, v85
  v_rcp_f32 v85, v85
  s_nop 0
  v_mul_f32 v69, v69, v85
  v_mul_f32 v86, v70, v70
  v_mov_b32 v88, s36
  v_fma_f32 v86, v86, s37, v88
  v_mul_f32 v86, v86, v70
  v_exp_f32 v86, v86
  s_nop 0
  v_add_f32 v86, 1.0, v86
  v_rcp_f32 v86, v86
  s_nop 0
  v_mul_f32 v70, v70, v86
  v_mul_f32 v87, v71, v71
  v_mov_b32 v88, s36
  v_fma_f32 v87, v87, s37, v88
  v_mul_f32 v87, v87, v71
  v_exp_f32 v87, v87
  s_nop 0
  v_add_f32 v87, 1.0, v87
  v_rcp_f32 v87, v87
  s_nop 0
  v_mul_f32 v71, v71, v87
  v_mul_f32 v84, v72, v72
  v_mov_b32 v88, s36
  v_fma_f32 v84, v84, s37, v88
  v_mul_f32 v84, v84, v72
  v_exp_f32 v84, v84
  s_nop 0
  v_add_f32 v84, 1.0, v84
  v_rcp_f32 v84, v84
  s_nop 0
  v_mul_f32 v72, v72, v84
  v_mul_f32 v85, v73, v73
  v_mov_b32 v88, s36
  v_fma_f32 v85, v85, s37, v88
  v_mul_f32 v85, v85, v73
  v_exp_f32 v85, v85
  s_nop 0
  v_add_f32 v85, 1.0, v85
  v_rcp_f32 v85, v85
  s_nop 0
  v_mul_f32 v73, v73, v85
  v_mul_f32 v86, v74, v74
  v_mov_b32 v88, s36
  v_fma_f32 v86, v86, s37, v88
  v_mul_f32 v86, v86, v74
  v_exp_f32 v86, v86
  s_nop 0
  v_add_f32 v86, 1.0, v86
  v_rcp_f32 v86, v86
  s_nop 0
  v_mul_f32 v74, v74, v86
  v_mul_f32 v87, v75, v75
  v_mov_b32 v88, s36
  v_fma_f32 v87, v87, s37, v88
  v_mul_f32 v87, v87, v75
  v_exp_f32 v87, v87
  s_nop 0
  v_add_f32 v87, 1.0, v87
  v_rcp_f32 v87, v87
  s_nop 0
  v_mul_f32 v75, v75, v87
  v_mul_f32 v84, v76, v76
  v_mov_b32 v88, s36
  v_fma_f32 v84, v84, s37, v88
  v_mul_f32 v84, v84, v76
  v_exp_f32 v84, v84
  s_nop 0
  v_add_f32 v84, 1.0, v84
  v_rcp_f32 v84, v84
  s_nop 0
  v_mul_f32 v76, v76, v84
  v_mul_f32 v85, v77, v77
  v_mov_b32 v88, s36
  v_fma_f32 v85, v85, s37, v88
  v_mul_f32 v85, v85, v77
  v_exp_f32 v85, v85
  s_nop 0
  v_add_f32 v85, 1.0, v85
  v_rcp_f32 v85, v85
  s_nop 0
  v_mul_f32 v77, v77, v85
  v_mul_f32 v86, v78, v78
  v_mov_b32 v88, s36
  v_fma_f32 v86, v86, s37, v88
  v_mul_f32 v86, v86, v78
  v_exp_f32 v86, v86
  s_nop 0
  v_add_f32 v86, 1.0, v86
  v_rcp_f32 v86, v86
  s_nop 0
  v_mul_f32 v78, v78, v86
  v_mul_f32 v87, v79, v79
  v_mov_b32 v88, s36
  v_fma_f32 v87, v87, s37, v88
  v_mul_f32 v87, v87, v79
  v_exp_f32 v87, v87
  s_nop 0
  v_add_f32 v87, 1.0, v87
  v_rcp_f32 v87, v87
  s_nop 0
  v_mul_f32 v79, v79, v87
  v_cvt_pk_bf16_f32 v80, v64, v72
  v_cvt_pk_bf16_f32 v81, v65, v73
  v_cvt_pk_bf16_f32 v82, v66, v74
  v_cvt_pk_bf16_f32 v83, v67, v75
  v_add_u32 v25, 0, v30
  v_xor_b32 v25, v25, v31
  v_lshl_add_u32 v25, v25, 4, v29
  ds_write_b128 v25, v[80:83] offset:8192
  v_cvt_pk_bf16_f32 v80, v68, v76
  v_cvt_pk_bf16_f32 v81, v69, v77
  v_cvt_pk_bf16_f32 v82, v70, v78
  v_cvt_pk_bf16_f32 v83, v71, v79
  v_add_u32 v25, 2, v30
  v_xor_b32 v25, v25, v31
  v_lshl_add_u32 v25, v25, 4, v29
  ds_write_b128 v25, v[80:83] offset:8192
  s_add_u32 m0, s28, 0
  s_nop 0
  global_load_lds_dwordx4 v12, s[18:19] offset:0
  global_load_lds_dwordx4 v13, s[18:19] offset:1024
  v_mov_b64 v[64:65], v[176:177]
  v_mov_b64 v[66:67], v[178:179]
  v_mov_b64 v[68:69], v[180:181]
  v_mov_b64 v[70:71], v[182:183]
  v_mov_b64 v[72:73], v[184:185]
  v_mov_b64 v[74:75], v[186:187]
  v_mov_b64 v[76:77], v[188:189]
  v_mov_b64 v[78:79], v[190:191]
  v_cvt_pk_bf16_f32 v64, v64, v64
  v_and_b32 v64, 0xffff0000, v64
  v_lshlrev_b32 v84, 16, v112
  v_add_f32 v64, v64, v84
  v_cvt_pk_bf16_f32 v64, v64, v64
  v_and_b32 v64, 0xffff0000, v64
  v_cvt_pk_bf16_f32 v65, v65, v65
  v_and_b32 v65, 0xffff0000, v65
  v_and_b32 v84, 0xffff0000, v112
  v_add_f32 v65, v65, v84
  v_cvt_pk_bf16_f32 v65, v65, v65
  v_and_b32 v65, 0xffff0000, v65
  v_cvt_pk_bf16_f32 v66, v66, v66
  v_and_b32 v66, 0xffff0000, v66
  v_lshlrev_b32 v84, 16, v113
  v_add_f32 v66, v66, v84
  v_cvt_pk_bf16_f32 v66, v66, v66
  v_and_b32 v66, 0xffff0000, v66
  v_cvt_pk_bf16_f32 v67, v67, v67
  v_and_b32 v67, 0xffff0000, v67
  v_and_b32 v84, 0xffff0000, v113
  v_add_f32 v67, v67, v84
  v_cvt_pk_bf16_f32 v67, v67, v67
  v_and_b32 v67, 0xffff0000, v67
  v_cvt_pk_bf16_f32 v68, v68, v68
  v_and_b32 v68, 0xffff0000, v68
  v_lshlrev_b32 v84, 16, v114
  v_add_f32 v68, v68, v84
  v_cvt_pk_bf16_f32 v68, v68, v68
  v_and_b32 v68, 0xffff0000, v68
  v_cvt_pk_bf16_f32 v69, v69, v69
  v_and_b32 v69, 0xffff0000, v69
  v_and_b32 v84, 0xffff0000, v114
  v_add_f32 v69, v69, v84
  v_cvt_pk_bf16_f32 v69, v69, v69
  v_and_b32 v69, 0xffff0000, v69
  v_cvt_pk_bf16_f32 v70, v70, v70
  v_and_b32 v70, 0xffff0000, v70
  v_lshlrev_b32 v84, 16, v115
  v_add_f32 v70, v70, v84
  v_cvt_pk_bf16_f32 v70, v70, v70
  v_and_b32 v70, 0xffff0000, v70
  v_cvt_pk_bf16_f32 v71, v71, v71
  v_and_b32 v71, 0xffff0000, v71
  v_and_b32 v84, 0xffff0000, v115
  v_add_f32 v71, v71, v84
  v_cvt_pk_bf16_f32 v71, v71, v71
  v_and_b32 v71, 0xffff0000, v71
  v_cvt_pk_bf16_f32 v72, v72, v72
  v_and_b32 v72, 0xffff0000, v72
  v_lshlrev_b32 v84, 16, v116
  v_add_f32 v72, v72, v84
  v_cvt_pk_bf16_f32 v72, v72, v72
  v_and_b32 v72, 0xffff0000, v72
  v_cvt_pk_bf16_f32 v73, v73, v73
  v_and_b32 v73, 0xffff0000, v73
  v_and_b32 v84, 0xffff0000, v116
  v_add_f32 v73, v73, v84
  v_cvt_pk_bf16_f32 v73, v73, v73
  v_and_b32 v73, 0xffff0000, v73
  v_cvt_pk_bf16_f32 v74, v74, v74
  v_and_b32 v74, 0xffff0000, v74
  v_lshlrev_b32 v84, 16, v117
  v_add_f32 v74, v74, v84
  v_cvt_pk_bf16_f32 v74, v74, v74
  v_and_b32 v74, 0xffff0000, v74
  v_cvt_pk_bf16_f32 v75, v75, v75
  v_and_b32 v75, 0xffff0000, v75
  v_and_b32 v84, 0xffff0000, v117
  v_add_f32 v75, v75, v84
  v_cvt_pk_bf16_f32 v75, v75, v75
  v_and_b32 v75, 0xffff0000, v75
  v_cvt_pk_bf16_f32 v76, v76, v76
  v_and_b32 v76, 0xffff0000, v76
  v_lshlrev_b32 v84, 16, v118
  v_add_f32 v76, v76, v84
  v_cvt_pk_bf16_f32 v76, v76, v76
  v_and_b32 v76, 0xffff0000, v76
  v_cvt_pk_bf16_f32 v77, v77, v77
  v_and_b32 v77, 0xffff0000, v77
  v_and_b32 v84, 0xffff0000, v118
  v_add_f32 v77, v77, v84
  v_cvt_pk_bf16_f32 v77, v77, v77
  v_and_b32 v77, 0xffff0000, v77
  v_cvt_pk_bf16_f32 v78, v78, v78
  v_and_b32 v78, 0xffff0000, v78
  v_lshlrev_b32 v84, 16, v119
  v_add_f32 v78, v78, v84
  v_cvt_pk_bf16_f32 v78, v78, v78
  v_and_b32 v78, 0xffff0000, v78
  v_cvt_pk_bf16_f32 v79, v79, v79
  v_and_b32 v79, 0xffff0000, v79
  v_and_b32 v84, 0xffff0000, v119
  v_add_f32 v79, v79, v84
  v_cvt_pk_bf16_f32 v79, v79, v79
  v_and_b32 v79, 0xffff0000, v79
  v_mul_f32 v84, v64, v64
  v_mov_b32 v88, s36
  v_fma_f32 v84, v84, s37, v88
  v_mul_f32 v84, v84, v64
  v_exp_f32 v84, v84
  s_nop 0
  v_add_f32 v84, 1.0, v84
  v_rcp_f32 v84, v84
  s_nop 0
  v_mul_f32 v64, v64, v84
  v_mul_f32 v85, v65, v65
  v_mov_b32 v88, s36
  v_fma_f32 v85, v85, s37, v88
  v_mul_f32 v85, v85, v65
  v_exp_f32 v85, v85
  s_nop 0
  v_add_f32 v85, 1.0, v85
  v_rcp_f32 v85, v85
  s_nop 0
  v_mul_f32 v65, v65, v85
  v_mul_f32 v86, v66, v66
  v_mov_b32 v88, s36
  v_fma_f32 v86, v86, s37, v88
  v_mul_f32 v86, v86, v66
  v_exp_f32 v86, v86
  s_nop 0
  v_add_f32 v86, 1.0, v86
  v_rcp_f32 v86, v86
  s_nop 0
  v_mul_f32 v66, v66, v86
  v_mul_f32 v87, v67, v67
  v_mov_b32 v88, s36
  v_fma_f32 v87, v87, s37, v88
  v_mul_f32 v87, v87, v67
  v_exp_f32 v87, v87
  s_nop 0
  v_add_f32 v87, 1.0, v87
  v_rcp_f32 v87, v87
  s_nop 0
  v_mul_f32 v67, v67, v87
  v_mul_f32 v84, v68, v68
  v_mov_b32 v88, s36
  v_fma_f32 v84, v84, s37, v88
  v_mul_f32 v84, v84, v68
  v_exp_f32 v84, v84
  s_nop 0
  v_add_f32 v84, 1.0, v84
  v_rcp_f32 v84, v84
  s_nop 0
  v_mul_f32 v68, v68, v84
  v_mul_f32 v85, v69, v69
  v_mov_b32 v88, s36
  v_fma_f32 v85, v85, s37, v88
  v_mul_f32 v85, v85, v69
  v_exp_f32 v85, v85
  s_nop 0
  v_add_f32 v85, 1.0, v85
  v_rcp_f32 v85, v85
  s_nop 0
  v_mul_f32 v69, v69, v85
  v_mul_f32 v86, v70, v70
  v_mov_b32 v88, s36
  v_fma_f32 v86, v86, s37, v88
  v_mul_f32 v86, v86, v70
  v_exp_f32 v86, v86
  s_nop 0
  v_add_f32 v86, 1.0, v86
  v_rcp_f32 v86, v86
  s_nop 0
  v_mul_f32 v70, v70, v86
  v_mul_f32 v87, v71, v71
  v_mov_b32 v88, s36
  v_fma_f32 v87, v87, s37, v88
  v_mul_f32 v87, v87, v71
  v_exp_f32 v87, v87
  s_nop 0
  v_add_f32 v87, 1.0, v87
  v_rcp_f32 v87, v87
  s_nop 0
  v_mul_f32 v71, v71, v87
  v_mul_f32 v84, v72, v72
  v_mov_b32 v88, s36
  v_fma_f32 v84, v84, s37, v88
  v_mul_f32 v84, v84, v72
  v_exp_f32 v84, v84
  s_nop 0
  v_add_f32 v84, 1.0, v84
  v_rcp_f32 v84, v84
  s_nop 0
  v_mul_f32 v72, v72, v84
  v_mul_f32 v85, v73, v73
  v_mov_b32 v88, s36
  v_fma_f32 v85, v85, s37, v88
  v_mul_f32 v85, v85, v73
  v_exp_f32 v85, v85
  s_nop 0
  v_add_f32 v85, 1.0, v85
  v_rcp_f32 v85, v85
  s_nop 0
  v_mul_f32 v73, v73, v85
  v_mul_f32 v86, v74, v74
  v_mov_b32 v88, s36
  v_fma_f32 v86, v86, s37, v88
  v_mul_f32 v86, v86, v74
  v_exp_f32 v86, v86
  s_nop 0
  v_add_f32 v86, 1.0, v86
  v_rcp_f32 v86, v86
  s_nop 0
  v_mul_f32 v74, v74, v86
  v_mul_f32 v87, v75, v75
  v_mov_b32 v88, s36
  v_fma_f32 v87, v87, s37, v88
  v_mul_f32 v87, v87, v75
  v_exp_f32 v87, v87
  s_nop 0
  v_add_f32 v87, 1.0, v87
  v_rcp_f32 v87, v87
  s_nop 0
  v_mul_f32 v75, v75, v87
  v_mul_f32 v84, v76, v76
  v_mov_b32 v88, s36
  v_fma_f32 v84, v84, s37, v88
  v_mul_f32 v84, v84, v76
  v_exp_f32 v84, v84
  s_nop 0
  v_add_f32 v84, 1.0, v84
  v_rcp_f32 v84, v84
  s_nop 0
  v_mul_f32 v76, v76, v84
  v_mul_f32 v85, v77, v77
  v_mov_b32 v88, s36
  v_fma_f32 v85, v85, s37, v88
  v_mul_f32 v85, v85, v77
  v_exp_f32 v85, v85
  s_nop 0
  v_add_f32 v85, 1.0, v85
  v_rcp_f32 v85, v85
  s_nop 0
  v_mul_f32 v77, v77, v85
  v_mul_f32 v86, v78, v78
  v_mov_b32 v88, s36
  v_fma_f32 v86, v86, s37, v88
  v_mul_f32 v86, v86, v78
  v_exp_f32 v86, v86
  s_nop 0
  v_add_f32 v86, 1.0, v86
  v_rcp_f32 v86, v86
  s_nop 0
  v_mul_f32 v78, v78, v86
  v_mul_f32 v87, v79, v79
  v_mov_b32 v88, s36
  v_fma_f32 v87, v87, s37, v88
  v_mul_f32 v87, v87, v79
  v_exp_f32 v87, v87
  s_nop 0
  v_add_f32 v87, 1.0, v87
  v_rcp_f32 v87, v87
  s_nop 0
  v_mul_f32 v79, v79, v87
  v_cvt_pk_bf16_f32 v80, v64, v72
  v_cvt_pk_bf16_f32 v81, v65, v73
  v_cvt_pk_bf16_f32 v82, v66, v74
  v_cvt_pk_bf16_f32 v83, v67, v75
  v_add_u32 v25, 4, v30
  v_xor_b32 v25, v25, v31
  v_lshl_add_u32 v25, v25, 4, v29
  ds_write_b128 v25, v[80:83] offset:8192
  v_cvt_pk_bf16_f32 v80, v68, v76
  v_cvt_pk_bf16_f32 v81, v69, v77
  v_cvt_pk_bf16_f32 v82, v70, v78
  v_cvt_pk_bf16_f32 v83, v71, v79
  v_add_u32 v25, 6, v30
  v_xor_b32 v25, v25, v31
  v_lshl_add_u32 v25, v25, 4, v29
  ds_write_b128 v25, v[80:83] offset:8192
  global_load_lds_dwordx4 v14, s[18:19] offset:2048
  global_load_lds_dwordx4 v15, s[18:19] offset:3072
  s_lshl_b32 s13, s26, 6
  s_add_u32 s18, s18, s13
  s_addc_u32 s19, s19, 0
  s_waitcnt lgkmcnt(0)
  s_barrier
  s_mul_i32 s13, s91, 458752
  s_add_u32 s13, s13, 71303168
  s_lshl_b32 s14, s92, 8
  s_add_u32 s13, s13, s14
  s_add_u32 s30, s4, s13
  s_addc_u32 s31, s5, 0
  v_lshlrev_b32 v25, 4, v22
  s_lshl_b32 s13, s10, 13
  s_add_u32 s13, s13, 98304
  v_add_u32 v25, s13, v25
  ds_read_b128 v[64:67], v25 offset:0
  ds_read_b128 v[68:71], v25 offset:1024
  ds_read_b128 v[72:75], v25 offset:2048
  ds_read_b128 v[76:79], v25 offset:3072
  ds_read_b128 v[80:83], v25 offset:4096
  ds_read_b128 v[84:87], v25 offset:5120
  ds_read_b128 v[88:91], v25 offset:6144
  ds_read_b128 v[92:95], v25 offset:7168
  v_lshrrev_b32 v27, 4, v22
  s_lshl_b32 s13, s10, 5
  v_add_u32 v27, s13, v27
  v_add_u32 v28, 0, v27
  v_xor_b32 v26, v28, v22
  v_and_b32 v26, 15, v26
  v_mul_u32_u24 v28, 3584, v28
  v_lshl_add_u32 v96, v26, 4, v28
  v_add_u32 v28, 4, v27
  v_xor_b32 v26, v28, v22
  v_and_b32 v26, 15, v26
  v_mul_u32_u24 v28, 3584, v28
  v_lshl_add_u32 v97, v26, 4, v28
  v_add_u32 v28, 8, v27
  v_xor_b32 v26, v28, v22
  v_and_b32 v26, 15, v26
  v_mul_u32_u24 v28, 3584, v28
  v_lshl_add_u32 v98, v26, 4, v28
  v_add_u32 v28, 12, v27
  v_xor_b32 v26, v28, v22
  v_and_b32 v26, 15, v26
  v_mul_u32_u24 v28, 3584, v28
  v_lshl_add_u32 v99, v26, 4, v28
  v_add_u32 v28, 16, v27
  v_xor_b32 v26, v28, v22
  v_and_b32 v26, 15, v26
  v_mul_u32_u24 v28, 3584, v28
  v_lshl_add_u32 v100, v26, 4, v28
  v_add_u32 v28, 20, v27
  v_xor_b32 v26, v28, v22
  v_and_b32 v26, 15, v26
  v_mul_u32_u24 v28, 3584, v28
  v_lshl_add_u32 v101, v26, 4, v28
  v_add_u32 v28, 24, v27
  v_xor_b32 v26, v28, v22
  v_and_b32 v26, 15, v26
  v_mul_u32_u24 v28, 3584, v28
  v_lshl_add_u32 v102, v26, 4, v28
  v_add_u32 v28, 28, v27
  v_xor_b32 v26, v28, v22
  v_and_b32 v26, 15, v26
  v_mul_u32_u24 v28, 3584, v28
  v_lshl_add_u32 v103, v26, 4, v28
  s_add_u32 m0, s27, 16384
  s_nop 0
  global_load_lds_dwordx4 v8, s[16:17] offset:0
  global_load_lds_dwordx4 v9, s[16:17] offset:1024
  global_load_lds_dwordx4 v10, s[16:17] offset:2048
  global_load_lds_dwordx4 v11, s[16:17] offset:3072
  s_add_u32 s16, s16, 128
  s_addc_u32 s17, s17, 0
  s_add_u32 m0, s28, 16384
  s_nop 0
  global_load_lds_dwordx4 v12, s[18:19] offset:0
  global_load_lds_dwordx4 v13, s[18:19] offset:1024
  global_load_lds_dwordx4 v14, s[18:19] offset:2048
  global_load_lds_dwordx4 v15, s[18:19] offset:3072
  s_lshl_b32 s13, s26, 6
  s_add_u32 s18, s18, s13
  s_addc_u32 s19, s19, 0
  s_waitcnt lgkmcnt(7)
  global_store_dwordx4 v96, v[64:67], s[30:31] sc1
  s_waitcnt lgkmcnt(6)
  global_store_dwordx4 v97, v[68:71], s[30:31] sc1
  s_waitcnt lgkmcnt(5)
  global_store_dwordx4 v98, v[72:75], s[30:31] sc1
  s_waitcnt lgkmcnt(4)
  global_store_dwordx4 v99, v[76:79], s[30:31] sc1
  s_waitcnt lgkmcnt(3)
  global_store_dwordx4 v100, v[80:83], s[30:31] sc1
  s_waitcnt lgkmcnt(2)
  global_store_dwordx4 v101, v[84:87], s[30:31] sc1
  s_waitcnt lgkmcnt(1)
  global_store_dwordx4 v102, v[88:91], s[30:31] sc1
  s_waitcnt lgkmcnt(0)
  global_store_dwordx4 v103, v[92:95], s[30:31] sc1
  s_lshl_b32 s94, s91, 8
  s_add_u32 s94, s94, 94400512
  s_lshl_b32 s14, s92, 4
  s_add_u32 s94, s94, s14
  s_branch Le_done_213
Le_v_210:
  s_lshl_b32 s13, s91, 20
  s_lshl_b32 s14, s92, 13
  s_add_u32 s13, s13, s14
  s_add_u32 s13, s13, 37748736
  s_add_u32 s30, s4, s13
  s_addc_u32 s31, s5, 0
  s_lshr_b32 s13, s10, 1
  s_lshl_b32 s13, s13, 14
  s_and_b32 s14, s10, 1
  s_lshl_b32 s14, s14, 12
  s_add_u32 s13, s13, s14
  s_add_u32 s13, s13, 98304
  v_lshlrev_b32 v29, 6, v23
  v_lshl_add_u32 v29, v24, 4, v29
  v_add_u32 v29, s13, v29
  v_cvt_pk_bf16_f32 v64, v128, v129
  v_cvt_pk_bf16_f32 v65, v130, v131
  v_cvt_pk_bf16_f32 v66, v136, v137
  v_cvt_pk_bf16_f32 v67, v138, v139
  ds_write_b128 v29, v[64:67] offset:0
  v_cvt_pk_bf16_f32 v68, v132, v133
  v_cvt_pk_bf16_f32 v69, v134, v135
  v_cvt_pk_bf16_f32 v70, v140, v141
  v_cvt_pk_bf16_f32 v71, v142, v143
  ds_write_b128 v29, v[68:71] offset:32
  s_add_u32 m0, s27, 0
  s_nop 0
  global_load_lds_dwordx4 v8, s[16:17] offset:0
  global_load_lds_dwordx4 v9, s[16:17] offset:1024
  v_cvt_pk_bf16_f32 v64, v144, v145
  v_cvt_pk_bf16_f32 v65, v146, v147
  v_cvt_pk_bf16_f32 v66, v152, v153
  v_cvt_pk_bf16_f32 v67, v154, v155
  ds_write_b128 v29, v[64:67] offset:2048
  v_cvt_pk_bf16_f32 v68, v148, v149
  v_cvt_pk_bf16_f32 v69, v150, v151
  v_cvt_pk_bf16_f32 v70, v156, v157
  v_cvt_pk_bf16_f32 v71, v158, v159
  ds_write_b128 v29, v[68:71] offset:2080
  global_load_lds_dwordx4 v10, s[16:17] offset:2048
  global_load_lds_dwordx4 v11, s[16:17] offset:3072
  s_add_u32 s16, s16, 128
  s_addc_u32 s17, s17, 0
  v_cvt_pk_bf16_f32 v64, v160, v161
  v_cvt_pk_bf16_f32 v65, v162, v163
  v_cvt_pk_bf16_f32 v66, v168, v169
  v_cvt_pk_bf16_f32 v67, v170, v171
  ds_write_b128 v29, v[64:67] offset:8192
  v_cvt_pk_bf16_f32 v68, v164, v165
  v_cvt_pk_bf16_f32 v69, v166, v167
  v_cvt_pk_bf16_f32 v70, v172, v173
  v_cvt_pk_bf16_f32 v71, v174, v175
  ds_write_b128 v29, v[68:71] offset:8224
  s_add_u32 m0, s28, 0
  s_nop 0
  global_load_lds_dwordx4 v12, s[18:19] offset:0
  global_load_lds_dwordx4 v13, s[18:19] offset:1024
  v_cvt_pk_bf16_f32 v64, v176, v177
  v_cvt_pk_bf16_f32 v65, v178, v179
  v_cvt_pk_bf16_f32 v66, v184, v185
  v_cvt_pk_bf16_f32 v67, v186, v187
  ds_write_b128 v29, v[64:67] offset:10240
  v_cvt_pk_bf16_f32 v68, v180, v181
  v_cvt_pk_bf16_f32 v69, v182, v183
  v_cvt_pk_bf16_f32 v70, v188, v189
  v_cvt_pk_bf16_f32 v71, v190, v191
  ds_write_b128 v29, v[68:71] offset:10272
  global_load_lds_dwordx4 v14, s[18:19] offset:2048
  global_load_lds_dwordx4 v15, s[18:19] offset:3072
  s_lshl_b32 s13, s26, 6
  s_add_u32 s18, s18, s13
  s_addc_u32 s19, s19, 0
  s_waitcnt lgkmcnt(0)
  s_barrier
  v_lshlrev_b32 v25, 4, v22
  s_lshl_b32 s13, s10, 13
  s_add_u32 s13, s13, 98304
  v_add_u32 v26, s13, v25
  ds_read_b128 v[64:67], v26 offset:0
  ds_read_b128 v[68:71], v26 offset:1024
  ds_read_b128 v[72:75], v26 offset:2048
  ds_read_b128 v[76:79], v26 offset:3072
  ds_read_b128 v[80:83], v26 offset:4096
  ds_read_b128 v[84:87], v26 offset:5120
  ds_read_b128 v[88:91], v26 offset:6144
  ds_read_b128 v[92:95], v26 offset:7168
  s_lshl_b32 s13, s10, 18
  s_add_u32 s34, s30, s13
  s_addc_u32 s35, s31, 0
  v_add_u32 v27, 4096, v25
  s_add_u32 m0, s27, 16384
  s_nop 0
  global_load_lds_dwordx4 v8, s[16:17] offset:0
  global_load_lds_dwordx4 v9, s[16:17] offset:1024
  global_load_lds_dwordx4 v10, s[16:17] offset:2048
  global_load_lds_dwordx4 v11, s[16:17] offset:3072
  s_add_u32 s16, s16, 128
  s_addc_u32 s17, s17, 0
  s_add_u32 m0, s28, 16384
  s_nop 0
  global_load_lds_dwordx4 v12, s[18:19] offset:0
  global_load_lds_dwordx4 v13, s[18:19] offset:1024
  global_load_lds_dwordx4 v14, s[18:19] offset:2048
  global_load_lds_dwordx4 v15, s[18:19] offset:3072
  s_lshl_b32 s13, s26, 6
  s_add_u32 s18, s18, s13
  s_addc_u32 s19, s19, 0
  s_waitcnt lgkmcnt(7)
  global_store_dwordx4 v25, v[64:67], s[34:35] offset:0 sc1
  s_waitcnt lgkmcnt(6)
  global_store_dwordx4 v25, v[68:71], s[34:35] offset:1024 sc1
  s_waitcnt lgkmcnt(5)
  global_store_dwordx4 v25, v[72:75], s[34:35] offset:2048 sc1
  s_waitcnt lgkmcnt(4)
  global_store_dwordx4 v25, v[76:79], s[34:35] offset:3072 sc1
  s_waitcnt lgkmcnt(3)
  global_store_dwordx4 v27, v[80:83], s[34:35] offset:0 sc1
  s_waitcnt lgkmcnt(2)
  global_store_dwordx4 v27, v[84:87], s[34:35] offset:1024 sc1
  s_waitcnt lgkmcnt(1)
  global_store_dwordx4 v27, v[88:91], s[34:35] offset:2048 sc1
  s_waitcnt lgkmcnt(0)
  global_store_dwordx4 v27, v[92:95], s[34:35] offset:3072 sc1
  s_lshl_b32 s94, s91, 9
  s_add_u32 s94, s94, 94384128
  s_lshl_b32 s14, s92, 4
  s_add_u32 s94, s94, s14
  s_branch Le_done_213
Le_b_211:
  s_lshr_b32 s13, s10, 1
  s_lshl_b32 s13, s13, 14
  s_add_u32 s13, s13, 98304
  v_lshlrev_b32 v29, 8, v23
  v_add_u32 v29, s13, v29
  v_and_b32 v31, 15, v23
  s_lshl_b32 s13, s92, 8
  s_and_b32 s14, s10, 1
  s_lshl_b32 s14, s14, 7
  s_add_u32 s13, s13, s14
  s_add_u32 s34, s52, s13
  s_addc_u32 s35, s53, 0
  v_lshlrev_b32 v25, 3, v24
  global_load_dwordx2 v[104:105], v25, s[34:35] offset:0
  global_load_dwordx2 v[106:107], v25, s[34:35] offset:16
  global_load_dwordx2 v[108:109], v25, s[34:35] offset:32
  global_load_dwordx2 v[110:111], v25, s[34:35] offset:48
  global_load_dwordx2 v[112:113], v25, s[34:35] offset:64
  global_load_dwordx2 v[114:115], v25, s[34:35] offset:80
  global_load_dwordx2 v[116:117], v25, s[34:35] offset:96
  global_load_dwordx2 v[118:119], v25, s[34:35] offset:112
  s_and_b32 s14, s10, 1
  s_lshl_b32 s14, s14, 3
  s_waitcnt vmcnt(0)
  v_mov_b64 v[64:65], v[128:129]
  v_mov_b64 v[66:67], v[130:131]
  v_mov_b64 v[68:69], v[132:133]
  v_mov_b64 v[70:71], v[134:135]
  v_mov_b64 v[72:73], v[136:137]
  v_mov_b64 v[74:75], v[138:139]
  v_mov_b64 v[76:77], v[140:141]
  v_mov_b64 v[78:79], v[142:143]
  v_cvt_pk_bf16_f32 v64, v64, v64
  v_and_b32 v64, 0xffff0000, v64
  v_lshlrev_b32 v84, 16, v104
  v_add_f32 v64, v64, v84
  v_cvt_pk_bf16_f32 v65, v65, v65
  v_and_b32 v65, 0xffff0000, v65
  v_and_b32 v84, 0xffff0000, v104
  v_add_f32 v65, v65, v84
  v_cvt_pk_bf16_f32 v66, v66, v66
  v_and_b32 v66, 0xffff0000, v66
  v_lshlrev_b32 v84, 16, v105
  v_add_f32 v66, v66, v84
  v_cvt_pk_bf16_f32 v67, v67, v67
  v_and_b32 v67, 0xffff0000, v67
  v_and_b32 v84, 0xffff0000, v105
  v_add_f32 v67, v67, v84
  v_cvt_pk_bf16_f32 v80, v64, v65
  v_cvt_pk_bf16_f32 v81, v66, v67
  s_add_u32 s13, s14, 0
  v_xor_b32 v25, s13, v31
  v_lshl_add_u32 v25, v25, 4, v29
  v_lshl_add_u32 v25, v24, 3, v25
  ds_write_b64 v25, v[80:81] offset:0
  v_cvt_pk_bf16_f32 v68, v68, v68
  v_and_b32 v68, 0xffff0000, v68
  v_lshlrev_b32 v84, 16, v106
  v_add_f32 v68, v68, v84
  v_cvt_pk_bf16_f32 v69, v69, v69
  v_and_b32 v69, 0xffff0000, v69
  v_and_b32 v84, 0xffff0000, v106
  v_add_f32 v69, v69, v84
  v_cvt_pk_bf16_f32 v70, v70, v70
  v_and_b32 v70, 0xffff0000, v70
  v_lshlrev_b32 v84, 16, v107
  v_add_f32 v70, v70, v84
  v_cvt_pk_bf16_f32 v71, v71, v71
  v_and_b32 v71, 0xffff0000, v71
  v_and_b32 v84, 0xffff0000, v107
  v_add_f32 v71, v71, v84
  v_cvt_pk_bf16_f32 v80, v68, v69
  v_cvt_pk_bf16_f32 v81, v70, v71
  s_add_u32 s13, s14, 1
  v_xor_b32 v25, s13, v31
  v_lshl_add_u32 v25, v25, 4, v29
  v_lshl_add_u32 v25, v24, 3, v25
  ds_write_b64 v25, v[80:81] offset:0
  v_cvt_pk_bf16_f32 v72, v72, v72
  v_and_b32 v72, 0xffff0000, v72
  v_lshlrev_b32 v84, 16, v108
  v_add_f32 v72, v72, v84
  v_cvt_pk_bf16_f32 v73, v73, v73
  v_and_b32 v73, 0xffff0000, v73
  v_and_b32 v84, 0xffff0000, v108
  v_add_f32 v73, v73, v84
  v_cvt_pk_bf16_f32 v74, v74, v74
  v_and_b32 v74, 0xffff0000, v74
  v_lshlrev_b32 v84, 16, v109
  v_add_f32 v74, v74, v84
  v_cvt_pk_bf16_f32 v75, v75, v75
  v_and_b32 v75, 0xffff0000, v75
  v_and_b32 v84, 0xffff0000, v109
  v_add_f32 v75, v75, v84
  v_cvt_pk_bf16_f32 v80, v72, v73
  v_cvt_pk_bf16_f32 v81, v74, v75
  s_add_u32 s13, s14, 2
  v_xor_b32 v25, s13, v31
  v_lshl_add_u32 v25, v25, 4, v29
  v_lshl_add_u32 v25, v24, 3, v25
  ds_write_b64 v25, v[80:81] offset:0
  v_cvt_pk_bf16_f32 v76, v76, v76
  v_and_b32 v76, 0xffff0000, v76
  v_lshlrev_b32 v84, 16, v110
  v_add_f32 v76, v76, v84
  v_cvt_pk_bf16_f32 v77, v77, v77
  v_and_b32 v77, 0xffff0000, v77
  v_and_b32 v84, 0xffff0000, v110
  v_add_f32 v77, v77, v84
  v_cvt_pk_bf16_f32 v78, v78, v78
  v_and_b32 v78, 0xffff0000, v78
  v_lshlrev_b32 v84, 16, v111
  v_add_f32 v78, v78, v84
  v_cvt_pk_bf16_f32 v79, v79, v79
  v_and_b32 v79, 0xffff0000, v79
  v_and_b32 v84, 0xffff0000, v111
  v_add_f32 v79, v79, v84
  v_cvt_pk_bf16_f32 v80, v76, v77
  v_cvt_pk_bf16_f32 v81, v78, v79
  s_add_u32 s13, s14, 3
  v_xor_b32 v25, s13, v31
  v_lshl_add_u32 v25, v25, 4, v29
  v_lshl_add_u32 v25, v24, 3, v25
  ds_write_b64 v25, v[80:81] offset:0
  s_add_u32 m0, s27, 0
  s_nop 0
  global_load_lds_dwordx4 v8, s[16:17] offset:0
  global_load_lds_dwordx4 v9, s[16:17] offset:1024
  v_mov_b64 v[64:65], v[144:145]
  v_mov_b64 v[66:67], v[146:147]
  v_mov_b64 v[68:69], v[148:149]
  v_mov_b64 v[70:71], v[150:151]
  v_mov_b64 v[72:73], v[152:153]
  v_mov_b64 v[74:75], v[154:155]
  v_mov_b64 v[76:77], v[156:157]
  v_mov_b64 v[78:79], v[158:159]
  v_cvt_pk_bf16_f32 v64, v64, v64
  v_and_b32 v64, 0xffff0000, v64
  v_lshlrev_b32 v84, 16, v112
  v_add_f32 v64, v64, v84
  v_cvt_pk_bf16_f32 v65, v65, v65
  v_and_b32 v65, 0xffff0000, v65
  v_and_b32 v84, 0xffff0000, v112
  v_add_f32 v65, v65, v84
  v_cvt_pk_bf16_f32 v66, v66, v66
  v_and_b32 v66, 0xffff0000, v66
  v_lshlrev_b32 v84, 16, v113
  v_add_f32 v66, v66, v84
  v_cvt_pk_bf16_f32 v67, v67, v67
  v_and_b32 v67, 0xffff0000, v67
  v_and_b32 v84, 0xffff0000, v113
  v_add_f32 v67, v67, v84
  v_cvt_pk_bf16_f32 v80, v64, v65
  v_cvt_pk_bf16_f32 v81, v66, v67
  s_add_u32 s13, s14, 4
  v_xor_b32 v25, s13, v31
  v_lshl_add_u32 v25, v25, 4, v29
  v_lshl_add_u32 v25, v24, 3, v25
  ds_write_b64 v25, v[80:81] offset:0
  v_cvt_pk_bf16_f32 v68, v68, v68
  v_and_b32 v68, 0xffff0000, v68
  v_lshlrev_b32 v84, 16, v114
  v_add_f32 v68, v68, v84
  v_cvt_pk_bf16_f32 v69, v69, v69
  v_and_b32 v69, 0xffff0000, v69
  v_and_b32 v84, 0xffff0000, v114
  v_add_f32 v69, v69, v84
  v_cvt_pk_bf16_f32 v70, v70, v70
  v_and_b32 v70, 0xffff0000, v70
  v_lshlrev_b32 v84, 16, v115
  v_add_f32 v70, v70, v84
  v_cvt_pk_bf16_f32 v71, v71, v71
  v_and_b32 v71, 0xffff0000, v71
  v_and_b32 v84, 0xffff0000, v115
  v_add_f32 v71, v71, v84
  v_cvt_pk_bf16_f32 v80, v68, v69
  v_cvt_pk_bf16_f32 v81, v70, v71
  s_add_u32 s13, s14, 5
  v_xor_b32 v25, s13, v31
  v_lshl_add_u32 v25, v25, 4, v29
  v_lshl_add_u32 v25, v24, 3, v25
  ds_write_b64 v25, v[80:81] offset:0
  v_cvt_pk_bf16_f32 v72, v72, v72
  v_and_b32 v72, 0xffff0000, v72
  v_lshlrev_b32 v84, 16, v116
  v_add_f32 v72, v72, v84
  v_cvt_pk_bf16_f32 v73, v73, v73
  v_and_b32 v73, 0xffff0000, v73
  v_and_b32 v84, 0xffff0000, v116
  v_add_f32 v73, v73, v84
  v_cvt_pk_bf16_f32 v74, v74, v74
  v_and_b32 v74, 0xffff0000, v74
  v_lshlrev_b32 v84, 16, v117
  v_add_f32 v74, v74, v84
  v_cvt_pk_bf16_f32 v75, v75, v75
  v_and_b32 v75, 0xffff0000, v75
  v_and_b32 v84, 0xffff0000, v117
  v_add_f32 v75, v75, v84
  v_cvt_pk_bf16_f32 v80, v72, v73
  v_cvt_pk_bf16_f32 v81, v74, v75
  s_add_u32 s13, s14, 6
  v_xor_b32 v25, s13, v31
  v_lshl_add_u32 v25, v25, 4, v29
  v_lshl_add_u32 v25, v24, 3, v25
  ds_write_b64 v25, v[80:81] offset:0
  v_cvt_pk_bf16_f32 v76, v76, v76
  v_and_b32 v76, 0xffff0000, v76
  v_lshlrev_b32 v84, 16, v118
  v_add_f32 v76, v76, v84
  v_cvt_pk_bf16_f32 v77, v77, v77
  v_and_b32 v77, 0xffff0000, v77
  v_and_b32 v84, 0xffff0000, v118
  v_add_f32 v77, v77, v84
  v_cvt_pk_bf16_f32 v78, v78, v78
  v_and_b32 v78, 0xffff0000, v78
  v_lshlrev_b32 v84, 16, v119
  v_add_f32 v78, v78, v84
  v_cvt_pk_bf16_f32 v79, v79, v79
  v_and_b32 v79, 0xffff0000, v79
  v_and_b32 v84, 0xffff0000, v119
  v_add_f32 v79, v79, v84
  v_cvt_pk_bf16_f32 v80, v76, v77
  v_cvt_pk_bf16_f32 v81, v78, v79
  s_add_u32 s13, s14, 7
  v_xor_b32 v25, s13, v31
  v_lshl_add_u32 v25, v25, 4, v29
  v_lshl_add_u32 v25, v24, 3, v25
  ds_write_b64 v25, v[80:81] offset:0
  global_load_lds_dwordx4 v10, s[16:17] offset:2048
  global_load_lds_dwordx4 v11, s[16:17] offset:3072
  s_add_u32 s16, s16, 128
  s_addc_u32 s17, s17, 0
  v_mov_b64 v[64:65], v[160:161]
  v_mov_b64 v[66:67], v[162:163]
  v_mov_b64 v[68:69], v[164:165]
  v_mov_b64 v[70:71], v[166:167]
  v_mov_b64 v[72:73], v[168:169]
  v_mov_b64 v[74:75], v[170:171]
  v_mov_b64 v[76:77], v[172:173]
  v_mov_b64 v[78:79], v[174:175]
  v_cvt_pk_bf16_f32 v64, v64, v64
  v_and_b32 v64, 0xffff0000, v64
  v_lshlrev_b32 v84, 16, v104
  v_add_f32 v64, v64, v84
  v_cvt_pk_bf16_f32 v65, v65, v65
  v_and_b32 v65, 0xffff0000, v65
  v_and_b32 v84, 0xffff0000, v104
  v_add_f32 v65, v65, v84
  v_cvt_pk_bf16_f32 v66, v66, v66
  v_and_b32 v66, 0xffff0000, v66
  v_lshlrev_b32 v84, 16, v105
  v_add_f32 v66, v66, v84
  v_cvt_pk_bf16_f32 v67, v67, v67
  v_and_b32 v67, 0xffff0000, v67
  v_and_b32 v84, 0xffff0000, v105
  v_add_f32 v67, v67, v84
  v_cvt_pk_bf16_f32 v80, v64, v65
  v_cvt_pk_bf16_f32 v81, v66, v67
  s_add_u32 s13, s14, 0
  v_xor_b32 v25, s13, v31
  v_lshl_add_u32 v25, v25, 4, v29
  v_lshl_add_u32 v25, v24, 3, v25
  ds_write_b64 v25, v[80:81] offset:8192
  v_cvt_pk_bf16_f32 v68, v68, v68
  v_and_b32 v68, 0xffff0000, v68
  v_lshlrev_b32 v84, 16, v106
  v_add_f32 v68, v68, v84
  v_cvt_pk_bf16_f32 v69, v69, v69
  v_and_b32 v69, 0xffff0000, v69
  v_and_b32 v84, 0xffff0000, v106
  v_add_f32 v69, v69, v84
  v_cvt_pk_bf16_f32 v70, v70, v70
  v_and_b32 v70, 0xffff0000, v70
  v_lshlrev_b32 v84, 16, v107
  v_add_f32 v70, v70, v84
  v_cvt_pk_bf16_f32 v71, v71, v71
  v_and_b32 v71, 0xffff0000, v71
  v_and_b32 v84, 0xffff0000, v107
  v_add_f32 v71, v71, v84
  v_cvt_pk_bf16_f32 v80, v68, v69
  v_cvt_pk_bf16_f32 v81, v70, v71
  s_add_u32 s13, s14, 1
  v_xor_b32 v25, s13, v31
  v_lshl_add_u32 v25, v25, 4, v29
  v_lshl_add_u32 v25, v24, 3, v25
  ds_write_b64 v25, v[80:81] offset:8192
  v_cvt_pk_bf16_f32 v72, v72, v72
  v_and_b32 v72, 0xffff0000, v72
  v_lshlrev_b32 v84, 16, v108
  v_add_f32 v72, v72, v84
  v_cvt_pk_bf16_f32 v73, v73, v73
  v_and_b32 v73, 0xffff0000, v73
  v_and_b32 v84, 0xffff0000, v108
  v_add_f32 v73, v73, v84
  v_cvt_pk_bf16_f32 v74, v74, v74
  v_and_b32 v74, 0xffff0000, v74
  v_lshlrev_b32 v84, 16, v109
  v_add_f32 v74, v74, v84
  v_cvt_pk_bf16_f32 v75, v75, v75
  v_and_b32 v75, 0xffff0000, v75
  v_and_b32 v84, 0xffff0000, v109
  v_add_f32 v75, v75, v84
  v_cvt_pk_bf16_f32 v80, v72, v73
  v_cvt_pk_bf16_f32 v81, v74, v75
  s_add_u32 s13, s14, 2
  v_xor_b32 v25, s13, v31
  v_lshl_add_u32 v25, v25, 4, v29
  v_lshl_add_u32 v25, v24, 3, v25
  ds_write_b64 v25, v[80:81] offset:8192
  v_cvt_pk_bf16_f32 v76, v76, v76
  v_and_b32 v76, 0xffff0000, v76
  v_lshlrev_b32 v84, 16, v110
  v_add_f32 v76, v76, v84
  v_cvt_pk_bf16_f32 v77, v77, v77
  v_and_b32 v77, 0xffff0000, v77
  v_and_b32 v84, 0xffff0000, v110
  v_add_f32 v77, v77, v84
  v_cvt_pk_bf16_f32 v78, v78, v78
  v_and_b32 v78, 0xffff0000, v78
  v_lshlrev_b32 v84, 16, v111
  v_add_f32 v78, v78, v84
  v_cvt_pk_bf16_f32 v79, v79, v79
  v_and_b32 v79, 0xffff0000, v79
  v_and_b32 v84, 0xffff0000, v111
  v_add_f32 v79, v79, v84
  v_cvt_pk_bf16_f32 v80, v76, v77
  v_cvt_pk_bf16_f32 v81, v78, v79
  s_add_u32 s13, s14, 3
  v_xor_b32 v25, s13, v31
  v_lshl_add_u32 v25, v25, 4, v29
  v_lshl_add_u32 v25, v24, 3, v25
  ds_write_b64 v25, v[80:81] offset:8192
  s_add_u32 m0, s28, 0
  s_nop 0
  global_load_lds_dwordx4 v12, s[18:19] offset:0
  global_load_lds_dwordx4 v13, s[18:19] offset:1024
  v_mov_b64 v[64:65], v[176:177]
  v_mov_b64 v[66:67], v[178:179]
  v_mov_b64 v[68:69], v[180:181]
  v_mov_b64 v[70:71], v[182:183]
  v_mov_b64 v[72:73], v[184:185]
  v_mov_b64 v[74:75], v[186:187]
  v_mov_b64 v[76:77], v[188:189]
  v_mov_b64 v[78:79], v[190:191]
  v_cvt_pk_bf16_f32 v64, v64, v64
  v_and_b32 v64, 0xffff0000, v64
  v_lshlrev_b32 v84, 16, v112
  v_add_f32 v64, v64, v84
  v_cvt_pk_bf16_f32 v65, v65, v65
  v_and_b32 v65, 0xffff0000, v65
  v_and_b32 v84, 0xffff0000, v112
  v_add_f32 v65, v65, v84
  v_cvt_pk_bf16_f32 v66, v66, v66
  v_and_b32 v66, 0xffff0000, v66
  v_lshlrev_b32 v84, 16, v113
  v_add_f32 v66, v66, v84
  v_cvt_pk_bf16_f32 v67, v67, v67
  v_and_b32 v67, 0xffff0000, v67
  v_and_b32 v84, 0xffff0000, v113
  v_add_f32 v67, v67, v84
  v_cvt_pk_bf16_f32 v80, v64, v65
  v_cvt_pk_bf16_f32 v81, v66, v67
  s_add_u32 s13, s14, 4
  v_xor_b32 v25, s13, v31
  v_lshl_add_u32 v25, v25, 4, v29
  v_lshl_add_u32 v25, v24, 3, v25
  ds_write_b64 v25, v[80:81] offset:8192
  v_cvt_pk_bf16_f32 v68, v68, v68
  v_and_b32 v68, 0xffff0000, v68
  v_lshlrev_b32 v84, 16, v114
  v_add_f32 v68, v68, v84
  v_cvt_pk_bf16_f32 v69, v69, v69
  v_and_b32 v69, 0xffff0000, v69
  v_and_b32 v84, 0xffff0000, v114
  v_add_f32 v69, v69, v84
  v_cvt_pk_bf16_f32 v70, v70, v70
  v_and_b32 v70, 0xffff0000, v70
  v_lshlrev_b32 v84, 16, v115
  v_add_f32 v70, v70, v84
  v_cvt_pk_bf16_f32 v71, v71, v71
  v_and_b32 v71, 0xffff0000, v71
  v_and_b32 v84, 0xffff0000, v115
  v_add_f32 v71, v71, v84
  v_cvt_pk_bf16_f32 v80, v68, v69
  v_cvt_pk_bf16_f32 v81, v70, v71
  s_add_u32 s13, s14, 5
  v_xor_b32 v25, s13, v31
  v_lshl_add_u32 v25, v25, 4, v29
  v_lshl_add_u32 v25, v24, 3, v25
  ds_write_b64 v25, v[80:81] offset:8192
  v_cvt_pk_bf16_f32 v72, v72, v72
  v_and_b32 v72, 0xffff0000, v72
  v_lshlrev_b32 v84, 16, v116
  v_add_f32 v72, v72, v84
  v_cvt_pk_bf16_f32 v73, v73, v73
  v_and_b32 v73, 0xffff0000, v73
  v_and_b32 v84, 0xffff0000, v116
  v_add_f32 v73, v73, v84
  v_cvt_pk_bf16_f32 v74, v74, v74
  v_and_b32 v74, 0xffff0000, v74
  v_lshlrev_b32 v84, 16, v117
  v_add_f32 v74, v74, v84
  v_cvt_pk_bf16_f32 v75, v75, v75
  v_and_b32 v75, 0xffff0000, v75
  v_and_b32 v84, 0xffff0000, v117
  v_add_f32 v75, v75, v84
  v_cvt_pk_bf16_f32 v80, v72, v73
  v_cvt_pk_bf16_f32 v81, v74, v75
  s_add_u32 s13, s14, 6
  v_xor_b32 v25, s13, v31
  v_lshl_add_u32 v25, v25, 4, v29
  v_lshl_add_u32 v25, v24, 3, v25
  ds_write_b64 v25, v[80:81] offset:8192
  v_cvt_pk_bf16_f32 v76, v76, v76
  v_and_b32 v76, 0xffff0000, v76
  v_lshlrev_b32 v84, 16, v118
  v_add_f32 v76, v76, v84
  v_cvt_pk_bf16_f32 v77, v77, v77
  v_and_b32 v77, 0xffff0000, v77
  v_and_b32 v84, 0xffff0000, v118
  v_add_f32 v77, v77, v84
  v_cvt_pk_bf16_f32 v78, v78, v78
  v_and_b32 v78, 0xffff0000, v78
  v_lshlrev_b32 v84, 16, v119
  v_add_f32 v78, v78, v84
  v_cvt_pk_bf16_f32 v79, v79, v79
  v_and_b32 v79, 0xffff0000, v79
  v_and_b32 v84, 0xffff0000, v119
  v_add_f32 v79, v79, v84
  v_cvt_pk_bf16_f32 v80, v76, v77
  v_cvt_pk_bf16_f32 v81, v78, v79
  s_add_u32 s13, s14, 7
  v_xor_b32 v25, s13, v31
  v_lshl_add_u32 v25, v25, 4, v29
  v_lshl_add_u32 v25, v24, 3, v25
  ds_write_b64 v25, v[80:81] offset:8192
  global_load_lds_dwordx4 v14, s[18:19] offset:2048
  global_load_lds_dwordx4 v15, s[18:19] offset:3072
  s_lshl_b32 s13, s26, 6
  s_add_u32 s18, s18, s13
  s_addc_u32 s19, s19, 0
  s_waitcnt lgkmcnt(0)
  s_barrier
  s_lshl_b32 s13, s91, 17
  s_add_u32 s13, s13, 79691776
  s_lshl_b32 s14, s92, 8
  s_add_u32 s13, s13, s14
  s_add_u32 s30, s4, s13
  s_addc_u32 s31, s5, 0
  v_lshlrev_b32 v25, 4, v22
  s_lshl_b32 s13, s10, 13
  s_add_u32 s13, s13, 98304
  v_add_u32 v25, s13, v25
  ds_read_b128 v[64:67], v25 offset:0
  ds_read_b128 v[68:71], v25 offset:1024
  ds_read_b128 v[72:75], v25 offset:2048
  ds_read_b128 v[76:79], v25 offset:3072
  ds_read_b128 v[80:83], v25 offset:4096
  ds_read_b128 v[84:87], v25 offset:5120
  ds_read_b128 v[88:91], v25 offset:6144
  ds_read_b128 v[92:95], v25 offset:7168
  v_lshrrev_b32 v27, 4, v22
  s_lshl_b32 s13, s10, 5
  v_add_u32 v27, s13, v27
  v_add_u32 v28, 0, v27
  v_xor_b32 v26, v28, v22
  v_and_b32 v26, 15, v26
  v_mul_u32_u24 v28, 1024, v28
  v_lshl_add_u32 v96, v26, 4, v28
  v_add_u32 v28, 4, v27
  v_xor_b32 v26, v28, v22
  v_and_b32 v26, 15, v26
  v_mul_u32_u24 v28, 1024, v28
  v_lshl_add_u32 v97, v26, 4, v28
  v_add_u32 v28, 8, v27
  v_xor_b32 v26, v28, v22
  v_and_b32 v26, 15, v26
  v_mul_u32_u24 v28, 1024, v28
  v_lshl_add_u32 v98, v26, 4, v28
  v_add_u32 v28, 12, v27
  v_xor_b32 v26, v28, v22
  v_and_b32 v26, 15, v26
  v_mul_u32_u24 v28, 1024, v28
  v_lshl_add_u32 v99, v26, 4, v28
  v_add_u32 v28, 16, v27
  v_xor_b32 v26, v28, v22
  v_and_b32 v26, 15, v26
  v_mul_u32_u24 v28, 1024, v28
  v_lshl_add_u32 v100, v26, 4, v28
  v_add_u32 v28, 20, v27
  v_xor_b32 v26, v28, v22
  v_and_b32 v26, 15, v26
  v_mul_u32_u24 v28, 1024, v28
  v_lshl_add_u32 v101, v26, 4, v28
  v_add_u32 v28, 24, v27
  v_xor_b32 v26, v28, v22
  v_and_b32 v26, 15, v26
  v_mul_u32_u24 v28, 1024, v28
  v_lshl_add_u32 v102, v26, 4, v28
  v_add_u32 v28, 28, v27
  v_xor_b32 v26, v28, v22
  v_and_b32 v26, 15, v26
  v_mul_u32_u24 v28, 1024, v28
  v_lshl_add_u32 v103, v26, 4, v28
  s_add_u32 m0, s27, 16384
  s_nop 0
  global_load_lds_dwordx4 v8, s[16:17] offset:0
  global_load_lds_dwordx4 v9, s[16:17] offset:1024
  global_load_lds_dwordx4 v10, s[16:17] offset:2048
  global_load_lds_dwordx4 v11, s[16:17] offset:3072
  s_add_u32 s16, s16, 128
  s_addc_u32 s17, s17, 0
  s_add_u32 m0, s28, 16384
  s_nop 0
  global_load_lds_dwordx4 v12, s[18:19] offset:0
  global_load_lds_dwordx4 v13, s[18:19] offset:1024
  global_load_lds_dwordx4 v14, s[18:19] offset:2048
  global_load_lds_dwordx4 v15, s[18:19] offset:3072
  s_lshl_b32 s13, s26, 6
  s_add_u32 s18, s18, s13
  s_addc_u32 s19, s19, 0
  s_waitcnt lgkmcnt(7)
  global_store_dwordx4 v96, v[64:67], s[30:31] sc1
  s_waitcnt lgkmcnt(6)
  global_store_dwordx4 v97, v[68:71], s[30:31] sc1
  s_waitcnt lgkmcnt(5)
  global_store_dwordx4 v98, v[72:75], s[30:31] sc1
  s_waitcnt lgkmcnt(4)
  global_store_dwordx4 v99, v[76:79], s[30:31] sc1
  s_waitcnt lgkmcnt(3)
  global_store_dwordx4 v100, v[80:83], s[30:31] sc1
  s_waitcnt lgkmcnt(2)
  global_store_dwordx4 v101, v[84:87], s[30:31] sc1
  s_waitcnt lgkmcnt(1)
  global_store_dwordx4 v102, v[88:91], s[30:31] sc1
  s_waitcnt lgkmcnt(0)
  global_store_dwordx4 v103, v[92:95], s[30:31] sc1
  s_lshl_b32 s94, s91, 7
  s_add_u32 s94, s94, 94404608
  s_lshl_b32 s14, s92, 4
  s_add_u32 s94, s94, s14
Le_done_213:
  s_mov_b32 s93, 1
  s_branch Lw1_loop_109
Lw1_waitb_115:
  s_nop 15
  s_nop 3
  s_cmp_eq_u32 s90, 1
  s_cbranch_scc1 Le_v_214
  s_cmp_eq_u32 s90, 4
  s_cbranch_scc1 Le_b_215
  s_cmp_eq_u32 s90, 3
  s_cbranch_scc1 Le_h_216
  s_cmp_eq_u32 s90, 0
  s_mov_b32 s13, 4194304
  s_cselect_b32 s13, 20971520, s13
  s_lshl_b32 s14, s91, 20
  s_add_u32 s13, s13, s14
  s_lshl_b32 s14, s92, 13
  s_add_u32 s13, s13, s14
  s_add_u32 s30, s4, s13
  s_addc_u32 s31, s5, 0
  s_lshr_b32 s13, s10, 1
  s_lshl_b32 s13, s13, 14
  s_and_b32 s14, s10, 1
  s_lshl_b32 s14, s14, 11
  s_add_u32 s13, s13, s14
  s_add_u32 s13, s13, 98304
  v_bfe_u32 v29, v23, 4, 1
  v_lshlrev_b32 v29, 12, v29
  v_and_b32 v25, 15, v23
  v_lshl_add_u32 v29, v25, 4, v29
  v_lshl_add_u32 v29, v24, 8, v29
  v_add_u32 v29, s13, v29
  v_cvt_pk_bf16_f32 v64, v128, v136
  v_cvt_pk_bf16_f32 v65, v129, v137
  v_cvt_pk_bf16_f32 v66, v130, v138
  v_cvt_pk_bf16_f32 v67, v131, v139
  ds_write_b128 v29, v[64:67] offset:0
  v_cvt_pk_bf16_f32 v68, v132, v140
  v_cvt_pk_bf16_f32 v69, v133, v141
  v_cvt_pk_bf16_f32 v70, v134, v142
  v_cvt_pk_bf16_f32 v71, v135, v143
  ds_write_b128 v29, v[68:71] offset:512
  v_cvt_pk_bf16_f32 v64, v144, v152
  v_cvt_pk_bf16_f32 v65, v145, v153
  v_cvt_pk_bf16_f32 v66, v146, v154
  v_cvt_pk_bf16_f32 v67, v147, v155
  ds_write_b128 v29, v[64:67] offset:1024
  v_cvt_pk_bf16_f32 v68, v148, v156
  v_cvt_pk_bf16_f32 v69, v149, v157
  v_cvt_pk_bf16_f32 v70, v150, v158
  v_cvt_pk_bf16_f32 v71, v151, v159
  ds_write_b128 v29, v[68:71] offset:1536
  v_cvt_pk_bf16_f32 v64, v160, v168
  v_cvt_pk_bf16_f32 v65, v161, v169
  v_cvt_pk_bf16_f32 v66, v162, v170
  v_cvt_pk_bf16_f32 v67, v163, v171
  ds_write_b128 v29, v[64:67] offset:8192
  v_cvt_pk_bf16_f32 v68, v164, v172
  v_cvt_pk_bf16_f32 v69, v165, v173
  v_cvt_pk_bf16_f32 v70, v166, v174
  v_cvt_pk_bf16_f32 v71, v167, v175
  ds_write_b128 v29, v[68:71] offset:8704
  v_cvt_pk_bf16_f32 v64, v176, v184
  v_cvt_pk_bf16_f32 v65, v177, v185
  v_cvt_pk_bf16_f32 v66, v178, v186
  v_cvt_pk_bf16_f32 v67, v179, v187
  ds_write_b128 v29, v[64:67] offset:9216
  v_cvt_pk_bf16_f32 v68, v180, v188
  v_cvt_pk_bf16_f32 v69, v181, v189
  v_cvt_pk_bf16_f32 v70, v182, v190
  v_cvt_pk_bf16_f32 v71, v183, v191
  ds_write_b128 v29, v[68:71] offset:9728
  s_waitcnt lgkmcnt(0)
  s_barrier
  v_lshlrev_b32 v25, 4, v22
  s_lshl_b32 s13, s10, 13
  s_add_u32 s13, s13, 98304
  v_add_u32 v26, s13, v25
  ds_read_b128 v[64:67], v26 offset:0
  ds_read_b128 v[68:71], v26 offset:1024
  ds_read_b128 v[72:75], v26 offset:2048
  ds_read_b128 v[76:79], v26 offset:3072
  ds_read_b128 v[80:83], v26 offset:4096
  ds_read_b128 v[84:87], v26 offset:5120
  ds_read_b128 v[88:91], v26 offset:6144
  ds_read_b128 v[92:95], v26 offset:7168
  s_lshl_b32 s13, s10, 18
  s_add_u32 s34, s30, s13
  s_addc_u32 s35, s31, 0
  v_add_u32 v27, 4096, v25
  s_waitcnt lgkmcnt(7)
  global_store_dwordx4 v25, v[64:67], s[34:35] offset:0 sc1
  s_waitcnt lgkmcnt(6)
  global_store_dwordx4 v25, v[68:71], s[34:35] offset:1024 sc1
  s_waitcnt lgkmcnt(5)
  global_store_dwordx4 v25, v[72:75], s[34:35] offset:2048 sc1
  s_waitcnt lgkmcnt(4)
  global_store_dwordx4 v25, v[76:79], s[34:35] offset:3072 sc1
  s_waitcnt lgkmcnt(3)
  global_store_dwordx4 v27, v[80:83], s[34:35] offset:0 sc1
  s_waitcnt lgkmcnt(2)
  global_store_dwordx4 v27, v[84:87], s[34:35] offset:1024 sc1
  s_waitcnt lgkmcnt(1)
  global_store_dwordx4 v27, v[88:91], s[34:35] offset:2048 sc1
  s_waitcnt lgkmcnt(0)
  global_store_dwordx4 v27, v[92:95], s[34:35] offset:3072 sc1
  s_cmp_eq_u32 s90, 0
  s_mov_b32 s94, 94392320
  s_cselect_b32 s94, 94375936, s94
  s_lshl_b32 s14, s91, 9
  s_add_u32 s94, s94, s14
  s_lshl_b32 s14, s92, 4
  s_add_u32 s94, s94, s14
  s_branch Le_done_217
Le_h_216:
  s_lshr_b32 s13, s10, 1
  s_lshl_b32 s13, s13, 14
  s_add_u32 s13, s13, 98304
  v_lshlrev_b32 v29, 8, v23
  v_add_u32 v29, s13, v29
  v_and_b32 v31, 15, v23
  s_and_b32 s14, s10, 1
  s_lshl_b32 s14, s14, 3
  v_add_u32 v30, s14, v24
  s_lshl_b32 s13, s92, 8
  s_and_b32 s14, s10, 1
  s_lshl_b32 s14, s14, 7
  s_add_u32 s13, s13, s14
  s_add_u32 s34, s48, s13
  s_addc_u32 s35, s49, 0
  v_lshlrev_b32 v25, 3, v24
  global_load_dwordx2 v[104:105], v25, s[34:35] offset:0
  global_load_dwordx2 v[106:107], v25, s[34:35] offset:16
  global_load_dwordx2 v[108:109], v25, s[34:35] offset:32
  global_load_dwordx2 v[110:111], v25, s[34:35] offset:48
  global_load_dwordx2 v[112:113], v25, s[34:35] offset:64
  global_load_dwordx2 v[114:115], v25, s[34:35] offset:80
  global_load_dwordx2 v[116:117], v25, s[34:35] offset:96
  global_load_dwordx2 v[118:119], v25, s[34:35] offset:112
  s_mov_b32 s36, 0xc0135761
  s_mov_b32 s37, 0xbdd2d3e8
  s_waitcnt vmcnt(0)
  v_mov_b64 v[64:65], v[128:129]
  v_mov_b64 v[66:67], v[130:131]
  v_mov_b64 v[68:69], v[132:133]
  v_mov_b64 v[70:71], v[134:135]
  v_mov_b64 v[72:73], v[136:137]
  v_mov_b64 v[74:75], v[138:139]
  v_mov_b64 v[76:77], v[140:141]
  v_mov_b64 v[78:79], v[142:143]
  v_cvt_pk_bf16_f32 v64, v64, v64
  v_and_b32 v64, 0xffff0000, v64
  v_lshlrev_b32 v84, 16, v104
  v_add_f32 v64, v64, v84
  v_cvt_pk_bf16_f32 v64, v64, v64
  v_and_b32 v64, 0xffff0000, v64
  v_cvt_pk_bf16_f32 v65, v65, v65
  v_and_b32 v65, 0xffff0000, v65
  v_and_b32 v84, 0xffff0000, v104
  v_add_f32 v65, v65, v84
  v_cvt_pk_bf16_f32 v65, v65, v65
  v_and_b32 v65, 0xffff0000, v65
  v_cvt_pk_bf16_f32 v66, v66, v66
  v_and_b32 v66, 0xffff0000, v66
  v_lshlrev_b32 v84, 16, v105
  v_add_f32 v66, v66, v84
  v_cvt_pk_bf16_f32 v66, v66, v66
  v_and_b32 v66, 0xffff0000, v66
  v_cvt_pk_bf16_f32 v67, v67, v67
  v_and_b32 v67, 0xffff0000, v67
  v_and_b32 v84, 0xffff0000, v105
  v_add_f32 v67, v67, v84
  v_cvt_pk_bf16_f32 v67, v67, v67
  v_and_b32 v67, 0xffff0000, v67
  v_cvt_pk_bf16_f32 v68, v68, v68
  v_and_b32 v68, 0xffff0000, v68
  v_lshlrev_b32 v84, 16, v106
  v_add_f32 v68, v68, v84
  v_cvt_pk_bf16_f32 v68, v68, v68
  v_and_b32 v68, 0xffff0000, v68
  v_cvt_pk_bf16_f32 v69, v69, v69
  v_and_b32 v69, 0xffff0000, v69
  v_and_b32 v84, 0xffff0000, v106
  v_add_f32 v69, v69, v84
  v_cvt_pk_bf16_f32 v69, v69, v69
  v_and_b32 v69, 0xffff0000, v69
  v_cvt_pk_bf16_f32 v70, v70, v70
  v_and_b32 v70, 0xffff0000, v70
  v_lshlrev_b32 v84, 16, v107
  v_add_f32 v70, v70, v84
  v_cvt_pk_bf16_f32 v70, v70, v70
  v_and_b32 v70, 0xffff0000, v70
  v_cvt_pk_bf16_f32 v71, v71, v71
  v_and_b32 v71, 0xffff0000, v71
  v_and_b32 v84, 0xffff0000, v107
  v_add_f32 v71, v71, v84
  v_cvt_pk_bf16_f32 v71, v71, v71
  v_and_b32 v71, 0xffff0000, v71
  v_cvt_pk_bf16_f32 v72, v72, v72
  v_and_b32 v72, 0xffff0000, v72
  v_lshlrev_b32 v84, 16, v108
  v_add_f32 v72, v72, v84
  v_cvt_pk_bf16_f32 v72, v72, v72
  v_and_b32 v72, 0xffff0000, v72
  v_cvt_pk_bf16_f32 v73, v73, v73
  v_and_b32 v73, 0xffff0000, v73
  v_and_b32 v84, 0xffff0000, v108
  v_add_f32 v73, v73, v84
  v_cvt_pk_bf16_f32 v73, v73, v73
  v_and_b32 v73, 0xffff0000, v73
  v_cvt_pk_bf16_f32 v74, v74, v74
  v_and_b32 v74, 0xffff0000, v74
  v_lshlrev_b32 v84, 16, v109
  v_add_f32 v74, v74, v84
  v_cvt_pk_bf16_f32 v74, v74, v74
  v_and_b32 v74, 0xffff0000, v74
  v_cvt_pk_bf16_f32 v75, v75, v75
  v_and_b32 v75, 0xffff0000, v75
  v_and_b32 v84, 0xffff0000, v109
  v_add_f32 v75, v75, v84
  v_cvt_pk_bf16_f32 v75, v75, v75
  v_and_b32 v75, 0xffff0000, v75
  v_cvt_pk_bf16_f32 v76, v76, v76
  v_and_b32 v76, 0xffff0000, v76
  v_lshlrev_b32 v84, 16, v110
  v_add_f32 v76, v76, v84
  v_cvt_pk_bf16_f32 v76, v76, v76
  v_and_b32 v76, 0xffff0000, v76
  v_cvt_pk_bf16_f32 v77, v77, v77
  v_and_b32 v77, 0xffff0000, v77
  v_and_b32 v84, 0xffff0000, v110
  v_add_f32 v77, v77, v84
  v_cvt_pk_bf16_f32 v77, v77, v77
  v_and_b32 v77, 0xffff0000, v77
  v_cvt_pk_bf16_f32 v78, v78, v78
  v_and_b32 v78, 0xffff0000, v78
  v_lshlrev_b32 v84, 16, v111
  v_add_f32 v78, v78, v84
  v_cvt_pk_bf16_f32 v78, v78, v78
  v_and_b32 v78, 0xffff0000, v78
  v_cvt_pk_bf16_f32 v79, v79, v79
  v_and_b32 v79, 0xffff0000, v79
  v_and_b32 v84, 0xffff0000, v111
  v_add_f32 v79, v79, v84
  v_cvt_pk_bf16_f32 v79, v79, v79
  v_and_b32 v79, 0xffff0000, v79
  v_mul_f32 v84, v64, v64
  v_mov_b32 v88, s36
  v_fma_f32 v84, v84, s37, v88
  v_mul_f32 v84, v84, v64
  v_exp_f32 v84, v84
  s_nop 0
  v_add_f32 v84, 1.0, v84
  v_rcp_f32 v84, v84
  s_nop 0
  v_mul_f32 v64, v64, v84
  v_mul_f32 v85, v65, v65
  v_mov_b32 v88, s36
  v_fma_f32 v85, v85, s37, v88
  v_mul_f32 v85, v85, v65
  v_exp_f32 v85, v85
  s_nop 0
  v_add_f32 v85, 1.0, v85
  v_rcp_f32 v85, v85
  s_nop 0
  v_mul_f32 v65, v65, v85
  v_mul_f32 v86, v66, v66
  v_mov_b32 v88, s36
  v_fma_f32 v86, v86, s37, v88
  v_mul_f32 v86, v86, v66
  v_exp_f32 v86, v86
  s_nop 0
  v_add_f32 v86, 1.0, v86
  v_rcp_f32 v86, v86
  s_nop 0
  v_mul_f32 v66, v66, v86
  v_mul_f32 v87, v67, v67
  v_mov_b32 v88, s36
  v_fma_f32 v87, v87, s37, v88
  v_mul_f32 v87, v87, v67
  v_exp_f32 v87, v87
  s_nop 0
  v_add_f32 v87, 1.0, v87
  v_rcp_f32 v87, v87
  s_nop 0
  v_mul_f32 v67, v67, v87
  v_mul_f32 v84, v68, v68
  v_mov_b32 v88, s36
  v_fma_f32 v84, v84, s37, v88
  v_mul_f32 v84, v84, v68
  v_exp_f32 v84, v84
  s_nop 0
  v_add_f32 v84, 1.0, v84
  v_rcp_f32 v84, v84
  s_nop 0
  v_mul_f32 v68, v68, v84
  v_mul_f32 v85, v69, v69
  v_mov_b32 v88, s36
  v_fma_f32 v85, v85, s37, v88
  v_mul_f32 v85, v85, v69
  v_exp_f32 v85, v85
  s_nop 0
  v_add_f32 v85, 1.0, v85
  v_rcp_f32 v85, v85
  s_nop 0
  v_mul_f32 v69, v69, v85
  v_mul_f32 v86, v70, v70
  v_mov_b32 v88, s36
  v_fma_f32 v86, v86, s37, v88
  v_mul_f32 v86, v86, v70
  v_exp_f32 v86, v86
  s_nop 0
  v_add_f32 v86, 1.0, v86
  v_rcp_f32 v86, v86
  s_nop 0
  v_mul_f32 v70, v70, v86
  v_mul_f32 v87, v71, v71
  v_mov_b32 v88, s36
  v_fma_f32 v87, v87, s37, v88
  v_mul_f32 v87, v87, v71
  v_exp_f32 v87, v87
  s_nop 0
  v_add_f32 v87, 1.0, v87
  v_rcp_f32 v87, v87
  s_nop 0
  v_mul_f32 v71, v71, v87
  v_mul_f32 v84, v72, v72
  v_mov_b32 v88, s36
  v_fma_f32 v84, v84, s37, v88
  v_mul_f32 v84, v84, v72
  v_exp_f32 v84, v84
  s_nop 0
  v_add_f32 v84, 1.0, v84
  v_rcp_f32 v84, v84
  s_nop 0
  v_mul_f32 v72, v72, v84
  v_mul_f32 v85, v73, v73
  v_mov_b32 v88, s36
  v_fma_f32 v85, v85, s37, v88
  v_mul_f32 v85, v85, v73
  v_exp_f32 v85, v85
  s_nop 0
  v_add_f32 v85, 1.0, v85
  v_rcp_f32 v85, v85
  s_nop 0
  v_mul_f32 v73, v73, v85
  v_mul_f32 v86, v74, v74
  v_mov_b32 v88, s36
  v_fma_f32 v86, v86, s37, v88
  v_mul_f32 v86, v86, v74
  v_exp_f32 v86, v86
  s_nop 0
  v_add_f32 v86, 1.0, v86
  v_rcp_f32 v86, v86
  s_nop 0
  v_mul_f32 v74, v74, v86
  v_mul_f32 v87, v75, v75
  v_mov_b32 v88, s36
  v_fma_f32 v87, v87, s37, v88
  v_mul_f32 v87, v87, v75
  v_exp_f32 v87, v87
  s_nop 0
  v_add_f32 v87, 1.0, v87
  v_rcp_f32 v87, v87
  s_nop 0
  v_mul_f32 v75, v75, v87
  v_mul_f32 v84, v76, v76
  v_mov_b32 v88, s36
  v_fma_f32 v84, v84, s37, v88
  v_mul_f32 v84, v84, v76
  v_exp_f32 v84, v84
  s_nop 0
  v_add_f32 v84, 1.0, v84
  v_rcp_f32 v84, v84
  s_nop 0
  v_mul_f32 v76, v76, v84
  v_mul_f32 v85, v77, v77
  v_mov_b32 v88, s36
  v_fma_f32 v85, v85, s37, v88
  v_mul_f32 v85, v85, v77
  v_exp_f32 v85, v85
  s_nop 0
  v_add_f32 v85, 1.0, v85
  v_rcp_f32 v85, v85
  s_nop 0
  v_mul_f32 v77, v77, v85
  v_mul_f32 v86, v78, v78
  v_mov_b32 v88, s36
  v_fma_f32 v86, v86, s37, v88
  v_mul_f32 v86, v86, v78
  v_exp_f32 v86, v86
  s_nop 0
  v_add_f32 v86, 1.0, v86
  v_rcp_f32 v86, v86
  s_nop 0
  v_mul_f32 v78, v78, v86
  v_mul_f32 v87, v79, v79
  v_mov_b32 v88, s36
  v_fma_f32 v87, v87, s37, v88
  v_mul_f32 v87, v87, v79
  v_exp_f32 v87, v87
  s_nop 0
  v_add_f32 v87, 1.0, v87
  v_rcp_f32 v87, v87
  s_nop 0
  v_mul_f32 v79, v79, v87
  v_cvt_pk_bf16_f32 v80, v64, v72
  v_cvt_pk_bf16_f32 v81, v65, v73
  v_cvt_pk_bf16_f32 v82, v66, v74
  v_cvt_pk_bf16_f32 v83, v67, v75
  v_add_u32 v25, 0, v30
  v_xor_b32 v25, v25, v31
  v_lshl_add_u32 v25, v25, 4, v29
  ds_write_b128 v25, v[80:83] offset:0
  v_cvt_pk_bf16_f32 v80, v68, v76
  v_cvt_pk_bf16_f32 v81, v69, v77
  v_cvt_pk_bf16_f32 v82, v70, v78
  v_cvt_pk_bf16_f32 v83, v71, v79
  v_add_u32 v25, 2, v30
  v_xor_b32 v25, v25, v31
  v_lshl_add_u32 v25, v25, 4, v29
  ds_write_b128 v25, v[80:83] offset:0
  v_mov_b64 v[64:65], v[144:145]
  v_mov_b64 v[66:67], v[146:147]
  v_mov_b64 v[68:69], v[148:149]
  v_mov_b64 v[70:71], v[150:151]
  v_mov_b64 v[72:73], v[152:153]
  v_mov_b64 v[74:75], v[154:155]
  v_mov_b64 v[76:77], v[156:157]
  v_mov_b64 v[78:79], v[158:159]
  v_cvt_pk_bf16_f32 v64, v64, v64
  v_and_b32 v64, 0xffff0000, v64
  v_lshlrev_b32 v84, 16, v112
  v_add_f32 v64, v64, v84
  v_cvt_pk_bf16_f32 v64, v64, v64
  v_and_b32 v64, 0xffff0000, v64
  v_cvt_pk_bf16_f32 v65, v65, v65
  v_and_b32 v65, 0xffff0000, v65
  v_and_b32 v84, 0xffff0000, v112
  v_add_f32 v65, v65, v84
  v_cvt_pk_bf16_f32 v65, v65, v65
  v_and_b32 v65, 0xffff0000, v65
  v_cvt_pk_bf16_f32 v66, v66, v66
  v_and_b32 v66, 0xffff0000, v66
  v_lshlrev_b32 v84, 16, v113
  v_add_f32 v66, v66, v84
  v_cvt_pk_bf16_f32 v66, v66, v66
  v_and_b32 v66, 0xffff0000, v66
  v_cvt_pk_bf16_f32 v67, v67, v67
  v_and_b32 v67, 0xffff0000, v67
  v_and_b32 v84, 0xffff0000, v113
  v_add_f32 v67, v67, v84
  v_cvt_pk_bf16_f32 v67, v67, v67
  v_and_b32 v67, 0xffff0000, v67
  v_cvt_pk_bf16_f32 v68, v68, v68
  v_and_b32 v68, 0xffff0000, v68
  v_lshlrev_b32 v84, 16, v114
  v_add_f32 v68, v68, v84
  v_cvt_pk_bf16_f32 v68, v68, v68
  v_and_b32 v68, 0xffff0000, v68
  v_cvt_pk_bf16_f32 v69, v69, v69
  v_and_b32 v69, 0xffff0000, v69
  v_and_b32 v84, 0xffff0000, v114
  v_add_f32 v69, v69, v84
  v_cvt_pk_bf16_f32 v69, v69, v69
  v_and_b32 v69, 0xffff0000, v69
  v_cvt_pk_bf16_f32 v70, v70, v70
  v_and_b32 v70, 0xffff0000, v70
  v_lshlrev_b32 v84, 16, v115
  v_add_f32 v70, v70, v84
  v_cvt_pk_bf16_f32 v70, v70, v70
  v_and_b32 v70, 0xffff0000, v70
  v_cvt_pk_bf16_f32 v71, v71, v71
  v_and_b32 v71, 0xffff0000, v71
  v_and_b32 v84, 0xffff0000, v115
  v_add_f32 v71, v71, v84
  v_cvt_pk_bf16_f32 v71, v71, v71
  v_and_b32 v71, 0xffff0000, v71
  v_cvt_pk_bf16_f32 v72, v72, v72
  v_and_b32 v72, 0xffff0000, v72
  v_lshlrev_b32 v84, 16, v116
  v_add_f32 v72, v72, v84
  v_cvt_pk_bf16_f32 v72, v72, v72
  v_and_b32 v72, 0xffff0000, v72
  v_cvt_pk_bf16_f32 v73, v73, v73
  v_and_b32 v73, 0xffff0000, v73
  v_and_b32 v84, 0xffff0000, v116
  v_add_f32 v73, v73, v84
  v_cvt_pk_bf16_f32 v73, v73, v73
  v_and_b32 v73, 0xffff0000, v73
  v_cvt_pk_bf16_f32 v74, v74, v74
  v_and_b32 v74, 0xffff0000, v74
  v_lshlrev_b32 v84, 16, v117
  v_add_f32 v74, v74, v84
  v_cvt_pk_bf16_f32 v74, v74, v74
  v_and_b32 v74, 0xffff0000, v74
  v_cvt_pk_bf16_f32 v75, v75, v75
  v_and_b32 v75, 0xffff0000, v75
  v_and_b32 v84, 0xffff0000, v117
  v_add_f32 v75, v75, v84
  v_cvt_pk_bf16_f32 v75, v75, v75
  v_and_b32 v75, 0xffff0000, v75
  v_cvt_pk_bf16_f32 v76, v76, v76
  v_and_b32 v76, 0xffff0000, v76
  v_lshlrev_b32 v84, 16, v118
  v_add_f32 v76, v76, v84
  v_cvt_pk_bf16_f32 v76, v76, v76
  v_and_b32 v76, 0xffff0000, v76
  v_cvt_pk_bf16_f32 v77, v77, v77
  v_and_b32 v77, 0xffff0000, v77
  v_and_b32 v84, 0xffff0000, v118
  v_add_f32 v77, v77, v84
  v_cvt_pk_bf16_f32 v77, v77, v77
  v_and_b32 v77, 0xffff0000, v77
  v_cvt_pk_bf16_f32 v78, v78, v78
  v_and_b32 v78, 0xffff0000, v78
  v_lshlrev_b32 v84, 16, v119
  v_add_f32 v78, v78, v84
  v_cvt_pk_bf16_f32 v78, v78, v78
  v_and_b32 v78, 0xffff0000, v78
  v_cvt_pk_bf16_f32 v79, v79, v79
  v_and_b32 v79, 0xffff0000, v79
  v_and_b32 v84, 0xffff0000, v119
  v_add_f32 v79, v79, v84
  v_cvt_pk_bf16_f32 v79, v79, v79
  v_and_b32 v79, 0xffff0000, v79
  v_mul_f32 v84, v64, v64
  v_mov_b32 v88, s36
  v_fma_f32 v84, v84, s37, v88
  v_mul_f32 v84, v84, v64
  v_exp_f32 v84, v84
  s_nop 0
  v_add_f32 v84, 1.0, v84
  v_rcp_f32 v84, v84
  s_nop 0
  v_mul_f32 v64, v64, v84
  v_mul_f32 v85, v65, v65
  v_mov_b32 v88, s36
  v_fma_f32 v85, v85, s37, v88
  v_mul_f32 v85, v85, v65
  v_exp_f32 v85, v85
  s_nop 0
  v_add_f32 v85, 1.0, v85
  v_rcp_f32 v85, v85
  s_nop 0
  v_mul_f32 v65, v65, v85
  v_mul_f32 v86, v66, v66
  v_mov_b32 v88, s36
  v_fma_f32 v86, v86, s37, v88
  v_mul_f32 v86, v86, v66
  v_exp_f32 v86, v86
  s_nop 0
  v_add_f32 v86, 1.0, v86
  v_rcp_f32 v86, v86
  s_nop 0
  v_mul_f32 v66, v66, v86
  v_mul_f32 v87, v67, v67
  v_mov_b32 v88, s36
  v_fma_f32 v87, v87, s37, v88
  v_mul_f32 v87, v87, v67
  v_exp_f32 v87, v87
  s_nop 0
  v_add_f32 v87, 1.0, v87
  v_rcp_f32 v87, v87
  s_nop 0
  v_mul_f32 v67, v67, v87
  v_mul_f32 v84, v68, v68
  v_mov_b32 v88, s36
  v_fma_f32 v84, v84, s37, v88
  v_mul_f32 v84, v84, v68
  v_exp_f32 v84, v84
  s_nop 0
  v_add_f32 v84, 1.0, v84
  v_rcp_f32 v84, v84
  s_nop 0
  v_mul_f32 v68, v68, v84
  v_mul_f32 v85, v69, v69
  v_mov_b32 v88, s36
  v_fma_f32 v85, v85, s37, v88
  v_mul_f32 v85, v85, v69
  v_exp_f32 v85, v85
  s_nop 0
  v_add_f32 v85, 1.0, v85
  v_rcp_f32 v85, v85
  s_nop 0
  v_mul_f32 v69, v69, v85
  v_mul_f32 v86, v70, v70
  v_mov_b32 v88, s36
  v_fma_f32 v86, v86, s37, v88
  v_mul_f32 v86, v86, v70
  v_exp_f32 v86, v86
  s_nop 0
  v_add_f32 v86, 1.0, v86
  v_rcp_f32 v86, v86
  s_nop 0
  v_mul_f32 v70, v70, v86
  v_mul_f32 v87, v71, v71
  v_mov_b32 v88, s36
  v_fma_f32 v87, v87, s37, v88
  v_mul_f32 v87, v87, v71
  v_exp_f32 v87, v87
  s_nop 0
  v_add_f32 v87, 1.0, v87
  v_rcp_f32 v87, v87
  s_nop 0
  v_mul_f32 v71, v71, v87
  v_mul_f32 v84, v72, v72
  v_mov_b32 v88, s36
  v_fma_f32 v84, v84, s37, v88
  v_mul_f32 v84, v84, v72
  v_exp_f32 v84, v84
  s_nop 0
  v_add_f32 v84, 1.0, v84
  v_rcp_f32 v84, v84
  s_nop 0
  v_mul_f32 v72, v72, v84
  v_mul_f32 v85, v73, v73
  v_mov_b32 v88, s36
  v_fma_f32 v85, v85, s37, v88
  v_mul_f32 v85, v85, v73
  v_exp_f32 v85, v85
  s_nop 0
  v_add_f32 v85, 1.0, v85
  v_rcp_f32 v85, v85
  s_nop 0
  v_mul_f32 v73, v73, v85
  v_mul_f32 v86, v74, v74
  v_mov_b32 v88, s36
  v_fma_f32 v86, v86, s37, v88
  v_mul_f32 v86, v86, v74
  v_exp_f32 v86, v86
  s_nop 0
  v_add_f32 v86, 1.0, v86
  v_rcp_f32 v86, v86
  s_nop 0
  v_mul_f32 v74, v74, v86
  v_mul_f32 v87, v75, v75
  v_mov_b32 v88, s36
  v_fma_f32 v87, v87, s37, v88
  v_mul_f32 v87, v87, v75
  v_exp_f32 v87, v87
  s_nop 0
  v_add_f32 v87, 1.0, v87
  v_rcp_f32 v87, v87
  s_nop 0
  v_mul_f32 v75, v75, v87
  v_mul_f32 v84, v76, v76
  v_mov_b32 v88, s36
  v_fma_f32 v84, v84, s37, v88
  v_mul_f32 v84, v84, v76
  v_exp_f32 v84, v84
  s_nop 0
  v_add_f32 v84, 1.0, v84
  v_rcp_f32 v84, v84
  s_nop 0
  v_mul_f32 v76, v76, v84
  v_mul_f32 v85, v77, v77
  v_mov_b32 v88, s36
  v_fma_f32 v85, v85, s37, v88
  v_mul_f32 v85, v85, v77
  v_exp_f32 v85, v85
  s_nop 0
  v_add_f32 v85, 1.0, v85
  v_rcp_f32 v85, v85
  s_nop 0
  v_mul_f32 v77, v77, v85
  v_mul_f32 v86, v78, v78
  v_mov_b32 v88, s36
  v_fma_f32 v86, v86, s37, v88
  v_mul_f32 v86, v86, v78
  v_exp_f32 v86, v86
  s_nop 0
  v_add_f32 v86, 1.0, v86
  v_rcp_f32 v86, v86
  s_nop 0
  v_mul_f32 v78, v78, v86
  v_mul_f32 v87, v79, v79
  v_mov_b32 v88, s36
  v_fma_f32 v87, v87, s37, v88
  v_mul_f32 v87, v87, v79
  v_exp_f32 v87, v87
  s_nop 0
  v_add_f32 v87, 1.0, v87
  v_rcp_f32 v87, v87
  s_nop 0
  v_mul_f32 v79, v79, v87
  v_cvt_pk_bf16_f32 v80, v64, v72
  v_cvt_pk_bf16_f32 v81, v65, v73
  v_cvt_pk_bf16_f32 v82, v66, v74
  v_cvt_pk_bf16_f32 v83, v67, v75
  v_add_u32 v25, 4, v30
  v_xor_b32 v25, v25, v31
  v_lshl_add_u32 v25, v25, 4, v29
  ds_write_b128 v25, v[80:83] offset:0
  v_cvt_pk_bf16_f32 v80, v68, v76
  v_cvt_pk_bf16_f32 v81, v69, v77
  v_cvt_pk_bf16_f32 v82, v70, v78
  v_cvt_pk_bf16_f32 v83, v71, v79
  v_add_u32 v25, 6, v30
  v_xor_b32 v25, v25, v31
  v_lshl_add_u32 v25, v25, 4, v29
  ds_write_b128 v25, v[80:83] offset:0
  v_mov_b64 v[64:65], v[160:161]
  v_mov_b64 v[66:67], v[162:163]
  v_mov_b64 v[68:69], v[164:165]
  v_mov_b64 v[70:71], v[166:167]
  v_mov_b64 v[72:73], v[168:169]
  v_mov_b64 v[74:75], v[170:171]
  v_mov_b64 v[76:77], v[172:173]
  v_mov_b64 v[78:79], v[174:175]
  v_cvt_pk_bf16_f32 v64, v64, v64
  v_and_b32 v64, 0xffff0000, v64
  v_lshlrev_b32 v84, 16, v104
  v_add_f32 v64, v64, v84
  v_cvt_pk_bf16_f32 v64, v64, v64
  v_and_b32 v64, 0xffff0000, v64
  v_cvt_pk_bf16_f32 v65, v65, v65
  v_and_b32 v65, 0xffff0000, v65
  v_and_b32 v84, 0xffff0000, v104
  v_add_f32 v65, v65, v84
  v_cvt_pk_bf16_f32 v65, v65, v65
  v_and_b32 v65, 0xffff0000, v65
  v_cvt_pk_bf16_f32 v66, v66, v66
  v_and_b32 v66, 0xffff0000, v66
  v_lshlrev_b32 v84, 16, v105
  v_add_f32 v66, v66, v84
  v_cvt_pk_bf16_f32 v66, v66, v66
  v_and_b32 v66, 0xffff0000, v66
  v_cvt_pk_bf16_f32 v67, v67, v67
  v_and_b32 v67, 0xffff0000, v67
  v_and_b32 v84, 0xffff0000, v105
  v_add_f32 v67, v67, v84
  v_cvt_pk_bf16_f32 v67, v67, v67
  v_and_b32 v67, 0xffff0000, v67
  v_cvt_pk_bf16_f32 v68, v68, v68
  v_and_b32 v68, 0xffff0000, v68
  v_lshlrev_b32 v84, 16, v106
  v_add_f32 v68, v68, v84
  v_cvt_pk_bf16_f32 v68, v68, v68
  v_and_b32 v68, 0xffff0000, v68
  v_cvt_pk_bf16_f32 v69, v69, v69
  v_and_b32 v69, 0xffff0000, v69
  v_and_b32 v84, 0xffff0000, v106
  v_add_f32 v69, v69, v84
  v_cvt_pk_bf16_f32 v69, v69, v69
  v_and_b32 v69, 0xffff0000, v69
  v_cvt_pk_bf16_f32 v70, v70, v70
  v_and_b32 v70, 0xffff0000, v70
  v_lshlrev_b32 v84, 16, v107
  v_add_f32 v70, v70, v84
  v_cvt_pk_bf16_f32 v70, v70, v70
  v_and_b32 v70, 0xffff0000, v70
  v_cvt_pk_bf16_f32 v71, v71, v71
  v_and_b32 v71, 0xffff0000, v71
  v_and_b32 v84, 0xffff0000, v107
  v_add_f32 v71, v71, v84
  v_cvt_pk_bf16_f32 v71, v71, v71
  v_and_b32 v71, 0xffff0000, v71
  v_cvt_pk_bf16_f32 v72, v72, v72
  v_and_b32 v72, 0xffff0000, v72
  v_lshlrev_b32 v84, 16, v108
  v_add_f32 v72, v72, v84
  v_cvt_pk_bf16_f32 v72, v72, v72
  v_and_b32 v72, 0xffff0000, v72
  v_cvt_pk_bf16_f32 v73, v73, v73
  v_and_b32 v73, 0xffff0000, v73
  v_and_b32 v84, 0xffff0000, v108
  v_add_f32 v73, v73, v84
  v_cvt_pk_bf16_f32 v73, v73, v73
  v_and_b32 v73, 0xffff0000, v73
  v_cvt_pk_bf16_f32 v74, v74, v74
  v_and_b32 v74, 0xffff0000, v74
  v_lshlrev_b32 v84, 16, v109
  v_add_f32 v74, v74, v84
  v_cvt_pk_bf16_f32 v74, v74, v74
  v_and_b32 v74, 0xffff0000, v74
  v_cvt_pk_bf16_f32 v75, v75, v75
  v_and_b32 v75, 0xffff0000, v75
  v_and_b32 v84, 0xffff0000, v109
  v_add_f32 v75, v75, v84
  v_cvt_pk_bf16_f32 v75, v75, v75
  v_and_b32 v75, 0xffff0000, v75
  v_cvt_pk_bf16_f32 v76, v76, v76
  v_and_b32 v76, 0xffff0000, v76
  v_lshlrev_b32 v84, 16, v110
  v_add_f32 v76, v76, v84
  v_cvt_pk_bf16_f32 v76, v76, v76
  v_and_b32 v76, 0xffff0000, v76
  v_cvt_pk_bf16_f32 v77, v77, v77
  v_and_b32 v77, 0xffff0000, v77
  v_and_b32 v84, 0xffff0000, v110
  v_add_f32 v77, v77, v84
  v_cvt_pk_bf16_f32 v77, v77, v77
  v_and_b32 v77, 0xffff0000, v77
  v_cvt_pk_bf16_f32 v78, v78, v78
  v_and_b32 v78, 0xffff0000, v78
  v_lshlrev_b32 v84, 16, v111
  v_add_f32 v78, v78, v84
  v_cvt_pk_bf16_f32 v78, v78, v78
  v_and_b32 v78, 0xffff0000, v78
  v_cvt_pk_bf16_f32 v79, v79, v79
  v_and_b32 v79, 0xffff0000, v79
  v_and_b32 v84, 0xffff0000, v111
  v_add_f32 v79, v79, v84
  v_cvt_pk_bf16_f32 v79, v79, v79
  v_and_b32 v79, 0xffff0000, v79
  v_mul_f32 v84, v64, v64
  v_mov_b32 v88, s36
  v_fma_f32 v84, v84, s37, v88
  v_mul_f32 v84, v84, v64
  v_exp_f32 v84, v84
  s_nop 0
  v_add_f32 v84, 1.0, v84
  v_rcp_f32 v84, v84
  s_nop 0
  v_mul_f32 v64, v64, v84
  v_mul_f32 v85, v65, v65
  v_mov_b32 v88, s36
  v_fma_f32 v85, v85, s37, v88
  v_mul_f32 v85, v85, v65
  v_exp_f32 v85, v85
  s_nop 0
  v_add_f32 v85, 1.0, v85
  v_rcp_f32 v85, v85
  s_nop 0
  v_mul_f32 v65, v65, v85
  v_mul_f32 v86, v66, v66
  v_mov_b32 v88, s36
  v_fma_f32 v86, v86, s37, v88
  v_mul_f32 v86, v86, v66
  v_exp_f32 v86, v86
  s_nop 0
  v_add_f32 v86, 1.0, v86
  v_rcp_f32 v86, v86
  s_nop 0
  v_mul_f32 v66, v66, v86
  v_mul_f32 v87, v67, v67
  v_mov_b32 v88, s36
  v_fma_f32 v87, v87, s37, v88
  v_mul_f32 v87, v87, v67
  v_exp_f32 v87, v87
  s_nop 0
  v_add_f32 v87, 1.0, v87
  v_rcp_f32 v87, v87
  s_nop 0
  v_mul_f32 v67, v67, v87
  v_mul_f32 v84, v68, v68
  v_mov_b32 v88, s36
  v_fma_f32 v84, v84, s37, v88
  v_mul_f32 v84, v84, v68
  v_exp_f32 v84, v84
  s_nop 0
  v_add_f32 v84, 1.0, v84
  v_rcp_f32 v84, v84
  s_nop 0
  v_mul_f32 v68, v68, v84
  v_mul_f32 v85, v69, v69
  v_mov_b32 v88, s36
  v_fma_f32 v85, v85, s37, v88
  v_mul_f32 v85, v85, v69
  v_exp_f32 v85, v85
  s_nop 0
  v_add_f32 v85, 1.0, v85
  v_rcp_f32 v85, v85
  s_nop 0
  v_mul_f32 v69, v69, v85
  v_mul_f32 v86, v70, v70
  v_mov_b32 v88, s36
  v_fma_f32 v86, v86, s37, v88
  v_mul_f32 v86, v86, v70
  v_exp_f32 v86, v86
  s_nop 0
  v_add_f32 v86, 1.0, v86
  v_rcp_f32 v86, v86
  s_nop 0
  v_mul_f32 v70, v70, v86
  v_mul_f32 v87, v71, v71
  v_mov_b32 v88, s36
  v_fma_f32 v87, v87, s37, v88
  v_mul_f32 v87, v87, v71
  v_exp_f32 v87, v87
  s_nop 0
  v_add_f32 v87, 1.0, v87
  v_rcp_f32 v87, v87
  s_nop 0
  v_mul_f32 v71, v71, v87
  v_mul_f32 v84, v72, v72
  v_mov_b32 v88, s36
  v_fma_f32 v84, v84, s37, v88
  v_mul_f32 v84, v84, v72
  v_exp_f32 v84, v84
  s_nop 0
  v_add_f32 v84, 1.0, v84
  v_rcp_f32 v84, v84
  s_nop 0
  v_mul_f32 v72, v72, v84
  v_mul_f32 v85, v73, v73
  v_mov_b32 v88, s36
  v_fma_f32 v85, v85, s37, v88
  v_mul_f32 v85, v85, v73
  v_exp_f32 v85, v85
  s_nop 0
  v_add_f32 v85, 1.0, v85
  v_rcp_f32 v85, v85
  s_nop 0
  v_mul_f32 v73, v73, v85
  v_mul_f32 v86, v74, v74
  v_mov_b32 v88, s36
  v_fma_f32 v86, v86, s37, v88
  v_mul_f32 v86, v86, v74
  v_exp_f32 v86, v86
  s_nop 0
  v_add_f32 v86, 1.0, v86
  v_rcp_f32 v86, v86
  s_nop 0
  v_mul_f32 v74, v74, v86
  v_mul_f32 v87, v75, v75
  v_mov_b32 v88, s36
  v_fma_f32 v87, v87, s37, v88
  v_mul_f32 v87, v87, v75
  v_exp_f32 v87, v87
  s_nop 0
  v_add_f32 v87, 1.0, v87
  v_rcp_f32 v87, v87
  s_nop 0
  v_mul_f32 v75, v75, v87
  v_mul_f32 v84, v76, v76
  v_mov_b32 v88, s36
  v_fma_f32 v84, v84, s37, v88
  v_mul_f32 v84, v84, v76
  v_exp_f32 v84, v84
  s_nop 0
  v_add_f32 v84, 1.0, v84
  v_rcp_f32 v84, v84
  s_nop 0
  v_mul_f32 v76, v76, v84
  v_mul_f32 v85, v77, v77
  v_mov_b32 v88, s36
  v_fma_f32 v85, v85, s37, v88
  v_mul_f32 v85, v85, v77
  v_exp_f32 v85, v85
  s_nop 0
  v_add_f32 v85, 1.0, v85
  v_rcp_f32 v85, v85
  s_nop 0
  v_mul_f32 v77, v77, v85
  v_mul_f32 v86, v78, v78
  v_mov_b32 v88, s36
  v_fma_f32 v86, v86, s37, v88
  v_mul_f32 v86, v86, v78
  v_exp_f32 v86, v86
  s_nop 0
  v_add_f32 v86, 1.0, v86
  v_rcp_f32 v86, v86
  s_nop 0
  v_mul_f32 v78, v78, v86
  v_mul_f32 v87, v79, v79
  v_mov_b32 v88, s36
  v_fma_f32 v87, v87, s37, v88
  v_mul_f32 v87, v87, v79
  v_exp_f32 v87, v87
  s_nop 0
  v_add_f32 v87, 1.0, v87
  v_rcp_f32 v87, v87
  s_nop 0
  v_mul_f32 v79, v79, v87
  v_cvt_pk_bf16_f32 v80, v64, v72
  v_cvt_pk_bf16_f32 v81, v65, v73
  v_cvt_pk_bf16_f32 v82, v66, v74
  v_cvt_pk_bf16_f32 v83, v67, v75
  v_add_u32 v25, 0, v30
  v_xor_b32 v25, v25, v31
  v_lshl_add_u32 v25, v25, 4, v29
  ds_write_b128 v25, v[80:83] offset:8192
  v_cvt_pk_bf16_f32 v80, v68, v76
  v_cvt_pk_bf16_f32 v81, v69, v77
  v_cvt_pk_bf16_f32 v82, v70, v78
  v_cvt_pk_bf16_f32 v83, v71, v79
  v_add_u32 v25, 2, v30
  v_xor_b32 v25, v25, v31
  v_lshl_add_u32 v25, v25, 4, v29
  ds_write_b128 v25, v[80:83] offset:8192
  v_mov_b64 v[64:65], v[176:177]
  v_mov_b64 v[66:67], v[178:179]
  v_mov_b64 v[68:69], v[180:181]
  v_mov_b64 v[70:71], v[182:183]
  v_mov_b64 v[72:73], v[184:185]
  v_mov_b64 v[74:75], v[186:187]
  v_mov_b64 v[76:77], v[188:189]
  v_mov_b64 v[78:79], v[190:191]
  v_cvt_pk_bf16_f32 v64, v64, v64
  v_and_b32 v64, 0xffff0000, v64
  v_lshlrev_b32 v84, 16, v112
  v_add_f32 v64, v64, v84
  v_cvt_pk_bf16_f32 v64, v64, v64
  v_and_b32 v64, 0xffff0000, v64
  v_cvt_pk_bf16_f32 v65, v65, v65
  v_and_b32 v65, 0xffff0000, v65
  v_and_b32 v84, 0xffff0000, v112
  v_add_f32 v65, v65, v84
  v_cvt_pk_bf16_f32 v65, v65, v65
  v_and_b32 v65, 0xffff0000, v65
  v_cvt_pk_bf16_f32 v66, v66, v66
  v_and_b32 v66, 0xffff0000, v66
  v_lshlrev_b32 v84, 16, v113
  v_add_f32 v66, v66, v84
  v_cvt_pk_bf16_f32 v66, v66, v66
  v_and_b32 v66, 0xffff0000, v66
  v_cvt_pk_bf16_f32 v67, v67, v67
  v_and_b32 v67, 0xffff0000, v67
  v_and_b32 v84, 0xffff0000, v113
  v_add_f32 v67, v67, v84
  v_cvt_pk_bf16_f32 v67, v67, v67
  v_and_b32 v67, 0xffff0000, v67
  v_cvt_pk_bf16_f32 v68, v68, v68
  v_and_b32 v68, 0xffff0000, v68
  v_lshlrev_b32 v84, 16, v114
  v_add_f32 v68, v68, v84
  v_cvt_pk_bf16_f32 v68, v68, v68
  v_and_b32 v68, 0xffff0000, v68
  v_cvt_pk_bf16_f32 v69, v69, v69
  v_and_b32 v69, 0xffff0000, v69
  v_and_b32 v84, 0xffff0000, v114
  v_add_f32 v69, v69, v84
  v_cvt_pk_bf16_f32 v69, v69, v69
  v_and_b32 v69, 0xffff0000, v69
  v_cvt_pk_bf16_f32 v70, v70, v70
  v_and_b32 v70, 0xffff0000, v70
  v_lshlrev_b32 v84, 16, v115
  v_add_f32 v70, v70, v84
  v_cvt_pk_bf16_f32 v70, v70, v70
  v_and_b32 v70, 0xffff0000, v70
  v_cvt_pk_bf16_f32 v71, v71, v71
  v_and_b32 v71, 0xffff0000, v71
  v_and_b32 v84, 0xffff0000, v115
  v_add_f32 v71, v71, v84
  v_cvt_pk_bf16_f32 v71, v71, v71
  v_and_b32 v71, 0xffff0000, v71
  v_cvt_pk_bf16_f32 v72, v72, v72
  v_and_b32 v72, 0xffff0000, v72
  v_lshlrev_b32 v84, 16, v116
  v_add_f32 v72, v72, v84
  v_cvt_pk_bf16_f32 v72, v72, v72
  v_and_b32 v72, 0xffff0000, v72
  v_cvt_pk_bf16_f32 v73, v73, v73
  v_and_b32 v73, 0xffff0000, v73
  v_and_b32 v84, 0xffff0000, v116
  v_add_f32 v73, v73, v84
  v_cvt_pk_bf16_f32 v73, v73, v73
  v_and_b32 v73, 0xffff0000, v73
  v_cvt_pk_bf16_f32 v74, v74, v74
  v_and_b32 v74, 0xffff0000, v74
  v_lshlrev_b32 v84, 16, v117
  v_add_f32 v74, v74, v84
  v_cvt_pk_bf16_f32 v74, v74, v74
  v_and_b32 v74, 0xffff0000, v74
  v_cvt_pk_bf16_f32 v75, v75, v75
  v_and_b32 v75, 0xffff0000, v75
  v_and_b32 v84, 0xffff0000, v117
  v_add_f32 v75, v75, v84
  v_cvt_pk_bf16_f32 v75, v75, v75
  v_and_b32 v75, 0xffff0000, v75
  v_cvt_pk_bf16_f32 v76, v76, v76
  v_and_b32 v76, 0xffff0000, v76
  v_lshlrev_b32 v84, 16, v118
  v_add_f32 v76, v76, v84
  v_cvt_pk_bf16_f32 v76, v76, v76
  v_and_b32 v76, 0xffff0000, v76
  v_cvt_pk_bf16_f32 v77, v77, v77
  v_and_b32 v77, 0xffff0000, v77
  v_and_b32 v84, 0xffff0000, v118
  v_add_f32 v77, v77, v84
  v_cvt_pk_bf16_f32 v77, v77, v77
  v_and_b32 v77, 0xffff0000, v77
  v_cvt_pk_bf16_f32 v78, v78, v78
  v_and_b32 v78, 0xffff0000, v78
  v_lshlrev_b32 v84, 16, v119
  v_add_f32 v78, v78, v84
  v_cvt_pk_bf16_f32 v78, v78, v78
  v_and_b32 v78, 0xffff0000, v78
  v_cvt_pk_bf16_f32 v79, v79, v79
  v_and_b32 v79, 0xffff0000, v79
  v_and_b32 v84, 0xffff0000, v119
  v_add_f32 v79, v79, v84
  v_cvt_pk_bf16_f32 v79, v79, v79
  v_and_b32 v79, 0xffff0000, v79
  v_mul_f32 v84, v64, v64
  v_mov_b32 v88, s36
  v_fma_f32 v84, v84, s37, v88
  v_mul_f32 v84, v84, v64
  v_exp_f32 v84, v84
  s_nop 0
  v_add_f32 v84, 1.0, v84
  v_rcp_f32 v84, v84
  s_nop 0
  v_mul_f32 v64, v64, v84
  v_mul_f32 v85, v65, v65
  v_mov_b32 v88, s36
  v_fma_f32 v85, v85, s37, v88
  v_mul_f32 v85, v85, v65
  v_exp_f32 v85, v85
  s_nop 0
  v_add_f32 v85, 1.0, v85
  v_rcp_f32 v85, v85
  s_nop 0
  v_mul_f32 v65, v65, v85
  v_mul_f32 v86, v66, v66
  v_mov_b32 v88, s36
  v_fma_f32 v86, v86, s37, v88
  v_mul_f32 v86, v86, v66
  v_exp_f32 v86, v86
  s_nop 0
  v_add_f32 v86, 1.0, v86
  v_rcp_f32 v86, v86
  s_nop 0
  v_mul_f32 v66, v66, v86
  v_mul_f32 v87, v67, v67
  v_mov_b32 v88, s36
  v_fma_f32 v87, v87, s37, v88
  v_mul_f32 v87, v87, v67
  v_exp_f32 v87, v87
  s_nop 0
  v_add_f32 v87, 1.0, v87
  v_rcp_f32 v87, v87
  s_nop 0
  v_mul_f32 v67, v67, v87
  v_mul_f32 v84, v68, v68
  v_mov_b32 v88, s36
  v_fma_f32 v84, v84, s37, v88
  v_mul_f32 v84, v84, v68
  v_exp_f32 v84, v84
  s_nop 0
  v_add_f32 v84, 1.0, v84
  v_rcp_f32 v84, v84
  s_nop 0
  v_mul_f32 v68, v68, v84
  v_mul_f32 v85, v69, v69
  v_mov_b32 v88, s36
  v_fma_f32 v85, v85, s37, v88
  v_mul_f32 v85, v85, v69
  v_exp_f32 v85, v85
  s_nop 0
  v_add_f32 v85, 1.0, v85
  v_rcp_f32 v85, v85
  s_nop 0
  v_mul_f32 v69, v69, v85
  v_mul_f32 v86, v70, v70
  v_mov_b32 v88, s36
  v_fma_f32 v86, v86, s37, v88
  v_mul_f32 v86, v86, v70
  v_exp_f32 v86, v86
  s_nop 0
  v_add_f32 v86, 1.0, v86
  v_rcp_f32 v86, v86
  s_nop 0
  v_mul_f32 v70, v70, v86
  v_mul_f32 v87, v71, v71
  v_mov_b32 v88, s36
  v_fma_f32 v87, v87, s37, v88
  v_mul_f32 v87, v87, v71
  v_exp_f32 v87, v87
  s_nop 0
  v_add_f32 v87, 1.0, v87
  v_rcp_f32 v87, v87
  s_nop 0
  v_mul_f32 v71, v71, v87
  v_mul_f32 v84, v72, v72
  v_mov_b32 v88, s36
  v_fma_f32 v84, v84, s37, v88
  v_mul_f32 v84, v84, v72
  v_exp_f32 v84, v84
  s_nop 0
  v_add_f32 v84, 1.0, v84
  v_rcp_f32 v84, v84
  s_nop 0
  v_mul_f32 v72, v72, v84
  v_mul_f32 v85, v73, v73
  v_mov_b32 v88, s36
  v_fma_f32 v85, v85, s37, v88
  v_mul_f32 v85, v85, v73
  v_exp_f32 v85, v85
  s_nop 0
  v_add_f32 v85, 1.0, v85
  v_rcp_f32 v85, v85
  s_nop 0
  v_mul_f32 v73, v73, v85
  v_mul_f32 v86, v74, v74
  v_mov_b32 v88, s36
  v_fma_f32 v86, v86, s37, v88
  v_mul_f32 v86, v86, v74
  v_exp_f32 v86, v86
  s_nop 0
  v_add_f32 v86, 1.0, v86
  v_rcp_f32 v86, v86
  s_nop 0
  v_mul_f32 v74, v74, v86
  v_mul_f32 v87, v75, v75
  v_mov_b32 v88, s36
  v_fma_f32 v87, v87, s37, v88
  v_mul_f32 v87, v87, v75
  v_exp_f32 v87, v87
  s_nop 0
  v_add_f32 v87, 1.0, v87
  v_rcp_f32 v87, v87
  s_nop 0
  v_mul_f32 v75, v75, v87
  v_mul_f32 v84, v76, v76
  v_mov_b32 v88, s36
  v_fma_f32 v84, v84, s37, v88
  v_mul_f32 v84, v84, v76
  v_exp_f32 v84, v84
  s_nop 0
  v_add_f32 v84, 1.0, v84
  v_rcp_f32 v84, v84
  s_nop 0
  v_mul_f32 v76, v76, v84
  v_mul_f32 v85, v77, v77
  v_mov_b32 v88, s36
  v_fma_f32 v85, v85, s37, v88
  v_mul_f32 v85, v85, v77
  v_exp_f32 v85, v85
  s_nop 0
  v_add_f32 v85, 1.0, v85
  v_rcp_f32 v85, v85
  s_nop 0
  v_mul_f32 v77, v77, v85
  v_mul_f32 v86, v78, v78
  v_mov_b32 v88, s36
  v_fma_f32 v86, v86, s37, v88
  v_mul_f32 v86, v86, v78
  v_exp_f32 v86, v86
  s_nop 0
  v_add_f32 v86, 1.0, v86
  v_rcp_f32 v86, v86
  s_nop 0
  v_mul_f32 v78, v78, v86
  v_mul_f32 v87, v79, v79
  v_mov_b32 v88, s36
  v_fma_f32 v87, v87, s37, v88
  v_mul_f32 v87, v87, v79
  v_exp_f32 v87, v87
  s_nop 0
  v_add_f32 v87, 1.0, v87
  v_rcp_f32 v87, v87
  s_nop 0
  v_mul_f32 v79, v79, v87
  v_cvt_pk_bf16_f32 v80, v64, v72
  v_cvt_pk_bf16_f32 v81, v65, v73
  v_cvt_pk_bf16_f32 v82, v66, v74
  v_cvt_pk_bf16_f32 v83, v67, v75
  v_add_u32 v25, 4, v30
  v_xor_b32 v25, v25, v31
  v_lshl_add_u32 v25, v25, 4, v29
  ds_write_b128 v25, v[80:83] offset:8192
  v_cvt_pk_bf16_f32 v80, v68, v76
  v_cvt_pk_bf16_f32 v81, v69, v77
  v_cvt_pk_bf16_f32 v82, v70, v78
  v_cvt_pk_bf16_f32 v83, v71, v79
  v_add_u32 v25, 6, v30
  v_xor_b32 v25, v25, v31
  v_lshl_add_u32 v25, v25, 4, v29
  ds_write_b128 v25, v[80:83] offset:8192
  s_waitcnt lgkmcnt(0)
  s_barrier
  s_mul_i32 s13, s91, 458752
  s_add_u32 s13, s13, 71303168
  s_lshl_b32 s14, s92, 8
  s_add_u32 s13, s13, s14
  s_add_u32 s30, s4, s13
  s_addc_u32 s31, s5, 0
  v_lshlrev_b32 v25, 4, v22
  s_lshl_b32 s13, s10, 13
  s_add_u32 s13, s13, 98304
  v_add_u32 v25, s13, v25
  ds_read_b128 v[64:67], v25 offset:0
  ds_read_b128 v[68:71], v25 offset:1024
  ds_read_b128 v[72:75], v25 offset:2048
  ds_read_b128 v[76:79], v25 offset:3072
  ds_read_b128 v[80:83], v25 offset:4096
  ds_read_b128 v[84:87], v25 offset:5120
  ds_read_b128 v[88:91], v25 offset:6144
  ds_read_b128 v[92:95], v25 offset:7168
  v_lshrrev_b32 v27, 4, v22
  s_lshl_b32 s13, s10, 5
  v_add_u32 v27, s13, v27
  v_add_u32 v28, 0, v27
  v_xor_b32 v26, v28, v22
  v_and_b32 v26, 15, v26
  v_mul_u32_u24 v28, 3584, v28
  v_lshl_add_u32 v96, v26, 4, v28
  v_add_u32 v28, 4, v27
  v_xor_b32 v26, v28, v22
  v_and_b32 v26, 15, v26
  v_mul_u32_u24 v28, 3584, v28
  v_lshl_add_u32 v97, v26, 4, v28
  v_add_u32 v28, 8, v27
  v_xor_b32 v26, v28, v22
  v_and_b32 v26, 15, v26
  v_mul_u32_u24 v28, 3584, v28
  v_lshl_add_u32 v98, v26, 4, v28
  v_add_u32 v28, 12, v27
  v_xor_b32 v26, v28, v22
  v_and_b32 v26, 15, v26
  v_mul_u32_u24 v28, 3584, v28
  v_lshl_add_u32 v99, v26, 4, v28
  v_add_u32 v28, 16, v27
  v_xor_b32 v26, v28, v22
  v_and_b32 v26, 15, v26
  v_mul_u32_u24 v28, 3584, v28
  v_lshl_add_u32 v100, v26, 4, v28
  v_add_u32 v28, 20, v27
  v_xor_b32 v26, v28, v22
  v_and_b32 v26, 15, v26
  v_mul_u32_u24 v28, 3584, v28
  v_lshl_add_u32 v101, v26, 4, v28
  v_add_u32 v28, 24, v27
  v_xor_b32 v26, v28, v22
  v_and_b32 v26, 15, v26
  v_mul_u32_u24 v28, 3584, v28
  v_lshl_add_u32 v102, v26, 4, v28
  v_add_u32 v28, 28, v27
  v_xor_b32 v26, v28, v22
  v_and_b32 v26, 15, v26
  v_mul_u32_u24 v28, 3584, v28
  v_lshl_add_u32 v103, v26, 4, v28
  s_waitcnt lgkmcnt(7)
  global_store_dwordx4 v96, v[64:67], s[30:31] sc1
  s_waitcnt lgkmcnt(6)
  global_store_dwordx4 v97, v[68:71], s[30:31] sc1
  s_waitcnt lgkmcnt(5)
  global_store_dwordx4 v98, v[72:75], s[30:31] sc1
  s_waitcnt lgkmcnt(4)
  global_store_dwordx4 v99, v[76:79], s[30:31] sc1
  s_waitcnt lgkmcnt(3)
  global_store_dwordx4 v100, v[80:83], s[30:31] sc1
  s_waitcnt lgkmcnt(2)
  global_store_dwordx4 v101, v[84:87], s[30:31] sc1
  s_waitcnt lgkmcnt(1)
  global_store_dwordx4 v102, v[88:91], s[30:31] sc1
  s_waitcnt lgkmcnt(0)
  global_store_dwordx4 v103, v[92:95], s[30:31] sc1
  s_lshl_b32 s94, s91, 8
  s_add_u32 s94, s94, 94400512
  s_lshl_b32 s14, s92, 4
  s_add_u32 s94, s94, s14
  s_branch Le_done_217
Le_v_214:
  s_lshl_b32 s13, s91, 20
  s_lshl_b32 s14, s92, 13
  s_add_u32 s13, s13, s14
  s_add_u32 s13, s13, 37748736
  s_add_u32 s30, s4, s13
  s_addc_u32 s31, s5, 0
  s_lshr_b32 s13, s10, 1
  s_lshl_b32 s13, s13, 14
  s_and_b32 s14, s10, 1
  s_lshl_b32 s14, s14, 12
  s_add_u32 s13, s13, s14
  s_add_u32 s13, s13, 98304
  v_lshlrev_b32 v29, 6, v23
  v_lshl_add_u32 v29, v24, 4, v29
  v_add_u32 v29, s13, v29
  v_cvt_pk_bf16_f32 v64, v128, v129
  v_cvt_pk_bf16_f32 v65, v130, v131
  v_cvt_pk_bf16_f32 v66, v136, v137
  v_cvt_pk_bf16_f32 v67, v138, v139
  ds_write_b128 v29, v[64:67] offset:0
  v_cvt_pk_bf16_f32 v68, v132, v133
  v_cvt_pk_bf16_f32 v69, v134, v135
  v_cvt_pk_bf16_f32 v70, v140, v141
  v_cvt_pk_bf16_f32 v71, v142, v143
  ds_write_b128 v29, v[68:71] offset:32
  v_cvt_pk_bf16_f32 v64, v144, v145
  v_cvt_pk_bf16_f32 v65, v146, v147
  v_cvt_pk_bf16_f32 v66, v152, v153
  v_cvt_pk_bf16_f32 v67, v154, v155
  ds_write_b128 v29, v[64:67] offset:2048
  v_cvt_pk_bf16_f32 v68, v148, v149
  v_cvt_pk_bf16_f32 v69, v150, v151
  v_cvt_pk_bf16_f32 v70, v156, v157
  v_cvt_pk_bf16_f32 v71, v158, v159
  ds_write_b128 v29, v[68:71] offset:2080
  v_cvt_pk_bf16_f32 v64, v160, v161
  v_cvt_pk_bf16_f32 v65, v162, v163
  v_cvt_pk_bf16_f32 v66, v168, v169
  v_cvt_pk_bf16_f32 v67, v170, v171
  ds_write_b128 v29, v[64:67] offset:8192
  v_cvt_pk_bf16_f32 v68, v164, v165
  v_cvt_pk_bf16_f32 v69, v166, v167
  v_cvt_pk_bf16_f32 v70, v172, v173
  v_cvt_pk_bf16_f32 v71, v174, v175
  ds_write_b128 v29, v[68:71] offset:8224
  v_cvt_pk_bf16_f32 v64, v176, v177
  v_cvt_pk_bf16_f32 v65, v178, v179
  v_cvt_pk_bf16_f32 v66, v184, v185
  v_cvt_pk_bf16_f32 v67, v186, v187
  ds_write_b128 v29, v[64:67] offset:10240
  v_cvt_pk_bf16_f32 v68, v180, v181
  v_cvt_pk_bf16_f32 v69, v182, v183
  v_cvt_pk_bf16_f32 v70, v188, v189
  v_cvt_pk_bf16_f32 v71, v190, v191
  ds_write_b128 v29, v[68:71] offset:10272
  s_waitcnt lgkmcnt(0)
  s_barrier
  v_lshlrev_b32 v25, 4, v22
  s_lshl_b32 s13, s10, 13
  s_add_u32 s13, s13, 98304
  v_add_u32 v26, s13, v25
  ds_read_b128 v[64:67], v26 offset:0
  ds_read_b128 v[68:71], v26 offset:1024
  ds_read_b128 v[72:75], v26 offset:2048
  ds_read_b128 v[76:79], v26 offset:3072
  ds_read_b128 v[80:83], v26 offset:4096
  ds_read_b128 v[84:87], v26 offset:5120
  ds_read_b128 v[88:91], v26 offset:6144
  ds_read_b128 v[92:95], v26 offset:7168
  s_lshl_b32 s13, s10, 18
  s_add_u32 s34, s30, s13
  s_addc_u32 s35, s31, 0
  v_add_u32 v27, 4096, v25
  s_waitcnt lgkmcnt(7)
  global_store_dwordx4 v25, v[64:67], s[34:35] offset:0 sc1
  s_waitcnt lgkmcnt(6)
  global_store_dwordx4 v25, v[68:71], s[34:35] offset:1024 sc1
  s_waitcnt lgkmcnt(5)
  global_store_dwordx4 v25, v[72:75], s[34:35] offset:2048 sc1
  s_waitcnt lgkmcnt(4)
  global_store_dwordx4 v25, v[76:79], s[34:35] offset:3072 sc1
  s_waitcnt lgkmcnt(3)
  global_store_dwordx4 v27, v[80:83], s[34:35] offset:0 sc1
  s_waitcnt lgkmcnt(2)
  global_store_dwordx4 v27, v[84:87], s[34:35] offset:1024 sc1
  s_waitcnt lgkmcnt(1)
  global_store_dwordx4 v27, v[88:91], s[34:35] offset:2048 sc1
  s_waitcnt lgkmcnt(0)
  global_store_dwordx4 v27, v[92:95], s[34:35] offset:3072 sc1
  s_lshl_b32 s94, s91, 9
  s_add_u32 s94, s94, 94384128
  s_lshl_b32 s14, s92, 4
  s_add_u32 s94, s94, s14
  s_branch Le_done_217
Le_b_215:
  s_lshr_b32 s13, s10, 1
  s_lshl_b32 s13, s13, 14
  s_add_u32 s13, s13, 98304
  v_lshlrev_b32 v29, 8, v23
  v_add_u32 v29, s13, v29
  v_and_b32 v31, 15, v23
  s_lshl_b32 s13, s92, 8
  s_and_b32 s14, s10, 1
  s_lshl_b32 s14, s14, 7
  s_add_u32 s13, s13, s14
  s_add_u32 s34, s52, s13
  s_addc_u32 s35, s53, 0
  v_lshlrev_b32 v25, 3, v24
  global_load_dwordx2 v[104:105], v25, s[34:35] offset:0
  global_load_dwordx2 v[106:107], v25, s[34:35] offset:16
  global_load_dwordx2 v[108:109], v25, s[34:35] offset:32
  global_load_dwordx2 v[110:111], v25, s[34:35] offset:48
  global_load_dwordx2 v[112:113], v25, s[34:35] offset:64
  global_load_dwordx2 v[114:115], v25, s[34:35] offset:80
  global_load_dwordx2 v[116:117], v25, s[34:35] offset:96
  global_load_dwordx2 v[118:119], v25, s[34:35] offset:112
  s_and_b32 s14, s10, 1
  s_lshl_b32 s14, s14, 3
  s_waitcnt vmcnt(0)
  v_mov_b64 v[64:65], v[128:129]
  v_mov_b64 v[66:67], v[130:131]
  v_mov_b64 v[68:69], v[132:133]
  v_mov_b64 v[70:71], v[134:135]
  v_mov_b64 v[72:73], v[136:137]
  v_mov_b64 v[74:75], v[138:139]
  v_mov_b64 v[76:77], v[140:141]
  v_mov_b64 v[78:79], v[142:143]
  v_cvt_pk_bf16_f32 v64, v64, v64
  v_and_b32 v64, 0xffff0000, v64
  v_lshlrev_b32 v84, 16, v104
  v_add_f32 v64, v64, v84
  v_cvt_pk_bf16_f32 v65, v65, v65
  v_and_b32 v65, 0xffff0000, v65
  v_and_b32 v84, 0xffff0000, v104
  v_add_f32 v65, v65, v84
  v_cvt_pk_bf16_f32 v66, v66, v66
  v_and_b32 v66, 0xffff0000, v66
  v_lshlrev_b32 v84, 16, v105
  v_add_f32 v66, v66, v84
  v_cvt_pk_bf16_f32 v67, v67, v67
  v_and_b32 v67, 0xffff0000, v67
  v_and_b32 v84, 0xffff0000, v105
  v_add_f32 v67, v67, v84
  v_cvt_pk_bf16_f32 v80, v64, v65
  v_cvt_pk_bf16_f32 v81, v66, v67
  s_add_u32 s13, s14, 0
  v_xor_b32 v25, s13, v31
  v_lshl_add_u32 v25, v25, 4, v29
  v_lshl_add_u32 v25, v24, 3, v25
  ds_write_b64 v25, v[80:81] offset:0
  v_cvt_pk_bf16_f32 v68, v68, v68
  v_and_b32 v68, 0xffff0000, v68
  v_lshlrev_b32 v84, 16, v106
  v_add_f32 v68, v68, v84
  v_cvt_pk_bf16_f32 v69, v69, v69
  v_and_b32 v69, 0xffff0000, v69
  v_and_b32 v84, 0xffff0000, v106
  v_add_f32 v69, v69, v84
  v_cvt_pk_bf16_f32 v70, v70, v70
  v_and_b32 v70, 0xffff0000, v70
  v_lshlrev_b32 v84, 16, v107
  v_add_f32 v70, v70, v84
  v_cvt_pk_bf16_f32 v71, v71, v71
  v_and_b32 v71, 0xffff0000, v71
  v_and_b32 v84, 0xffff0000, v107
  v_add_f32 v71, v71, v84
  v_cvt_pk_bf16_f32 v80, v68, v69
  v_cvt_pk_bf16_f32 v81, v70, v71
  s_add_u32 s13, s14, 1
  v_xor_b32 v25, s13, v31
  v_lshl_add_u32 v25, v25, 4, v29
  v_lshl_add_u32 v25, v24, 3, v25
  ds_write_b64 v25, v[80:81] offset:0
  v_cvt_pk_bf16_f32 v72, v72, v72
  v_and_b32 v72, 0xffff0000, v72
  v_lshlrev_b32 v84, 16, v108
  v_add_f32 v72, v72, v84
  v_cvt_pk_bf16_f32 v73, v73, v73
  v_and_b32 v73, 0xffff0000, v73
  v_and_b32 v84, 0xffff0000, v108
  v_add_f32 v73, v73, v84
  v_cvt_pk_bf16_f32 v74, v74, v74
  v_and_b32 v74, 0xffff0000, v74
  v_lshlrev_b32 v84, 16, v109
  v_add_f32 v74, v74, v84
  v_cvt_pk_bf16_f32 v75, v75, v75
  v_and_b32 v75, 0xffff0000, v75
  v_and_b32 v84, 0xffff0000, v109
  v_add_f32 v75, v75, v84
  v_cvt_pk_bf16_f32 v80, v72, v73
  v_cvt_pk_bf16_f32 v81, v74, v75
  s_add_u32 s13, s14, 2
  v_xor_b32 v25, s13, v31
  v_lshl_add_u32 v25, v25, 4, v29
  v_lshl_add_u32 v25, v24, 3, v25
  ds_write_b64 v25, v[80:81] offset:0
  v_cvt_pk_bf16_f32 v76, v76, v76
  v_and_b32 v76, 0xffff0000, v76
  v_lshlrev_b32 v84, 16, v110
  v_add_f32 v76, v76, v84
  v_cvt_pk_bf16_f32 v77, v77, v77
  v_and_b32 v77, 0xffff0000, v77
  v_and_b32 v84, 0xffff0000, v110
  v_add_f32 v77, v77, v84
  v_cvt_pk_bf16_f32 v78, v78, v78
  v_and_b32 v78, 0xffff0000, v78
  v_lshlrev_b32 v84, 16, v111
  v_add_f32 v78, v78, v84
  v_cvt_pk_bf16_f32 v79, v79, v79
  v_and_b32 v79, 0xffff0000, v79
  v_and_b32 v84, 0xffff0000, v111
  v_add_f32 v79, v79, v84
  v_cvt_pk_bf16_f32 v80, v76, v77
  v_cvt_pk_bf16_f32 v81, v78, v79
  s_add_u32 s13, s14, 3
  v_xor_b32 v25, s13, v31
  v_lshl_add_u32 v25, v25, 4, v29
  v_lshl_add_u32 v25, v24, 3, v25
  ds_write_b64 v25, v[80:81] offset:0
  v_mov_b64 v[64:65], v[144:145]
  v_mov_b64 v[66:67], v[146:147]
  v_mov_b64 v[68:69], v[148:149]
  v_mov_b64 v[70:71], v[150:151]
  v_mov_b64 v[72:73], v[152:153]
  v_mov_b64 v[74:75], v[154:155]
  v_mov_b64 v[76:77], v[156:157]
  v_mov_b64 v[78:79], v[158:159]
  v_cvt_pk_bf16_f32 v64, v64, v64
  v_and_b32 v64, 0xffff0000, v64
  v_lshlrev_b32 v84, 16, v112
  v_add_f32 v64, v64, v84
  v_cvt_pk_bf16_f32 v65, v65, v65
  v_and_b32 v65, 0xffff0000, v65
  v_and_b32 v84, 0xffff0000, v112
  v_add_f32 v65, v65, v84
  v_cvt_pk_bf16_f32 v66, v66, v66
  v_and_b32 v66, 0xffff0000, v66
  v_lshlrev_b32 v84, 16, v113
  v_add_f32 v66, v66, v84
  v_cvt_pk_bf16_f32 v67, v67, v67
  v_and_b32 v67, 0xffff0000, v67
  v_and_b32 v84, 0xffff0000, v113
  v_add_f32 v67, v67, v84
  v_cvt_pk_bf16_f32 v80, v64, v65
  v_cvt_pk_bf16_f32 v81, v66, v67
  s_add_u32 s13, s14, 4
  v_xor_b32 v25, s13, v31
  v_lshl_add_u32 v25, v25, 4, v29
  v_lshl_add_u32 v25, v24, 3, v25
  ds_write_b64 v25, v[80:81] offset:0
  v_cvt_pk_bf16_f32 v68, v68, v68
  v_and_b32 v68, 0xffff0000, v68
  v_lshlrev_b32 v84, 16, v114
  v_add_f32 v68, v68, v84
  v_cvt_pk_bf16_f32 v69, v69, v69
  v_and_b32 v69, 0xffff0000, v69
  v_and_b32 v84, 0xffff0000, v114
  v_add_f32 v69, v69, v84
  v_cvt_pk_bf16_f32 v70, v70, v70
  v_and_b32 v70, 0xffff0000, v70
  v_lshlrev_b32 v84, 16, v115
  v_add_f32 v70, v70, v84
  v_cvt_pk_bf16_f32 v71, v71, v71
  v_and_b32 v71, 0xffff0000, v71
  v_and_b32 v84, 0xffff0000, v115
  v_add_f32 v71, v71, v84
  v_cvt_pk_bf16_f32 v80, v68, v69
  v_cvt_pk_bf16_f32 v81, v70, v71
  s_add_u32 s13, s14, 5
  v_xor_b32 v25, s13, v31
  v_lshl_add_u32 v25, v25, 4, v29
  v_lshl_add_u32 v25, v24, 3, v25
  ds_write_b64 v25, v[80:81] offset:0
  v_cvt_pk_bf16_f32 v72, v72, v72
  v_and_b32 v72, 0xffff0000, v72
  v_lshlrev_b32 v84, 16, v116
  v_add_f32 v72, v72, v84
  v_cvt_pk_bf16_f32 v73, v73, v73
  v_and_b32 v73, 0xffff0000, v73
  v_and_b32 v84, 0xffff0000, v116
  v_add_f32 v73, v73, v84
  v_cvt_pk_bf16_f32 v74, v74, v74
  v_and_b32 v74, 0xffff0000, v74
  v_lshlrev_b32 v84, 16, v117
  v_add_f32 v74, v74, v84
  v_cvt_pk_bf16_f32 v75, v75, v75
  v_and_b32 v75, 0xffff0000, v75
  v_and_b32 v84, 0xffff0000, v117
  v_add_f32 v75, v75, v84
  v_cvt_pk_bf16_f32 v80, v72, v73
  v_cvt_pk_bf16_f32 v81, v74, v75
  s_add_u32 s13, s14, 6
  v_xor_b32 v25, s13, v31
  v_lshl_add_u32 v25, v25, 4, v29
  v_lshl_add_u32 v25, v24, 3, v25
  ds_write_b64 v25, v[80:81] offset:0
  v_cvt_pk_bf16_f32 v76, v76, v76
  v_and_b32 v76, 0xffff0000, v76
  v_lshlrev_b32 v84, 16, v118
  v_add_f32 v76, v76, v84
  v_cvt_pk_bf16_f32 v77, v77, v77
  v_and_b32 v77, 0xffff0000, v77
  v_and_b32 v84, 0xffff0000, v118
  v_add_f32 v77, v77, v84
  v_cvt_pk_bf16_f32 v78, v78, v78
  v_and_b32 v78, 0xffff0000, v78
  v_lshlrev_b32 v84, 16, v119
  v_add_f32 v78, v78, v84
  v_cvt_pk_bf16_f32 v79, v79, v79
  v_and_b32 v79, 0xffff0000, v79
  v_and_b32 v84, 0xffff0000, v119
  v_add_f32 v79, v79, v84
  v_cvt_pk_bf16_f32 v80, v76, v77
  v_cvt_pk_bf16_f32 v81, v78, v79
  s_add_u32 s13, s14, 7
  v_xor_b32 v25, s13, v31
  v_lshl_add_u32 v25, v25, 4, v29
  v_lshl_add_u32 v25, v24, 3, v25
  ds_write_b64 v25, v[80:81] offset:0
  v_mov_b64 v[64:65], v[160:161]
  v_mov_b64 v[66:67], v[162:163]
  v_mov_b64 v[68:69], v[164:165]
  v_mov_b64 v[70:71], v[166:167]
  v_mov_b64 v[72:73], v[168:169]
  v_mov_b64 v[74:75], v[170:171]
  v_mov_b64 v[76:77], v[172:173]
  v_mov_b64 v[78:79], v[174:175]
  v_cvt_pk_bf16_f32 v64, v64, v64
  v_and_b32 v64, 0xffff0000, v64
  v_lshlrev_b32 v84, 16, v104
  v_add_f32 v64, v64, v84
  v_cvt_pk_bf16_f32 v65, v65, v65
  v_and_b32 v65, 0xffff0000, v65
  v_and_b32 v84, 0xffff0000, v104
  v_add_f32 v65, v65, v84
  v_cvt_pk_bf16_f32 v66, v66, v66
  v_and_b32 v66, 0xffff0000, v66
  v_lshlrev_b32 v84, 16, v105
  v_add_f32 v66, v66, v84
  v_cvt_pk_bf16_f32 v67, v67, v67
  v_and_b32 v67, 0xffff0000, v67
  v_and_b32 v84, 0xffff0000, v105
  v_add_f32 v67, v67, v84
  v_cvt_pk_bf16_f32 v80, v64, v65
  v_cvt_pk_bf16_f32 v81, v66, v67
  s_add_u32 s13, s14, 0
  v_xor_b32 v25, s13, v31
  v_lshl_add_u32 v25, v25, 4, v29
  v_lshl_add_u32 v25, v24, 3, v25
  ds_write_b64 v25, v[80:81] offset:8192
  v_cvt_pk_bf16_f32 v68, v68, v68
  v_and_b32 v68, 0xffff0000, v68
  v_lshlrev_b32 v84, 16, v106
  v_add_f32 v68, v68, v84
  v_cvt_pk_bf16_f32 v69, v69, v69
  v_and_b32 v69, 0xffff0000, v69
  v_and_b32 v84, 0xffff0000, v106
  v_add_f32 v69, v69, v84
  v_cvt_pk_bf16_f32 v70, v70, v70
  v_and_b32 v70, 0xffff0000, v70
  v_lshlrev_b32 v84, 16, v107
  v_add_f32 v70, v70, v84
  v_cvt_pk_bf16_f32 v71, v71, v71
  v_and_b32 v71, 0xffff0000, v71
  v_and_b32 v84, 0xffff0000, v107
  v_add_f32 v71, v71, v84
  v_cvt_pk_bf16_f32 v80, v68, v69
  v_cvt_pk_bf16_f32 v81, v70, v71
  s_add_u32 s13, s14, 1
  v_xor_b32 v25, s13, v31
  v_lshl_add_u32 v25, v25, 4, v29
  v_lshl_add_u32 v25, v24, 3, v25
  ds_write_b64 v25, v[80:81] offset:8192
  v_cvt_pk_bf16_f32 v72, v72, v72
  v_and_b32 v72, 0xffff0000, v72
  v_lshlrev_b32 v84, 16, v108
  v_add_f32 v72, v72, v84
  v_cvt_pk_bf16_f32 v73, v73, v73
  v_and_b32 v73, 0xffff0000, v73
  v_and_b32 v84, 0xffff0000, v108
  v_add_f32 v73, v73, v84
  v_cvt_pk_bf16_f32 v74, v74, v74
  v_and_b32 v74, 0xffff0000, v74
  v_lshlrev_b32 v84, 16, v109
  v_add_f32 v74, v74, v84
  v_cvt_pk_bf16_f32 v75, v75, v75
  v_and_b32 v75, 0xffff0000, v75
  v_and_b32 v84, 0xffff0000, v109
  v_add_f32 v75, v75, v84
  v_cvt_pk_bf16_f32 v80, v72, v73
  v_cvt_pk_bf16_f32 v81, v74, v75
  s_add_u32 s13, s14, 2
  v_xor_b32 v25, s13, v31
  v_lshl_add_u32 v25, v25, 4, v29
  v_lshl_add_u32 v25, v24, 3, v25
  ds_write_b64 v25, v[80:81] offset:8192
  v_cvt_pk_bf16_f32 v76, v76, v76
  v_and_b32 v76, 0xffff0000, v76
  v_lshlrev_b32 v84, 16, v110
  v_add_f32 v76, v76, v84
  v_cvt_pk_bf16_f32 v77, v77, v77
  v_and_b32 v77, 0xffff0000, v77
  v_and_b32 v84, 0xffff0000, v110
  v_add_f32 v77, v77, v84
  v_cvt_pk_bf16_f32 v78, v78, v78
  v_and_b32 v78, 0xffff0000, v78
  v_lshlrev_b32 v84, 16, v111
  v_add_f32 v78, v78, v84
  v_cvt_pk_bf16_f32 v79, v79, v79
  v_and_b32 v79, 0xffff0000, v79
  v_and_b32 v84, 0xffff0000, v111
  v_add_f32 v79, v79, v84
  v_cvt_pk_bf16_f32 v80, v76, v77
  v_cvt_pk_bf16_f32 v81, v78, v79
  s_add_u32 s13, s14, 3
  v_xor_b32 v25, s13, v31
  v_lshl_add_u32 v25, v25, 4, v29
  v_lshl_add_u32 v25, v24, 3, v25
  ds_write_b64 v25, v[80:81] offset:8192
  v_mov_b64 v[64:65], v[176:177]
  v_mov_b64 v[66:67], v[178:179]
  v_mov_b64 v[68:69], v[180:181]
  v_mov_b64 v[70:71], v[182:183]
  v_mov_b64 v[72:73], v[184:185]
  v_mov_b64 v[74:75], v[186:187]
  v_mov_b64 v[76:77], v[188:189]
  v_mov_b64 v[78:79], v[190:191]
  v_cvt_pk_bf16_f32 v64, v64, v64
  v_and_b32 v64, 0xffff0000, v64
  v_lshlrev_b32 v84, 16, v112
  v_add_f32 v64, v64, v84
  v_cvt_pk_bf16_f32 v65, v65, v65
  v_and_b32 v65, 0xffff0000, v65
  v_and_b32 v84, 0xffff0000, v112
  v_add_f32 v65, v65, v84
  v_cvt_pk_bf16_f32 v66, v66, v66
  v_and_b32 v66, 0xffff0000, v66
  v_lshlrev_b32 v84, 16, v113
  v_add_f32 v66, v66, v84
  v_cvt_pk_bf16_f32 v67, v67, v67
  v_and_b32 v67, 0xffff0000, v67
  v_and_b32 v84, 0xffff0000, v113
  v_add_f32 v67, v67, v84
  v_cvt_pk_bf16_f32 v80, v64, v65
  v_cvt_pk_bf16_f32 v81, v66, v67
  s_add_u32 s13, s14, 4
  v_xor_b32 v25, s13, v31
  v_lshl_add_u32 v25, v25, 4, v29
  v_lshl_add_u32 v25, v24, 3, v25
  ds_write_b64 v25, v[80:81] offset:8192
  v_cvt_pk_bf16_f32 v68, v68, v68
  v_and_b32 v68, 0xffff0000, v68
  v_lshlrev_b32 v84, 16, v114
  v_add_f32 v68, v68, v84
  v_cvt_pk_bf16_f32 v69, v69, v69
  v_and_b32 v69, 0xffff0000, v69
  v_and_b32 v84, 0xffff0000, v114
  v_add_f32 v69, v69, v84
  v_cvt_pk_bf16_f32 v70, v70, v70
  v_and_b32 v70, 0xffff0000, v70
  v_lshlrev_b32 v84, 16, v115
  v_add_f32 v70, v70, v84
  v_cvt_pk_bf16_f32 v71, v71, v71
  v_and_b32 v71, 0xffff0000, v71
  v_and_b32 v84, 0xffff0000, v115
  v_add_f32 v71, v71, v84
  v_cvt_pk_bf16_f32 v80, v68, v69
  v_cvt_pk_bf16_f32 v81, v70, v71
  s_add_u32 s13, s14, 5
  v_xor_b32 v25, s13, v31
  v_lshl_add_u32 v25, v25, 4, v29
  v_lshl_add_u32 v25, v24, 3, v25
  ds_write_b64 v25, v[80:81] offset:8192
  v_cvt_pk_bf16_f32 v72, v72, v72
  v_and_b32 v72, 0xffff0000, v72
  v_lshlrev_b32 v84, 16, v116
  v_add_f32 v72, v72, v84
  v_cvt_pk_bf16_f32 v73, v73, v73
  v_and_b32 v73, 0xffff0000, v73
  v_and_b32 v84, 0xffff0000, v116
  v_add_f32 v73, v73, v84
  v_cvt_pk_bf16_f32 v74, v74, v74
  v_and_b32 v74, 0xffff0000, v74
  v_lshlrev_b32 v84, 16, v117
  v_add_f32 v74, v74, v84
  v_cvt_pk_bf16_f32 v75, v75, v75
  v_and_b32 v75, 0xffff0000, v75
  v_and_b32 v84, 0xffff0000, v117
  v_add_f32 v75, v75, v84
  v_cvt_pk_bf16_f32 v80, v72, v73
  v_cvt_pk_bf16_f32 v81, v74, v75
  s_add_u32 s13, s14, 6
  v_xor_b32 v25, s13, v31
  v_lshl_add_u32 v25, v25, 4, v29
  v_lshl_add_u32 v25, v24, 3, v25
  ds_write_b64 v25, v[80:81] offset:8192
  v_cvt_pk_bf16_f32 v76, v76, v76
  v_and_b32 v76, 0xffff0000, v76
  v_lshlrev_b32 v84, 16, v118
  v_add_f32 v76, v76, v84
  v_cvt_pk_bf16_f32 v77, v77, v77
  v_and_b32 v77, 0xffff0000, v77
  v_and_b32 v84, 0xffff0000, v118
  v_add_f32 v77, v77, v84
  v_cvt_pk_bf16_f32 v78, v78, v78
  v_and_b32 v78, 0xffff0000, v78
  v_lshlrev_b32 v84, 16, v119
  v_add_f32 v78, v78, v84
  v_cvt_pk_bf16_f32 v79, v79, v79
  v_and_b32 v79, 0xffff0000, v79
  v_and_b32 v84, 0xffff0000, v119
  v_add_f32 v79, v79, v84
  v_cvt_pk_bf16_f32 v80, v76, v77
  v_cvt_pk_bf16_f32 v81, v78, v79
  s_add_u32 s13, s14, 7
  v_xor_b32 v25, s13, v31
  v_lshl_add_u32 v25, v25, 4, v29
  v_lshl_add_u32 v25, v24, 3, v25
  ds_write_b64 v25, v[80:81] offset:8192
  s_waitcnt lgkmcnt(0)
  s_barrier
  s_lshl_b32 s13, s91, 17
  s_add_u32 s13, s13, 79691776
  s_lshl_b32 s14, s92, 8
  s_add_u32 s13, s13, s14
  s_add_u32 s30, s4, s13
  s_addc_u32 s31, s5, 0
  v_lshlrev_b32 v25, 4, v22
  s_lshl_b32 s13, s10, 13
  s_add_u32 s13, s13, 98304
  v_add_u32 v25, s13, v25
  ds_read_b128 v[64:67], v25 offset:0
  ds_read_b128 v[68:71], v25 offset:1024
  ds_read_b128 v[72:75], v25 offset:2048
  ds_read_b128 v[76:79], v25 offset:3072
  ds_read_b128 v[80:83], v25 offset:4096
  ds_read_b128 v[84:87], v25 offset:5120
  ds_read_b128 v[88:91], v25 offset:6144
  ds_read_b128 v[92:95], v25 offset:7168
  v_lshrrev_b32 v27, 4, v22
  s_lshl_b32 s13, s10, 5
  v_add_u32 v27, s13, v27
  v_add_u32 v28, 0, v27
  v_xor_b32 v26, v28, v22
  v_and_b32 v26, 15, v26
  v_mul_u32_u24 v28, 1024, v28
  v_lshl_add_u32 v96, v26, 4, v28
  v_add_u32 v28, 4, v27
  v_xor_b32 v26, v28, v22
  v_and_b32 v26, 15, v26
  v_mul_u32_u24 v28, 1024, v28
  v_lshl_add_u32 v97, v26, 4, v28
  v_add_u32 v28, 8, v27
  v_xor_b32 v26, v28, v22
  v_and_b32 v26, 15, v26
  v_mul_u32_u24 v28, 1024, v28
  v_lshl_add_u32 v98, v26, 4, v28
  v_add_u32 v28, 12, v27
  v_xor_b32 v26, v28, v22
  v_and_b32 v26, 15, v26
  v_mul_u32_u24 v28, 1024, v28
  v_lshl_add_u32 v99, v26, 4, v28
  v_add_u32 v28, 16, v27
  v_xor_b32 v26, v28, v22
  v_and_b32 v26, 15, v26
  v_mul_u32_u24 v28, 1024, v28
  v_lshl_add_u32 v100, v26, 4, v28
  v_add_u32 v28, 20, v27
  v_xor_b32 v26, v28, v22
  v_and_b32 v26, 15, v26
  v_mul_u32_u24 v28, 1024, v28
  v_lshl_add_u32 v101, v26, 4, v28
  v_add_u32 v28, 24, v27
  v_xor_b32 v26, v28, v22
  v_and_b32 v26, 15, v26
  v_mul_u32_u24 v28, 1024, v28
  v_lshl_add_u32 v102, v26, 4, v28
  v_add_u32 v28, 28, v27
  v_xor_b32 v26, v28, v22
  v_and_b32 v26, 15, v26
  v_mul_u32_u24 v28, 1024, v28
  v_lshl_add_u32 v103, v26, 4, v28
  s_waitcnt lgkmcnt(7)
  global_store_dwordx4 v96, v[64:67], s[30:31] sc1
  s_waitcnt lgkmcnt(6)
  global_store_dwordx4 v97, v[68:71], s[30:31] sc1
  s_waitcnt lgkmcnt(5)
  global_store_dwordx4 v98, v[72:75], s[30:31] sc1
  s_waitcnt lgkmcnt(4)
  global_store_dwordx4 v99, v[76:79], s[30:31] sc1
  s_waitcnt lgkmcnt(3)
  global_store_dwordx4 v100, v[80:83], s[30:31] sc1
  s_waitcnt lgkmcnt(2)
  global_store_dwordx4 v101, v[84:87], s[30:31] sc1
  s_waitcnt lgkmcnt(1)
  global_store_dwordx4 v102, v[88:91], s[30:31] sc1
  s_waitcnt lgkmcnt(0)
  global_store_dwordx4 v103, v[92:95], s[30:31] sc1
  s_lshl_b32 s94, s91, 7
  s_add_u32 s94, s94, 94404608
  s_lshl_b32 s14, s92, 4
  s_add_u32 s94, s94, s14
Le_done_217:
  s_mov_b32 s93, 1
  s_waitcnt vmcnt(0)
  s_barrier
  s_cmp_eq_u32 s93, 0
  s_cbranch_scc1 Lsp_218
  s_mov_b32 s93, 0
  s_cmp_lg_u32 s10, 0
  s_cbranch_scc1 Lsp_218
  s_add_u32 s15, s98, 1
  v_mov_b32 v26, s15
  v_mov_b32 v27, s99
  v_mov_b32 v28, s94
  s_mov_b64 exec, 1
  global_store_dwordx2 v28, v[26:27], s[4:5] sc1
  s_mov_b64 exec, -1
  s_mov_b64 exec, 1
  s_mov_b64 exec, -1
Lsp_218:
  s_cmp_lg_u32 s10, 0
  s_cbranch_scc1 Lwh_219
  s_lshl_b32 s13, s23, 8
  s_add_u32 s13, s13, 94400512
  v_min_u32 v25, 13, v22
  v_lshlrev_b32 v25, 4, v25
  v_add_u32 v25, s13, v25
Lwf_p_220:
  global_load_dwordx2 v[26:27], v25, s[4:5] sc1
  s_waitcnt vmcnt(0)
  v_subrev_u32 v26, s98, v26
  v_xor_b32 v27, s99, v27
  v_subrev_u32 v26, 1, v26
  v_lshrrev_b32 v26, 7, v26
  v_or_b32 v26, v26, v27
  v_cmp_ne_u32 vcc, 0, v26
  s_cbranch_vccz Lwf_d_221
  s_sleep 4
  s_cmp_eq_u32 s12, 0
  s_cbranch_scc1 Lwf_d_221
  s_sub_u32 s12, s12, 1
  s_branch Lwf_p_220
Lwf_d_221:
Lwh_219:
  s_barrier
  s_mov_b32 s25, 1024
  s_mov_b32 s26, 8192
  s_mov_b32 s20, 8
  s_lshl_b32 s36, s23, 17
  s_add_u32 s16, s4, s36
  s_addc_u32 s17, s5, 0
  s_lshl_b32 s37, s24, 8
  s_cmp_eq_u32 s22, 1
  s_cbranch_scc1 Lsetupv_222
  s_cmp_eq_u32 s22, 2
  s_cbranch_scc1 Lsetupq_223
  s_cmp_eq_u32 s22, 3
  s_cbranch_scc1 Lsetuph_224
  s_cmp_eq_u32 s22, 4
  s_cbranch_scc1 Lsetupb_225
  s_mov_b64 s[18:19], s[42:43]
  s_branch Lsetupdone_226
Lsetupv_222:
  s_mov_b64 s[18:19], s[44:45]
  s_branch Lsetupdone_226
Lsetupq_223:
  s_mov_b64 s[18:19], s[40:41]
  s_branch Lsetupdone_226
Lsetuph_224:
  s_mov_b64 s[18:19], s[46:47]
  s_mov_b32 s26, 3584
  s_add_u32 s16, s16, 2097152
  s_addc_u32 s17, s17, 0
  s_branch Lsetupdone_226
Lsetupb_225:
  s_mov_b64 s[18:19], s[50:51]
  s_mov_b32 s26, 1024
  s_mov_b32 s25, 3584
  s_mov_b32 s20, 28
  s_mul_i32 s36, s23, 458752
  s_add_u32 s36, s36, 71303168
  s_add_u32 s16, s4, s36
  s_addc_u32 s17, s5, 0
Lsetupdone_226:
  s_add_u32 s18, s18, s37
  s_addc_u32 s19, s19, 0
  s_lshl_b32 s13, s10, 5
  s_add_u32 s13, s13, 0
  v_lshrrev_b32 v25, 3, v22
  v_add_u32 v25, s13, v25
  v_bfe_u32 v26, v25, 1, 3
  v_xor_b32 v26, v26, v22
  v_and_b32 v26, 7, v26
  v_mul_lo_u32 v25, v25, s25
  v_lshl_add_u32 v25, v26, 4, v25
  v_subrev_u32 v8, 0, v25
  s_lshl_b32 s13, s10, 5
  s_add_u32 s13, s13, 8
  v_lshrrev_b32 v25, 3, v22
  v_add_u32 v25, s13, v25
  v_bfe_u32 v26, v25, 1, 3
  v_xor_b32 v26, v26, v22
  v_and_b32 v26, 7, v26
  v_mul_lo_u32 v25, v25, s25
  v_lshl_add_u32 v25, v26, 4, v25
  v_subrev_u32 v9, 1024, v25
  s_lshl_b32 s13, s10, 5
  s_add_u32 s13, s13, 16
  v_lshrrev_b32 v25, 3, v22
  v_add_u32 v25, s13, v25
  v_bfe_u32 v26, v25, 1, 3
  v_xor_b32 v26, v26, v22
  v_and_b32 v26, 7, v26
  v_mul_lo_u32 v25, v25, s25
  v_lshl_add_u32 v25, v26, 4, v25
  v_subrev_u32 v10, 2048, v25
  s_lshl_b32 s13, s10, 5
  s_add_u32 s13, s13, 24
  v_lshrrev_b32 v25, 3, v22
  v_add_u32 v25, s13, v25
  v_bfe_u32 v26, v25, 1, 3
  v_xor_b32 v26, v26, v22
  v_and_b32 v26, 7, v26
  v_mul_lo_u32 v25, v25, s25
  v_lshl_add_u32 v25, v26, 4, v25
  v_subrev_u32 v11, 3072, v25
  v_lshrrev_b32 v27, 4, v22
  v_lshlrev_b32 v26, 2, v27
  v_xor_b32 v26, v26, v22
  v_and_b32 v26, 15, v26
  v_lshlrev_b32 v26, 4, v26
  s_cmp_eq_u32 s22, 4
  s_cbranch_scc1 Lperm_227
  s_lshl_b32 s13, s10, 4
  s_add_u32 s13, s13, 0
  v_add_u32 v25, s13, v27
  v_mul_lo_u32 v25, v25, s26
  v_add_u32 v25, v25, v26
  v_subrev_u32 v12, 0, v25
  s_lshl_b32 s13, s10, 4
  s_add_u32 s13, s13, 4
  v_add_u32 v25, s13, v27
  v_mul_lo_u32 v25, v25, s26
  v_add_u32 v25, v25, v26
  v_subrev_u32 v13, 1024, v25
  s_lshl_b32 s13, s10, 4
  s_add_u32 s13, s13, 8
  v_add_u32 v25, s13, v27
  v_mul_lo_u32 v25, v25, s26
  v_add_u32 v25, v25, v26
  v_subrev_u32 v14, 2048, v25
  s_lshl_b32 s13, s10, 4
  s_add_u32 s13, s13, 12
  v_add_u32 v25, s13, v27
  v_mul_lo_u32 v25, v25, s26
  v_add_u32 v25, v25, v26
  v_subrev_u32 v15, 3072, v25
  s_branch Lpermd_228
Lperm_227:
  v_and_b32 v25, 1, v27
  v_lshlrev_b32 v25, 4, v25
  v_lshrrev_b32 v27, 1, v27
  v_add_u32 v27, v27, v25
  s_lshl_b32 s13, s10, 4
  s_add_u32 s13, s13, 0
  s_and_b32 s14, s13, 31
  s_lshr_b32 s14, s14, 1
  s_and_b32 s13, s13, 32
  s_add_u32 s13, s13, s14
  v_add_u32 v25, s13, v27
  v_mul_lo_u32 v25, v25, s26
  v_add_u32 v25, v25, v26
  v_subrev_u32 v12, 0, v25
  s_lshl_b32 s13, s10, 4
  s_add_u32 s13, s13, 4
  s_and_b32 s14, s13, 31
  s_lshr_b32 s14, s14, 1
  s_and_b32 s13, s13, 32
  s_add_u32 s13, s13, s14
  v_add_u32 v25, s13, v27
  v_mul_lo_u32 v25, v25, s26
  v_add_u32 v25, v25, v26
  v_subrev_u32 v13, 1024, v25
  s_lshl_b32 s13, s10, 4
  s_add_u32 s13, s13, 8
  s_and_b32 s14, s13, 31
  s_lshr_b32 s14, s14, 1
  s_and_b32 s13, s13, 32
  s_add_u32 s13, s13, s14
  v_add_u32 v25, s13, v27
  v_mul_lo_u32 v25, v25, s26
  v_add_u32 v25, v25, v26
  v_subrev_u32 v14, 2048, v25
  s_lshl_b32 s13, s10, 4
  s_add_u32 s13, s13, 12
  s_and_b32 s14, s13, 31
  s_lshr_b32 s14, s14, 1
  s_and_b32 s13, s13, 32
  s_add_u32 s13, s13, s14
  v_add_u32 v25, s13, v27
  v_mul_lo_u32 v25, v25, s26
  v_add_u32 v25, v25, v26
  v_subrev_u32 v15, 3072, v25
Lpermd_228:
  s_add_u32 m0, s27, 0
  s_nop 0
  global_load_lds_dwordx4 v8, s[16:17] offset:0
  global_load_lds_dwordx4 v9, s[16:17] offset:1024
  global_load_lds_dwordx4 v10, s[16:17] offset:2048
  global_load_lds_dwordx4 v11, s[16:17] offset:3072
  s_add_u32 s16, s16, 128
  s_addc_u32 s17, s17, 0
  s_add_u32 m0, s28, 0
  s_nop 0
  global_load_lds_dwordx4 v12, s[18:19] offset:0
  global_load_lds_dwordx4 v13, s[18:19] offset:1024
  global_load_lds_dwordx4 v14, s[18:19] offset:2048
  global_load_lds_dwordx4 v15, s[18:19] offset:3072
  s_lshl_b32 s13, s26, 6
  s_add_u32 s18, s18, s13
  s_addc_u32 s19, s19, 0
  s_add_u32 m0, s27, 16384
  s_nop 0
  global_load_lds_dwordx4 v8, s[16:17] offset:0
  global_load_lds_dwordx4 v9, s[16:17] offset:1024
  global_load_lds_dwordx4 v10, s[16:17] offset:2048
  global_load_lds_dwordx4 v11, s[16:17] offset:3072
  s_add_u32 s16, s16, 128
  s_addc_u32 s17, s17, 0
  s_add_u32 m0, s28, 16384
  s_nop 0
  global_load_lds_dwordx4 v12, s[18:19] offset:0
  global_load_lds_dwordx4 v13, s[18:19] offset:1024
  global_load_lds_dwordx4 v14, s[18:19] offset:2048
  global_load_lds_dwordx4 v15, s[18:19] offset:3072
  s_lshl_b32 s13, s26, 6
  s_add_u32 s18, s18, s13
  s_addc_u32 s19, s19, 0
  s_branch Lw1_loop_109
Lw1_nonext_113:
  s_nop 15
  s_nop 3
  s_cmp_eq_u32 s90, 1
  s_cbranch_scc1 Le_v_229
  s_cmp_eq_u32 s90, 4
  s_cbranch_scc1 Le_b_230
  s_cmp_eq_u32 s90, 3
  s_cbranch_scc1 Le_h_231
  s_cmp_eq_u32 s90, 0
  s_mov_b32 s13, 4194304
  s_cselect_b32 s13, 20971520, s13
  s_lshl_b32 s14, s91, 20
  s_add_u32 s13, s13, s14
  s_lshl_b32 s14, s92, 13
  s_add_u32 s13, s13, s14
  s_add_u32 s30, s4, s13
  s_addc_u32 s31, s5, 0
  s_lshr_b32 s13, s10, 1
  s_lshl_b32 s13, s13, 14
  s_and_b32 s14, s10, 1
  s_lshl_b32 s14, s14, 11
  s_add_u32 s13, s13, s14
  s_add_u32 s13, s13, 98304
  v_bfe_u32 v29, v23, 4, 1
  v_lshlrev_b32 v29, 12, v29
  v_and_b32 v25, 15, v23
  v_lshl_add_u32 v29, v25, 4, v29
  v_lshl_add_u32 v29, v24, 8, v29
  v_add_u32 v29, s13, v29
  v_cvt_pk_bf16_f32 v64, v128, v136
  v_cvt_pk_bf16_f32 v65, v129, v137
  v_cvt_pk_bf16_f32 v66, v130, v138
  v_cvt_pk_bf16_f32 v67, v131, v139
  ds_write_b128 v29, v[64:67] offset:0
  v_cvt_pk_bf16_f32 v68, v132, v140
  v_cvt_pk_bf16_f32 v69, v133, v141
  v_cvt_pk_bf16_f32 v70, v134, v142
  v_cvt_pk_bf16_f32 v71, v135, v143
  ds_write_b128 v29, v[68:71] offset:512
  v_cvt_pk_bf16_f32 v64, v144, v152
  v_cvt_pk_bf16_f32 v65, v145, v153
  v_cvt_pk_bf16_f32 v66, v146, v154
  v_cvt_pk_bf16_f32 v67, v147, v155
  ds_write_b128 v29, v[64:67] offset:1024
  v_cvt_pk_bf16_f32 v68, v148, v156
  v_cvt_pk_bf16_f32 v69, v149, v157
  v_cvt_pk_bf16_f32 v70, v150, v158
  v_cvt_pk_bf16_f32 v71, v151, v159
  ds_write_b128 v29, v[68:71] offset:1536
  v_cvt_pk_bf16_f32 v64, v160, v168
  v_cvt_pk_bf16_f32 v65, v161, v169
  v_cvt_pk_bf16_f32 v66, v162, v170
  v_cvt_pk_bf16_f32 v67, v163, v171
  ds_write_b128 v29, v[64:67] offset:8192
  v_cvt_pk_bf16_f32 v68, v164, v172
  v_cvt_pk_bf16_f32 v69, v165, v173
  v_cvt_pk_bf16_f32 v70, v166, v174
  v_cvt_pk_bf16_f32 v71, v167, v175
  ds_write_b128 v29, v[68:71] offset:8704
  v_cvt_pk_bf16_f32 v64, v176, v184
  v_cvt_pk_bf16_f32 v65, v177, v185
  v_cvt_pk_bf16_f32 v66, v178, v186
  v_cvt_pk_bf16_f32 v67, v179, v187
  ds_write_b128 v29, v[64:67] offset:9216
  v_cvt_pk_bf16_f32 v68, v180, v188
  v_cvt_pk_bf16_f32 v69, v181, v189
  v_cvt_pk_bf16_f32 v70, v182, v190
  v_cvt_pk_bf16_f32 v71, v183, v191
  ds_write_b128 v29, v[68:71] offset:9728
  s_waitcnt lgkmcnt(0)
  s_barrier
  v_lshlrev_b32 v25, 4, v22
  s_lshl_b32 s13, s10, 13
  s_add_u32 s13, s13, 98304
  v_add_u32 v26, s13, v25
  ds_read_b128 v[64:67], v26 offset:0
  ds_read_b128 v[68:71], v26 offset:1024
  ds_read_b128 v[72:75], v26 offset:2048
  ds_read_b128 v[76:79], v26 offset:3072
  ds_read_b128 v[80:83], v26 offset:4096
  ds_read_b128 v[84:87], v26 offset:5120
  ds_read_b128 v[88:91], v26 offset:6144
  ds_read_b128 v[92:95], v26 offset:7168
  s_lshl_b32 s13, s10, 18
  s_add_u32 s34, s30, s13
  s_addc_u32 s35, s31, 0
  v_add_u32 v27, 4096, v25
  s_waitcnt lgkmcnt(7)
  global_store_dwordx4 v25, v[64:67], s[34:35] offset:0 sc1
  s_waitcnt lgkmcnt(6)
  global_store_dwordx4 v25, v[68:71], s[34:35] offset:1024 sc1
  s_waitcnt lgkmcnt(5)
  global_store_dwordx4 v25, v[72:75], s[34:35] offset:2048 sc1
  s_waitcnt lgkmcnt(4)
  global_store_dwordx4 v25, v[76:79], s[34:35] offset:3072 sc1
  s_waitcnt lgkmcnt(3)
  global_store_dwordx4 v27, v[80:83], s[34:35] offset:0 sc1
  s_waitcnt lgkmcnt(2)
  global_store_dwordx4 v27, v[84:87], s[34:35] offset:1024 sc1
  s_waitcnt lgkmcnt(1)
  global_store_dwordx4 v27, v[88:91], s[34:35] offset:2048 sc1
  s_waitcnt lgkmcnt(0)
  global_store_dwordx4 v27, v[92:95], s[34:35] offset:3072 sc1
  s_cmp_eq_u32 s90, 0
  s_mov_b32 s94, 94392320
  s_cselect_b32 s94, 94375936, s94
  s_lshl_b32 s14, s91, 9
  s_add_u32 s94, s94, s14
  s_lshl_b32 s14, s92, 4
  s_add_u32 s94, s94, s14
  s_branch Le_done_232
Le_h_231:
  s_lshr_b32 s13, s10, 1
  s_lshl_b32 s13, s13, 14
  s_add_u32 s13, s13, 98304
  v_lshlrev_b32 v29, 8, v23
  v_add_u32 v29, s13, v29
  v_and_b32 v31, 15, v23
  s_and_b32 s14, s10, 1
  s_lshl_b32 s14, s14, 3
  v_add_u32 v30, s14, v24
  s_lshl_b32 s13, s92, 8
  s_and_b32 s14, s10, 1
  s_lshl_b32 s14, s14, 7
  s_add_u32 s13, s13, s14
  s_add_u32 s34, s48, s13
  s_addc_u32 s35, s49, 0
  v_lshlrev_b32 v25, 3, v24
  global_load_dwordx2 v[104:105], v25, s[34:35] offset:0
  global_load_dwordx2 v[106:107], v25, s[34:35] offset:16
  global_load_dwordx2 v[108:109], v25, s[34:35] offset:32
  global_load_dwordx2 v[110:111], v25, s[34:35] offset:48
  global_load_dwordx2 v[112:113], v25, s[34:35] offset:64
  global_load_dwordx2 v[114:115], v25, s[34:35] offset:80
  global_load_dwordx2 v[116:117], v25, s[34:35] offset:96
  global_load_dwordx2 v[118:119], v25, s[34:35] offset:112
  s_mov_b32 s36, 0xc0135761
  s_mov_b32 s37, 0xbdd2d3e8
  s_waitcnt vmcnt(0)
  v_mov_b64 v[64:65], v[128:129]
  v_mov_b64 v[66:67], v[130:131]
  v_mov_b64 v[68:69], v[132:133]
  v_mov_b64 v[70:71], v[134:135]
  v_mov_b64 v[72:73], v[136:137]
  v_mov_b64 v[74:75], v[138:139]
  v_mov_b64 v[76:77], v[140:141]
  v_mov_b64 v[78:79], v[142:143]
  v_cvt_pk_bf16_f32 v64, v64, v64
  v_and_b32 v64, 0xffff0000, v64
  v_lshlrev_b32 v84, 16, v104
  v_add_f32 v64, v64, v84
  v_cvt_pk_bf16_f32 v64, v64, v64
  v_and_b32 v64, 0xffff0000, v64
  v_cvt_pk_bf16_f32 v65, v65, v65
  v_and_b32 v65, 0xffff0000, v65
  v_and_b32 v84, 0xffff0000, v104
  v_add_f32 v65, v65, v84
  v_cvt_pk_bf16_f32 v65, v65, v65
  v_and_b32 v65, 0xffff0000, v65
  v_cvt_pk_bf16_f32 v66, v66, v66
  v_and_b32 v66, 0xffff0000, v66
  v_lshlrev_b32 v84, 16, v105
  v_add_f32 v66, v66, v84
  v_cvt_pk_bf16_f32 v66, v66, v66
  v_and_b32 v66, 0xffff0000, v66
  v_cvt_pk_bf16_f32 v67, v67, v67
  v_and_b32 v67, 0xffff0000, v67
  v_and_b32 v84, 0xffff0000, v105
  v_add_f32 v67, v67, v84
  v_cvt_pk_bf16_f32 v67, v67, v67
  v_and_b32 v67, 0xffff0000, v67
  v_cvt_pk_bf16_f32 v68, v68, v68
  v_and_b32 v68, 0xffff0000, v68
  v_lshlrev_b32 v84, 16, v106
  v_add_f32 v68, v68, v84
  v_cvt_pk_bf16_f32 v68, v68, v68
  v_and_b32 v68, 0xffff0000, v68
  v_cvt_pk_bf16_f32 v69, v69, v69
  v_and_b32 v69, 0xffff0000, v69
  v_and_b32 v84, 0xffff0000, v106
  v_add_f32 v69, v69, v84
  v_cvt_pk_bf16_f32 v69, v69, v69
  v_and_b32 v69, 0xffff0000, v69
  v_cvt_pk_bf16_f32 v70, v70, v70
  v_and_b32 v70, 0xffff0000, v70
  v_lshlrev_b32 v84, 16, v107
  v_add_f32 v70, v70, v84
  v_cvt_pk_bf16_f32 v70, v70, v70
  v_and_b32 v70, 0xffff0000, v70
  v_cvt_pk_bf16_f32 v71, v71, v71
  v_and_b32 v71, 0xffff0000, v71
  v_and_b32 v84, 0xffff0000, v107
  v_add_f32 v71, v71, v84
  v_cvt_pk_bf16_f32 v71, v71, v71
  v_and_b32 v71, 0xffff0000, v71
  v_cvt_pk_bf16_f32 v72, v72, v72
  v_and_b32 v72, 0xffff0000, v72
  v_lshlrev_b32 v84, 16, v108
  v_add_f32 v72, v72, v84
  v_cvt_pk_bf16_f32 v72, v72, v72
  v_and_b32 v72, 0xffff0000, v72
  v_cvt_pk_bf16_f32 v73, v73, v73
  v_and_b32 v73, 0xffff0000, v73
  v_and_b32 v84, 0xffff0000, v108
  v_add_f32 v73, v73, v84
  v_cvt_pk_bf16_f32 v73, v73, v73
  v_and_b32 v73, 0xffff0000, v73
  v_cvt_pk_bf16_f32 v74, v74, v74
  v_and_b32 v74, 0xffff0000, v74
  v_lshlrev_b32 v84, 16, v109
  v_add_f32 v74, v74, v84
  v_cvt_pk_bf16_f32 v74, v74, v74
  v_and_b32 v74, 0xffff0000, v74
  v_cvt_pk_bf16_f32 v75, v75, v75
  v_and_b32 v75, 0xffff0000, v75
  v_and_b32 v84, 0xffff0000, v109
  v_add_f32 v75, v75, v84
  v_cvt_pk_bf16_f32 v75, v75, v75
  v_and_b32 v75, 0xffff0000, v75
  v_cvt_pk_bf16_f32 v76, v76, v76
  v_and_b32 v76, 0xffff0000, v76
  v_lshlrev_b32 v84, 16, v110
  v_add_f32 v76, v76, v84
  v_cvt_pk_bf16_f32 v76, v76, v76
  v_and_b32 v76, 0xffff0000, v76
  v_cvt_pk_bf16_f32 v77, v77, v77
  v_and_b32 v77, 0xffff0000, v77
  v_and_b32 v84, 0xffff0000, v110
  v_add_f32 v77, v77, v84
  v_cvt_pk_bf16_f32 v77, v77, v77
  v_and_b32 v77, 0xffff0000, v77
  v_cvt_pk_bf16_f32 v78, v78, v78
  v_and_b32 v78, 0xffff0000, v78
  v_lshlrev_b32 v84, 16, v111
  v_add_f32 v78, v78, v84
  v_cvt_pk_bf16_f32 v78, v78, v78
  v_and_b32 v78, 0xffff0000, v78
  v_cvt_pk_bf16_f32 v79, v79, v79
  v_and_b32 v79, 0xffff0000, v79
  v_and_b32 v84, 0xffff0000, v111
  v_add_f32 v79, v79, v84
  v_cvt_pk_bf16_f32 v79, v79, v79
  v_and_b32 v79, 0xffff0000, v79
  v_mul_f32 v84, v64, v64
  v_mov_b32 v88, s36
  v_fma_f32 v84, v84, s37, v88
  v_mul_f32 v84, v84, v64
  v_exp_f32 v84, v84
  s_nop 0
  v_add_f32 v84, 1.0, v84
  v_rcp_f32 v84, v84
  s_nop 0
  v_mul_f32 v64, v64, v84
  v_mul_f32 v85, v65, v65
  v_mov_b32 v88, s36
  v_fma_f32 v85, v85, s37, v88
  v_mul_f32 v85, v85, v65
  v_exp_f32 v85, v85
  s_nop 0
  v_add_f32 v85, 1.0, v85
  v_rcp_f32 v85, v85
  s_nop 0
  v_mul_f32 v65, v65, v85
  v_mul_f32 v86, v66, v66
  v_mov_b32 v88, s36
  v_fma_f32 v86, v86, s37, v88
  v_mul_f32 v86, v86, v66
  v_exp_f32 v86, v86
  s_nop 0
  v_add_f32 v86, 1.0, v86
  v_rcp_f32 v86, v86
  s_nop 0
  v_mul_f32 v66, v66, v86
  v_mul_f32 v87, v67, v67
  v_mov_b32 v88, s36
  v_fma_f32 v87, v87, s37, v88
  v_mul_f32 v87, v87, v67
  v_exp_f32 v87, v87
  s_nop 0
  v_add_f32 v87, 1.0, v87
  v_rcp_f32 v87, v87
  s_nop 0
  v_mul_f32 v67, v67, v87
  v_mul_f32 v84, v68, v68
  v_mov_b32 v88, s36
  v_fma_f32 v84, v84, s37, v88
  v_mul_f32 v84, v84, v68
  v_exp_f32 v84, v84
  s_nop 0
  v_add_f32 v84, 1.0, v84
  v_rcp_f32 v84, v84
  s_nop 0
  v_mul_f32 v68, v68, v84
  v_mul_f32 v85, v69, v69
  v_mov_b32 v88, s36
  v_fma_f32 v85, v85, s37, v88
  v_mul_f32 v85, v85, v69
  v_exp_f32 v85, v85
  s_nop 0
  v_add_f32 v85, 1.0, v85
  v_rcp_f32 v85, v85
  s_nop 0
  v_mul_f32 v69, v69, v85
  v_mul_f32 v86, v70, v70
  v_mov_b32 v88, s36
  v_fma_f32 v86, v86, s37, v88
  v_mul_f32 v86, v86, v70
  v_exp_f32 v86, v86
  s_nop 0
  v_add_f32 v86, 1.0, v86
  v_rcp_f32 v86, v86
  s_nop 0
  v_mul_f32 v70, v70, v86
  v_mul_f32 v87, v71, v71
  v_mov_b32 v88, s36
  v_fma_f32 v87, v87, s37, v88
  v_mul_f32 v87, v87, v71
  v_exp_f32 v87, v87
  s_nop 0
  v_add_f32 v87, 1.0, v87
  v_rcp_f32 v87, v87
  s_nop 0
  v_mul_f32 v71, v71, v87
  v_mul_f32 v84, v72, v72
  v_mov_b32 v88, s36
  v_fma_f32 v84, v84, s37, v88
  v_mul_f32 v84, v84, v72
  v_exp_f32 v84, v84
  s_nop 0
  v_add_f32 v84, 1.0, v84
  v_rcp_f32 v84, v84
  s_nop 0
  v_mul_f32 v72, v72, v84
  v_mul_f32 v85, v73, v73
  v_mov_b32 v88, s36
  v_fma_f32 v85, v85, s37, v88
  v_mul_f32 v85, v85, v73
  v_exp_f32 v85, v85
  s_nop 0
  v_add_f32 v85, 1.0, v85
  v_rcp_f32 v85, v85
  s_nop 0
  v_mul_f32 v73, v73, v85
  v_mul_f32 v86, v74, v74
  v_mov_b32 v88, s36
  v_fma_f32 v86, v86, s37, v88
  v_mul_f32 v86, v86, v74
  v_exp_f32 v86, v86
  s_nop 0
  v_add_f32 v86, 1.0, v86
  v_rcp_f32 v86, v86
  s_nop 0
  v_mul_f32 v74, v74, v86
  v_mul_f32 v87, v75, v75
  v_mov_b32 v88, s36
  v_fma_f32 v87, v87, s37, v88
  v_mul_f32 v87, v87, v75
  v_exp_f32 v87, v87
  s_nop 0
  v_add_f32 v87, 1.0, v87
  v_rcp_f32 v87, v87
  s_nop 0
  v_mul_f32 v75, v75, v87
  v_mul_f32 v84, v76, v76
  v_mov_b32 v88, s36
  v_fma_f32 v84, v84, s37, v88
  v_mul_f32 v84, v84, v76
  v_exp_f32 v84, v84
  s_nop 0
  v_add_f32 v84, 1.0, v84
  v_rcp_f32 v84, v84
  s_nop 0
  v_mul_f32 v76, v76, v84
  v_mul_f32 v85, v77, v77
  v_mov_b32 v88, s36
  v_fma_f32 v85, v85, s37, v88
  v_mul_f32 v85, v85, v77
  v_exp_f32 v85, v85
  s_nop 0
  v_add_f32 v85, 1.0, v85
  v_rcp_f32 v85, v85
  s_nop 0
  v_mul_f32 v77, v77, v85
  v_mul_f32 v86, v78, v78
  v_mov_b32 v88, s36
  v_fma_f32 v86, v86, s37, v88
  v_mul_f32 v86, v86, v78
  v_exp_f32 v86, v86
  s_nop 0
  v_add_f32 v86, 1.0, v86
  v_rcp_f32 v86, v86
  s_nop 0
  v_mul_f32 v78, v78, v86
  v_mul_f32 v87, v79, v79
  v_mov_b32 v88, s36
  v_fma_f32 v87, v87, s37, v88
  v_mul_f32 v87, v87, v79
  v_exp_f32 v87, v87
  s_nop 0
  v_add_f32 v87, 1.0, v87
  v_rcp_f32 v87, v87
  s_nop 0
  v_mul_f32 v79, v79, v87
  v_cvt_pk_bf16_f32 v80, v64, v72
  v_cvt_pk_bf16_f32 v81, v65, v73
  v_cvt_pk_bf16_f32 v82, v66, v74
  v_cvt_pk_bf16_f32 v83, v67, v75
  v_add_u32 v25, 0, v30
  v_xor_b32 v25, v25, v31
  v_lshl_add_u32 v25, v25, 4, v29
  ds_write_b128 v25, v[80:83] offset:0
  v_cvt_pk_bf16_f32 v80, v68, v76
  v_cvt_pk_bf16_f32 v81, v69, v77
  v_cvt_pk_bf16_f32 v82, v70, v78
  v_cvt_pk_bf16_f32 v83, v71, v79
  v_add_u32 v25, 2, v30
  v_xor_b32 v25, v25, v31
  v_lshl_add_u32 v25, v25, 4, v29
  ds_write_b128 v25, v[80:83] offset:0
  v_mov_b64 v[64:65], v[144:145]
  v_mov_b64 v[66:67], v[146:147]
  v_mov_b64 v[68:69], v[148:149]
  v_mov_b64 v[70:71], v[150:151]
  v_mov_b64 v[72:73], v[152:153]
  v_mov_b64 v[74:75], v[154:155]
  v_mov_b64 v[76:77], v[156:157]
  v_mov_b64 v[78:79], v[158:159]
  v_cvt_pk_bf16_f32 v64, v64, v64
  v_and_b32 v64, 0xffff0000, v64
  v_lshlrev_b32 v84, 16, v112
  v_add_f32 v64, v64, v84
  v_cvt_pk_bf16_f32 v64, v64, v64
  v_and_b32 v64, 0xffff0000, v64
  v_cvt_pk_bf16_f32 v65, v65, v65
  v_and_b32 v65, 0xffff0000, v65
  v_and_b32 v84, 0xffff0000, v112
  v_add_f32 v65, v65, v84
  v_cvt_pk_bf16_f32 v65, v65, v65
  v_and_b32 v65, 0xffff0000, v65
  v_cvt_pk_bf16_f32 v66, v66, v66
  v_and_b32 v66, 0xffff0000, v66
  v_lshlrev_b32 v84, 16, v113
  v_add_f32 v66, v66, v84
  v_cvt_pk_bf16_f32 v66, v66, v66
  v_and_b32 v66, 0xffff0000, v66
  v_cvt_pk_bf16_f32 v67, v67, v67
  v_and_b32 v67, 0xffff0000, v67
  v_and_b32 v84, 0xffff0000, v113
  v_add_f32 v67, v67, v84
  v_cvt_pk_bf16_f32 v67, v67, v67
  v_and_b32 v67, 0xffff0000, v67
  v_cvt_pk_bf16_f32 v68, v68, v68
  v_and_b32 v68, 0xffff0000, v68
  v_lshlrev_b32 v84, 16, v114
  v_add_f32 v68, v68, v84
  v_cvt_pk_bf16_f32 v68, v68, v68
  v_and_b32 v68, 0xffff0000, v68
  v_cvt_pk_bf16_f32 v69, v69, v69
  v_and_b32 v69, 0xffff0000, v69
  v_and_b32 v84, 0xffff0000, v114
  v_add_f32 v69, v69, v84
  v_cvt_pk_bf16_f32 v69, v69, v69
  v_and_b32 v69, 0xffff0000, v69
  v_cvt_pk_bf16_f32 v70, v70, v70
  v_and_b32 v70, 0xffff0000, v70
  v_lshlrev_b32 v84, 16, v115
  v_add_f32 v70, v70, v84
  v_cvt_pk_bf16_f32 v70, v70, v70
  v_and_b32 v70, 0xffff0000, v70
  v_cvt_pk_bf16_f32 v71, v71, v71
  v_and_b32 v71, 0xffff0000, v71
  v_and_b32 v84, 0xffff0000, v115
  v_add_f32 v71, v71, v84
  v_cvt_pk_bf16_f32 v71, v71, v71
  v_and_b32 v71, 0xffff0000, v71
  v_cvt_pk_bf16_f32 v72, v72, v72
  v_and_b32 v72, 0xffff0000, v72
  v_lshlrev_b32 v84, 16, v116
  v_add_f32 v72, v72, v84
  v_cvt_pk_bf16_f32 v72, v72, v72
  v_and_b32 v72, 0xffff0000, v72
  v_cvt_pk_bf16_f32 v73, v73, v73
  v_and_b32 v73, 0xffff0000, v73
  v_and_b32 v84, 0xffff0000, v116
  v_add_f32 v73, v73, v84
  v_cvt_pk_bf16_f32 v73, v73, v73
  v_and_b32 v73, 0xffff0000, v73
  v_cvt_pk_bf16_f32 v74, v74, v74
  v_and_b32 v74, 0xffff0000, v74
  v_lshlrev_b32 v84, 16, v117
  v_add_f32 v74, v74, v84
  v_cvt_pk_bf16_f32 v74, v74, v74
  v_and_b32 v74, 0xffff0000, v74
  v_cvt_pk_bf16_f32 v75, v75, v75
  v_and_b32 v75, 0xffff0000, v75
  v_and_b32 v84, 0xffff0000, v117
  v_add_f32 v75, v75, v84
  v_cvt_pk_bf16_f32 v75, v75, v75
  v_and_b32 v75, 0xffff0000, v75
  v_cvt_pk_bf16_f32 v76, v76, v76
  v_and_b32 v76, 0xffff0000, v76
  v_lshlrev_b32 v84, 16, v118
  v_add_f32 v76, v76, v84
  v_cvt_pk_bf16_f32 v76, v76, v76
  v_and_b32 v76, 0xffff0000, v76
  v_cvt_pk_bf16_f32 v77, v77, v77
  v_and_b32 v77, 0xffff0000, v77
  v_and_b32 v84, 0xffff0000, v118
  v_add_f32 v77, v77, v84
  v_cvt_pk_bf16_f32 v77, v77, v77
  v_and_b32 v77, 0xffff0000, v77
  v_cvt_pk_bf16_f32 v78, v78, v78
  v_and_b32 v78, 0xffff0000, v78
  v_lshlrev_b32 v84, 16, v119
  v_add_f32 v78, v78, v84
  v_cvt_pk_bf16_f32 v78, v78, v78
  v_and_b32 v78, 0xffff0000, v78
  v_cvt_pk_bf16_f32 v79, v79, v79
  v_and_b32 v79, 0xffff0000, v79
  v_and_b32 v84, 0xffff0000, v119
  v_add_f32 v79, v79, v84
  v_cvt_pk_bf16_f32 v79, v79, v79
  v_and_b32 v79, 0xffff0000, v79
  v_mul_f32 v84, v64, v64
  v_mov_b32 v88, s36
  v_fma_f32 v84, v84, s37, v88
  v_mul_f32 v84, v84, v64
  v_exp_f32 v84, v84
  s_nop 0
  v_add_f32 v84, 1.0, v84
  v_rcp_f32 v84, v84
  s_nop 0
  v_mul_f32 v64, v64, v84
  v_mul_f32 v85, v65, v65
  v_mov_b32 v88, s36
  v_fma_f32 v85, v85, s37, v88
  v_mul_f32 v85, v85, v65
  v_exp_f32 v85, v85
  s_nop 0
  v_add_f32 v85, 1.0, v85
  v_rcp_f32 v85, v85
  s_nop 0
  v_mul_f32 v65, v65, v85
  v_mul_f32 v86, v66, v66
  v_mov_b32 v88, s36
  v_fma_f32 v86, v86, s37, v88
  v_mul_f32 v86, v86, v66
  v_exp_f32 v86, v86
  s_nop 0
  v_add_f32 v86, 1.0, v86
  v_rcp_f32 v86, v86
  s_nop 0
  v_mul_f32 v66, v66, v86
  v_mul_f32 v87, v67, v67
  v_mov_b32 v88, s36
  v_fma_f32 v87, v87, s37, v88
  v_mul_f32 v87, v87, v67
  v_exp_f32 v87, v87
  s_nop 0
  v_add_f32 v87, 1.0, v87
  v_rcp_f32 v87, v87
  s_nop 0
  v_mul_f32 v67, v67, v87
  v_mul_f32 v84, v68, v68
  v_mov_b32 v88, s36
  v_fma_f32 v84, v84, s37, v88
  v_mul_f32 v84, v84, v68
  v_exp_f32 v84, v84
  s_nop 0
  v_add_f32 v84, 1.0, v84
  v_rcp_f32 v84, v84
  s_nop 0
  v_mul_f32 v68, v68, v84
  v_mul_f32 v85, v69, v69
  v_mov_b32 v88, s36
  v_fma_f32 v85, v85, s37, v88
  v_mul_f32 v85, v85, v69
  v_exp_f32 v85, v85
  s_nop 0
  v_add_f32 v85, 1.0, v85
  v_rcp_f32 v85, v85
  s_nop 0
  v_mul_f32 v69, v69, v85
  v_mul_f32 v86, v70, v70
  v_mov_b32 v88, s36
  v_fma_f32 v86, v86, s37, v88
  v_mul_f32 v86, v86, v70
  v_exp_f32 v86, v86
  s_nop 0
  v_add_f32 v86, 1.0, v86
  v_rcp_f32 v86, v86
  s_nop 0
  v_mul_f32 v70, v70, v86
  v_mul_f32 v87, v71, v71
  v_mov_b32 v88, s36
  v_fma_f32 v87, v87, s37, v88
  v_mul_f32 v87, v87, v71
  v_exp_f32 v87, v87
  s_nop 0
  v_add_f32 v87, 1.0, v87
  v_rcp_f32 v87, v87
  s_nop 0
  v_mul_f32 v71, v71, v87
  v_mul_f32 v84, v72, v72
  v_mov_b32 v88, s36
  v_fma_f32 v84, v84, s37, v88
  v_mul_f32 v84, v84, v72
  v_exp_f32 v84, v84
  s_nop 0
  v_add_f32 v84, 1.0, v84
  v_rcp_f32 v84, v84
  s_nop 0
  v_mul_f32 v72, v72, v84
  v_mul_f32 v85, v73, v73
  v_mov_b32 v88, s36
  v_fma_f32 v85, v85, s37, v88
  v_mul_f32 v85, v85, v73
  v_exp_f32 v85, v85
  s_nop 0
  v_add_f32 v85, 1.0, v85
  v_rcp_f32 v85, v85
  s_nop 0
  v_mul_f32 v73, v73, v85
  v_mul_f32 v86, v74, v74
  v_mov_b32 v88, s36
  v_fma_f32 v86, v86, s37, v88
  v_mul_f32 v86, v86, v74
  v_exp_f32 v86, v86
  s_nop 0
  v_add_f32 v86, 1.0, v86
  v_rcp_f32 v86, v86
  s_nop 0
  v_mul_f32 v74, v74, v86
  v_mul_f32 v87, v75, v75
  v_mov_b32 v88, s36
  v_fma_f32 v87, v87, s37, v88
  v_mul_f32 v87, v87, v75
  v_exp_f32 v87, v87
  s_nop 0
  v_add_f32 v87, 1.0, v87
  v_rcp_f32 v87, v87
  s_nop 0
  v_mul_f32 v75, v75, v87
  v_mul_f32 v84, v76, v76
  v_mov_b32 v88, s36
  v_fma_f32 v84, v84, s37, v88
  v_mul_f32 v84, v84, v76
  v_exp_f32 v84, v84
  s_nop 0
  v_add_f32 v84, 1.0, v84
  v_rcp_f32 v84, v84
  s_nop 0
  v_mul_f32 v76, v76, v84
  v_mul_f32 v85, v77, v77
  v_mov_b32 v88, s36
  v_fma_f32 v85, v85, s37, v88
  v_mul_f32 v85, v85, v77
  v_exp_f32 v85, v85
  s_nop 0
  v_add_f32 v85, 1.0, v85
  v_rcp_f32 v85, v85
  s_nop 0
  v_mul_f32 v77, v77, v85
  v_mul_f32 v86, v78, v78
  v_mov_b32 v88, s36
  v_fma_f32 v86, v86, s37, v88
  v_mul_f32 v86, v86, v78
  v_exp_f32 v86, v86
  s_nop 0
  v_add_f32 v86, 1.0, v86
  v_rcp_f32 v86, v86
  s_nop 0
  v_mul_f32 v78, v78, v86
  v_mul_f32 v87, v79, v79
  v_mov_b32 v88, s36
  v_fma_f32 v87, v87, s37, v88
  v_mul_f32 v87, v87, v79
  v_exp_f32 v87, v87
  s_nop 0
  v_add_f32 v87, 1.0, v87
  v_rcp_f32 v87, v87
  s_nop 0
  v_mul_f32 v79, v79, v87
  v_cvt_pk_bf16_f32 v80, v64, v72
  v_cvt_pk_bf16_f32 v81, v65, v73
  v_cvt_pk_bf16_f32 v82, v66, v74
  v_cvt_pk_bf16_f32 v83, v67, v75
  v_add_u32 v25, 4, v30
  v_xor_b32 v25, v25, v31
  v_lshl_add_u32 v25, v25, 4, v29
  ds_write_b128 v25, v[80:83] offset:0
  v_cvt_pk_bf16_f32 v80, v68, v76
  v_cvt_pk_bf16_f32 v81, v69, v77
  v_cvt_pk_bf16_f32 v82, v70, v78
  v_cvt_pk_bf16_f32 v83, v71, v79
  v_add_u32 v25, 6, v30
  v_xor_b32 v25, v25, v31
  v_lshl_add_u32 v25, v25, 4, v29
  ds_write_b128 v25, v[80:83] offset:0
  v_mov_b64 v[64:65], v[160:161]
  v_mov_b64 v[66:67], v[162:163]
  v_mov_b64 v[68:69], v[164:165]
  v_mov_b64 v[70:71], v[166:167]
  v_mov_b64 v[72:73], v[168:169]
  v_mov_b64 v[74:75], v[170:171]
  v_mov_b64 v[76:77], v[172:173]
  v_mov_b64 v[78:79], v[174:175]
  v_cvt_pk_bf16_f32 v64, v64, v64
  v_and_b32 v64, 0xffff0000, v64
  v_lshlrev_b32 v84, 16, v104
  v_add_f32 v64, v64, v84
  v_cvt_pk_bf16_f32 v64, v64, v64
  v_and_b32 v64, 0xffff0000, v64
  v_cvt_pk_bf16_f32 v65, v65, v65
  v_and_b32 v65, 0xffff0000, v65
  v_and_b32 v84, 0xffff0000, v104
  v_add_f32 v65, v65, v84
  v_cvt_pk_bf16_f32 v65, v65, v65
  v_and_b32 v65, 0xffff0000, v65
  v_cvt_pk_bf16_f32 v66, v66, v66
  v_and_b32 v66, 0xffff0000, v66
  v_lshlrev_b32 v84, 16, v105
  v_add_f32 v66, v66, v84
  v_cvt_pk_bf16_f32 v66, v66, v66
  v_and_b32 v66, 0xffff0000, v66
  v_cvt_pk_bf16_f32 v67, v67, v67
  v_and_b32 v67, 0xffff0000, v67
  v_and_b32 v84, 0xffff0000, v105
  v_add_f32 v67, v67, v84
  v_cvt_pk_bf16_f32 v67, v67, v67
  v_and_b32 v67, 0xffff0000, v67
  v_cvt_pk_bf16_f32 v68, v68, v68
  v_and_b32 v68, 0xffff0000, v68
  v_lshlrev_b32 v84, 16, v106
  v_add_f32 v68, v68, v84
  v_cvt_pk_bf16_f32 v68, v68, v68
  v_and_b32 v68, 0xffff0000, v68
  v_cvt_pk_bf16_f32 v69, v69, v69
  v_and_b32 v69, 0xffff0000, v69
  v_and_b32 v84, 0xffff0000, v106
  v_add_f32 v69, v69, v84
  v_cvt_pk_bf16_f32 v69, v69, v69
  v_and_b32 v69, 0xffff0000, v69
  v_cvt_pk_bf16_f32 v70, v70, v70
  v_and_b32 v70, 0xffff0000, v70
  v_lshlrev_b32 v84, 16, v107
  v_add_f32 v70, v70, v84
  v_cvt_pk_bf16_f32 v70, v70, v70
  v_and_b32 v70, 0xffff0000, v70
  v_cvt_pk_bf16_f32 v71, v71, v71
  v_and_b32 v71, 0xffff0000, v71
  v_and_b32 v84, 0xffff0000, v107
  v_add_f32 v71, v71, v84
  v_cvt_pk_bf16_f32 v71, v71, v71
  v_and_b32 v71, 0xffff0000, v71
  v_cvt_pk_bf16_f32 v72, v72, v72
  v_and_b32 v72, 0xffff0000, v72
  v_lshlrev_b32 v84, 16, v108
  v_add_f32 v72, v72, v84
  v_cvt_pk_bf16_f32 v72, v72, v72
  v_and_b32 v72, 0xffff0000, v72
  v_cvt_pk_bf16_f32 v73, v73, v73
  v_and_b32 v73, 0xffff0000, v73
  v_and_b32 v84, 0xffff0000, v108
  v_add_f32 v73, v73, v84
  v_cvt_pk_bf16_f32 v73, v73, v73
  v_and_b32 v73, 0xffff0000, v73
  v_cvt_pk_bf16_f32 v74, v74, v74
  v_and_b32 v74, 0xffff0000, v74
  v_lshlrev_b32 v84, 16, v109
  v_add_f32 v74, v74, v84
  v_cvt_pk_bf16_f32 v74, v74, v74
  v_and_b32 v74, 0xffff0000, v74
  v_cvt_pk_bf16_f32 v75, v75, v75
  v_and_b32 v75, 0xffff0000, v75
  v_and_b32 v84, 0xffff0000, v109
  v_add_f32 v75, v75, v84
  v_cvt_pk_bf16_f32 v75, v75, v75
  v_and_b32 v75, 0xffff0000, v75
  v_cvt_pk_bf16_f32 v76, v76, v76
  v_and_b32 v76, 0xffff0000, v76
  v_lshlrev_b32 v84, 16, v110
  v_add_f32 v76, v76, v84
  v_cvt_pk_bf16_f32 v76, v76, v76
  v_and_b32 v76, 0xffff0000, v76
  v_cvt_pk_bf16_f32 v77, v77, v77
  v_and_b32 v77, 0xffff0000, v77
  v_and_b32 v84, 0xffff0000, v110
  v_add_f32 v77, v77, v84
  v_cvt_pk_bf16_f32 v77, v77, v77
  v_and_b32 v77, 0xffff0000, v77
  v_cvt_pk_bf16_f32 v78, v78, v78
  v_and_b32 v78, 0xffff0000, v78
  v_lshlrev_b32 v84, 16, v111
  v_add_f32 v78, v78, v84
  v_cvt_pk_bf16_f32 v78, v78, v78
  v_and_b32 v78, 0xffff0000, v78
  v_cvt_pk_bf16_f32 v79, v79, v79
  v_and_b32 v79, 0xffff0000, v79
  v_and_b32 v84, 0xffff0000, v111
  v_add_f32 v79, v79, v84
  v_cvt_pk_bf16_f32 v79, v79, v79
  v_and_b32 v79, 0xffff0000, v79
  v_mul_f32 v84, v64, v64
  v_mov_b32 v88, s36
  v_fma_f32 v84, v84, s37, v88
  v_mul_f32 v84, v84, v64
  v_exp_f32 v84, v84
  s_nop 0
  v_add_f32 v84, 1.0, v84
  v_rcp_f32 v84, v84
  s_nop 0
  v_mul_f32 v64, v64, v84
  v_mul_f32 v85, v65, v65
  v_mov_b32 v88, s36
  v_fma_f32 v85, v85, s37, v88
  v_mul_f32 v85, v85, v65
  v_exp_f32 v85, v85
  s_nop 0
  v_add_f32 v85, 1.0, v85
  v_rcp_f32 v85, v85
  s_nop 0
  v_mul_f32 v65, v65, v85
  v_mul_f32 v86, v66, v66
  v_mov_b32 v88, s36
  v_fma_f32 v86, v86, s37, v88
  v_mul_f32 v86, v86, v66
  v_exp_f32 v86, v86
  s_nop 0
  v_add_f32 v86, 1.0, v86
  v_rcp_f32 v86, v86
  s_nop 0
  v_mul_f32 v66, v66, v86
  v_mul_f32 v87, v67, v67
  v_mov_b32 v88, s36
  v_fma_f32 v87, v87, s37, v88
  v_mul_f32 v87, v87, v67
  v_exp_f32 v87, v87
  s_nop 0
  v_add_f32 v87, 1.0, v87
  v_rcp_f32 v87, v87
  s_nop 0
  v_mul_f32 v67, v67, v87
  v_mul_f32 v84, v68, v68
  v_mov_b32 v88, s36
  v_fma_f32 v84, v84, s37, v88
  v_mul_f32 v84, v84, v68
  v_exp_f32 v84, v84
  s_nop 0
  v_add_f32 v84, 1.0, v84
  v_rcp_f32 v84, v84
  s_nop 0
  v_mul_f32 v68, v68, v84
  v_mul_f32 v85, v69, v69
  v_mov_b32 v88, s36
  v_fma_f32 v85, v85, s37, v88
  v_mul_f32 v85, v85, v69
  v_exp_f32 v85, v85
  s_nop 0
  v_add_f32 v85, 1.0, v85
  v_rcp_f32 v85, v85
  s_nop 0
  v_mul_f32 v69, v69, v85
  v_mul_f32 v86, v70, v70
  v_mov_b32 v88, s36
  v_fma_f32 v86, v86, s37, v88
  v_mul_f32 v86, v86, v70
  v_exp_f32 v86, v86
  s_nop 0
  v_add_f32 v86, 1.0, v86
  v_rcp_f32 v86, v86
  s_nop 0
  v_mul_f32 v70, v70, v86
  v_mul_f32 v87, v71, v71
  v_mov_b32 v88, s36
  v_fma_f32 v87, v87, s37, v88
  v_mul_f32 v87, v87, v71
  v_exp_f32 v87, v87
  s_nop 0
  v_add_f32 v87, 1.0, v87
  v_rcp_f32 v87, v87
  s_nop 0
  v_mul_f32 v71, v71, v87
  v_mul_f32 v84, v72, v72
  v_mov_b32 v88, s36
  v_fma_f32 v84, v84, s37, v88
  v_mul_f32 v84, v84, v72
  v_exp_f32 v84, v84
  s_nop 0
  v_add_f32 v84, 1.0, v84
  v_rcp_f32 v84, v84
  s_nop 0
  v_mul_f32 v72, v72, v84
  v_mul_f32 v85, v73, v73
  v_mov_b32 v88, s36
  v_fma_f32 v85, v85, s37, v88
  v_mul_f32 v85, v85, v73
  v_exp_f32 v85, v85
  s_nop 0
  v_add_f32 v85, 1.0, v85
  v_rcp_f32 v85, v85
  s_nop 0
  v_mul_f32 v73, v73, v85
  v_mul_f32 v86, v74, v74
  v_mov_b32 v88, s36
  v_fma_f32 v86, v86, s37, v88
  v_mul_f32 v86, v86, v74
  v_exp_f32 v86, v86
  s_nop 0
  v_add_f32 v86, 1.0, v86
  v_rcp_f32 v86, v86
  s_nop 0
  v_mul_f32 v74, v74, v86
  v_mul_f32 v87, v75, v75
  v_mov_b32 v88, s36
  v_fma_f32 v87, v87, s37, v88
  v_mul_f32 v87, v87, v75
  v_exp_f32 v87, v87
  s_nop 0
  v_add_f32 v87, 1.0, v87
  v_rcp_f32 v87, v87
  s_nop 0
  v_mul_f32 v75, v75, v87
  v_mul_f32 v84, v76, v76
  v_mov_b32 v88, s36
  v_fma_f32 v84, v84, s37, v88
  v_mul_f32 v84, v84, v76
  v_exp_f32 v84, v84
  s_nop 0
  v_add_f32 v84, 1.0, v84
  v_rcp_f32 v84, v84
  s_nop 0
  v_mul_f32 v76, v76, v84
  v_mul_f32 v85, v77, v77
  v_mov_b32 v88, s36
  v_fma_f32 v85, v85, s37, v88
  v_mul_f32 v85, v85, v77
  v_exp_f32 v85, v85
  s_nop 0
  v_add_f32 v85, 1.0, v85
  v_rcp_f32 v85, v85
  s_nop 0
  v_mul_f32 v77, v77, v85
  v_mul_f32 v86, v78, v78
  v_mov_b32 v88, s36
  v_fma_f32 v86, v86, s37, v88
  v_mul_f32 v86, v86, v78
  v_exp_f32 v86, v86
  s_nop 0
  v_add_f32 v86, 1.0, v86
  v_rcp_f32 v86, v86
  s_nop 0
  v_mul_f32 v78, v78, v86
  v_mul_f32 v87, v79, v79
  v_mov_b32 v88, s36
  v_fma_f32 v87, v87, s37, v88
  v_mul_f32 v87, v87, v79
  v_exp_f32 v87, v87
  s_nop 0
  v_add_f32 v87, 1.0, v87
  v_rcp_f32 v87, v87
  s_nop 0
  v_mul_f32 v79, v79, v87
  v_cvt_pk_bf16_f32 v80, v64, v72
  v_cvt_pk_bf16_f32 v81, v65, v73
  v_cvt_pk_bf16_f32 v82, v66, v74
  v_cvt_pk_bf16_f32 v83, v67, v75
  v_add_u32 v25, 0, v30
  v_xor_b32 v25, v25, v31
  v_lshl_add_u32 v25, v25, 4, v29
  ds_write_b128 v25, v[80:83] offset:8192
  v_cvt_pk_bf16_f32 v80, v68, v76
  v_cvt_pk_bf16_f32 v81, v69, v77
  v_cvt_pk_bf16_f32 v82, v70, v78
  v_cvt_pk_bf16_f32 v83, v71, v79
  v_add_u32 v25, 2, v30
  v_xor_b32 v25, v25, v31
  v_lshl_add_u32 v25, v25, 4, v29
  ds_write_b128 v25, v[80:83] offset:8192
  v_mov_b64 v[64:65], v[176:177]
  v_mov_b64 v[66:67], v[178:179]
  v_mov_b64 v[68:69], v[180:181]
  v_mov_b64 v[70:71], v[182:183]
  v_mov_b64 v[72:73], v[184:185]
  v_mov_b64 v[74:75], v[186:187]
  v_mov_b64 v[76:77], v[188:189]
  v_mov_b64 v[78:79], v[190:191]
  v_cvt_pk_bf16_f32 v64, v64, v64
  v_and_b32 v64, 0xffff0000, v64
  v_lshlrev_b32 v84, 16, v112
  v_add_f32 v64, v64, v84
  v_cvt_pk_bf16_f32 v64, v64, v64
  v_and_b32 v64, 0xffff0000, v64
  v_cvt_pk_bf16_f32 v65, v65, v65
  v_and_b32 v65, 0xffff0000, v65
  v_and_b32 v84, 0xffff0000, v112
  v_add_f32 v65, v65, v84
  v_cvt_pk_bf16_f32 v65, v65, v65
  v_and_b32 v65, 0xffff0000, v65
  v_cvt_pk_bf16_f32 v66, v66, v66
  v_and_b32 v66, 0xffff0000, v66
  v_lshlrev_b32 v84, 16, v113
  v_add_f32 v66, v66, v84
  v_cvt_pk_bf16_f32 v66, v66, v66
  v_and_b32 v66, 0xffff0000, v66
  v_cvt_pk_bf16_f32 v67, v67, v67
  v_and_b32 v67, 0xffff0000, v67
  v_and_b32 v84, 0xffff0000, v113
  v_add_f32 v67, v67, v84
  v_cvt_pk_bf16_f32 v67, v67, v67
  v_and_b32 v67, 0xffff0000, v67
  v_cvt_pk_bf16_f32 v68, v68, v68
  v_and_b32 v68, 0xffff0000, v68
  v_lshlrev_b32 v84, 16, v114
  v_add_f32 v68, v68, v84
  v_cvt_pk_bf16_f32 v68, v68, v68
  v_and_b32 v68, 0xffff0000, v68
  v_cvt_pk_bf16_f32 v69, v69, v69
  v_and_b32 v69, 0xffff0000, v69
  v_and_b32 v84, 0xffff0000, v114
  v_add_f32 v69, v69, v84
  v_cvt_pk_bf16_f32 v69, v69, v69
  v_and_b32 v69, 0xffff0000, v69
  v_cvt_pk_bf16_f32 v70, v70, v70
  v_and_b32 v70, 0xffff0000, v70
  v_lshlrev_b32 v84, 16, v115
  v_add_f32 v70, v70, v84
  v_cvt_pk_bf16_f32 v70, v70, v70
  v_and_b32 v70, 0xffff0000, v70
  v_cvt_pk_bf16_f32 v71, v71, v71
  v_and_b32 v71, 0xffff0000, v71
  v_and_b32 v84, 0xffff0000, v115
  v_add_f32 v71, v71, v84
  v_cvt_pk_bf16_f32 v71, v71, v71
  v_and_b32 v71, 0xffff0000, v71
  v_cvt_pk_bf16_f32 v72, v72, v72
  v_and_b32 v72, 0xffff0000, v72
  v_lshlrev_b32 v84, 16, v116
  v_add_f32 v72, v72, v84
  v_cvt_pk_bf16_f32 v72, v72, v72
  v_and_b32 v72, 0xffff0000, v72
  v_cvt_pk_bf16_f32 v73, v73, v73
  v_and_b32 v73, 0xffff0000, v73
  v_and_b32 v84, 0xffff0000, v116
  v_add_f32 v73, v73, v84
  v_cvt_pk_bf16_f32 v73, v73, v73
  v_and_b32 v73, 0xffff0000, v73
  v_cvt_pk_bf16_f32 v74, v74, v74
  v_and_b32 v74, 0xffff0000, v74
  v_lshlrev_b32 v84, 16, v117
  v_add_f32 v74, v74, v84
  v_cvt_pk_bf16_f32 v74, v74, v74
  v_and_b32 v74, 0xffff0000, v74
  v_cvt_pk_bf16_f32 v75, v75, v75
  v_and_b32 v75, 0xffff0000, v75
  v_and_b32 v84, 0xffff0000, v117
  v_add_f32 v75, v75, v84
  v_cvt_pk_bf16_f32 v75, v75, v75
  v_and_b32 v75, 0xffff0000, v75
  v_cvt_pk_bf16_f32 v76, v76, v76
  v_and_b32 v76, 0xffff0000, v76
  v_lshlrev_b32 v84, 16, v118
  v_add_f32 v76, v76, v84
  v_cvt_pk_bf16_f32 v76, v76, v76
  v_and_b32 v76, 0xffff0000, v76
  v_cvt_pk_bf16_f32 v77, v77, v77
  v_and_b32 v77, 0xffff0000, v77
  v_and_b32 v84, 0xffff0000, v118
  v_add_f32 v77, v77, v84
  v_cvt_pk_bf16_f32 v77, v77, v77
  v_and_b32 v77, 0xffff0000, v77
  v_cvt_pk_bf16_f32 v78, v78, v78
  v_and_b32 v78, 0xffff0000, v78
  v_lshlrev_b32 v84, 16, v119
  v_add_f32 v78, v78, v84
  v_cvt_pk_bf16_f32 v78, v78, v78
  v_and_b32 v78, 0xffff0000, v78
  v_cvt_pk_bf16_f32 v79, v79, v79
  v_and_b32 v79, 0xffff0000, v79
  v_and_b32 v84, 0xffff0000, v119
  v_add_f32 v79, v79, v84
  v_cvt_pk_bf16_f32 v79, v79, v79
  v_and_b32 v79, 0xffff0000, v79
  v_mul_f32 v84, v64, v64
  v_mov_b32 v88, s36
  v_fma_f32 v84, v84, s37, v88
  v_mul_f32 v84, v84, v64
  v_exp_f32 v84, v84
  s_nop 0
  v_add_f32 v84, 1.0, v84
  v_rcp_f32 v84, v84
  s_nop 0
  v_mul_f32 v64, v64, v84
  v_mul_f32 v85, v65, v65
  v_mov_b32 v88, s36
  v_fma_f32 v85, v85, s37, v88
  v_mul_f32 v85, v85, v65
  v_exp_f32 v85, v85
  s_nop 0
  v_add_f32 v85, 1.0, v85
  v_rcp_f32 v85, v85
  s_nop 0
  v_mul_f32 v65, v65, v85
  v_mul_f32 v86, v66, v66
  v_mov_b32 v88, s36
  v_fma_f32 v86, v86, s37, v88
  v_mul_f32 v86, v86, v66
  v_exp_f32 v86, v86
  s_nop 0
  v_add_f32 v86, 1.0, v86
  v_rcp_f32 v86, v86
  s_nop 0
  v_mul_f32 v66, v66, v86
  v_mul_f32 v87, v67, v67
  v_mov_b32 v88, s36
  v_fma_f32 v87, v87, s37, v88
  v_mul_f32 v87, v87, v67
  v_exp_f32 v87, v87
  s_nop 0
  v_add_f32 v87, 1.0, v87
  v_rcp_f32 v87, v87
  s_nop 0
  v_mul_f32 v67, v67, v87
  v_mul_f32 v84, v68, v68
  v_mov_b32 v88, s36
  v_fma_f32 v84, v84, s37, v88
  v_mul_f32 v84, v84, v68
  v_exp_f32 v84, v84
  s_nop 0
  v_add_f32 v84, 1.0, v84
  v_rcp_f32 v84, v84
  s_nop 0
  v_mul_f32 v68, v68, v84
  v_mul_f32 v85, v69, v69
  v_mov_b32 v88, s36
  v_fma_f32 v85, v85, s37, v88
  v_mul_f32 v85, v85, v69
  v_exp_f32 v85, v85
  s_nop 0
  v_add_f32 v85, 1.0, v85
  v_rcp_f32 v85, v85
  s_nop 0
  v_mul_f32 v69, v69, v85
  v_mul_f32 v86, v70, v70
  v_mov_b32 v88, s36
  v_fma_f32 v86, v86, s37, v88
  v_mul_f32 v86, v86, v70
  v_exp_f32 v86, v86
  s_nop 0
  v_add_f32 v86, 1.0, v86
  v_rcp_f32 v86, v86
  s_nop 0
  v_mul_f32 v70, v70, v86
  v_mul_f32 v87, v71, v71
  v_mov_b32 v88, s36
  v_fma_f32 v87, v87, s37, v88
  v_mul_f32 v87, v87, v71
  v_exp_f32 v87, v87
  s_nop 0
  v_add_f32 v87, 1.0, v87
  v_rcp_f32 v87, v87
  s_nop 0
  v_mul_f32 v71, v71, v87
  v_mul_f32 v84, v72, v72
  v_mov_b32 v88, s36
  v_fma_f32 v84, v84, s37, v88
  v_mul_f32 v84, v84, v72
  v_exp_f32 v84, v84
  s_nop 0
  v_add_f32 v84, 1.0, v84
  v_rcp_f32 v84, v84
  s_nop 0
  v_mul_f32 v72, v72, v84
  v_mul_f32 v85, v73, v73
  v_mov_b32 v88, s36
  v_fma_f32 v85, v85, s37, v88
  v_mul_f32 v85, v85, v73
  v_exp_f32 v85, v85
  s_nop 0
  v_add_f32 v85, 1.0, v85
  v_rcp_f32 v85, v85
  s_nop 0
  v_mul_f32 v73, v73, v85
  v_mul_f32 v86, v74, v74
  v_mov_b32 v88, s36
  v_fma_f32 v86, v86, s37, v88
  v_mul_f32 v86, v86, v74
  v_exp_f32 v86, v86
  s_nop 0
  v_add_f32 v86, 1.0, v86
  v_rcp_f32 v86, v86
  s_nop 0
  v_mul_f32 v74, v74, v86
  v_mul_f32 v87, v75, v75
  v_mov_b32 v88, s36
  v_fma_f32 v87, v87, s37, v88
  v_mul_f32 v87, v87, v75
  v_exp_f32 v87, v87
  s_nop 0
  v_add_f32 v87, 1.0, v87
  v_rcp_f32 v87, v87
  s_nop 0
  v_mul_f32 v75, v75, v87
  v_mul_f32 v84, v76, v76
  v_mov_b32 v88, s36
  v_fma_f32 v84, v84, s37, v88
  v_mul_f32 v84, v84, v76
  v_exp_f32 v84, v84
  s_nop 0
  v_add_f32 v84, 1.0, v84
  v_rcp_f32 v84, v84
  s_nop 0
  v_mul_f32 v76, v76, v84
  v_mul_f32 v85, v77, v77
  v_mov_b32 v88, s36
  v_fma_f32 v85, v85, s37, v88
  v_mul_f32 v85, v85, v77
  v_exp_f32 v85, v85
  s_nop 0
  v_add_f32 v85, 1.0, v85
  v_rcp_f32 v85, v85
  s_nop 0
  v_mul_f32 v77, v77, v85
  v_mul_f32 v86, v78, v78
  v_mov_b32 v88, s36
  v_fma_f32 v86, v86, s37, v88
  v_mul_f32 v86, v86, v78
  v_exp_f32 v86, v86
  s_nop 0
  v_add_f32 v86, 1.0, v86
  v_rcp_f32 v86, v86
  s_nop 0
  v_mul_f32 v78, v78, v86
  v_mul_f32 v87, v79, v79
  v_mov_b32 v88, s36
  v_fma_f32 v87, v87, s37, v88
  v_mul_f32 v87, v87, v79
  v_exp_f32 v87, v87
  s_nop 0
  v_add_f32 v87, 1.0, v87
  v_rcp_f32 v87, v87
  s_nop 0
  v_mul_f32 v79, v79, v87
  v_cvt_pk_bf16_f32 v80, v64, v72
  v_cvt_pk_bf16_f32 v81, v65, v73
  v_cvt_pk_bf16_f32 v82, v66, v74
  v_cvt_pk_bf16_f32 v83, v67, v75
  v_add_u32 v25, 4, v30
  v_xor_b32 v25, v25, v31
  v_lshl_add_u32 v25, v25, 4, v29
  ds_write_b128 v25, v[80:83] offset:8192
  v_cvt_pk_bf16_f32 v80, v68, v76
  v_cvt_pk_bf16_f32 v81, v69, v77
  v_cvt_pk_bf16_f32 v82, v70, v78
  v_cvt_pk_bf16_f32 v83, v71, v79
  v_add_u32 v25, 6, v30
  v_xor_b32 v25, v25, v31
  v_lshl_add_u32 v25, v25, 4, v29
  ds_write_b128 v25, v[80:83] offset:8192
  s_waitcnt lgkmcnt(0)
  s_barrier
  s_mul_i32 s13, s91, 458752
  s_add_u32 s13, s13, 71303168
  s_lshl_b32 s14, s92, 8
  s_add_u32 s13, s13, s14
  s_add_u32 s30, s4, s13
  s_addc_u32 s31, s5, 0
  v_lshlrev_b32 v25, 4, v22
  s_lshl_b32 s13, s10, 13
  s_add_u32 s13, s13, 98304
  v_add_u32 v25, s13, v25
  ds_read_b128 v[64:67], v25 offset:0
  ds_read_b128 v[68:71], v25 offset:1024
  ds_read_b128 v[72:75], v25 offset:2048
  ds_read_b128 v[76:79], v25 offset:3072
  ds_read_b128 v[80:83], v25 offset:4096
  ds_read_b128 v[84:87], v25 offset:5120
  ds_read_b128 v[88:91], v25 offset:6144
  ds_read_b128 v[92:95], v25 offset:7168
  v_lshrrev_b32 v27, 4, v22
  s_lshl_b32 s13, s10, 5
  v_add_u32 v27, s13, v27
  v_add_u32 v28, 0, v27
  v_xor_b32 v26, v28, v22
  v_and_b32 v26, 15, v26
  v_mul_u32_u24 v28, 3584, v28
  v_lshl_add_u32 v96, v26, 4, v28
  v_add_u32 v28, 4, v27
  v_xor_b32 v26, v28, v22
  v_and_b32 v26, 15, v26
  v_mul_u32_u24 v28, 3584, v28
  v_lshl_add_u32 v97, v26, 4, v28
  v_add_u32 v28, 8, v27
  v_xor_b32 v26, v28, v22
  v_and_b32 v26, 15, v26
  v_mul_u32_u24 v28, 3584, v28
  v_lshl_add_u32 v98, v26, 4, v28
  v_add_u32 v28, 12, v27
  v_xor_b32 v26, v28, v22
  v_and_b32 v26, 15, v26
  v_mul_u32_u24 v28, 3584, v28
  v_lshl_add_u32 v99, v26, 4, v28
  v_add_u32 v28, 16, v27
  v_xor_b32 v26, v28, v22
  v_and_b32 v26, 15, v26
  v_mul_u32_u24 v28, 3584, v28
  v_lshl_add_u32 v100, v26, 4, v28
  v_add_u32 v28, 20, v27
  v_xor_b32 v26, v28, v22
  v_and_b32 v26, 15, v26
  v_mul_u32_u24 v28, 3584, v28
  v_lshl_add_u32 v101, v26, 4, v28
  v_add_u32 v28, 24, v27
  v_xor_b32 v26, v28, v22
  v_and_b32 v26, 15, v26
  v_mul_u32_u24 v28, 3584, v28
  v_lshl_add_u32 v102, v26, 4, v28
  v_add_u32 v28, 28, v27
  v_xor_b32 v26, v28, v22
  v_and_b32 v26, 15, v26
  v_mul_u32_u24 v28, 3584, v28
  v_lshl_add_u32 v103, v26, 4, v28
  s_waitcnt lgkmcnt(7)
  global_store_dwordx4 v96, v[64:67], s[30:31] sc1
  s_waitcnt lgkmcnt(6)
  global_store_dwordx4 v97, v[68:71], s[30:31] sc1
  s_waitcnt lgkmcnt(5)
  global_store_dwordx4 v98, v[72:75], s[30:31] sc1
  s_waitcnt lgkmcnt(4)
  global_store_dwordx4 v99, v[76:79], s[30:31] sc1
  s_waitcnt lgkmcnt(3)
  global_store_dwordx4 v100, v[80:83], s[30:31] sc1
  s_waitcnt lgkmcnt(2)
  global_store_dwordx4 v101, v[84:87], s[30:31] sc1
  s_waitcnt lgkmcnt(1)
  global_store_dwordx4 v102, v[88:91], s[30:31] sc1
  s_waitcnt lgkmcnt(0)
  global_store_dwordx4 v103, v[92:95], s[30:31] sc1
  s_lshl_b32 s94, s91, 8
  s_add_u32 s94, s94, 94400512
  s_lshl_b32 s14, s92, 4
  s_add_u32 s94, s94, s14
  s_branch Le_done_232
Le_v_229:
  s_lshl_b32 s13, s91, 20
  s_lshl_b32 s14, s92, 13
  s_add_u32 s13, s13, s14
  s_add_u32 s13, s13, 37748736
  s_add_u32 s30, s4, s13
  s_addc_u32 s31, s5, 0
  s_lshr_b32 s13, s10, 1
  s_lshl_b32 s13, s13, 14
  s_and_b32 s14, s10, 1
  s_lshl_b32 s14, s14, 12
  s_add_u32 s13, s13, s14
  s_add_u32 s13, s13, 98304
  v_lshlrev_b32 v29, 6, v23
  v_lshl_add_u32 v29, v24, 4, v29
  v_add_u32 v29, s13, v29
  v_cvt_pk_bf16_f32 v64, v128, v129
  v_cvt_pk_bf16_f32 v65, v130, v131
  v_cvt_pk_bf16_f32 v66, v136, v137
  v_cvt_pk_bf16_f32 v67, v138, v139
  ds_write_b128 v29, v[64:67] offset:0
  v_cvt_pk_bf16_f32 v68, v132, v133
  v_cvt_pk_bf16_f32 v69, v134, v135
  v_cvt_pk_bf16_f32 v70, v140, v141
  v_cvt_pk_bf16_f32 v71, v142, v143
  ds_write_b128 v29, v[68:71] offset:32
  v_cvt_pk_bf16_f32 v64, v144, v145
  v_cvt_pk_bf16_f32 v65, v146, v147
  v_cvt_pk_bf16_f32 v66, v152, v153
  v_cvt_pk_bf16_f32 v67, v154, v155
  ds_write_b128 v29, v[64:67] offset:2048
  v_cvt_pk_bf16_f32 v68, v148, v149
  v_cvt_pk_bf16_f32 v69, v150, v151
  v_cvt_pk_bf16_f32 v70, v156, v157
  v_cvt_pk_bf16_f32 v71, v158, v159
  ds_write_b128 v29, v[68:71] offset:2080
  v_cvt_pk_bf16_f32 v64, v160, v161
  v_cvt_pk_bf16_f32 v65, v162, v163
  v_cvt_pk_bf16_f32 v66, v168, v169
  v_cvt_pk_bf16_f32 v67, v170, v171
  ds_write_b128 v29, v[64:67] offset:8192
  v_cvt_pk_bf16_f32 v68, v164, v165
  v_cvt_pk_bf16_f32 v69, v166, v167
  v_cvt_pk_bf16_f32 v70, v172, v173
  v_cvt_pk_bf16_f32 v71, v174, v175
  ds_write_b128 v29, v[68:71] offset:8224
  v_cvt_pk_bf16_f32 v64, v176, v177
  v_cvt_pk_bf16_f32 v65, v178, v179
  v_cvt_pk_bf16_f32 v66, v184, v185
  v_cvt_pk_bf16_f32 v67, v186, v187
  ds_write_b128 v29, v[64:67] offset:10240
  v_cvt_pk_bf16_f32 v68, v180, v181
  v_cvt_pk_bf16_f32 v69, v182, v183
  v_cvt_pk_bf16_f32 v70, v188, v189
  v_cvt_pk_bf16_f32 v71, v190, v191
  ds_write_b128 v29, v[68:71] offset:10272
  s_waitcnt lgkmcnt(0)
  s_barrier
  v_lshlrev_b32 v25, 4, v22
  s_lshl_b32 s13, s10, 13
  s_add_u32 s13, s13, 98304
  v_add_u32 v26, s13, v25
  ds_read_b128 v[64:67], v26 offset:0
  ds_read_b128 v[68:71], v26 offset:1024
  ds_read_b128 v[72:75], v26 offset:2048
  ds_read_b128 v[76:79], v26 offset:3072
  ds_read_b128 v[80:83], v26 offset:4096
  ds_read_b128 v[84:87], v26 offset:5120
  ds_read_b128 v[88:91], v26 offset:6144
  ds_read_b128 v[92:95], v26 offset:7168
  s_lshl_b32 s13, s10, 18
  s_add_u32 s34, s30, s13
  s_addc_u32 s35, s31, 0
  v_add_u32 v27, 4096, v25
  s_waitcnt lgkmcnt(7)
  global_store_dwordx4 v25, v[64:67], s[34:35] offset:0 sc1
  s_waitcnt lgkmcnt(6)
  global_store_dwordx4 v25, v[68:71], s[34:35] offset:1024 sc1
  s_waitcnt lgkmcnt(5)
  global_store_dwordx4 v25, v[72:75], s[34:35] offset:2048 sc1
  s_waitcnt lgkmcnt(4)
  global_store_dwordx4 v25, v[76:79], s[34:35] offset:3072 sc1
  s_waitcnt lgkmcnt(3)
  global_store_dwordx4 v27, v[80:83], s[34:35] offset:0 sc1
  s_waitcnt lgkmcnt(2)
  global_store_dwordx4 v27, v[84:87], s[34:35] offset:1024 sc1
  s_waitcnt lgkmcnt(1)
  global_store_dwordx4 v27, v[88:91], s[34:35] offset:2048 sc1
  s_waitcnt lgkmcnt(0)
  global_store_dwordx4 v27, v[92:95], s[34:35] offset:3072 sc1
  s_lshl_b32 s94, s91, 9
  s_add_u32 s94, s94, 94384128
  s_lshl_b32 s14, s92, 4
  s_add_u32 s94, s94, s14
  s_branch Le_done_232
Le_b_230:
  s_lshr_b32 s13, s10, 1
  s_lshl_b32 s13, s13, 14
  s_add_u32 s13, s13, 98304
  v_lshlrev_b32 v29, 8, v23
  v_add_u32 v29, s13, v29
  v_and_b32 v31, 15, v23
  s_lshl_b32 s13, s92, 8
  s_and_b32 s14, s10, 1
  s_lshl_b32 s14, s14, 7
  s_add_u32 s13, s13, s14
  s_add_u32 s34, s52, s13
  s_addc_u32 s35, s53, 0
  v_lshlrev_b32 v25, 3, v24
  global_load_dwordx2 v[104:105], v25, s[34:35] offset:0
  global_load_dwordx2 v[106:107], v25, s[34:35] offset:16
  global_load_dwordx2 v[108:109], v25, s[34:35] offset:32
  global_load_dwordx2 v[110:111], v25, s[34:35] offset:48
  global_load_dwordx2 v[112:113], v25, s[34:35] offset:64
  global_load_dwordx2 v[114:115], v25, s[34:35] offset:80
  global_load_dwordx2 v[116:117], v25, s[34:35] offset:96
  global_load_dwordx2 v[118:119], v25, s[34:35] offset:112
  s_and_b32 s14, s10, 1
  s_lshl_b32 s14, s14, 3
  s_waitcnt vmcnt(0)
  v_mov_b64 v[64:65], v[128:129]
  v_mov_b64 v[66:67], v[130:131]
  v_mov_b64 v[68:69], v[132:133]
  v_mov_b64 v[70:71], v[134:135]
  v_mov_b64 v[72:73], v[136:137]
  v_mov_b64 v[74:75], v[138:139]
  v_mov_b64 v[76:77], v[140:141]
  v_mov_b64 v[78:79], v[142:143]
  v_cvt_pk_bf16_f32 v64, v64, v64
  v_and_b32 v64, 0xffff0000, v64
  v_lshlrev_b32 v84, 16, v104
  v_add_f32 v64, v64, v84
  v_cvt_pk_bf16_f32 v65, v65, v65
  v_and_b32 v65, 0xffff0000, v65
  v_and_b32 v84, 0xffff0000, v104
  v_add_f32 v65, v65, v84
  v_cvt_pk_bf16_f32 v66, v66, v66
  v_and_b32 v66, 0xffff0000, v66
  v_lshlrev_b32 v84, 16, v105
  v_add_f32 v66, v66, v84
  v_cvt_pk_bf16_f32 v67, v67, v67
  v_and_b32 v67, 0xffff0000, v67
  v_and_b32 v84, 0xffff0000, v105
  v_add_f32 v67, v67, v84
  v_cvt_pk_bf16_f32 v80, v64, v65
  v_cvt_pk_bf16_f32 v81, v66, v67
  s_add_u32 s13, s14, 0
  v_xor_b32 v25, s13, v31
  v_lshl_add_u32 v25, v25, 4, v29
  v_lshl_add_u32 v25, v24, 3, v25
  ds_write_b64 v25, v[80:81] offset:0
  v_cvt_pk_bf16_f32 v68, v68, v68
  v_and_b32 v68, 0xffff0000, v68
  v_lshlrev_b32 v84, 16, v106
  v_add_f32 v68, v68, v84
  v_cvt_pk_bf16_f32 v69, v69, v69
  v_and_b32 v69, 0xffff0000, v69
  v_and_b32 v84, 0xffff0000, v106
  v_add_f32 v69, v69, v84
  v_cvt_pk_bf16_f32 v70, v70, v70
  v_and_b32 v70, 0xffff0000, v70
  v_lshlrev_b32 v84, 16, v107
  v_add_f32 v70, v70, v84
  v_cvt_pk_bf16_f32 v71, v71, v71
  v_and_b32 v71, 0xffff0000, v71
  v_and_b32 v84, 0xffff0000, v107
  v_add_f32 v71, v71, v84
  v_cvt_pk_bf16_f32 v80, v68, v69
  v_cvt_pk_bf16_f32 v81, v70, v71
  s_add_u32 s13, s14, 1
  v_xor_b32 v25, s13, v31
  v_lshl_add_u32 v25, v25, 4, v29
  v_lshl_add_u32 v25, v24, 3, v25
  ds_write_b64 v25, v[80:81] offset:0
  v_cvt_pk_bf16_f32 v72, v72, v72
  v_and_b32 v72, 0xffff0000, v72
  v_lshlrev_b32 v84, 16, v108
  v_add_f32 v72, v72, v84
  v_cvt_pk_bf16_f32 v73, v73, v73
  v_and_b32 v73, 0xffff0000, v73
  v_and_b32 v84, 0xffff0000, v108
  v_add_f32 v73, v73, v84
  v_cvt_pk_bf16_f32 v74, v74, v74
  v_and_b32 v74, 0xffff0000, v74
  v_lshlrev_b32 v84, 16, v109
  v_add_f32 v74, v74, v84
  v_cvt_pk_bf16_f32 v75, v75, v75
  v_and_b32 v75, 0xffff0000, v75
  v_and_b32 v84, 0xffff0000, v109
  v_add_f32 v75, v75, v84
  v_cvt_pk_bf16_f32 v80, v72, v73
  v_cvt_pk_bf16_f32 v81, v74, v75
  s_add_u32 s13, s14, 2
  v_xor_b32 v25, s13, v31
  v_lshl_add_u32 v25, v25, 4, v29
  v_lshl_add_u32 v25, v24, 3, v25
  ds_write_b64 v25, v[80:81] offset:0
  v_cvt_pk_bf16_f32 v76, v76, v76
  v_and_b32 v76, 0xffff0000, v76
  v_lshlrev_b32 v84, 16, v110
  v_add_f32 v76, v76, v84
  v_cvt_pk_bf16_f32 v77, v77, v77
  v_and_b32 v77, 0xffff0000, v77
  v_and_b32 v84, 0xffff0000, v110
  v_add_f32 v77, v77, v84
  v_cvt_pk_bf16_f32 v78, v78, v78
  v_and_b32 v78, 0xffff0000, v78
  v_lshlrev_b32 v84, 16, v111
  v_add_f32 v78, v78, v84
  v_cvt_pk_bf16_f32 v79, v79, v79
  v_and_b32 v79, 0xffff0000, v79
  v_and_b32 v84, 0xffff0000, v111
  v_add_f32 v79, v79, v84
  v_cvt_pk_bf16_f32 v80, v76, v77
  v_cvt_pk_bf16_f32 v81, v78, v79
  s_add_u32 s13, s14, 3
  v_xor_b32 v25, s13, v31
  v_lshl_add_u32 v25, v25, 4, v29
  v_lshl_add_u32 v25, v24, 3, v25
  ds_write_b64 v25, v[80:81] offset:0
  v_mov_b64 v[64:65], v[144:145]
  v_mov_b64 v[66:67], v[146:147]
  v_mov_b64 v[68:69], v[148:149]
  v_mov_b64 v[70:71], v[150:151]
  v_mov_b64 v[72:73], v[152:153]
  v_mov_b64 v[74:75], v[154:155]
  v_mov_b64 v[76:77], v[156:157]
  v_mov_b64 v[78:79], v[158:159]
  v_cvt_pk_bf16_f32 v64, v64, v64
  v_and_b32 v64, 0xffff0000, v64
  v_lshlrev_b32 v84, 16, v112
  v_add_f32 v64, v64, v84
  v_cvt_pk_bf16_f32 v65, v65, v65
  v_and_b32 v65, 0xffff0000, v65
  v_and_b32 v84, 0xffff0000, v112
  v_add_f32 v65, v65, v84
  v_cvt_pk_bf16_f32 v66, v66, v66
  v_and_b32 v66, 0xffff0000, v66
  v_lshlrev_b32 v84, 16, v113
  v_add_f32 v66, v66, v84
  v_cvt_pk_bf16_f32 v67, v67, v67
  v_and_b32 v67, 0xffff0000, v67
  v_and_b32 v84, 0xffff0000, v113
  v_add_f32 v67, v67, v84
  v_cvt_pk_bf16_f32 v80, v64, v65
  v_cvt_pk_bf16_f32 v81, v66, v67
  s_add_u32 s13, s14, 4
  v_xor_b32 v25, s13, v31
  v_lshl_add_u32 v25, v25, 4, v29
  v_lshl_add_u32 v25, v24, 3, v25
  ds_write_b64 v25, v[80:81] offset:0
  v_cvt_pk_bf16_f32 v68, v68, v68
  v_and_b32 v68, 0xffff0000, v68
  v_lshlrev_b32 v84, 16, v114
  v_add_f32 v68, v68, v84
  v_cvt_pk_bf16_f32 v69, v69, v69
  v_and_b32 v69, 0xffff0000, v69
  v_and_b32 v84, 0xffff0000, v114
  v_add_f32 v69, v69, v84
  v_cvt_pk_bf16_f32 v70, v70, v70
  v_and_b32 v70, 0xffff0000, v70
  v_lshlrev_b32 v84, 16, v115
  v_add_f32 v70, v70, v84
  v_cvt_pk_bf16_f32 v71, v71, v71
  v_and_b32 v71, 0xffff0000, v71
  v_and_b32 v84, 0xffff0000, v115
  v_add_f32 v71, v71, v84
  v_cvt_pk_bf16_f32 v80, v68, v69
  v_cvt_pk_bf16_f32 v81, v70, v71
  s_add_u32 s13, s14, 5
  v_xor_b32 v25, s13, v31
  v_lshl_add_u32 v25, v25, 4, v29
  v_lshl_add_u32 v25, v24, 3, v25
  ds_write_b64 v25, v[80:81] offset:0
  v_cvt_pk_bf16_f32 v72, v72, v72
  v_and_b32 v72, 0xffff0000, v72
  v_lshlrev_b32 v84, 16, v116
  v_add_f32 v72, v72, v84
  v_cvt_pk_bf16_f32 v73, v73, v73
  v_and_b32 v73, 0xffff0000, v73
  v_and_b32 v84, 0xffff0000, v116
  v_add_f32 v73, v73, v84
  v_cvt_pk_bf16_f32 v74, v74, v74
  v_and_b32 v74, 0xffff0000, v74
  v_lshlrev_b32 v84, 16, v117
  v_add_f32 v74, v74, v84
  v_cvt_pk_bf16_f32 v75, v75, v75
  v_and_b32 v75, 0xffff0000, v75
  v_and_b32 v84, 0xffff0000, v117
  v_add_f32 v75, v75, v84
  v_cvt_pk_bf16_f32 v80, v72, v73
  v_cvt_pk_bf16_f32 v81, v74, v75
  s_add_u32 s13, s14, 6
  v_xor_b32 v25, s13, v31
  v_lshl_add_u32 v25, v25, 4, v29
  v_lshl_add_u32 v25, v24, 3, v25
  ds_write_b64 v25, v[80:81] offset:0
  v_cvt_pk_bf16_f32 v76, v76, v76
  v_and_b32 v76, 0xffff0000, v76
  v_lshlrev_b32 v84, 16, v118
  v_add_f32 v76, v76, v84
  v_cvt_pk_bf16_f32 v77, v77, v77
  v_and_b32 v77, 0xffff0000, v77
  v_and_b32 v84, 0xffff0000, v118
  v_add_f32 v77, v77, v84
  v_cvt_pk_bf16_f32 v78, v78, v78
  v_and_b32 v78, 0xffff0000, v78
  v_lshlrev_b32 v84, 16, v119
  v_add_f32 v78, v78, v84
  v_cvt_pk_bf16_f32 v79, v79, v79
  v_and_b32 v79, 0xffff0000, v79
  v_and_b32 v84, 0xffff0000, v119
  v_add_f32 v79, v79, v84
  v_cvt_pk_bf16_f32 v80, v76, v77
  v_cvt_pk_bf16_f32 v81, v78, v79
  s_add_u32 s13, s14, 7
  v_xor_b32 v25, s13, v31
  v_lshl_add_u32 v25, v25, 4, v29
  v_lshl_add_u32 v25, v24, 3, v25
  ds_write_b64 v25, v[80:81] offset:0
  v_mov_b64 v[64:65], v[160:161]
  v_mov_b64 v[66:67], v[162:163]
  v_mov_b64 v[68:69], v[164:165]
  v_mov_b64 v[70:71], v[166:167]
  v_mov_b64 v[72:73], v[168:169]
  v_mov_b64 v[74:75], v[170:171]
  v_mov_b64 v[76:77], v[172:173]
  v_mov_b64 v[78:79], v[174:175]
  v_cvt_pk_bf16_f32 v64, v64, v64
  v_and_b32 v64, 0xffff0000, v64
  v_lshlrev_b32 v84, 16, v104
  v_add_f32 v64, v64, v84
  v_cvt_pk_bf16_f32 v65, v65, v65
  v_and_b32 v65, 0xffff0000, v65
  v_and_b32 v84, 0xffff0000, v104
  v_add_f32 v65, v65, v84
  v_cvt_pk_bf16_f32 v66, v66, v66
  v_and_b32 v66, 0xffff0000, v66
  v_lshlrev_b32 v84, 16, v105
  v_add_f32 v66, v66, v84
  v_cvt_pk_bf16_f32 v67, v67, v67
  v_and_b32 v67, 0xffff0000, v67
  v_and_b32 v84, 0xffff0000, v105
  v_add_f32 v67, v67, v84
  v_cvt_pk_bf16_f32 v80, v64, v65
  v_cvt_pk_bf16_f32 v81, v66, v67
  s_add_u32 s13, s14, 0
  v_xor_b32 v25, s13, v31
  v_lshl_add_u32 v25, v25, 4, v29
  v_lshl_add_u32 v25, v24, 3, v25
  ds_write_b64 v25, v[80:81] offset:8192
  v_cvt_pk_bf16_f32 v68, v68, v68
  v_and_b32 v68, 0xffff0000, v68
  v_lshlrev_b32 v84, 16, v106
  v_add_f32 v68, v68, v84
  v_cvt_pk_bf16_f32 v69, v69, v69
  v_and_b32 v69, 0xffff0000, v69
  v_and_b32 v84, 0xffff0000, v106
  v_add_f32 v69, v69, v84
  v_cvt_pk_bf16_f32 v70, v70, v70
  v_and_b32 v70, 0xffff0000, v70
  v_lshlrev_b32 v84, 16, v107
  v_add_f32 v70, v70, v84
  v_cvt_pk_bf16_f32 v71, v71, v71
  v_and_b32 v71, 0xffff0000, v71
  v_and_b32 v84, 0xffff0000, v107
  v_add_f32 v71, v71, v84
  v_cvt_pk_bf16_f32 v80, v68, v69
  v_cvt_pk_bf16_f32 v81, v70, v71
  s_add_u32 s13, s14, 1
  v_xor_b32 v25, s13, v31
  v_lshl_add_u32 v25, v25, 4, v29
  v_lshl_add_u32 v25, v24, 3, v25
  ds_write_b64 v25, v[80:81] offset:8192
  v_cvt_pk_bf16_f32 v72, v72, v72
  v_and_b32 v72, 0xffff0000, v72
  v_lshlrev_b32 v84, 16, v108
  v_add_f32 v72, v72, v84
  v_cvt_pk_bf16_f32 v73, v73, v73
  v_and_b32 v73, 0xffff0000, v73
  v_and_b32 v84, 0xffff0000, v108
  v_add_f32 v73, v73, v84
  v_cvt_pk_bf16_f32 v74, v74, v74
  v_and_b32 v74, 0xffff0000, v74
  v_lshlrev_b32 v84, 16, v109
  v_add_f32 v74, v74, v84
  v_cvt_pk_bf16_f32 v75, v75, v75
  v_and_b32 v75, 0xffff0000, v75
  v_and_b32 v84, 0xffff0000, v109
  v_add_f32 v75, v75, v84
  v_cvt_pk_bf16_f32 v80, v72, v73
  v_cvt_pk_bf16_f32 v81, v74, v75
  s_add_u32 s13, s14, 2
  v_xor_b32 v25, s13, v31
  v_lshl_add_u32 v25, v25, 4, v29
  v_lshl_add_u32 v25, v24, 3, v25
  ds_write_b64 v25, v[80:81] offset:8192
  v_cvt_pk_bf16_f32 v76, v76, v76
  v_and_b32 v76, 0xffff0000, v76
  v_lshlrev_b32 v84, 16, v110
  v_add_f32 v76, v76, v84
  v_cvt_pk_bf16_f32 v77, v77, v77
  v_and_b32 v77, 0xffff0000, v77
  v_and_b32 v84, 0xffff0000, v110
  v_add_f32 v77, v77, v84
  v_cvt_pk_bf16_f32 v78, v78, v78
  v_and_b32 v78, 0xffff0000, v78
  v_lshlrev_b32 v84, 16, v111
  v_add_f32 v78, v78, v84
  v_cvt_pk_bf16_f32 v79, v79, v79
  v_and_b32 v79, 0xffff0000, v79
  v_and_b32 v84, 0xffff0000, v111
  v_add_f32 v79, v79, v84
  v_cvt_pk_bf16_f32 v80, v76, v77
  v_cvt_pk_bf16_f32 v81, v78, v79
  s_add_u32 s13, s14, 3
  v_xor_b32 v25, s13, v31
  v_lshl_add_u32 v25, v25, 4, v29
  v_lshl_add_u32 v25, v24, 3, v25
  ds_write_b64 v25, v[80:81] offset:8192
  v_mov_b64 v[64:65], v[176:177]
  v_mov_b64 v[66:67], v[178:179]
  v_mov_b64 v[68:69], v[180:181]
  v_mov_b64 v[70:71], v[182:183]
  v_mov_b64 v[72:73], v[184:185]
  v_mov_b64 v[74:75], v[186:187]
  v_mov_b64 v[76:77], v[188:189]
  v_mov_b64 v[78:79], v[190:191]
  v_cvt_pk_bf16_f32 v64, v64, v64
  v_and_b32 v64, 0xffff0000, v64
  v_lshlrev_b32 v84, 16, v112
  v_add_f32 v64, v64, v84
  v_cvt_pk_bf16_f32 v65, v65, v65
  v_and_b32 v65, 0xffff0000, v65
  v_and_b32 v84, 0xffff0000, v112
  v_add_f32 v65, v65, v84
  v_cvt_pk_bf16_f32 v66, v66, v66
  v_and_b32 v66, 0xffff0000, v66
  v_lshlrev_b32 v84, 16, v113
  v_add_f32 v66, v66, v84
  v_cvt_pk_bf16_f32 v67, v67, v67
  v_and_b32 v67, 0xffff0000, v67
  v_and_b32 v84, 0xffff0000, v113
  v_add_f32 v67, v67, v84
  v_cvt_pk_bf16_f32 v80, v64, v65
  v_cvt_pk_bf16_f32 v81, v66, v67
  s_add_u32 s13, s14, 4
  v_xor_b32 v25, s13, v31
  v_lshl_add_u32 v25, v25, 4, v29
  v_lshl_add_u32 v25, v24, 3, v25
  ds_write_b64 v25, v[80:81] offset:8192
  v_cvt_pk_bf16_f32 v68, v68, v68
  v_and_b32 v68, 0xffff0000, v68
  v_lshlrev_b32 v84, 16, v114
  v_add_f32 v68, v68, v84
  v_cvt_pk_bf16_f32 v69, v69, v69
  v_and_b32 v69, 0xffff0000, v69
  v_and_b32 v84, 0xffff0000, v114
  v_add_f32 v69, v69, v84
  v_cvt_pk_bf16_f32 v70, v70, v70
  v_and_b32 v70, 0xffff0000, v70
  v_lshlrev_b32 v84, 16, v115
  v_add_f32 v70, v70, v84
  v_cvt_pk_bf16_f32 v71, v71, v71
  v_and_b32 v71, 0xffff0000, v71
  v_and_b32 v84, 0xffff0000, v115
  v_add_f32 v71, v71, v84
  v_cvt_pk_bf16_f32 v80, v68, v69
  v_cvt_pk_bf16_f32 v81, v70, v71
  s_add_u32 s13, s14, 5
  v_xor_b32 v25, s13, v31
  v_lshl_add_u32 v25, v25, 4, v29
  v_lshl_add_u32 v25, v24, 3, v25
  ds_write_b64 v25, v[80:81] offset:8192
  v_cvt_pk_bf16_f32 v72, v72, v72
  v_and_b32 v72, 0xffff0000, v72
  v_lshlrev_b32 v84, 16, v116
  v_add_f32 v72, v72, v84
  v_cvt_pk_bf16_f32 v73, v73, v73
  v_and_b32 v73, 0xffff0000, v73
  v_and_b32 v84, 0xffff0000, v116
  v_add_f32 v73, v73, v84
  v_cvt_pk_bf16_f32 v74, v74, v74
  v_and_b32 v74, 0xffff0000, v74
  v_lshlrev_b32 v84, 16, v117
  v_add_f32 v74, v74, v84
  v_cvt_pk_bf16_f32 v75, v75, v75
  v_and_b32 v75, 0xffff0000, v75
  v_and_b32 v84, 0xffff0000, v117
  v_add_f32 v75, v75, v84
  v_cvt_pk_bf16_f32 v80, v72, v73
  v_cvt_pk_bf16_f32 v81, v74, v75
  s_add_u32 s13, s14, 6
  v_xor_b32 v25, s13, v31
  v_lshl_add_u32 v25, v25, 4, v29
  v_lshl_add_u32 v25, v24, 3, v25
  ds_write_b64 v25, v[80:81] offset:8192
  v_cvt_pk_bf16_f32 v76, v76, v76
  v_and_b32 v76, 0xffff0000, v76
  v_lshlrev_b32 v84, 16, v118
  v_add_f32 v76, v76, v84
  v_cvt_pk_bf16_f32 v77, v77, v77
  v_and_b32 v77, 0xffff0000, v77
  v_and_b32 v84, 0xffff0000, v118
  v_add_f32 v77, v77, v84
  v_cvt_pk_bf16_f32 v78, v78, v78
  v_and_b32 v78, 0xffff0000, v78
  v_lshlrev_b32 v84, 16, v119
  v_add_f32 v78, v78, v84
  v_cvt_pk_bf16_f32 v79, v79, v79
  v_and_b32 v79, 0xffff0000, v79
  v_and_b32 v84, 0xffff0000, v119
  v_add_f32 v79, v79, v84
  v_cvt_pk_bf16_f32 v80, v76, v77
  v_cvt_pk_bf16_f32 v81, v78, v79
  s_add_u32 s13, s14, 7
  v_xor_b32 v25, s13, v31
  v_lshl_add_u32 v25, v25, 4, v29
  v_lshl_add_u32 v25, v24, 3, v25
  ds_write_b64 v25, v[80:81] offset:8192
  s_waitcnt lgkmcnt(0)
  s_barrier
  s_lshl_b32 s13, s91, 17
  s_add_u32 s13, s13, 79691776
  s_lshl_b32 s14, s92, 8
  s_add_u32 s13, s13, s14
  s_add_u32 s30, s4, s13
  s_addc_u32 s31, s5, 0
  v_lshlrev_b32 v25, 4, v22
  s_lshl_b32 s13, s10, 13
  s_add_u32 s13, s13, 98304
  v_add_u32 v25, s13, v25
  ds_read_b128 v[64:67], v25 offset:0
  ds_read_b128 v[68:71], v25 offset:1024
  ds_read_b128 v[72:75], v25 offset:2048
  ds_read_b128 v[76:79], v25 offset:3072
  ds_read_b128 v[80:83], v25 offset:4096
  ds_read_b128 v[84:87], v25 offset:5120
  ds_read_b128 v[88:91], v25 offset:6144
  ds_read_b128 v[92:95], v25 offset:7168
  v_lshrrev_b32 v27, 4, v22
  s_lshl_b32 s13, s10, 5
  v_add_u32 v27, s13, v27
  v_add_u32 v28, 0, v27
  v_xor_b32 v26, v28, v22
  v_and_b32 v26, 15, v26
  v_mul_u32_u24 v28, 1024, v28
  v_lshl_add_u32 v96, v26, 4, v28
  v_add_u32 v28, 4, v27
  v_xor_b32 v26, v28, v22
  v_and_b32 v26, 15, v26
  v_mul_u32_u24 v28, 1024, v28
  v_lshl_add_u32 v97, v26, 4, v28
  v_add_u32 v28, 8, v27
  v_xor_b32 v26, v28, v22
  v_and_b32 v26, 15, v26
  v_mul_u32_u24 v28, 1024, v28
  v_lshl_add_u32 v98, v26, 4, v28
  v_add_u32 v28, 12, v27
  v_xor_b32 v26, v28, v22
  v_and_b32 v26, 15, v26
  v_mul_u32_u24 v28, 1024, v28
  v_lshl_add_u32 v99, v26, 4, v28
  v_add_u32 v28, 16, v27
  v_xor_b32 v26, v28, v22
  v_and_b32 v26, 15, v26
  v_mul_u32_u24 v28, 1024, v28
  v_lshl_add_u32 v100, v26, 4, v28
  v_add_u32 v28, 20, v27
  v_xor_b32 v26, v28, v22
  v_and_b32 v26, 15, v26
  v_mul_u32_u24 v28, 1024, v28
  v_lshl_add_u32 v101, v26, 4, v28
  v_add_u32 v28, 24, v27
  v_xor_b32 v26, v28, v22
  v_and_b32 v26, 15, v26
  v_mul_u32_u24 v28, 1024, v28
  v_lshl_add_u32 v102, v26, 4, v28
  v_add_u32 v28, 28, v27
  v_xor_b32 v26, v28, v22
  v_and_b32 v26, 15, v26
  v_mul_u32_u24 v28, 1024, v28
  v_lshl_add_u32 v103, v26, 4, v28
  s_waitcnt lgkmcnt(7)
  global_store_dwordx4 v96, v[64:67], s[30:31] sc1
  s_waitcnt lgkmcnt(6)
  global_store_dwordx4 v97, v[68:71], s[30:31] sc1
  s_waitcnt lgkmcnt(5)
  global_store_dwordx4 v98, v[72:75], s[30:31] sc1
  s_waitcnt lgkmcnt(4)
  global_store_dwordx4 v99, v[76:79], s[30:31] sc1
  s_waitcnt lgkmcnt(3)
  global_store_dwordx4 v100, v[80:83], s[30:31] sc1
  s_waitcnt lgkmcnt(2)
  global_store_dwordx4 v101, v[84:87], s[30:31] sc1
  s_waitcnt lgkmcnt(1)
  global_store_dwordx4 v102, v[88:91], s[30:31] sc1
  s_waitcnt lgkmcnt(0)
  global_store_dwordx4 v103, v[92:95], s[30:31] sc1
  s_lshl_b32 s94, s91, 7
  s_add_u32 s94, s94, 94404608
  s_lshl_b32 s14, s92, 4
  s_add_u32 s94, s94, s14
Le_done_232:
  s_mov_b32 s93, 1
  s_waitcnt vmcnt(0)
  s_barrier
  s_cmp_eq_u32 s93, 0
  s_cbranch_scc1 Lsp_233
  s_mov_b32 s93, 0
  s_cmp_lg_u32 s10, 0
  s_cbranch_scc1 Lsp_233
  s_add_u32 s15, s98, 1
  v_mov_b32 v26, s15
  v_mov_b32 v27, s99
  v_mov_b32 v28, s94
  s_mov_b64 exec, 1
  global_store_dwordx2 v28, v[26:27], s[4:5] sc1
  s_mov_b64 exec, -1
  s_mov_b64 exec, 1
  s_mov_b64 exec, -1
Lsp_233:
Lw1_done_114:
  s_load_dwordx2 s[38:39], s[0:1], 40
  s_load_dwordx2 s[40:41], s[0:1], 0
  s_load_dwordx2 s[42:43], s[0:1], 96
  v_and_b32 v1, 63, v0
  v_and_b32 v2, 15, v0
  v_lshrrev_b32 v3, 4, v1
  v_lshrrev_b32 v4, 2, v2
  v_lshlrev_b32 v4, 1, v4
  v_and_b32 v20, 1, v2
  v_add_u32 v4, v4, v20
  s_waitcnt lgkmcnt(0)
  s_lshl_b32 s13, s8, 2
  v_mov_b32 v20, s13
  global_load_dword v21, v20, s[6:7] sc1
  s_waitcnt vmcnt(0)
  v_readfirstlane_b32 s13, v21
  s_nop 3
  s_cmp_ge_u32 s13, 32
  s_cselect_b32 s11, 1, 0
  v_lshrrev_b32 v22, 2, v2
  v_lshl_add_u32 v22, v3, 2, v22
  v_lshlrev_b32 v22, 5, v22
  v_and_b32 v21, 3, v2
  v_lshl_add_u32 v22, v21, 3, v22
  s_lshl_b32 s13, s10, 15
  v_add_u32 v14, s13, v22
  v_lshrrev_b32 v20, 1, v1
  v_lshlrev_b32 v20, 10, v20
  v_and_b32 v21, 1, v1
  v_lshl_add_u32 v20, v21, 4, v20
  s_lshr_b32 s13, s9, 1
  s_lshl_b32 s13, s13, 6
  s_add_u32 s13, s13, 32
  s_lshl_b32 s14, s10, 20
  s_add_u32 s13, s13, s14
  s_add_u32 s14, s38, s13
  s_addc_u32 s15, s39, 0
  s_lshl_b32 s13, s10, 15
  s_mov_b32 m0, s13
  s_add_u32 s13, s13, 1024
  global_load_lds_dwordx4 v20, s[14:15]
  s_add_u32 s14, s14, 32768
  s_addc_u32 s15, s15, 0
  s_mov_b32 m0, s13
  s_add_u32 s13, s13, 1024
  global_load_lds_dwordx4 v20, s[14:15]
  s_add_u32 s14, s14, 32768
  s_addc_u32 s15, s15, 0
  s_mov_b32 m0, s13
  s_add_u32 s13, s13, 1024
  global_load_lds_dwordx4 v20, s[14:15]
  s_add_u32 s14, s14, 32768
  s_addc_u32 s15, s15, 0
  s_mov_b32 m0, s13
  s_add_u32 s13, s13, 1024
  global_load_lds_dwordx4 v20, s[14:15]
  s_add_u32 s14, s14, 32768
  s_addc_u32 s15, s15, 0
  s_mov_b32 m0, s13
  s_add_u32 s13, s13, 1024
  global_load_lds_dwordx4 v20, s[14:15]
  s_add_u32 s14, s14, 32768
  s_addc_u32 s15, s15, 0
  s_mov_b32 m0, s13
  s_add_u32 s13, s13, 1024
  global_load_lds_dwordx4 v20, s[14:15]
  s_add_u32 s14, s14, 32768
  s_addc_u32 s15, s15, 0
  s_mov_b32 m0, s13
  s_add_u32 s13, s13, 1024
  global_load_lds_dwordx4 v20, s[14:15]
  s_add_u32 s14, s14, 32768
  s_addc_u32 s15, s15, 0
  s_mov_b32 m0, s13
  s_add_u32 s13, s13, 1024
  global_load_lds_dwordx4 v20, s[14:15]
  s_add_u32 s14, s14, 32768
  s_addc_u32 s15, s15, 0
  s_mov_b32 m0, s13
  s_add_u32 s13, s13, 1024
  global_load_lds_dwordx4 v20, s[14:15]
  s_add_u32 s14, s14, 32768
  s_addc_u32 s15, s15, 0
  s_mov_b32 m0, s13
  s_add_u32 s13, s13, 1024
  global_load_lds_dwordx4 v20, s[14:15]
  s_add_u32 s14, s14, 32768
  s_addc_u32 s15, s15, 0
  s_mov_b32 m0, s13
  s_add_u32 s13, s13, 1024
  global_load_lds_dwordx4 v20, s[14:15]
  s_add_u32 s14, s14, 32768
  s_addc_u32 s15, s15, 0
  s_mov_b32 m0, s13
  s_add_u32 s13, s13, 1024
  global_load_lds_dwordx4 v20, s[14:15]
  s_add_u32 s14, s14, 32768
  s_addc_u32 s15, s15, 0
  s_mov_b32 m0, s13
  s_add_u32 s13, s13, 1024
  global_load_lds_dwordx4 v20, s[14:15]
  s_add_u32 s14, s14, 32768
  s_addc_u32 s15, s15, 0
  s_mov_b32 m0, s13
  s_add_u32 s13, s13, 1024
  global_load_lds_dwordx4 v20, s[14:15]
  s_add_u32 s14, s14, 32768
  s_addc_u32 s15, s15, 0
  s_mov_b32 m0, s13
  s_add_u32 s13, s13, 1024
  global_load_lds_dwordx4 v20, s[14:15]
  s_add_u32 s14, s14, 32768
  s_addc_u32 s15, s15, 0
  s_mov_b32 m0, s13
  s_add_u32 s13, s13, 1024
  global_load_lds_dwordx4 v20, s[14:15]
  s_add_u32 s14, s14, 32768
  s_addc_u32 s15, s15, 0
  s_mov_b32 m0, s13
  s_add_u32 s13, s13, 1024
  global_load_lds_dwordx4 v20, s[14:15]
  s_add_u32 s14, s14, 32768
  s_addc_u32 s15, s15, 0
  s_mov_b32 m0, s13
  s_add_u32 s13, s13, 1024
  global_load_lds_dwordx4 v20, s[14:15]
  s_add_u32 s14, s14, 32768
  s_addc_u32 s15, s15, 0
  s_mov_b32 m0, s13
  s_add_u32 s13, s13, 1024
  global_load_lds_dwordx4 v20, s[14:15]
  s_add_u32 s14, s14, 32768
  s_addc_u32 s15, s15, 0
  s_mov_b32 m0, s13
  s_add_u32 s13, s13, 1024
  global_load_lds_dwordx4 v20, s[14:15]
  s_add_u32 s14, s14, 32768
  s_addc_u32 s15, s15, 0
  s_mov_b32 m0, s13
  s_add_u32 s13, s13, 1024
  global_load_lds_dwordx4 v20, s[14:15]
  s_add_u32 s14, s14, 32768
  s_addc_u32 s15, s15, 0
  s_mov_b32 m0, s13
  s_add_u32 s13, s13, 1024
  global_load_lds_dwordx4 v20, s[14:15]
  s_add_u32 s14, s14, 32768
  s_addc_u32 s15, s15, 0
  s_mov_b32 m0, s13
  s_add_u32 s13, s13, 1024
  global_load_lds_dwordx4 v20, s[14:15]
  s_add_u32 s14, s14, 32768
  s_addc_u32 s15, s15, 0
  s_mov_b32 m0, s13
  s_add_u32 s13, s13, 1024
  global_load_lds_dwordx4 v20, s[14:15]
  s_add_u32 s14, s14, 32768
  s_addc_u32 s15, s15, 0
  s_mov_b32 m0, s13
  s_add_u32 s13, s13, 1024
  global_load_lds_dwordx4 v20, s[14:15]
  s_add_u32 s14, s14, 32768
  s_addc_u32 s15, s15, 0
  s_mov_b32 m0, s13
  s_add_u32 s13, s13, 1024
  global_load_lds_dwordx4 v20, s[14:15]
  s_add_u32 s14, s14, 32768
  s_addc_u32 s15, s15, 0
  s_mov_b32 m0, s13
  s_add_u32 s13, s13, 1024
  global_load_lds_dwordx4 v20, s[14:15]
  s_add_u32 s14, s14, 32768
  s_addc_u32 s15, s15, 0
  s_mov_b32 m0, s13
  s_add_u32 s13, s13, 1024
  global_load_lds_dwordx4 v20, s[14:15]
  s_add_u32 s14, s14, 32768
  s_addc_u32 s15, s15, 0
  s_mov_b32 m0, s13
  s_add_u32 s13, s13, 1024
  global_load_lds_dwordx4 v20, s[14:15]
  s_add_u32 s14, s14, 32768
  s_addc_u32 s15, s15, 0
  s_mov_b32 m0, s13
  s_add_u32 s13, s13, 1024
  global_load_lds_dwordx4 v20, s[14:15]
  s_add_u32 s14, s14, 32768
  s_addc_u32 s15, s15, 0
  s_mov_b32 m0, s13
  s_add_u32 s13, s13, 1024
  global_load_lds_dwordx4 v20, s[14:15]
  s_add_u32 s14, s14, 32768
  s_addc_u32 s15, s15, 0
  s_mov_b32 m0, s13
  s_add_u32 s13, s13, 1024
  global_load_lds_dwordx4 v20, s[14:15]
  s_add_u32 s14, s14, 32768
  s_addc_u32 s15, s15, 0
  s_waitcnt vmcnt(0)
  ds_read_b64_tr_b16 a[128:129], v14 offset:0
  ds_read_b64_tr_b16 a[130:131], v14 offset:512
  ds_read_b64_tr_b16 a[132:133], v14 offset:1024
  ds_read_b64_tr_b16 a[134:135], v14 offset:1536
  ds_read_b64_tr_b16 a[136:137], v14 offset:2048
  ds_read_b64_tr_b16 a[138:139], v14 offset:2560
  ds_read_b64_tr_b16 a[140:141], v14 offset:3072
  ds_read_b64_tr_b16 a[142:143], v14 offset:3584
  s_waitcnt lgkmcnt(0)
  ds_read_b64_tr_b16 a[144:145], v14 offset:4096
  ds_read_b64_tr_b16 a[146:147], v14 offset:4608
  ds_read_b64_tr_b16 a[148:149], v14 offset:5120
  ds_read_b64_tr_b16 a[150:151], v14 offset:5632
  ds_read_b64_tr_b16 a[152:153], v14 offset:6144
  ds_read_b64_tr_b16 a[154:155], v14 offset:6656
  ds_read_b64_tr_b16 a[156:157], v14 offset:7168
  ds_read_b64_tr_b16 a[158:159], v14 offset:7680
  s_waitcnt lgkmcnt(0)
  ds_read_b64_tr_b16 a[160:161], v14 offset:8192
  ds_read_b64_tr_b16 a[162:163], v14 offset:8704
  ds_read_b64_tr_b16 a[164:165], v14 offset:9216
  ds_read_b64_tr_b16 a[166:167], v14 offset:9728
  ds_read_b64_tr_b16 a[168:169], v14 offset:10240
  ds_read_b64_tr_b16 a[170:171], v14 offset:10752
  ds_read_b64_tr_b16 a[172:173], v14 offset:11264
  ds_read_b64_tr_b16 a[174:175], v14 offset:11776
  s_waitcnt lgkmcnt(0)
  ds_read_b64_tr_b16 a[176:177], v14 offset:12288
  ds_read_b64_tr_b16 a[178:179], v14 offset:12800
  ds_read_b64_tr_b16 a[180:181], v14 offset:13312
  ds_read_b64_tr_b16 a[182:183], v14 offset:13824
  ds_read_b64_tr_b16 a[184:185], v14 offset:14336
  ds_read_b64_tr_b16 a[186:187], v14 offset:14848
  ds_read_b64_tr_b16 a[188:189], v14 offset:15360
  ds_read_b64_tr_b16 a[190:191], v14 offset:15872
  s_waitcnt lgkmcnt(0)
  ds_read_b64_tr_b16 a[192:193], v14 offset:16384
  ds_read_b64_tr_b16 a[194:195], v14 offset:16896
  ds_read_b64_tr_b16 a[196:197], v14 offset:17408
  ds_read_b64_tr_b16 a[198:199], v14 offset:17920
  ds_read_b64_tr_b16 a[200:201], v14 offset:18432
  ds_read_b64_tr_b16 a[202:203], v14 offset:18944
  ds_read_b64_tr_b16 a[204:205], v14 offset:19456
  ds_read_b64_tr_b16 a[206:207], v14 offset:19968
  s_waitcnt lgkmcnt(0)
  ds_read_b64_tr_b16 a[208:209], v14 offset:20480
  ds_read_b64_tr_b16 a[210:211], v14 offset:20992
  ds_read_b64_tr_b16 a[212:213], v14 offset:21504
  ds_read_b64_tr_b16 a[214:215], v14 offset:22016
  ds_read_b64_tr_b16 a[216:217], v14 offset:22528
  ds_read_b64_tr_b16 a[218:219], v14 offset:23040
  ds_read_b64_tr_b16 a[220:221], v14 offset:23552
  ds_read_b64_tr_b16 a[222:223], v14 offset:24064
  s_waitcnt lgkmcnt(0)
  ds_read_b64_tr_b16 a[224:225], v14 offset:24576
  ds_read_b64_tr_b16 a[226:227], v14 offset:25088
  ds_read_b64_tr_b16 a[228:229], v14 offset:25600
  ds_read_b64_tr_b16 a[230:231], v14 offset:26112
  ds_read_b64_tr_b16 a[232:233], v14 offset:26624
  ds_read_b64_tr_b16 a[234:235], v14 offset:27136
  ds_read_b64_tr_b16 a[236:237], v14 offset:27648
  ds_read_b64_tr_b16 a[238:239], v14 offset:28160
  s_waitcnt lgkmcnt(0)
  ds_read_b64_tr_b16 a[240:241], v14 offset:28672
  ds_read_b64_tr_b16 a[242:243], v14 offset:29184
  ds_read_b64_tr_b16 a[244:245], v14 offset:29696
  ds_read_b64_tr_b16 a[246:247], v14 offset:30208
  ds_read_b64_tr_b16 a[248:249], v14 offset:30720
  ds_read_b64_tr_b16 a[250:251], v14 offset:31232
  ds_read_b64_tr_b16 a[252:253], v14 offset:31744
  ds_read_b64_tr_b16 a[254:255], v14 offset:32256
  s_waitcnt lgkmcnt(0)
  s_lshr_b32 s13, s9, 1
  s_lshl_b32 s13, s13, 6
  s_add_u32 s13, s13, 0
  s_lshl_b32 s14, s10, 20
  s_add_u32 s13, s13, s14
  s_add_u32 s14, s38, s13
  s_addc_u32 s15, s39, 0
  s_lshl_b32 s13, s10, 15
  s_mov_b32 m0, s13
  s_add_u32 s13, s13, 1024
  global_load_lds_dwordx4 v20, s[14:15]
  s_add_u32 s14, s14, 32768
  s_addc_u32 s15, s15, 0
  s_mov_b32 m0, s13
  s_add_u32 s13, s13, 1024
  global_load_lds_dwordx4 v20, s[14:15]
  s_add_u32 s14, s14, 32768
  s_addc_u32 s15, s15, 0
  s_mov_b32 m0, s13
  s_add_u32 s13, s13, 1024
  global_load_lds_dwordx4 v20, s[14:15]
  s_add_u32 s14, s14, 32768
  s_addc_u32 s15, s15, 0
  s_mov_b32 m0, s13
  s_add_u32 s13, s13, 1024
  global_load_lds_dwordx4 v20, s[14:15]
  s_add_u32 s14, s14, 32768
  s_addc_u32 s15, s15, 0
  s_mov_b32 m0, s13
  s_add_u32 s13, s13, 1024
  global_load_lds_dwordx4 v20, s[14:15]
  s_add_u32 s14, s14, 32768
  s_addc_u32 s15, s15, 0
  s_mov_b32 m0, s13
  s_add_u32 s13, s13, 1024
  global_load_lds_dwordx4 v20, s[14:15]
  s_add_u32 s14, s14, 32768
  s_addc_u32 s15, s15, 0
  s_mov_b32 m0, s13
  s_add_u32 s13, s13, 1024
  global_load_lds_dwordx4 v20, s[14:15]
  s_add_u32 s14, s14, 32768
  s_addc_u32 s15, s15, 0
  s_mov_b32 m0, s13
  s_add_u32 s13, s13, 1024
  global_load_lds_dwordx4 v20, s[14:15]
  s_add_u32 s14, s14, 32768
  s_addc_u32 s15, s15, 0
  s_mov_b32 m0, s13
  s_add_u32 s13, s13, 1024
  global_load_lds_dwordx4 v20, s[14:15]
  s_add_u32 s14, s14, 32768
  s_addc_u32 s15, s15, 0
  s_mov_b32 m0, s13
  s_add_u32 s13, s13, 1024
  global_load_lds_dwordx4 v20, s[14:15]
  s_add_u32 s14, s14, 32768
  s_addc_u32 s15, s15, 0
  s_mov_b32 m0, s13
  s_add_u32 s13, s13, 1024
  global_load_lds_dwordx4 v20, s[14:15]
  s_add_u32 s14, s14, 32768
  s_addc_u32 s15, s15, 0
  s_mov_b32 m0, s13
  s_add_u32 s13, s13, 1024
  global_load_lds_dwordx4 v20, s[14:15]
  s_add_u32 s14, s14, 32768
  s_addc_u32 s15, s15, 0
  s_mov_b32 m0, s13
  s_add_u32 s13, s13, 1024
  global_load_lds_dwordx4 v20, s[14:15]
  s_add_u32 s14, s14, 32768
  s_addc_u32 s15, s15, 0
  s_mov_b32 m0, s13
  s_add_u32 s13, s13, 1024
  global_load_lds_dwordx4 v20, s[14:15]
  s_add_u32 s14, s14, 32768
  s_addc_u32 s15, s15, 0
  s_mov_b32 m0, s13
  s_add_u32 s13, s13, 1024
  global_load_lds_dwordx4 v20, s[14:15]
  s_add_u32 s14, s14, 32768
  s_addc_u32 s15, s15, 0
  s_mov_b32 m0, s13
  s_add_u32 s13, s13, 1024
  global_load_lds_dwordx4 v20, s[14:15]
  s_add_u32 s14, s14, 32768
  s_addc_u32 s15, s15, 0
  s_mov_b32 m0, s13
  s_add_u32 s13, s13, 1024
  global_load_lds_dwordx4 v20, s[14:15]
  s_add_u32 s14, s14, 32768
  s_addc_u32 s15, s15, 0
  s_mov_b32 m0, s13
  s_add_u32 s13, s13, 1024
  global_load_lds_dwordx4 v20, s[14:15]
  s_add_u32 s14, s14, 32768
  s_addc_u32 s15, s15, 0
  s_mov_b32 m0, s13
  s_add_u32 s13, s13, 1024
  global_load_lds_dwordx4 v20, s[14:15]
  s_add_u32 s14, s14, 32768
  s_addc_u32 s15, s15, 0
  s_mov_b32 m0, s13
  s_add_u32 s13, s13, 1024
  global_load_lds_dwordx4 v20, s[14:15]
  s_add_u32 s14, s14, 32768
  s_addc_u32 s15, s15, 0
  s_mov_b32 m0, s13
  s_add_u32 s13, s13, 1024
  global_load_lds_dwordx4 v20, s[14:15]
  s_add_u32 s14, s14, 32768
  s_addc_u32 s15, s15, 0
  s_mov_b32 m0, s13
  s_add_u32 s13, s13, 1024
  global_load_lds_dwordx4 v20, s[14:15]
  s_add_u32 s14, s14, 32768
  s_addc_u32 s15, s15, 0
  s_mov_b32 m0, s13
  s_add_u32 s13, s13, 1024
  global_load_lds_dwordx4 v20, s[14:15]
  s_add_u32 s14, s14, 32768
  s_addc_u32 s15, s15, 0
  s_mov_b32 m0, s13
  s_add_u32 s13, s13, 1024
  global_load_lds_dwordx4 v20, s[14:15]
  s_add_u32 s14, s14, 32768
  s_addc_u32 s15, s15, 0
  s_mov_b32 m0, s13
  s_add_u32 s13, s13, 1024
  global_load_lds_dwordx4 v20, s[14:15]
  s_add_u32 s14, s14, 32768
  s_addc_u32 s15, s15, 0
  s_mov_b32 m0, s13
  s_add_u32 s13, s13, 1024
  global_load_lds_dwordx4 v20, s[14:15]
  s_add_u32 s14, s14, 32768
  s_addc_u32 s15, s15, 0
  s_mov_b32 m0, s13
  s_add_u32 s13, s13, 1024
  global_load_lds_dwordx4 v20, s[14:15]
  s_add_u32 s14, s14, 32768
  s_addc_u32 s15, s15, 0
  s_mov_b32 m0, s13
  s_add_u32 s13, s13, 1024
  global_load_lds_dwordx4 v20, s[14:15]
  s_add_u32 s14, s14, 32768
  s_addc_u32 s15, s15, 0
  s_mov_b32 m0, s13
  s_add_u32 s13, s13, 1024
  global_load_lds_dwordx4 v20, s[14:15]
  s_add_u32 s14, s14, 32768
  s_addc_u32 s15, s15, 0
  s_mov_b32 m0, s13
  s_add_u32 s13, s13, 1024
  global_load_lds_dwordx4 v20, s[14:15]
  s_add_u32 s14, s14, 32768
  s_addc_u32 s15, s15, 0
  s_mov_b32 m0, s13
  s_add_u32 s13, s13, 1024
  global_load_lds_dwordx4 v20, s[14:15]
  s_add_u32 s14, s14, 32768
  s_addc_u32 s15, s15, 0
  s_mov_b32 m0, s13
  s_add_u32 s13, s13, 1024
  global_load_lds_dwordx4 v20, s[14:15]
  s_add_u32 s14, s14, 32768
  s_addc_u32 s15, s15, 0
  s_and_b32 s44, s10, 1
  s_lshr_b32 s45, s10, 1
  v_lshlrev_b32 v6, 4, v1
  s_lshl_b32 s13, s44, 12
  v_add_u32 v5, s13, v6
  s_lshl_b32 s13, s45, 12
  s_lshl_b32 s14, s44, 10
  s_add_u32 s13, s13, s14
  v_add_u32 v10, s13, v6
  v_lshrrev_b32 v20, 2, v2
  v_lshlrev_b32 v20, 9, v20
  v_lshl_add_u32 v7, v3, 5, v20
  s_lshl_b32 s13, s45, 12
  v_lshlrev_b32 v20, 6, v2
  v_lshl_add_u32 v20, v3, 4, v20
  v_add_u32 v8, s13, v20
  s_lshl_b32 s13, s45, 11
  v_lshlrev_b32 v20, 6, v2
  v_lshl_add_u32 v20, v3, 4, v20
  v_add_u32 v9, s13, v20
  s_lshl_b32 s13, s44, 4
  v_add_u32 v20, s13, v2
  v_lshlrev_b32 v21, 2, v3
  v_sub_u32 v13, v20, v21
  s_lshl_b32 s13, s10, 16
  s_and_b32 s14, s9, 1
  s_lshl_b32 s14, s14, 10
  s_add_u32 s13, s13, s14
  v_add_u32 v15, s13, v6
  s_lshl_b32 s13, s10, 11
  v_lshlrev_b32 v20, 4, v1
  s_add_u32 s13, s13, 131072
  v_add_u32 v16, s13, v20
  s_lshl_b32 s13, s44, 10
  s_add_u32 s13, s13, 131072
  v_add_u32 v17, s13, v20
  s_and_b32 s13, s9, 1
  s_lshl_b32 s13, s13, 4
  v_add_u32 v20, s13, v2
  v_lshlrev_b32 v20, 10, v20
  v_lshl_add_u32 v20, v3, 3, v20
  s_lshr_b32 s13, s9, 1
  s_lshl_b32 s13, s13, 6
  s_lshl_b32 s14, s44, 5
  s_add_u32 s13, s13, s14
  v_add_u32 v18, s13, v20
  s_mov_b32 s36, 0x3e0293ee
  s_mov_b32 s37, 0x3e0293ee
  s_sub_u32 s16, s8, 1
  s_waitcnt vmcnt(0)
  s_barrier
Lw2_loop_234:
  s_cmp_ge_u32 s16, 64
  s_cbranch_scc1 Lw2_done_235
  s_cmp_ge_u32 s16, 0
  s_cselect_b32 s48, s11, 0
  s_lshr_b32 s17, s16, 2
  s_mul_i32 s13, s16, 262144
  s_mul_i32 s14, s9, 8192
  s_add_u32 s13, s13, s14
  s_add_u32 s13, s13, 4194304
  s_add_u32 s18, s4, s13
  s_addc_u32 s19, s5, 0
  s_mul_i32 s13, s16, 262144
  s_mul_i32 s14, s9, 8192
  s_add_u32 s13, s13, s14
  s_add_u32 s13, s13, 20971520
  s_add_u32 s20, s4, s13
  s_addc_u32 s21, s5, 0
  s_mul_i32 s13, s16, 65536
  s_mul_i32 s14, s9, 2048
  s_add_u32 s13, s13, s14
  s_add_u32 s13, s13, 81788928
  s_add_u32 s22, s4, s13
  s_addc_u32 s23, s5, 0
  s_mul_i32 s13, s16, 262144
  s_mul_i32 s14, s9, 8192
  s_add_u32 s13, s13, s14
  s_add_u32 s13, s13, 37748736
  s_add_u32 s24, s4, s13
  s_addc_u32 s25, s5, 0
  s_mul_i32 s13, s16, 131072
  s_mul_i32 s14, s9, 4096
  s_add_u32 s13, s13, s14
  s_add_u32 s13, s13, 85983232
  s_add_u32 s26, s4, s13
  s_addc_u32 s27, s5, 0
  s_mul_i32 s13, s16, 262144
  s_mul_i32 s14, s9, 8192
  s_add_u32 s13, s13, s14
  s_add_u32 s13, s13, 54525952
  s_add_u32 s28, s4, s13
  s_addc_u32 s29, s5, 0
  s_lshl_b32 s13, s17, 9
  s_lshl_b32 s14, s9, 4
  s_add_u32 s13, s13, s14
  s_add_u32 s14, s13, 94392320
  v_mov_b32 v11, s14
  s_add_u32 s14, s13, 94375936
  v_cmp_eq_u32 vcc, 0, v1
  v_mov_b32 v20, s14
  s_nop 0
  v_cndmask_b32 v11, v11, v20, vcc
  s_add_u32 s14, s13, 94384128
  v_cmp_eq_u32 vcc, 1, v1
  v_mov_b32 v20, s14
  s_nop 0
  v_cndmask_b32 v11, v11, v20, vcc
  s_lshl_b32 s14, s17, 7
  s_add_u32 s14, s14, 94404608
  v_and_b32 v20, 3, v1
  v_lshlrev_b32 v20, 4, v20
  v_add_u32 v20, s14, v20
  v_lshrrev_b32 v21, 2, v1
  v_cmp_eq_u32 vcc, 1, v21
  s_nop 1
  v_cndmask_b32 v11, v11, v20, vcc
Lwf_p_236:
  global_load_dwordx2 v[20:21], v11, s[4:5] sc1
  s_waitcnt vmcnt(0)
  v_subrev_u32 v20, s98, v20
  v_xor_b32 v21, s99, v21
  v_subrev_u32 v20, 1, v20
  v_lshrrev_b32 v20, 7, v20
  v_or_b32 v20, v20, v21
  v_cmp_ne_u32 vcc, 0, v20
  s_cbranch_vccz Lwf_d_237
  s_sleep 8
  s_cmp_eq_u32 s12, 0
  s_cbranch_scc1 Lwf_d_237
  s_sub_u32 s12, s12, 1
  s_branch Lwf_p_236
Lwf_d_237:
  s_lshl_b32 s13, s16, 15
  s_add_u32 s30, s40, s13
  s_addc_u32 s31, s41, 0
  s_add_u32 s34, s42, s13
  s_addc_u32 s35, s43, 0
  s_add_u32 s13, s13, 79691776
  s_add_u32 s32, s4, s13
  s_addc_u32 s33, s5, 0
  global_load_dwordx2 v[148:149], v18, s[30:31]
  global_load_dwordx2 v[150:151], v18, s[32:33] sc1
  global_load_dwordx4 v[24:27], v5, s[18:19] offset:0
  global_load_dwordx4 v[28:31], v5, s[18:19] offset:1024
  global_load_dwordx4 v[32:35], v5, s[18:19] offset:2048
  global_load_dwordx4 v[36:39], v5, s[18:19] offset:3072
  global_load_dwordx4 v[40:43], v6, s[20:21] offset:0
  global_load_dwordx4 v[44:47], v6, s[20:21] offset:1024
  global_load_dwordx4 v[48:51], v6, s[20:21] offset:2048
  global_load_dwordx4 v[52:55], v6, s[20:21] offset:3072
  s_add_u32 s14, s20, 4096
  s_addc_u32 s15, s21, 0
  global_load_dwordx4 v[56:59], v6, s[14:15] offset:0
  global_load_dwordx4 v[60:63], v6, s[14:15] offset:1024
  global_load_dwordx4 v[64:67], v6, s[14:15] offset:2048
  global_load_dwordx4 v[68:71], v6, s[14:15] offset:3072
  global_load_dwordx4 v[88:91], v8, s[24:25] offset:0 sc1
  global_load_dwordx4 v[92:95], v8, s[24:25] offset:1024 sc1
  global_load_dwordx4 v[96:99], v8, s[24:25] offset:2048 sc1
  global_load_dwordx4 v[100:103], v8, s[24:25] offset:3072 sc1
  s_lshl_b32 s13, s9, 6
  s_add_u32 s13, s13, 94406656
  v_and_b32 v11, 3, v1
  v_lshlrev_b32 v11, 4, v11
  v_add_u32 v11, s13, v11
  s_add_u32 s13, s16, 1
  v_mov_b32 v12, s13
Lwf_p_238:
  global_load_dwordx2 v[20:21], v11, s[4:5] sc1
  s_waitcnt vmcnt(0)
  v_subrev_u32 v20, s98, v20
  v_xor_b32 v21, s99, v21
  v_sub_u32 v20, v20, v12
  v_lshrrev_b32 v20, 7, v20
  v_or_b32 v20, v20, v21
  v_cmp_ne_u32 vcc, 0, v20
  s_cbranch_vccz Lwf_d_239
  s_sleep 4
  s_cmp_eq_u32 s12, 0
  s_cbranch_scc1 Lwf_d_239
  s_sub_u32 s12, s12, 1
  s_branch Lwf_p_238
Lwf_d_239:
  global_load_dwordx4 v[192:195], v7, s[22:23] offset:0
  global_load_dwordx4 v[196:199], v7, s[22:23] offset:16
  global_load_dwordx4 v[200:203], v7, s[22:23] offset:128
  global_load_dwordx4 v[204:207], v7, s[22:23] offset:144
  global_load_dwordx4 v[208:211], v7, s[22:23] offset:256
  global_load_dwordx4 v[212:215], v7, s[22:23] offset:272
  global_load_dwordx4 v[216:219], v7, s[22:23] offset:384
  global_load_dwordx4 v[220:223], v7, s[22:23] offset:400
  global_load_dwordx2 v[104:105], v9, s[26:27] offset:0 sc1
  global_load_dwordx2 v[106:107], v9, s[26:27] offset:8 sc1
  global_load_dwordx2 v[108:109], v9, s[26:27] offset:1024 sc1
  global_load_dwordx2 v[110:111], v9, s[26:27] offset:1032 sc1
  v_mfma_f32_16x16x32_bf16 v[112:115], v[40:43], v[24:27], 0
  v_mfma_f32_16x16x32_bf16 v[116:119], v[56:59], v[24:27], 0
  v_mfma_f32_16x16x32_bf16 v[112:115], v[44:47], v[28:31], v[112:115]
  v_mfma_f32_16x16x32_bf16 v[116:119], v[60:63], v[28:31], v[116:119]
  v_mfma_f32_16x16x32_bf16 v[112:115], v[48:51], v[32:35], v[112:115]
  v_mfma_f32_16x16x32_bf16 v[116:119], v[64:67], v[32:35], v[116:119]
  v_mfma_f32_16x16x32_bf16 v[112:115], v[52:55], v[36:39], v[112:115]
  v_mfma_f32_16x16x32_bf16 v[116:119], v[68:71], v[36:39], v[116:119]
  s_waitcnt vmcnt(4)
  v_and_b32 v20, 1, v2
  v_cmp_eq_u32 vcc, 1, v20
  s_nop 1
  v_cndmask_b32 v72, v192, v193, vcc
  v_cndmask_b32 v73, v194, v195, vcc
  v_cndmask_b32 v74, v196, v197, vcc
  v_cndmask_b32 v75, v198, v199, vcc
  v_cndmask_b32 v76, v200, v201, vcc
  v_cndmask_b32 v77, v202, v203, vcc
  v_cndmask_b32 v78, v204, v205, vcc
  v_cndmask_b32 v79, v206, v207, vcc
  v_cndmask_b32 v80, v208, v209, vcc
  v_cndmask_b32 v81, v210, v211, vcc
  v_cndmask_b32 v82, v212, v213, vcc
  v_cndmask_b32 v83, v214, v215, vcc
  v_cndmask_b32 v84, v216, v217, vcc
  v_cndmask_b32 v85, v218, v219, vcc
  v_cndmask_b32 v86, v220, v221, vcc
  v_cndmask_b32 v87, v222, v223, vcc
  s_nop 1
  v_mfma_f32_16x16x32_bf16 v[120:123], v[72:75], v[24:27], 0
  v_mfma_f32_16x16x32_bf16 v[120:123], v[76:79], v[28:31], v[120:123]
  v_mfma_f32_16x16x32_bf16 v[120:123], v[80:83], v[32:35], v[120:123]
  v_mfma_f32_16x16x32_bf16 v[120:123], v[84:87], v[36:39], v[120:123]
  s_nop 7
  v_mov_b32 v22, 0xff800000
  v_subrev_u32 v23, 16, v13
  v_cmp_le_i32 vcc, 0, v13
  s_nop 1
  v_cndmask_b32 v112, v22, v112, vcc
  v_cmp_le_i32 vcc, 1, v13
  s_nop 1
  v_cndmask_b32 v113, v22, v113, vcc
  v_cmp_le_i32 vcc, 2, v13
  s_nop 1
  v_cndmask_b32 v114, v22, v114, vcc
  v_cmp_le_i32 vcc, 3, v13
  s_nop 1
  v_cndmask_b32 v115, v22, v115, vcc
  v_cmp_le_i32 vcc, 0, v23
  s_nop 1
  v_cndmask_b32 v116, v22, v116, vcc
  v_cmp_le_i32 vcc, 1, v23
  s_nop 1
  v_cndmask_b32 v117, v22, v117, vcc
  v_cmp_le_i32 vcc, 2, v23
  s_nop 1
  v_cndmask_b32 v118, v22, v118, vcc
  v_cmp_le_i32 vcc, 3, v23
  s_nop 1
  v_cndmask_b32 v119, v22, v119, vcc
  v_max3_f32 v20, v112, v113, v114
  v_max3_f32 v21, v115, v116, v117
  v_max3_f32 v20, v20, v118, v119
  v_max3_f32 v21, v21, v120, v121
  v_max3_f32 v20, v20, v122, v123
  v_max_f32 v20, v20, v21
  v_mov_b32 v21, v20
  s_nop 1
  v_permlane16_swap_b32 v20, v21
  v_max_f32 v20, v20, v21
  v_mov_b32 v21, v20
  s_nop 1
  v_permlane32_swap_b32 v20, v21
  v_max_f32 v20, v20, v21
  v_mul_f32 v20, s36, v20
  v_fma_f32 v112, v112, s36, -v20
  v_fma_f32 v113, v113, s36, -v20
  v_fma_f32 v114, v114, s36, -v20
  v_fma_f32 v115, v115, s36, -v20
  v_fma_f32 v116, v116, s36, -v20
  v_fma_f32 v117, v117, s36, -v20
  v_fma_f32 v118, v118, s36, -v20
  v_fma_f32 v119, v119, s36, -v20
  v_fma_f32 v120, v120, s36, -v20
  v_fma_f32 v121, v121, s36, -v20
  v_fma_f32 v122, v122, s36, -v20
  v_fma_f32 v123, v123, s36, -v20
  v_exp_f32 v112, v112
  v_exp_f32 v113, v113
  v_exp_f32 v114, v114
  v_exp_f32 v115, v115
  v_exp_f32 v116, v116
  v_exp_f32 v117, v117
  v_exp_f32 v118, v118
  v_exp_f32 v119, v119
  v_exp_f32 v120, v120
  v_exp_f32 v121, v121
  v_exp_f32 v122, v122
  v_exp_f32 v123, v123
  s_nop 0
  v_cvt_pk_bf16_f32 v124, v112, v113
  v_cvt_pk_bf16_f32 v125, v114, v115
  v_cvt_pk_bf16_f32 v126, v116, v117
  v_cvt_pk_bf16_f32 v127, v118, v119
  v_cvt_pk_bf16_f32 v128, v120, v121
  v_cvt_pk_bf16_f32 v129, v122, v123
  s_waitcnt vmcnt(0)
  v_mfma_f32_16x16x32_bf16 v[132:135], v[88:91], v[124:127], 0
  v_mfma_f32_16x16x32_bf16 v[136:139], v[92:95], v[124:127], 0
  v_mfma_f32_16x16x32_bf16 v[140:143], v[96:99], v[124:127], 0
  v_mfma_f32_16x16x32_bf16 v[144:147], v[100:103], v[124:127], 0
  v_mfma_f32_16x16x16_bf16 v[132:135], v[104:105], v[128:129], v[132:135]
  v_mfma_f32_16x16x16_bf16 v[136:139], v[106:107], v[128:129], v[136:139]
  v_mfma_f32_16x16x16_bf16 v[140:143], v[108:109], v[128:129], v[140:143]
  v_mfma_f32_16x16x16_bf16 v[144:147], v[110:111], v[128:129], v[144:147]
  v_add_f32 v120, v120, v121
  v_add_f32 v122, v122, v123
  v_add_f32 v120, v120, v122
  v_add_f32 v112, v112, v113
  v_add_f32 v114, v114, v115
  v_add_f32 v116, v116, v117
  v_add_f32 v118, v118, v119
  v_add_f32 v112, v112, v114
  v_add_f32 v116, v116, v118
  v_add_f32 v112, v112, v116
  v_fma_f32 v20, v120, 0.5, v112
  v_mov_b32 v21, v20
  s_nop 1
  v_permlane16_swap_b32 v20, v21
  v_add_f32 v20, v20, v21
  v_mov_b32 v21, v20
  s_nop 1
  v_permlane32_swap_b32 v20, v21
  v_add_f32 v20, v20, v21
  v_rcp_f32 v20, v20
  s_nop 3
  v_mul_f32 v132, v132, v20
  v_mul_f32 v133, v133, v20
  v_mul_f32 v134, v134, v20
  v_mul_f32 v135, v135, v20
  v_mul_f32 v136, v136, v20
  v_mul_f32 v137, v137, v20
  v_mul_f32 v138, v138, v20
  v_mul_f32 v139, v139, v20
  v_mul_f32 v140, v140, v20
  v_mul_f32 v141, v141, v20
  v_mul_f32 v142, v142, v20
  v_mul_f32 v143, v143, v20
  v_mul_f32 v144, v144, v20
  v_mul_f32 v145, v145, v20
  v_mul_f32 v146, v146, v20
  v_mul_f32 v147, v147, v20
  v_cvt_pk_bf16_f32 v132, v132, v133
  v_cvt_pk_bf16_f32 v133, v134, v135
  v_cvt_pk_bf16_f32 v134, v136, v137
  v_cvt_pk_bf16_f32 v135, v138, v139
  v_cvt_pk_bf16_f32 v140, v140, v141
  v_cvt_pk_bf16_f32 v141, v142, v143
  v_cvt_pk_bf16_f32 v142, v144, v145
  v_cvt_pk_bf16_f32 v143, v146, v147
  s_cmp_eq_u32 s48, 0
  s_cbranch_scc1 Lw2_so_240
  global_store_dwordx4 v10, v[132:135], s[28:29] offset:0
  global_store_dwordx4 v10, v[140:143], s[28:29] offset:2048
  s_branch Lw2_sd_241
Lw2_so_240:
  global_store_dwordx4 v10, v[132:135], s[28:29] offset:0 sc1
  global_store_dwordx4 v10, v[140:143], s[28:29] offset:2048 sc1
Lw2_sd_241:
  s_waitcnt vmcnt(0)
  s_barrier
  s_cmp_lg_u32 s10, 0
  s_cbranch_scc1 Lw2_sig_242
  s_lshl_b32 s13, s16, 9
  s_lshl_b32 s14, s9, 4
  s_add_u32 s13, s13, s14
  s_add_u32 s13, s13, 94412800
  s_cmp_eq_u32 s48, 0
  s_cbranch_scc1 Lw2_f1_243
  s_add_u32 s15, s98, 1
  v_mov_b32 v20, s15
  v_mov_b32 v21, s99
  v_mov_b32 v22, s13
  s_mov_b64 exec, 1
  global_store_dwordx2 v22, v[20:21], s[4:5]
  s_mov_b64 exec, -1
  s_branch Lw2_f2_244
Lw2_f1_243:
  s_add_u32 s15, s98, 1
  v_mov_b32 v20, s15
  v_mov_b32 v21, s99
  v_mov_b32 v22, s13
  s_mov_b64 exec, 1
  global_store_dwordx2 v22, v[20:21], s[4:5] sc1
  s_mov_b64 exec, -1
Lw2_f2_244:
Lw2_sig_242:
  s_lshl_b32 s13, s16, 9
  s_add_u32 s13, s13, 94412800
  v_and_b32 v11, 31, v1
  v_lshlrev_b32 v11, 4, v11
  v_add_u32 v11, s13, v11
Lwf_p_245:
  global_load_dwordx2 v[20:21], v11, s[4:5] sc1
  s_waitcnt vmcnt(0)
  v_subrev_u32 v20, s98, v20
  v_xor_b32 v21, s99, v21
  v_subrev_u32 v20, 1, v20
  v_lshrrev_b32 v20, 7, v20
  v_or_b32 v20, v20, v21
  v_cmp_ne_u32 vcc, 0, v20
  s_cbranch_vccz Lwf_d_246
  s_sleep 1
  s_cmp_eq_u32 s12, 0
  s_cbranch_scc1 Lwf_d_246
  s_sub_u32 s12, s12, 1
  s_branch Lwf_p_245
Lwf_d_246:
  s_mul_i32 s13, s16, 262144
  s_add_u32 s13, s13, 54525952
  s_add_u32 s18, s4, s13
  s_addc_u32 s19, s5, 0
  global_load_dwordx4 a[0:3], v15, s[18:19] offset:0
  global_load_dwordx4 a[4:7], v15, s[18:19] offset:2048
  s_add_u32 s18, s18, 4096
  s_addc_u32 s19, s19, 0
  global_load_dwordx4 a[8:11], v15, s[18:19] offset:0
  global_load_dwordx4 a[12:15], v15, s[18:19] offset:2048
  s_add_u32 s18, s18, 4096
  s_addc_u32 s19, s19, 0
  global_load_dwordx4 a[16:19], v15, s[18:19] offset:0
  global_load_dwordx4 a[20:23], v15, s[18:19] offset:2048
  s_add_u32 s18, s18, 4096
  s_addc_u32 s19, s19, 0
  global_load_dwordx4 a[24:27], v15, s[18:19] offset:0
  global_load_dwordx4 a[28:31], v15, s[18:19] offset:2048
  s_add_u32 s18, s18, 4096
  s_addc_u32 s19, s19, 0
  global_load_dwordx4 a[32:35], v15, s[18:19] offset:0
  global_load_dwordx4 a[36:39], v15, s[18:19] offset:2048
  s_add_u32 s18, s18, 4096
  s_addc_u32 s19, s19, 0
  global_load_dwordx4 a[40:43], v15, s[18:19] offset:0
  global_load_dwordx4 a[44:47], v15, s[18:19] offset:2048
  s_add_u32 s18, s18, 4096
  s_addc_u32 s19, s19, 0
  global_load_dwordx4 a[48:51], v15, s[18:19] offset:0
  global_load_dwordx4 a[52:55], v15, s[18:19] offset:2048
  s_add_u32 s18, s18, 4096
  s_addc_u32 s19, s19, 0
  global_load_dwordx4 a[56:59], v15, s[18:19] offset:0
  global_load_dwordx4 a[60:63], v15, s[18:19] offset:2048
  s_add_u32 s18, s18, 4096
  s_addc_u32 s19, s19, 0
  global_load_dwordx4 a[64:67], v15, s[18:19] offset:0
  global_load_dwordx4 a[68:71], v15, s[18:19] offset:2048
  s_add_u32 s18, s18, 4096
  s_addc_u32 s19, s19, 0
  global_load_dwordx4 a[72:75], v15, s[18:19] offset:0
  global_load_dwordx4 a[76:79], v15, s[18:19] offset:2048
  s_add_u32 s18, s18, 4096
  s_addc_u32 s19, s19, 0
  global_load_dwordx4 a[80:83], v15, s[18:19] offset:0
  global_load_dwordx4 a[84:87], v15, s[18:19] offset:2048
  s_add_u32 s18, s18, 4096
  s_addc_u32 s19, s19, 0
  global_load_dwordx4 a[88:91], v15, s[18:19] offset:0
  global_load_dwordx4 a[92:95], v15, s[18:19] offset:2048
  s_add_u32 s18, s18, 4096
  s_addc_u32 s19, s19, 0
  global_load_dwordx4 a[96:99], v15, s[18:19] offset:0
  global_load_dwordx4 a[100:103], v15, s[18:19] offset:2048
  s_add_u32 s18, s18, 4096
  s_addc_u32 s19, s19, 0
  global_load_dwordx4 a[104:107], v15, s[18:19] offset:0
  global_load_dwordx4 a[108:111], v15, s[18:19] offset:2048
  s_add_u32 s18, s18, 4096
  s_addc_u32 s19, s19, 0
  global_load_dwordx4 a[112:115], v15, s[18:19] offset:0
  global_load_dwordx4 a[116:119], v15, s[18:19] offset:2048
  s_add_u32 s18, s18, 4096
  s_addc_u32 s19, s19, 0
  global_load_dwordx4 a[120:123], v15, s[18:19] offset:0
  global_load_dwordx4 a[124:127], v15, s[18:19] offset:2048
  v_mov_b64 v[168:169], 0
  v_mov_b64 v[170:171], 0
  v_mov_b64 v[172:173], 0
  v_mov_b64 v[174:175], 0
  ds_read_b64_tr_b16 v[152:153], v14 offset:0
  ds_read_b64_tr_b16 v[154:155], v14 offset:512
  ds_read_b64_tr_b16 v[156:157], v14 offset:1024
  ds_read_b64_tr_b16 v[158:159], v14 offset:1536
  ds_read_b64_tr_b16 v[160:161], v14 offset:2048
  ds_read_b64_tr_b16 v[162:163], v14 offset:2560
  ds_read_b64_tr_b16 v[164:165], v14 offset:3072
  ds_read_b64_tr_b16 v[166:167], v14 offset:3584
  s_waitcnt lgkmcnt(6)
  s_waitcnt vmcnt(31)
  v_mfma_f32_16x16x32_bf16 v[168:171], v[152:155], a[0:3], v[168:171]
  v_mfma_f32_16x16x32_bf16 v[172:175], a[128:131], a[0:3], v[172:175]
  ds_read_b64_tr_b16 v[152:153], v14 offset:4096
  ds_read_b64_tr_b16 v[154:155], v14 offset:4608
  s_waitcnt lgkmcnt(6)
  s_waitcnt vmcnt(30)
  v_mfma_f32_16x16x32_bf16 v[168:171], v[156:159], a[4:7], v[168:171]
  v_mfma_f32_16x16x32_bf16 v[172:175], a[132:135], a[4:7], v[172:175]
  ds_read_b64_tr_b16 v[156:157], v14 offset:5120
  ds_read_b64_tr_b16 v[158:159], v14 offset:5632
  s_waitcnt lgkmcnt(6)
  s_waitcnt vmcnt(29)
  v_mfma_f32_16x16x32_bf16 v[168:171], v[160:163], a[8:11], v[168:171]
  v_mfma_f32_16x16x32_bf16 v[172:175], a[136:139], a[8:11], v[172:175]
  ds_read_b64_tr_b16 v[160:161], v14 offset:6144
  ds_read_b64_tr_b16 v[162:163], v14 offset:6656
  s_waitcnt lgkmcnt(6)
  s_waitcnt vmcnt(28)
  v_mfma_f32_16x16x32_bf16 v[168:171], v[164:167], a[12:15], v[168:171]
  v_mfma_f32_16x16x32_bf16 v[172:175], a[140:143], a[12:15], v[172:175]
  ds_read_b64_tr_b16 v[164:165], v14 offset:7168
  ds_read_b64_tr_b16 v[166:167], v14 offset:7680
  s_waitcnt lgkmcnt(6)
  s_waitcnt vmcnt(27)
  v_mfma_f32_16x16x32_bf16 v[168:171], v[152:155], a[16:19], v[168:171]
  v_mfma_f32_16x16x32_bf16 v[172:175], a[144:147], a[16:19], v[172:175]
  ds_read_b64_tr_b16 v[152:153], v14 offset:8192
  ds_read_b64_tr_b16 v[154:155], v14 offset:8704
  s_waitcnt lgkmcnt(6)
  s_waitcnt vmcnt(26)
  v_mfma_f32_16x16x32_bf16 v[168:171], v[156:159], a[20:23], v[168:171]
  v_mfma_f32_16x16x32_bf16 v[172:175], a[148:151], a[20:23], v[172:175]
  ds_read_b64_tr_b16 v[156:157], v14 offset:9216
  ds_read_b64_tr_b16 v[158:159], v14 offset:9728
  s_waitcnt lgkmcnt(6)
  s_waitcnt vmcnt(25)
  v_mfma_f32_16x16x32_bf16 v[168:171], v[160:163], a[24:27], v[168:171]
  v_mfma_f32_16x16x32_bf16 v[172:175], a[152:155], a[24:27], v[172:175]
  ds_read_b64_tr_b16 v[160:161], v14 offset:10240
  ds_read_b64_tr_b16 v[162:163], v14 offset:10752
  s_waitcnt lgkmcnt(6)
  s_waitcnt vmcnt(24)
  v_mfma_f32_16x16x32_bf16 v[168:171], v[164:167], a[28:31], v[168:171]
  v_mfma_f32_16x16x32_bf16 v[172:175], a[156:159], a[28:31], v[172:175]
  ds_read_b64_tr_b16 v[164:165], v14 offset:11264
  ds_read_b64_tr_b16 v[166:167], v14 offset:11776
  s_waitcnt lgkmcnt(6)
  s_waitcnt vmcnt(23)
  v_mfma_f32_16x16x32_bf16 v[168:171], v[152:155], a[32:35], v[168:171]
  v_mfma_f32_16x16x32_bf16 v[172:175], a[160:163], a[32:35], v[172:175]
  ds_read_b64_tr_b16 v[152:153], v14 offset:12288
  ds_read_b64_tr_b16 v[154:155], v14 offset:12800
  s_waitcnt lgkmcnt(6)
  s_waitcnt vmcnt(22)
  v_mfma_f32_16x16x32_bf16 v[168:171], v[156:159], a[36:39], v[168:171]
  v_mfma_f32_16x16x32_bf16 v[172:175], a[164:167], a[36:39], v[172:175]
  ds_read_b64_tr_b16 v[156:157], v14 offset:13312
  ds_read_b64_tr_b16 v[158:159], v14 offset:13824
  s_waitcnt lgkmcnt(6)
  s_waitcnt vmcnt(21)
  v_mfma_f32_16x16x32_bf16 v[168:171], v[160:163], a[40:43], v[168:171]
  v_mfma_f32_16x16x32_bf16 v[172:175], a[168:171], a[40:43], v[172:175]
  ds_read_b64_tr_b16 v[160:161], v14 offset:14336
  ds_read_b64_tr_b16 v[162:163], v14 offset:14848
  s_waitcnt lgkmcnt(6)
  s_waitcnt vmcnt(20)
  v_mfma_f32_16x16x32_bf16 v[168:171], v[164:167], a[44:47], v[168:171]
  v_mfma_f32_16x16x32_bf16 v[172:175], a[172:175], a[44:47], v[172:175]
  ds_read_b64_tr_b16 v[164:165], v14 offset:15360
  ds_read_b64_tr_b16 v[166:167], v14 offset:15872
  s_waitcnt lgkmcnt(6)
  s_waitcnt vmcnt(19)
  v_mfma_f32_16x16x32_bf16 v[168:171], v[152:155], a[48:51], v[168:171]
  v_mfma_f32_16x16x32_bf16 v[172:175], a[176:179], a[48:51], v[172:175]
  ds_read_b64_tr_b16 v[152:153], v14 offset:16384
  ds_read_b64_tr_b16 v[154:155], v14 offset:16896
  s_waitcnt lgkmcnt(6)
  s_waitcnt vmcnt(18)
  v_mfma_f32_16x16x32_bf16 v[168:171], v[156:159], a[52:55], v[168:171]
  v_mfma_f32_16x16x32_bf16 v[172:175], a[180:183], a[52:55], v[172:175]
  ds_read_b64_tr_b16 v[156:157], v14 offset:17408
  ds_read_b64_tr_b16 v[158:159], v14 offset:17920
  s_waitcnt lgkmcnt(6)
  s_waitcnt vmcnt(17)
  v_mfma_f32_16x16x32_bf16 v[168:171], v[160:163], a[56:59], v[168:171]
  v_mfma_f32_16x16x32_bf16 v[172:175], a[184:187], a[56:59], v[172:175]
  ds_read_b64_tr_b16 v[160:161], v14 offset:18432
  ds_read_b64_tr_b16 v[162:163], v14 offset:18944
  s_waitcnt lgkmcnt(6)
  s_waitcnt vmcnt(16)
  v_mfma_f32_16x16x32_bf16 v[168:171], v[164:167], a[60:63], v[168:171]
  v_mfma_f32_16x16x32_bf16 v[172:175], a[188:191], a[60:63], v[172:175]
  ds_read_b64_tr_b16 v[164:165], v14 offset:19456
  ds_read_b64_tr_b16 v[166:167], v14 offset:19968
  s_waitcnt lgkmcnt(6)
  s_waitcnt vmcnt(15)
  v_mfma_f32_16x16x32_bf16 v[168:171], v[152:155], a[64:67], v[168:171]
  v_mfma_f32_16x16x32_bf16 v[172:175], a[192:195], a[64:67], v[172:175]
  ds_read_b64_tr_b16 v[152:153], v14 offset:20480
  ds_read_b64_tr_b16 v[154:155], v14 offset:20992
  s_waitcnt lgkmcnt(6)
  s_waitcnt vmcnt(14)
  v_mfma_f32_16x16x32_bf16 v[168:171], v[156:159], a[68:71], v[168:171]
  v_mfma_f32_16x16x32_bf16 v[172:175], a[196:199], a[68:71], v[172:175]
  ds_read_b64_tr_b16 v[156:157], v14 offset:21504
  ds_read_b64_tr_b16 v[158:159], v14 offset:22016
  s_waitcnt lgkmcnt(6)
  s_waitcnt vmcnt(13)
  v_mfma_f32_16x16x32_bf16 v[168:171], v[160:163], a[72:75], v[168:171]
  v_mfma_f32_16x16x32_bf16 v[172:175], a[200:203], a[72:75], v[172:175]
  ds_read_b64_tr_b16 v[160:161], v14 offset:22528
  ds_read_b64_tr_b16 v[162:163], v14 offset:23040
  s_waitcnt lgkmcnt(6)
  s_waitcnt vmcnt(12)
  v_mfma_f32_16x16x32_bf16 v[168:171], v[164:167], a[76:79], v[168:171]
  v_mfma_f32_16x16x32_bf16 v[172:175], a[204:207], a[76:79], v[172:175]
  ds_read_b64_tr_b16 v[164:165], v14 offset:23552
  ds_read_b64_tr_b16 v[166:167], v14 offset:24064
  s_waitcnt lgkmcnt(6)
  s_waitcnt vmcnt(11)
  v_mfma_f32_16x16x32_bf16 v[168:171], v[152:155], a[80:83], v[168:171]
  v_mfma_f32_16x16x32_bf16 v[172:175], a[208:211], a[80:83], v[172:175]
  ds_read_b64_tr_b16 v[152:153], v14 offset:24576
  ds_read_b64_tr_b16 v[154:155], v14 offset:25088
  s_waitcnt lgkmcnt(6)
  s_waitcnt vmcnt(10)
  v_mfma_f32_16x16x32_bf16 v[168:171], v[156:159], a[84:87], v[168:171]
  v_mfma_f32_16x16x32_bf16 v[172:175], a[212:215], a[84:87], v[172:175]
  ds_read_b64_tr_b16 v[156:157], v14 offset:25600
  ds_read_b64_tr_b16 v[158:159], v14 offset:26112
  s_waitcnt lgkmcnt(6)
  s_waitcnt vmcnt(9)
  v_mfma_f32_16x16x32_bf16 v[168:171], v[160:163], a[88:91], v[168:171]
  v_mfma_f32_16x16x32_bf16 v[172:175], a[216:219], a[88:91], v[172:175]
  ds_read_b64_tr_b16 v[160:161], v14 offset:26624
  ds_read_b64_tr_b16 v[162:163], v14 offset:27136
  s_waitcnt lgkmcnt(6)
  s_waitcnt vmcnt(8)
  v_mfma_f32_16x16x32_bf16 v[168:171], v[164:167], a[92:95], v[168:171]
  v_mfma_f32_16x16x32_bf16 v[172:175], a[220:223], a[92:95], v[172:175]
  ds_read_b64_tr_b16 v[164:165], v14 offset:27648
  ds_read_b64_tr_b16 v[166:167], v14 offset:28160
  s_waitcnt lgkmcnt(6)
  s_waitcnt vmcnt(7)
  v_mfma_f32_16x16x32_bf16 v[168:171], v[152:155], a[96:99], v[168:171]
  v_mfma_f32_16x16x32_bf16 v[172:175], a[224:227], a[96:99], v[172:175]
  ds_read_b64_tr_b16 v[152:153], v14 offset:28672
  ds_read_b64_tr_b16 v[154:155], v14 offset:29184
  s_waitcnt lgkmcnt(6)
  s_waitcnt vmcnt(6)
  v_mfma_f32_16x16x32_bf16 v[168:171], v[156:159], a[100:103], v[168:171]
  v_mfma_f32_16x16x32_bf16 v[172:175], a[228:231], a[100:103], v[172:175]
  ds_read_b64_tr_b16 v[156:157], v14 offset:29696
  ds_read_b64_tr_b16 v[158:159], v14 offset:30208
  s_waitcnt lgkmcnt(6)
  s_waitcnt vmcnt(5)
  v_mfma_f32_16x16x32_bf16 v[168:171], v[160:163], a[104:107], v[168:171]
  v_mfma_f32_16x16x32_bf16 v[172:175], a[232:235], a[104:107], v[172:175]
  ds_read_b64_tr_b16 v[160:161], v14 offset:30720
  ds_read_b64_tr_b16 v[162:163], v14 offset:31232
  s_waitcnt lgkmcnt(6)
  s_waitcnt vmcnt(4)
  v_mfma_f32_16x16x32_bf16 v[168:171], v[164:167], a[108:111], v[168:171]
  v_mfma_f32_16x16x32_bf16 v[172:175], a[236:239], a[108:111], v[172:175]
  ds_read_b64_tr_b16 v[164:165], v14 offset:31744
  ds_read_b64_tr_b16 v[166:167], v14 offset:32256
  s_waitcnt lgkmcnt(6)
  s_waitcnt vmcnt(3)
  v_mfma_f32_16x16x32_bf16 v[168:171], v[152:155], a[112:115], v[168:171]
  v_mfma_f32_16x16x32_bf16 v[172:175], a[240:243], a[112:115], v[172:175]
  s_waitcnt lgkmcnt(4)
  s_waitcnt vmcnt(2)
  v_mfma_f32_16x16x32_bf16 v[168:171], v[156:159], a[116:119], v[168:171]
  v_mfma_f32_16x16x32_bf16 v[172:175], a[244:247], a[116:119], v[172:175]
  s_waitcnt lgkmcnt(2)
  s_waitcnt vmcnt(1)
  v_mfma_f32_16x16x32_bf16 v[168:171], v[160:163], a[120:123], v[168:171]
  v_mfma_f32_16x16x32_bf16 v[172:175], a[248:251], a[120:123], v[172:175]
  s_waitcnt lgkmcnt(0)
  s_waitcnt vmcnt(0)
  v_mfma_f32_16x16x32_bf16 v[168:171], v[164:167], a[124:127], v[168:171]
  v_mfma_f32_16x16x32_bf16 v[172:175], a[252:255], a[124:127], v[172:175]
  s_nop 7
  ds_write_b128 v16, v[168:171]
  ds_write_b128 v16, v[172:175] offset:1024
  s_waitcnt lgkmcnt(0)
  s_barrier
  s_cmp_ge_u32 s10, 2
  s_cbranch_scc1 Lw2_fin_247
  ds_read_b128 v[176:179], v17 offset:0
  ds_read_b128 v[180:183], v17 offset:2048
  ds_read_b128 v[184:187], v17 offset:4096
  ds_read_b128 v[188:191], v17 offset:6144
  s_waitcnt lgkmcnt(0)
  v_add_f32 v176, v176, v180
  v_add_f32 v184, v184, v188
  v_add_f32 v176, v176, v184
  v_add_f32 v177, v177, v181
  v_add_f32 v185, v185, v189
  v_add_f32 v177, v177, v185
  v_add_f32 v178, v178, v182
  v_add_f32 v186, v186, v190
  v_add_f32 v178, v178, v186
  v_add_f32 v179, v179, v183
  v_add_f32 v187, v187, v191
  v_add_f32 v179, v179, v187
  v_cvt_pk_bf16_f32 v176, v176, v176
  v_and_b32 v176, 0xffff0000, v176
  v_lshlrev_b32 v20, 16, v148
  v_add_f32 v176, v176, v20
  v_cvt_pk_bf16_f32 v176, v176, v176
  v_and_b32 v176, 0xffff0000, v176
  v_lshlrev_b32 v20, 16, v150
  v_add_f32 v176, v176, v20
  v_cvt_pk_bf16_f32 v177, v177, v177
  v_and_b32 v177, 0xffff0000, v177
  v_and_b32 v20, 0xffff0000, v148
  v_add_f32 v177, v177, v20
  v_cvt_pk_bf16_f32 v177, v177, v177
  v_and_b32 v177, 0xffff0000, v177
  v_and_b32 v20, 0xffff0000, v150
  v_add_f32 v177, v177, v20
  v_cvt_pk_bf16_f32 v178, v178, v178
  v_and_b32 v178, 0xffff0000, v178
  v_lshlrev_b32 v20, 16, v149
  v_add_f32 v178, v178, v20
  v_cvt_pk_bf16_f32 v178, v178, v178
  v_and_b32 v178, 0xffff0000, v178
  v_lshlrev_b32 v20, 16, v151
  v_add_f32 v178, v178, v20
  v_cvt_pk_bf16_f32 v179, v179, v179
  v_and_b32 v179, 0xffff0000, v179
  v_and_b32 v20, 0xffff0000, v149
  v_add_f32 v179, v179, v20
  v_cvt_pk_bf16_f32 v179, v179, v179
  v_and_b32 v179, 0xffff0000, v179
  v_and_b32 v20, 0xffff0000, v151
  v_add_f32 v179, v179, v20
  v_cvt_pk_bf16_f32 v176, v176, v177
  v_cvt_pk_bf16_f32 v177, v178, v179
  global_store_dwordx2 v18, v[176:177], s[34:35]
Lw2_fin_247:
  s_barrier
  s_add_u32 s16, s16, 7
  s_branch Lw2_loop_234
Lw2_done_235:
Lmain_exit_1:
  s_endpgm
Lcode_end:
.section .rodata,"a"
.p2align 6
.amdhsa_kernel parallel_sum__memory_aug_recurrent_mem_tr__mixer_channel_mlp__prompt_kernel
.amdhsa_next_free_vgpr 512
.amdhsa_next_free_sgpr 100
.amdhsa_accum_offset 256
.amdhsa_group_segment_fixed_size 0
.amdhsa_kernarg_size 120
.amdhsa_user_sgpr_count 2
.amdhsa_user_sgpr_kernarg_segment_ptr 1
.amdhsa_system_sgpr_workgroup_id_x 1
.amdhsa_float_denorm_mode_32 3
.end_amdhsa_kernel
```
